```python
import torch

def _softmax(x, axis=-1):
    return torch.softmax(x, dim=axis)
def _gelu(x):
    return torch.nn.functional.gelu(x, approximate="tanh")
def _silu(x):
    return torch.nn.functional.silu(x)
def _sigmoid(x):
    return torch.sigmoid(x)
def _layernorm(x, axis=-1, eps=1e-5):
    m = x.mean(dim=axis, keepdim=True)
    v = x.var(dim=axis, keepdim=True, unbiased=False)
    return (x - m) / torch.sqrt(v + eps)
def _scatter_add(tgt, idx, src, axis=0):
    return tgt.clone().index_add_(axis, idx, src)
def _segment_sum(src, seg, n):
    out = torch.zeros((n,) + src.shape[1:], dtype=src.dtype)
    return out.index_add_(0, seg, src)
def _pad(x, pw):
    flat = tuple(v for pair in reversed(pw) for v in pair)
    return torch.nn.functional.pad(x, flat)

kernel_name = 'recurrent_scan__mha_block_cached__swiglu_ffn__prompt'

def setup_inputs():

    _w = (lambda a: (lambda t: t.to(torch.bfloat16) if t.is_floating_point() else t)(torch.as_tensor(a)))
    def _A_setup():
        B, Sq, D = 1, 2048, 576
        H, Sk, Dh = 32, 2048, 128
        return {
            "x": _w((lambda *s: torch.randn(*s, dtype=torch.bfloat16) * 0.05)(B, Sq, D)),
            "k_cache": _w((lambda *s: torch.randn(*s, dtype=torch.bfloat16) * 0.8)(B, H, Sk, Dh)),
            "v_cache": _w((lambda *s: torch.randn(*s, dtype=torch.bfloat16) * 0.2)(B, H, Sk, Dh)),
            "wq": _w((lambda *s: torch.randn(*s, dtype=torch.bfloat16) * 0.8)(D, H * Dh) * (D ** -0.5)),
            "wo": _w((lambda *s: torch.randn(*s, dtype=torch.bfloat16) * 0.2)(H * Dh, D) * ((H * Dh) ** -0.5)),
        }
    _A_in = _A_setup()

    def _B_setup():
        B, S, D, F = 1, 2048, 576, 4608
        return {
            "x": _w((lambda *s: torch.randn(*s, dtype=torch.bfloat16) * 0.05)(B, S, D)),
            "w_gate": _w((lambda *s: torch.randn(*s, dtype=torch.bfloat16) * 0.1)(D, F)),
            "w_up": _w((lambda *s: torch.randn(*s, dtype=torch.bfloat16) * 0.1)(D, F)),
            "w_down": _w((lambda *s: torch.randn(*s, dtype=torch.bfloat16) * 0.1)(F, D)),
        }
    _B_in = _B_setup()

    return {
        "A_x": _A_in["x"],
        "A_k_cache": _A_in["k_cache"],
        "A_v_cache": _A_in["v_cache"],
        "A_wq": _A_in["wq"],
        "A_wo": _A_in["wo"],
        "B_x": _B_in["x"],
        "B_w_gate": _B_in["w_gate"],
        "B_w_up": _B_in["w_up"],
        "B_w_down": _B_in["w_down"],
    }

def reference(A_x, A_k_cache, A_v_cache, A_wq, A_wo, B_x, B_w_gate, B_w_up, B_w_down):
    def _A_ref(x, k_cache, v_cache, wq, wo):
        B, Sq, D = x.shape
        H, Dh = 32, 128
        q = (lambda x, *d: x.permute(*d))((x @ wq).reshape(B, Sq, H, Dh), 0, 2, 1, 3)
        scores = torch.einsum("bhqd,bhkd->bhqk", q, k_cache) * (Dh ** -0.5)
        p = _softmax(scores, axis=-1)
        o = torch.einsum("bhqk,bhkd->bhqd", p, v_cache)
        return (lambda x, *d: x.permute(*d))(o, 0, 2, 1, 3).reshape(B, Sq, H * Dh) @ wo

    def _B_ref(x, w_gate, w_up, w_down):
        g = _silu(x @ w_gate)
        u = x @ w_up
        return (g * u) @ w_down

    x = A_x
    xn = _layernorm(x, axis=-1)
    s = _A_ref(xn, A_k_cache, A_v_cache, A_wq, A_wo)
    g = _silu(_B_ref(xn, B_w_gate, B_w_up, B_w_down))
    return x + s * g
```

```asm
; @launch grid=(256,1,1) block=(256,1,1) lds=163840
.amdgcn_target "amdgcn-amd-amdhsa--gfx950"
.text
.globl recurrent_scan__mha_block_cached__swiglu_ffn__prompt_kernel
.p2align 8
.type recurrent_scan__mha_block_cached__swiglu_ffn__prompt_kernel,@function
recurrent_scan__mha_block_cached__swiglu_ffn__prompt_kernel:
    s_cmp_lt_u32 s2, 256
    s_cbranch_scc1 L_go
    s_endpgm
L_go:
    s_load_dwordx8 s[76:83], s[0:1], 0
    s_load_dwordx8 s[84:91], s[0:1], 32
    s_load_dwordx8 s[92:99], s[0:1], 64
    s_lshr_b32 s66, s2, 3
    s_cmp_ge_u32 s66, 10
    s_cbranch_scc1 L_ct0
    v_cmp_gt_u32 vcc, 64, v0
    s_getpc_b64 s[64:65]
L_ct0_pc:
    s_lshl_b32 s66, s66, 13
    s_add_u32 s64, s64, s66
    s_addc_u32 s65, s65, 0
    v_and_b32 v36, 63, v0
    v_lshlrev_b32 v36, 7, v36
    v_mov_b32 v37, s65
    s_cbranch_vccz L_ct0
    v_add_co_u32 v36, vcc, s64, v36
    s_nop 1
    v_addc_co_u32 v37, vcc, 0, v37, vcc
    global_load_dword v22, v[36:37], off
L_ct0:
    v_and_b32 v1, 63, v0
    v_lshrrev_b32 v3, 6, v0
    v_lshlrev_b32 v2, 4, v1
    v_readfirstlane_b32 s48, v3
    s_and_b32 s49, s2, 7
    s_lshl_b32 s49, s49, 2
    s_lshr_b32 s3, s2, 3
    s_and_b32 s3, s3, 3
    s_add_u32 s49, s49, s3
    s_lshr_b32 s50, s2, 5
    s_and_b32 s3, s3, 0
    s_lshl_b32 s51, s48, 10
    s_lshl_b32 s52, s48, 12
    s_mov_b32 s64, 0xaaaaaab
    v_add_u32 v36, 0, v1
    v_mul_hi_u32 v37, v36, s64
    v_mul_u32_u24 v38, 24, v37
    v_sub_u32 v38, v36, v38
    v_bfe_u32 v39, v37, 1, 3
    v_xor_b32 v38, v38, v39
    v_mul_u32_u24 v37, 1152, v37
    v_lshl_add_u32 v37, v38, 4, v37
    v_subrev_u32 v4, 0, v37
    v_add_u32 v36, 64, v1
    v_mul_hi_u32 v37, v36, s64
    v_mul_u32_u24 v38, 24, v37
    v_sub_u32 v38, v36, v38
    v_bfe_u32 v39, v37, 1, 3
    v_xor_b32 v38, v38, v39
    v_mul_u32_u24 v37, 1152, v37
    v_lshl_add_u32 v37, v38, 4, v37
    v_subrev_u32 v5, 1024, v37
    v_add_u32 v36, 128, v1
    v_mul_hi_u32 v37, v36, s64
    v_mul_u32_u24 v38, 24, v37
    v_sub_u32 v38, v36, v38
    v_bfe_u32 v39, v37, 1, 3
    v_xor_b32 v38, v38, v39
    v_mul_u32_u24 v37, 1152, v37
    v_lshl_add_u32 v37, v38, 4, v37
    v_subrev_u32 v6, 2048, v37
    v_add_u32 v36, 192, v1
    v_mul_hi_u32 v37, v36, s64
    v_mul_u32_u24 v38, 24, v37
    v_sub_u32 v38, v36, v38
    v_bfe_u32 v39, v37, 1, 3
    v_xor_b32 v38, v38, v39
    v_mul_u32_u24 v37, 1152, v37
    v_lshl_add_u32 v37, v38, 4, v37
    v_subrev_u32 v7, 3072, v37
    v_add_u32 v36, 256, v1
    v_mul_hi_u32 v37, v36, s64
    v_mul_u32_u24 v38, 24, v37
    v_sub_u32 v38, v36, v38
    v_bfe_u32 v39, v37, 1, 3
    v_xor_b32 v38, v38, v39
    v_mul_u32_u24 v37, 1152, v37
    v_lshl_add_u32 v37, v38, 4, v37
    v_subrev_u32 v8, 0, v37
    v_add_u32 v36, 320, v1
    v_mul_hi_u32 v37, v36, s64
    v_mul_u32_u24 v38, 24, v37
    v_sub_u32 v38, v36, v38
    v_bfe_u32 v39, v37, 1, 3
    v_xor_b32 v38, v38, v39
    v_mul_u32_u24 v37, 1152, v37
    v_lshl_add_u32 v37, v38, 4, v37
    v_subrev_u32 v9, 1024, v37
    s_lshl_b32 s64, s50, 2
    s_add_u32 s64, s64, s48
    s_mul_i32 s57, s64, 73728
    s_mul_i32 s58, s48, 24576
    s_add_u32 s58, s58, 65536
    s_mul_i32 s64, s50, 11
    s_lshr_b32 s64, s64, 5
    s_mul_i32 s64, s64, 3
    s_sub_u32 s72, s50, s64
    s_add_u32 s73, s72, 1
    s_cmp_eq_u32 s73, 3
    s_cselect_b32 s73, 0, s73
    s_add_u32 s74, s73, 1
    s_cmp_eq_u32 s74, 3
    s_cselect_b32 s74, 0, s74
    s_waitcnt lgkmcnt(0)
    s_mov_b32 s4, s76
    s_and_b32 s5, s77, 0xffff
    s_mov_b32 s6, 2359296
    s_mov_b32 s7, 0x20000
    s_lshl_b32 s64, s2, 2
    s_add_u32 s64, s64, s48
    s_mul_i32 s64, s64, 2304
    v_min_u32 v36, 17, v1
    v_lshlrev_b32 v36, 7, v36
    buffer_load_dword v23, v36, s[4:7], s64 offen
    s_add_u32 s62, s3, 0
    s_and_b32 s62, s62, 3
    s_mul_i32 s62, s62, 18432
    s_add_u32 s62, s62, s57
    s_mul_i32 s61, s72, 384
    s_add_u32 m0, s58, 0
    s_add_u32 s61, s61, s62
    buffer_load_dwordx4 v4, s[4:7], s61 offen offset:0 lds
    buffer_load_dwordx4 v5, s[4:7], s61 offen offset:1024 lds
    buffer_load_dwordx4 v6, s[4:7], s61 offen offset:2048 lds
    buffer_load_dwordx4 v7, s[4:7], s61 offen offset:3072 lds
    s_add_u32 m0, s58, 4096
    s_nop 0
    buffer_load_dwordx4 v8, s[4:7], s61 offen offset:0 lds
    buffer_load_dwordx4 v9, s[4:7], s61 offen offset:1024 lds
    s_mov_b32 s8, s82
    s_and_b32 s9, s83, 0xffff
    s_mov_b32 s10, 4718592
    s_mov_b32 s11, 0x20000
    s_cmp_lt_u32 s48, 2
    s_cselect_b32 s12, s88, s90
    s_cselect_b32 s13, s89, s91
    s_and_b32 s13, s13, 0xffff
    s_mov_b32 s14, 5308416
    s_mov_b32 s15, 0x20000
    s_lshl_b32 s64, s49, 19
    s_add_u32 s20, s78, s64
    s_addc_u32 s21, s79, 0
    s_and_b32 s21, s21, 0xffff
    s_mov_b32 s22, 524288
    s_mov_b32 s23, 0x20000
    s_add_u32 s24, s80, s64
    s_addc_u32 s25, s81, 0
    s_and_b32 s25, s25, 0xffff
    s_mov_b32 s26, 524288
    s_mov_b32 s27, 0x20000
    s_mul_i32 s18, s49, 16384
    s_add_u32 s18, s18, s52
    s_and_b32 s18, s18, 0x7ffff
    s_mov_b32 s28, s98
    s_and_b32 s29, s99, 0xffff
    s_mov_b32 s30, 268435456
    s_mov_b32 s31, 0x20000
    s_mov_b32 s32, s84
    s_and_b32 s33, s85, 0xffff
    s_mov_b32 s34, 4718592
    s_mov_b32 s35, 0x20000
    s_mov_b32 s36, s92
    s_and_b32 s37, s93, 0xffff
    s_mov_b32 s38, 5308416
    s_mov_b32 s39, 0x20000
    s_mov_b32 s40, s94
    s_and_b32 s41, s95, 0xffff
    s_mov_b32 s42, 2359296
    s_mov_b32 s43, 0x20000
    s_mov_b32 s44, s96
    s_and_b32 s45, s97, 0xffff
    s_mov_b32 s46, 256
    s_mov_b32 s47, 0x20000
    s_lshr_b32 s64, s49, 3
    s_lshl_b32 s75, s50, 2
    s_add_u32 s75, s75, s64
    s_lshl_b32 s75, s75, 7
    s_and_b32 s64, s49, 7
    s_lshl_b32 s64, s64, 2
    s_add_u32 s75, s75, s64
    s_add_u32 s75, s75, 83886112
    s_mov_b32 s0, 0
    s_mov_b32 s101, 1
    s_cmp_lg_u32 s48, 0
    s_cbranch_scc1 L_zflag
    s_mov_b64 exec, 15
    s_lshl_b32 s64, s2, 7
    s_add_u32 s64, s64, 83886080
    v_mov_b32 v36, 0
    v_mov_b32 v37, 0
    v_mov_b32 v38, 0
    v_mov_b32 v39, 0
    buffer_store_dwordx4 v[36:39], v2, s[28:31], s64 offen sc1
    s_nop 1
    s_mov_b64 exec, -1
L_zflag:
    s_lshl_b32 s64, s2, 2
    s_add_u32 s64, s64, s48
    s_lshl_b32 s64, s64, 7
    s_add_u32 s64, s64, 84934656
    v_mov_b32 v36, 0
    v_mov_b32 v37, 0
    v_mov_b32 v38, 0
    v_mov_b32 v39, 0
    s_mov_b64 exec, 1
    buffer_store_dwordx4 v[36:39], off, s[28:31], s64 sc1
    s_mov_b64 exec, -1
    s_nop 1
    v_lshrrev_b32 v36, 3, v1
    v_bfe_u32 v37, v1, 4, 1
    v_lshlrev_b32 v37, 1, v37
    v_and_b32 v38, 7, v1
    v_xor_b32 v37, v37, v38
    v_mul_u32_u24 v36, 9216, v36
    v_lshl_add_u32 v11, v37, 4, v36
    v_xor_b32 v12, 64, v11
    v_add_u32 v12, 72704, v12
    v_lshrrev_b32 v36, 1, v1
    v_and_b32 v37, 0x13, v36
    v_bfe_u32 v38, v36, 2, 1
    v_lshl_add_u32 v37, v38, 3, v37
    v_bfe_u32 v38, v36, 3, 1
    v_lshl_add_u32 v37, v38, 2, v37
    v_mul_u32_u24 v37, 9216, v37
    v_and_b32 v38, 1, v1
    v_lshl_add_u32 v10, v38, 4, v37
    s_lshl_b32 s64, s49, 8
    s_and_b32 s65, s48, 1
    s_mul_i32 s66, s65, 147456
    s_add_u32 s53, s64, s66
    s_lshl_b32 s66, s66, 1
    s_lshl_b32 s54, s49, 5
    s_add_u32 s54, s54, s66
    s_add_u32 s54, s54, 8192
    s_lshl_b32 s55, s48, 16
    s_add_u32 s55, s55, s64
    s_lshl_b32 s63, s48, 11
    s_lshl_b32 s64, s50, 2
    s_add_u32 s64, s64, s48
    s_lshl_b32 s64, s64, 14
    s_add_u32 s64, s64, 16777216
    s_lshl_b32 s65, s49, 19
    s_add_u32 s59, s64, s65
    s_lshr_b32 s65, s49, 3
    s_add_u32 s65, s65, 32
    s_lshl_b32 s65, s65, 19
    s_add_u32 s64, s64, s65
    s_bfe_u32 s65, s49, 0x20001
    s_lshl_b32 s65, s65, 10
    s_add_u32 s64, s64, s65
    s_and_b32 s65, s49, 1
    s_lshl_b32 s65, s65, 3
    s_add_u32 s60, s64, s65
    v_lshrrev_b32 v36, 4, v1
    v_bfe_u32 v37, v1, 2, 2
    v_and_b32 v38, 3, v1
    v_lshl_add_u32 v39, v36, 3, v37
    v_lshlrev_b32 v40, 7, v39
    v_lshl_add_u32 v40, v38, 3, v40
    v_and_b32 v41, 1, v36
    v_lshl_add_u32 v40, v41, 6, v40
    v_lshrrev_b32 v42, 1, v37
    v_lshl_add_u32 v14, v42, 5, v40
    v_xor_b32 v15, 32, v14
    v_lshrrev_b32 v40, 1, v36
    v_lshl_add_u32 v40, v40, 2, v41
    v_lshl_add_u32 v40, v40, 2, v37
    v_lshlrev_b32 v40, 5, v40
    v_lshl_add_u32 v13, v38, 3, v40
    v_lshl_add_u32 v40, v37, 2, v38
    v_lshlrev_b32 v40, 4, v40
    v_lshl_add_u32 v16, v39, 8, v40
    v_xor_b32 v17, 64, v16
    v_and_b32 v36, 15, v1
    v_lshrrev_b32 v37, 4, v1
    v_lshrrev_b32 v38, 1, v36
    v_xor_b32 v37, v37, v38
    v_mul_u32_u24 v36, 384, v36
    v_lshl_add_u32 v36, v37, 4, v36
    v_add_u32 v26, s58, v36
    v_xor_b32 v36, 64, v36
    v_add_u32 v27, s58, v36
    v_and_b32 v36, 15, v1
    v_lshrrev_b32 v37, 4, v1
    v_lshrrev_b32 v38, 2, v36
    v_cmp_eq_u32 vcc, v37, v38
    v_and_b32 v38, 1, v1
    v_lshlrev_b32 v38, 4, v38
    v_mov_b32 v39, 0x3f80
    v_lshlrev_b32 v39, v38, v39
    v_cndmask_b32 v39, 0, v39, vcc
    v_bfe_u32 v38, v1, 1, 1
    v_cmp_eq_u32 vcc, 0, v38
    v_mov_b32 v42, 0x3f803f80
    s_nop 0
    v_cndmask_b32 v40, 0, v39, vcc
    v_sub_u32 v41, v39, v40
    v_accvgpr_write_b32 a0, v40
    v_accvgpr_write_b32 a1, v41
    v_accvgpr_write_b32 a2, 0
    v_accvgpr_write_b32 a3, 0
    v_accvgpr_write_b32 a4, 0
    v_accvgpr_write_b32 a5, 0
    v_accvgpr_write_b32 a6, v40
    v_accvgpr_write_b32 a7, v41
    v_accvgpr_write_b32 a8, v42
    v_accvgpr_write_b32 a9, v42
    v_accvgpr_write_b32 a10, v42
    v_accvgpr_write_b32 a11, v42
    s_mul_i32 s61, s73, 384
    s_add_u32 m0, s58, 6144
    s_add_u32 s61, s61, s62
    buffer_load_dwordx4 v4, s[4:7], s61 offen offset:0 lds
    buffer_load_dwordx4 v5, s[4:7], s61 offen offset:1024 lds
    buffer_load_dwordx4 v6, s[4:7], s61 offen offset:2048 lds
    buffer_load_dwordx4 v7, s[4:7], s61 offen offset:3072 lds
    s_add_u32 m0, s58, 10240
    s_nop 0
    buffer_load_dwordx4 v8, s[4:7], s61 offen offset:0 lds
    buffer_load_dwordx4 v9, s[4:7], s61 offen offset:1024 lds
    s_mul_i32 s61, s74, 384
    s_add_u32 m0, s58, 12288
    s_add_u32 s61, s61, s62
    buffer_load_dwordx4 v4, s[4:7], s61 offen offset:0 lds
    buffer_load_dwordx4 v5, s[4:7], s61 offen offset:1024 lds
    buffer_load_dwordx4 v6, s[4:7], s61 offen offset:2048 lds
    buffer_load_dwordx4 v7, s[4:7], s61 offen offset:3072 lds
    s_add_u32 m0, s58, 16384
    s_nop 0
    buffer_load_dwordx4 v8, s[4:7], s61 offen offset:0 lds
    buffer_load_dwordx4 v9, s[4:7], s61 offen offset:1024 lds
    s_add_u32 s62, s3, 1
    s_and_b32 s62, s62, 3
    s_mul_i32 s62, s62, 18432
    s_add_u32 s62, s62, s57
    s_mul_i32 s61, s72, 384
    s_add_u32 m0, s58, 18432
    s_add_u32 s61, s61, s62
    buffer_load_dwordx4 v4, s[4:7], s61 offen offset:0 lds
    buffer_load_dwordx4 v5, s[4:7], s61 offen offset:1024 lds
    buffer_load_dwordx4 v6, s[4:7], s61 offen offset:2048 lds
    buffer_load_dwordx4 v7, s[4:7], s61 offen offset:3072 lds
    s_add_u32 m0, s58, 22528
    s_nop 0
    buffer_load_dwordx4 v8, s[4:7], s61 offen offset:0 lds
    buffer_load_dwordx4 v9, s[4:7], s61 offen offset:1024 lds
    s_waitcnt vmcnt(18)
    ds_read_b128 a[168:171], v26 offset:0
    ds_read_b128 a[172:175], v27 offset:0
    ds_read_b128 a[176:179], v26 offset:128
    ds_read_b128 a[180:183], v27 offset:128
    ds_read_b128 a[184:187], v26 offset:256
    ds_read_b128 a[188:191], v27 offset:256
    s_waitcnt lgkmcnt(5)
    v_mfma_f32_16x16x32_bf16 a[16:19], a[8:11], a[168:171], 0
    s_waitcnt lgkmcnt(4)
    v_mfma_f32_16x16x32_bf16 a[16:19], a[8:11], a[172:175], a[16:19]
    s_waitcnt lgkmcnt(3)
    v_mfma_f32_16x16x32_bf16 a[16:19], a[8:11], a[176:179], a[16:19]
    s_waitcnt lgkmcnt(2)
    v_mfma_f32_16x16x32_bf16 a[16:19], a[8:11], a[180:183], a[16:19]
    s_waitcnt lgkmcnt(1)
    v_mfma_f32_16x16x32_bf16 a[16:19], a[8:11], a[184:187], a[16:19]
    s_waitcnt lgkmcnt(0)
    v_mfma_f32_16x16x32_bf16 a[16:19], a[8:11], a[188:191], a[16:19]
    s_mul_i32 s61, s73, 384
    s_add_u32 m0, s58, 0
    s_add_u32 s61, s61, s62
    buffer_load_dwordx4 v4, s[4:7], s61 offen offset:0 lds
    buffer_load_dwordx4 v5, s[4:7], s61 offen offset:1024 lds
    buffer_load_dwordx4 v6, s[4:7], s61 offen offset:2048 lds
    buffer_load_dwordx4 v7, s[4:7], s61 offen offset:3072 lds
    s_add_u32 m0, s58, 4096
    s_nop 0
    buffer_load_dwordx4 v8, s[4:7], s61 offen offset:0 lds
    buffer_load_dwordx4 v9, s[4:7], s61 offen offset:1024 lds
    s_waitcnt vmcnt(18)
    ds_read_b128 a[192:195], v26 offset:6144
    ds_read_b128 a[196:199], v27 offset:6144
    ds_read_b128 a[200:203], v26 offset:6272
    ds_read_b128 a[204:207], v27 offset:6272
    ds_read_b128 a[208:211], v26 offset:6400
    ds_read_b128 a[212:215], v27 offset:6400
    s_waitcnt lgkmcnt(5)
    v_mfma_f32_16x16x32_bf16 a[16:19], a[8:11], a[192:195], a[16:19]
    s_waitcnt lgkmcnt(4)
    v_mfma_f32_16x16x32_bf16 a[16:19], a[8:11], a[196:199], a[16:19]
    s_waitcnt lgkmcnt(3)
    v_mfma_f32_16x16x32_bf16 a[16:19], a[8:11], a[200:203], a[16:19]
    s_waitcnt lgkmcnt(2)
    v_mfma_f32_16x16x32_bf16 a[16:19], a[8:11], a[204:207], a[16:19]
    s_waitcnt lgkmcnt(1)
    v_mfma_f32_16x16x32_bf16 a[16:19], a[8:11], a[208:211], a[16:19]
    s_waitcnt lgkmcnt(0)
    v_mfma_f32_16x16x32_bf16 a[16:19], a[8:11], a[212:215], a[16:19]
    s_mul_i32 s61, s74, 384
    s_add_u32 m0, s58, 6144
    s_add_u32 s61, s61, s62
    buffer_load_dwordx4 v4, s[4:7], s61 offen offset:0 lds
    buffer_load_dwordx4 v5, s[4:7], s61 offen offset:1024 lds
    buffer_load_dwordx4 v6, s[4:7], s61 offen offset:2048 lds
    buffer_load_dwordx4 v7, s[4:7], s61 offen offset:3072 lds
    s_add_u32 m0, s58, 10240
    s_nop 0
    buffer_load_dwordx4 v8, s[4:7], s61 offen offset:0 lds
    buffer_load_dwordx4 v9, s[4:7], s61 offen offset:1024 lds
    s_waitcnt vmcnt(18)
    ds_read_b128 a[216:219], v26 offset:12288
    ds_read_b128 a[220:223], v27 offset:12288
    ds_read_b128 a[224:227], v26 offset:12416
    ds_read_b128 a[228:231], v27 offset:12416
    ds_read_b128 a[232:235], v26 offset:12544
    ds_read_b128 a[236:239], v27 offset:12544
    s_waitcnt lgkmcnt(5)
    v_mfma_f32_16x16x32_bf16 a[16:19], a[8:11], a[216:219], a[16:19]
    s_waitcnt lgkmcnt(4)
    v_mfma_f32_16x16x32_bf16 a[16:19], a[8:11], a[220:223], a[16:19]
    s_waitcnt lgkmcnt(3)
    v_mfma_f32_16x16x32_bf16 a[16:19], a[8:11], a[224:227], a[16:19]
    s_waitcnt lgkmcnt(2)
    v_mfma_f32_16x16x32_bf16 a[16:19], a[8:11], a[228:231], a[16:19]
    s_waitcnt lgkmcnt(1)
    v_mfma_f32_16x16x32_bf16 a[16:19], a[8:11], a[232:235], a[16:19]
    s_waitcnt lgkmcnt(0)
    v_mfma_f32_16x16x32_bf16 a[16:19], a[8:11], a[236:239], a[16:19]
    s_add_u32 s62, s3, 2
    s_and_b32 s62, s62, 3
    s_mul_i32 s62, s62, 18432
    s_add_u32 s62, s62, s57
    s_mul_i32 s61, s72, 384
    s_add_u32 m0, s58, 12288
    s_add_u32 s61, s61, s62
    buffer_load_dwordx4 v4, s[4:7], s61 offen offset:0 lds
    buffer_load_dwordx4 v5, s[4:7], s61 offen offset:1024 lds
    buffer_load_dwordx4 v6, s[4:7], s61 offen offset:2048 lds
    buffer_load_dwordx4 v7, s[4:7], s61 offen offset:3072 lds
    s_add_u32 m0, s58, 16384
    s_nop 0
    buffer_load_dwordx4 v8, s[4:7], s61 offen offset:0 lds
    buffer_load_dwordx4 v9, s[4:7], s61 offen offset:1024 lds
    v_accvgpr_read_b32 v32, a16
    v_mul_f32 v32, 0xbae38e39, v32
    v_cvt_pk_bf16_f32 v32, v32, v32
    v_lshlrev_b32 v28, 16, v32
    v_lshlrev_b32 v29, 16, v32
    v_lshlrev_b32 v30, 16, v32
    v_lshlrev_b32 v31, 16, v32
    s_nop 1
    v_mfma_f32_16x16x32_bf16 v[36:39], a[0:3], a[168:171], v[28:31]
    v_mfma_f32_16x16x32_bf16 v[40:43], a[4:7], a[168:171], v[28:31]
    v_mfma_f32_16x16x32_bf16 v[44:47], a[0:3], a[172:175], v[28:31]
    v_mfma_f32_16x16x32_bf16 v[48:51], a[4:7], a[172:175], v[28:31]
    s_nop 4
    v_cvt_pk_bf16_f32 v52, v36, v37
    v_cvt_pk_bf16_f32 v53, v38, v39
    v_cvt_pk_bf16_f32 v54, v40, v41
    v_cvt_pk_bf16_f32 v55, v42, v43
    v_mfma_f32_16x16x32_bf16 v[36:39], a[0:3], a[176:179], v[28:31]
    v_accvgpr_write_b32 a168, v52
    v_accvgpr_write_b32 a169, v53
    v_accvgpr_write_b32 a170, v54
    v_accvgpr_write_b32 a171, v55
    v_mfma_f32_16x16x32_bf16 v[40:43], a[4:7], a[176:179], v[28:31]
    v_cvt_pk_bf16_f32 v52, v44, v45
    v_cvt_pk_bf16_f32 v53, v46, v47
    v_cvt_pk_bf16_f32 v54, v48, v49
    v_cvt_pk_bf16_f32 v55, v50, v51
    v_mfma_f32_16x16x32_bf16 v[44:47], a[0:3], a[180:183], v[28:31]
    v_accvgpr_write_b32 a172, v52
    v_accvgpr_write_b32 a173, v53
    v_accvgpr_write_b32 a174, v54
    v_accvgpr_write_b32 a175, v55
    v_mfma_f32_16x16x32_bf16 v[48:51], a[4:7], a[180:183], v[28:31]
    v_cvt_pk_bf16_f32 v52, v36, v37
    v_cvt_pk_bf16_f32 v53, v38, v39
    v_mfma_f32_16x16x32_bf16 a[64:67], a[168:171], a[168:171], 0
    v_cvt_pk_bf16_f32 v54, v40, v41
    v_cvt_pk_bf16_f32 v55, v42, v43
    v_mfma_f32_16x16x32_bf16 v[36:39], a[0:3], a[184:187], v[28:31]
    s_waitcnt vmcnt(18)
    v_accvgpr_write_b32 a176, v52
    v_accvgpr_write_b32 a177, v53
    v_accvgpr_write_b32 a178, v54
    v_accvgpr_write_b32 a179, v55
    v_mfma_f32_16x16x32_bf16 v[40:43], a[4:7], a[184:187], v[28:31]
    ds_read_b128 a[240:243], v26 offset:18432
    ds_read_b128 a[244:247], v27 offset:18432
    ds_read_b128 a[248:251], v26 offset:18560
    ds_read_b128 a[252:255], v27 offset:18560
    ds_read_b128 v[56:59], v26 offset:18688
    ds_read_b128 v[60:63], v27 offset:18688
    v_cvt_pk_bf16_f32 v52, v44, v45
    v_cvt_pk_bf16_f32 v53, v46, v47
    v_mfma_f32_16x16x32_bf16 a[64:67], a[172:175], a[172:175], a[64:67]
    v_cvt_pk_bf16_f32 v54, v48, v49
    v_cvt_pk_bf16_f32 v55, v50, v51
    v_mfma_f32_16x16x32_bf16 v[44:47], a[0:3], a[188:191], v[28:31]
    v_accvgpr_write_b32 a180, v52
    v_accvgpr_write_b32 a181, v53
    v_accvgpr_write_b32 a182, v54
    v_accvgpr_write_b32 a183, v55
    v_mfma_f32_16x16x32_bf16 v[48:51], a[4:7], a[188:191], v[28:31]
    v_cvt_pk_bf16_f32 v52, v36, v37
    v_cvt_pk_bf16_f32 v53, v38, v39
    v_mfma_f32_16x16x32_bf16 a[64:67], a[176:179], a[176:179], a[64:67]
    v_cvt_pk_bf16_f32 v54, v40, v41
    v_cvt_pk_bf16_f32 v55, v42, v43
    v_mfma_f32_16x16x32_bf16 v[36:39], a[0:3], a[192:195], v[28:31]
    v_accvgpr_write_b32 a184, v52
    v_accvgpr_write_b32 a185, v53
    v_accvgpr_write_b32 a186, v54
    v_accvgpr_write_b32 a187, v55
    v_mfma_f32_16x16x32_bf16 v[40:43], a[4:7], a[192:195], v[28:31]
    v_cvt_pk_bf16_f32 v52, v44, v45
    v_cvt_pk_bf16_f32 v53, v46, v47
    v_mfma_f32_16x16x32_bf16 a[64:67], a[180:183], a[180:183], a[64:67]
    v_cvt_pk_bf16_f32 v54, v48, v49
    v_cvt_pk_bf16_f32 v55, v50, v51
    s_waitcnt lgkmcnt(5)
    v_mfma_f32_16x16x32_bf16 a[20:23], a[8:11], a[240:243], 0
    s_waitcnt lgkmcnt(4)
    v_mfma_f32_16x16x32_bf16 a[20:23], a[8:11], a[244:247], a[20:23]
    s_waitcnt lgkmcnt(3)
    v_mfma_f32_16x16x32_bf16 a[20:23], a[8:11], a[248:251], a[20:23]
    s_waitcnt lgkmcnt(2)
    v_mfma_f32_16x16x32_bf16 a[20:23], a[8:11], a[252:255], a[20:23]
    s_waitcnt lgkmcnt(1)
    v_mfma_f32_16x16x32_bf16 a[20:23], a[8:11], v[56:59], a[20:23]
    s_waitcnt lgkmcnt(0)
    v_mfma_f32_16x16x32_bf16 a[20:23], a[8:11], v[60:63], a[20:23]
    s_mul_i32 s61, s73, 384
    s_add_u32 m0, s58, 18432
    s_add_u32 s61, s61, s62
    v_mfma_f32_16x16x32_bf16 v[44:47], a[0:3], a[196:199], v[28:31]
    v_accvgpr_write_b32 a188, v52
    v_accvgpr_write_b32 a189, v53
    v_accvgpr_write_b32 a190, v54
    v_accvgpr_write_b32 a191, v55
    v_mfma_f32_16x16x32_bf16 v[48:51], a[4:7], a[196:199], v[28:31]
    v_cvt_pk_bf16_f32 v52, v36, v37
    v_cvt_pk_bf16_f32 v53, v38, v39
    v_mfma_f32_16x16x32_bf16 a[64:67], a[184:187], a[184:187], a[64:67]
    v_cvt_pk_bf16_f32 v54, v40, v41
    v_cvt_pk_bf16_f32 v55, v42, v43
    v_mfma_f32_16x16x32_bf16 v[36:39], a[0:3], a[200:203], v[28:31]
    v_accvgpr_write_b32 a192, v52
    v_accvgpr_write_b32 a193, v53
    v_accvgpr_write_b32 a194, v54
    v_accvgpr_write_b32 a195, v55
    v_mfma_f32_16x16x32_bf16 v[40:43], a[4:7], a[200:203], v[28:31]
    v_cvt_pk_bf16_f32 v52, v44, v45
    v_cvt_pk_bf16_f32 v53, v46, v47
    v_mfma_f32_16x16x32_bf16 a[64:67], a[188:191], a[188:191], a[64:67]
    v_cvt_pk_bf16_f32 v54, v48, v49
    v_cvt_pk_bf16_f32 v55, v50, v51
    v_mfma_f32_16x16x32_bf16 v[44:47], a[0:3], a[204:207], v[28:31]
    v_accvgpr_write_b32 a196, v52
    v_accvgpr_write_b32 a197, v53
    v_accvgpr_write_b32 a198, v54
    v_accvgpr_write_b32 a199, v55
    v_mfma_f32_16x16x32_bf16 v[48:51], a[4:7], a[204:207], v[28:31]
    v_cvt_pk_bf16_f32 v52, v36, v37
    v_cvt_pk_bf16_f32 v53, v38, v39
    v_mfma_f32_16x16x32_bf16 a[64:67], a[192:195], a[192:195], a[64:67]
    v_cvt_pk_bf16_f32 v54, v40, v41
    v_cvt_pk_bf16_f32 v55, v42, v43
    v_mfma_f32_16x16x32_bf16 v[36:39], a[0:3], a[208:211], v[28:31]
    s_waitcnt vmcnt(12)
    v_accvgpr_write_b32 a200, v52
    v_accvgpr_write_b32 a201, v53
    v_accvgpr_write_b32 a202, v54
    v_accvgpr_write_b32 a203, v55
    v_mfma_f32_16x16x32_bf16 v[40:43], a[4:7], a[208:211], v[28:31]
    ds_read_b128 v[64:67], v26 offset:0
    ds_read_b128 v[68:71], v27 offset:0
    ds_read_b128 v[72:75], v26 offset:128
    ds_read_b128 v[76:79], v27 offset:128
    ds_read_b128 v[80:83], v26 offset:256
    ds_read_b128 v[84:87], v27 offset:256
    v_cvt_pk_bf16_f32 v52, v44, v45
    v_cvt_pk_bf16_f32 v53, v46, v47
    v_mfma_f32_16x16x32_bf16 a[64:67], a[196:199], a[196:199], a[64:67]
    v_cvt_pk_bf16_f32 v54, v48, v49
    v_cvt_pk_bf16_f32 v55, v50, v51
    v_mfma_f32_16x16x32_bf16 v[44:47], a[0:3], a[212:215], v[28:31]
    v_accvgpr_write_b32 a204, v52
    v_accvgpr_write_b32 a205, v53
    v_accvgpr_write_b32 a206, v54
    v_accvgpr_write_b32 a207, v55
    v_mfma_f32_16x16x32_bf16 v[48:51], a[4:7], a[212:215], v[28:31]
    v_cvt_pk_bf16_f32 v52, v36, v37
    v_cvt_pk_bf16_f32 v53, v38, v39
    v_mfma_f32_16x16x32_bf16 a[64:67], a[200:203], a[200:203], a[64:67]
    v_cvt_pk_bf16_f32 v54, v40, v41
    v_cvt_pk_bf16_f32 v55, v42, v43
    v_mfma_f32_16x16x32_bf16 v[36:39], a[0:3], a[216:219], v[28:31]
    v_accvgpr_write_b32 a208, v52
    v_accvgpr_write_b32 a209, v53
    v_accvgpr_write_b32 a210, v54
    v_accvgpr_write_b32 a211, v55
    v_mfma_f32_16x16x32_bf16 v[40:43], a[4:7], a[216:219], v[28:31]
    v_cvt_pk_bf16_f32 v52, v44, v45
    v_cvt_pk_bf16_f32 v53, v46, v47
    v_mfma_f32_16x16x32_bf16 a[64:67], a[204:207], a[204:207], a[64:67]
    v_cvt_pk_bf16_f32 v54, v48, v49
    v_cvt_pk_bf16_f32 v55, v50, v51
    s_waitcnt lgkmcnt(5)
    v_mfma_f32_16x16x32_bf16 a[20:23], a[8:11], v[64:67], a[20:23]
    buffer_load_dwordx4 v4, s[4:7], s61 offen offset:0 lds
    s_waitcnt lgkmcnt(4)
    v_mfma_f32_16x16x32_bf16 a[20:23], a[8:11], v[68:71], a[20:23]
    s_waitcnt lgkmcnt(3)
    v_mfma_f32_16x16x32_bf16 a[20:23], a[8:11], v[72:75], a[20:23]
    buffer_load_dwordx4 v5, s[4:7], s61 offen offset:1024 lds
    s_waitcnt lgkmcnt(2)
    v_mfma_f32_16x16x32_bf16 a[20:23], a[8:11], v[76:79], a[20:23]
    s_waitcnt lgkmcnt(1)
    v_mfma_f32_16x16x32_bf16 a[20:23], a[8:11], v[80:83], a[20:23]
    buffer_load_dwordx4 v6, s[4:7], s61 offen offset:2048 lds
    s_waitcnt lgkmcnt(0)
    v_mfma_f32_16x16x32_bf16 a[20:23], a[8:11], v[84:87], a[20:23]
    buffer_load_dwordx4 v7, s[4:7], s61 offen offset:3072 lds
    v_mfma_f32_16x16x32_bf16 v[44:47], a[0:3], a[220:223], v[28:31]
    v_accvgpr_write_b32 a212, v52
    v_accvgpr_write_b32 a213, v53
    v_accvgpr_write_b32 a214, v54
    v_accvgpr_write_b32 a215, v55
    v_mfma_f32_16x16x32_bf16 v[48:51], a[4:7], a[220:223], v[28:31]
    s_add_u32 m0, s58, 22528
    v_cvt_pk_bf16_f32 v52, v36, v37
    v_cvt_pk_bf16_f32 v53, v38, v39
    v_mfma_f32_16x16x32_bf16 a[64:67], a[208:211], a[208:211], a[64:67]
    v_cvt_pk_bf16_f32 v54, v40, v41
    v_cvt_pk_bf16_f32 v55, v42, v43
    v_mfma_f32_16x16x32_bf16 v[36:39], a[0:3], a[224:227], v[28:31]
    v_accvgpr_write_b32 a216, v52
    v_accvgpr_write_b32 a217, v53
    v_accvgpr_write_b32 a218, v54
    v_accvgpr_write_b32 a219, v55
    v_mfma_f32_16x16x32_bf16 v[40:43], a[4:7], a[224:227], v[28:31]
    v_cvt_pk_bf16_f32 v52, v44, v45
    v_cvt_pk_bf16_f32 v53, v46, v47
    v_mfma_f32_16x16x32_bf16 a[64:67], a[212:215], a[212:215], a[64:67]
    v_cvt_pk_bf16_f32 v54, v48, v49
    v_cvt_pk_bf16_f32 v55, v50, v51
    v_mfma_f32_16x16x32_bf16 v[44:47], a[0:3], a[228:231], v[28:31]
    v_accvgpr_write_b32 a220, v52
    v_accvgpr_write_b32 a221, v53
    v_accvgpr_write_b32 a222, v54
    v_accvgpr_write_b32 a223, v55
    v_mfma_f32_16x16x32_bf16 v[48:51], a[4:7], a[228:231], v[28:31]
    v_cvt_pk_bf16_f32 v52, v36, v37
    v_cvt_pk_bf16_f32 v53, v38, v39
    v_mfma_f32_16x16x32_bf16 a[64:67], a[216:219], a[216:219], a[64:67]
    v_cvt_pk_bf16_f32 v54, v40, v41
    v_cvt_pk_bf16_f32 v55, v42, v43
    v_mfma_f32_16x16x32_bf16 v[36:39], a[0:3], a[232:235], v[28:31]
    s_waitcnt vmcnt(10)
    v_accvgpr_write_b32 a224, v52
    v_accvgpr_write_b32 a225, v53
    v_accvgpr_write_b32 a226, v54
    v_accvgpr_write_b32 a227, v55
    v_mfma_f32_16x16x32_bf16 v[40:43], a[4:7], a[232:235], v[28:31]
    ds_read_b128 v[96:99], v26 offset:6272
    ds_read_b128 v[100:103], v27 offset:6272
    ds_read_b128 v[104:107], v26 offset:6400
    ds_read_b128 v[108:111], v27 offset:6400
    v_cvt_pk_bf16_f32 v52, v44, v45
    v_cvt_pk_bf16_f32 v53, v46, v47
    v_mfma_f32_16x16x32_bf16 a[64:67], a[220:223], a[220:223], a[64:67]
    v_cvt_pk_bf16_f32 v54, v48, v49
    v_cvt_pk_bf16_f32 v55, v50, v51
    v_mfma_f32_16x16x32_bf16 v[44:47], a[0:3], a[236:239], v[28:31]
    v_accvgpr_write_b32 a228, v52
    v_accvgpr_write_b32 a229, v53
    v_accvgpr_write_b32 a230, v54
    v_accvgpr_write_b32 a231, v55
    v_mfma_f32_16x16x32_bf16 v[48:51], a[4:7], a[236:239], v[28:31]
    v_cvt_pk_bf16_f32 v52, v36, v37
    v_cvt_pk_bf16_f32 v53, v38, v39
    v_mfma_f32_16x16x32_bf16 a[64:67], a[224:227], a[224:227], a[64:67]
    v_cvt_pk_bf16_f32 v54, v40, v41
    v_cvt_pk_bf16_f32 v55, v42, v43
    v_mfma_f32_16x16x32_bf16 a[64:67], a[228:231], a[228:231], a[64:67]
    s_nop 1
    v_accvgpr_write_b32 a232, v52
    v_accvgpr_write_b32 a233, v53
    v_accvgpr_write_b32 a234, v54
    v_accvgpr_write_b32 a235, v55
    v_cvt_pk_bf16_f32 v52, v44, v45
    v_cvt_pk_bf16_f32 v53, v46, v47
    v_mfma_f32_16x16x32_bf16 a[64:67], a[232:235], a[232:235], a[64:67]
    v_cvt_pk_bf16_f32 v54, v48, v49
    v_cvt_pk_bf16_f32 v55, v50, v51
    v_accvgpr_write_b32 a236, v52
    v_accvgpr_write_b32 a237, v53
    v_accvgpr_write_b32 a238, v54
    v_accvgpr_write_b32 a239, v55
    s_nop 1
    v_mfma_f32_16x16x32_bf16 a[64:67], a[236:239], a[236:239], a[64:67]
    ds_read_b128 v[88:91], v26 offset:6144
    ds_read_b128 v[92:95], v27 offset:6144
    s_waitcnt lgkmcnt(1)
    v_mfma_f32_16x16x32_bf16 a[20:23], a[8:11], v[88:91], a[20:23]
    buffer_load_dwordx4 v8, s[4:7], s61 offen offset:0 lds
    s_waitcnt lgkmcnt(0)
    v_mfma_f32_16x16x32_bf16 a[20:23], a[8:11], v[92:95], a[20:23]
    v_mfma_f32_16x16x32_bf16 a[20:23], a[8:11], v[96:99], a[20:23]
    buffer_load_dwordx4 v9, s[4:7], s61 offen offset:1024 lds
    v_mfma_f32_16x16x32_bf16 a[20:23], a[8:11], v[100:103], a[20:23]
    v_mfma_f32_16x16x32_bf16 a[20:23], a[8:11], v[104:107], a[20:23]
    s_mul_i32 s61, s74, 384
    s_add_u32 m0, s58, 0
    s_add_u32 s61, s61, s62
    v_mfma_f32_16x16x32_bf16 a[20:23], a[8:11], v[108:111], a[20:23]
    buffer_load_dwordx4 v4, s[4:7], s61 offen offset:0 lds
    s_nop 6
    v_accvgpr_read_b32 v32, a20
    v_mul_f32 v32, 0xbae38e39, v32
    v_cvt_pk_bf16_f32 v32, v32, v32
    v_lshlrev_b32 v28, 16, v32
    v_lshlrev_b32 v29, 16, v32
    v_lshlrev_b32 v30, 16, v32
    v_lshlrev_b32 v31, 16, v32
    s_nop 1
    v_mfma_f32_16x16x32_bf16 v[36:39], a[0:3], a[240:243], v[28:31]
    buffer_load_dwordx4 v5, s[4:7], s61 offen offset:1024 lds
    v_mfma_f32_16x16x32_bf16 v[40:43], a[4:7], a[240:243], v[28:31]
    v_mfma_f32_16x16x32_bf16 v[44:47], a[0:3], a[244:247], v[28:31]
    buffer_load_dwordx4 v6, s[4:7], s61 offen offset:2048 lds
    v_mfma_f32_16x16x32_bf16 v[48:51], a[4:7], a[244:247], v[28:31]
    s_nop 2
    v_cvt_pk_bf16_f32 v52, v36, v37
    v_cvt_pk_bf16_f32 v53, v38, v39
    v_cvt_pk_bf16_f32 v54, v40, v41
    v_cvt_pk_bf16_f32 v55, v42, v43
    v_mfma_f32_16x16x32_bf16 v[36:39], a[0:3], a[248:251], v[28:31]
    v_accvgpr_write_b32 a240, v52
    v_accvgpr_write_b32 a241, v53
    v_accvgpr_write_b32 a242, v54
    v_accvgpr_write_b32 a243, v55
    v_mfma_f32_16x16x32_bf16 v[40:43], a[4:7], a[248:251], v[28:31]
    v_cvt_pk_bf16_f32 v52, v44, v45
    v_cvt_pk_bf16_f32 v53, v46, v47
    v_cvt_pk_bf16_f32 v54, v48, v49
    v_cvt_pk_bf16_f32 v55, v50, v51
    v_mfma_f32_16x16x32_bf16 v[44:47], a[0:3], a[252:255], v[28:31]
    v_accvgpr_write_b32 a244, v52
    v_accvgpr_write_b32 a245, v53
    v_accvgpr_write_b32 a246, v54
    v_accvgpr_write_b32 a247, v55
    v_mfma_f32_16x16x32_bf16 v[48:51], a[4:7], a[252:255], v[28:31]
    v_cvt_pk_bf16_f32 v52, v36, v37
    v_cvt_pk_bf16_f32 v53, v38, v39
    v_mfma_f32_16x16x32_bf16 a[68:71], a[240:243], a[240:243], 0
    v_cvt_pk_bf16_f32 v54, v40, v41
    v_cvt_pk_bf16_f32 v55, v42, v43
    v_mfma_f32_16x16x32_bf16 v[36:39], a[0:3], v[56:59], v[28:31]
    s_waitcnt vmcnt(9)
    v_accvgpr_write_b32 a248, v52
    v_accvgpr_write_b32 a249, v53
    v_accvgpr_write_b32 a250, v54
    v_accvgpr_write_b32 a251, v55
    v_mfma_f32_16x16x32_bf16 v[40:43], a[4:7], v[56:59], v[28:31]
    ds_read_b128 v[120:123], v26 offset:12416
    ds_read_b128 v[124:127], v27 offset:12416
    ds_read_b128 v[128:131], v26 offset:12544
    ds_read_b128 v[132:135], v27 offset:12544
    v_cvt_pk_bf16_f32 v52, v44, v45
    v_cvt_pk_bf16_f32 v53, v46, v47
    v_mfma_f32_16x16x32_bf16 a[68:71], a[244:247], a[244:247], a[68:71]
    v_cvt_pk_bf16_f32 v54, v48, v49
    v_cvt_pk_bf16_f32 v55, v50, v51
    v_mfma_f32_16x16x32_bf16 v[44:47], a[0:3], v[60:63], v[28:31]
    v_accvgpr_write_b32 a252, v52
    v_accvgpr_write_b32 a253, v53
    v_accvgpr_write_b32 a254, v54
    v_accvgpr_write_b32 a255, v55
    v_mfma_f32_16x16x32_bf16 v[48:51], a[4:7], v[60:63], v[28:31]
    v_cvt_pk_bf16_f32 v56, v36, v37
    v_cvt_pk_bf16_f32 v57, v38, v39
    v_mfma_f32_16x16x32_bf16 a[68:71], a[248:251], a[248:251], a[68:71]
    v_cvt_pk_bf16_f32 v58, v40, v41
    v_cvt_pk_bf16_f32 v59, v42, v43
    v_mfma_f32_16x16x32_bf16 v[36:39], a[0:3], v[64:67], v[28:31]
    ds_read_b128 v[112:115], v26 offset:12288
    ds_read_b128 v[116:119], v27 offset:12288
    v_mfma_f32_16x16x32_bf16 v[40:43], a[4:7], v[64:67], v[28:31]
    v_cvt_pk_bf16_f32 v60, v44, v45
    v_cvt_pk_bf16_f32 v61, v46, v47
    v_mfma_f32_16x16x32_bf16 a[68:71], a[252:255], a[252:255], a[68:71]
    v_cvt_pk_bf16_f32 v62, v48, v49
    v_cvt_pk_bf16_f32 v63, v50, v51
    s_waitcnt lgkmcnt(1)
    v_mfma_f32_16x16x32_bf16 a[24:27], a[8:11], v[112:115], 0
    buffer_load_dwordx4 v7, s[4:7], s61 offen offset:3072 lds
    s_waitcnt lgkmcnt(0)
    v_mfma_f32_16x16x32_bf16 a[24:27], a[8:11], v[116:119], a[24:27]
    v_mfma_f32_16x16x32_bf16 a[24:27], a[8:11], v[120:123], a[24:27]
    s_add_u32 m0, s58, 4096
    v_mfma_f32_16x16x32_bf16 a[24:27], a[8:11], v[124:127], a[24:27]
    buffer_load_dwordx4 v8, s[4:7], s61 offen offset:0 lds
    v_mfma_f32_16x16x32_bf16 a[24:27], a[8:11], v[128:131], a[24:27]
    v_mfma_f32_16x16x32_bf16 a[24:27], a[8:11], v[132:135], a[24:27]
    buffer_load_dwordx4 v9, s[4:7], s61 offen offset:1024 lds
    v_mfma_f32_16x16x32_bf16 v[44:47], a[0:3], v[68:71], v[28:31]
    s_add_u32 s62, s3, 3
    s_and_b32 s62, s62, 3
    s_mul_i32 s62, s62, 18432
    v_mfma_f32_16x16x32_bf16 v[48:51], a[4:7], v[68:71], v[28:31]
    s_add_u32 s62, s62, s57
    v_cvt_pk_bf16_f32 v64, v36, v37
    v_cvt_pk_bf16_f32 v65, v38, v39
    v_mfma_f32_16x16x32_bf16 a[68:71], v[56:59], v[56:59], a[68:71]
    s_mul_i32 s61, s72, 384
    v_cvt_pk_bf16_f32 v66, v40, v41
    v_cvt_pk_bf16_f32 v67, v42, v43
    v_mfma_f32_16x16x32_bf16 v[36:39], a[0:3], v[72:75], v[28:31]
    s_add_u32 m0, s58, 6144
    s_add_u32 s61, s61, s62
    v_mfma_f32_16x16x32_bf16 v[40:43], a[4:7], v[72:75], v[28:31]
    v_cvt_pk_bf16_f32 v68, v44, v45
    v_cvt_pk_bf16_f32 v69, v46, v47
    v_mfma_f32_16x16x32_bf16 a[68:71], v[60:63], v[60:63], a[68:71]
    v_cvt_pk_bf16_f32 v70, v48, v49
    v_cvt_pk_bf16_f32 v71, v50, v51
    v_mfma_f32_16x16x32_bf16 v[44:47], a[0:3], v[76:79], v[28:31]
    buffer_load_dwordx4 v4, s[4:7], s61 offen offset:0 lds
    v_mfma_f32_16x16x32_bf16 v[48:51], a[4:7], v[76:79], v[28:31]
    v_cvt_pk_bf16_f32 v72, v36, v37
    v_cvt_pk_bf16_f32 v73, v38, v39
    v_mfma_f32_16x16x32_bf16 a[68:71], v[64:67], v[64:67], a[68:71]
    v_cvt_pk_bf16_f32 v74, v40, v41
    v_cvt_pk_bf16_f32 v75, v42, v43
    v_mfma_f32_16x16x32_bf16 v[36:39], a[0:3], v[80:83], v[28:31]
    s_waitcnt vmcnt(7)
    buffer_load_dwordx4 v5, s[4:7], s61 offen offset:1024 lds
    v_mfma_f32_16x16x32_bf16 v[40:43], a[4:7], v[80:83], v[28:31]
    ds_read_b128 v[152:155], v26 offset:18688
    ds_read_b128 v[156:159], v27 offset:18688
    v_cvt_pk_bf16_f32 v76, v44, v45
    v_cvt_pk_bf16_f32 v77, v46, v47
    v_mfma_f32_16x16x32_bf16 a[68:71], v[68:71], v[68:71], a[68:71]
    v_cvt_pk_bf16_f32 v78, v48, v49
    v_cvt_pk_bf16_f32 v79, v50, v51
    v_mfma_f32_16x16x32_bf16 v[44:47], a[0:3], v[84:87], v[28:31]
    ds_read_b128 v[136:139], v26 offset:18432
    ds_read_b128 v[140:143], v27 offset:18432
    v_mfma_f32_16x16x32_bf16 v[48:51], a[4:7], v[84:87], v[28:31]
    v_cvt_pk_bf16_f32 v80, v36, v37
    v_cvt_pk_bf16_f32 v81, v38, v39
    v_mfma_f32_16x16x32_bf16 a[68:71], v[72:75], v[72:75], a[68:71]
    v_cvt_pk_bf16_f32 v82, v40, v41
    v_cvt_pk_bf16_f32 v83, v42, v43
    v_mfma_f32_16x16x32_bf16 v[36:39], a[0:3], v[88:91], v[28:31]
    ds_read_b128 v[144:147], v26 offset:18560
    ds_read_b128 v[148:151], v27 offset:18560
    v_mfma_f32_16x16x32_bf16 v[40:43], a[4:7], v[88:91], v[28:31]
    v_cvt_pk_bf16_f32 v84, v44, v45
    v_cvt_pk_bf16_f32 v85, v46, v47
    v_mfma_f32_16x16x32_bf16 a[68:71], v[76:79], v[76:79], a[68:71]
    v_cvt_pk_bf16_f32 v86, v48, v49
    v_cvt_pk_bf16_f32 v87, v50, v51
    s_waitcnt lgkmcnt(3)
    v_mfma_f32_16x16x32_bf16 a[24:27], a[8:11], v[136:139], a[24:27]
    buffer_load_dwordx4 v6, s[4:7], s61 offen offset:2048 lds
    s_waitcnt lgkmcnt(2)
    v_mfma_f32_16x16x32_bf16 a[24:27], a[8:11], v[140:143], a[24:27]
    s_waitcnt lgkmcnt(1)
    v_mfma_f32_16x16x32_bf16 a[24:27], a[8:11], v[144:147], a[24:27]
    buffer_load_dwordx4 v7, s[4:7], s61 offen offset:3072 lds
    s_waitcnt lgkmcnt(0)
    v_mfma_f32_16x16x32_bf16 a[24:27], a[8:11], v[148:151], a[24:27]
    v_mfma_f32_16x16x32_bf16 a[24:27], a[8:11], v[152:155], a[24:27]
    s_add_u32 m0, s58, 10240
    v_mfma_f32_16x16x32_bf16 a[24:27], a[8:11], v[156:159], a[24:27]
    buffer_load_dwordx4 v8, s[4:7], s61 offen offset:0 lds
    v_mfma_f32_16x16x32_bf16 v[44:47], a[0:3], v[92:95], v[28:31]
    buffer_load_dwordx4 v9, s[4:7], s61 offen offset:1024 lds
    v_mfma_f32_16x16x32_bf16 v[48:51], a[4:7], v[92:95], v[28:31]
    v_cvt_pk_bf16_f32 v88, v36, v37
    v_cvt_pk_bf16_f32 v89, v38, v39
    v_mfma_f32_16x16x32_bf16 a[68:71], v[80:83], v[80:83], a[68:71]
    s_mul_i32 s61, s73, 384
    v_cvt_pk_bf16_f32 v90, v40, v41
    v_cvt_pk_bf16_f32 v91, v42, v43
    v_mfma_f32_16x16x32_bf16 v[36:39], a[0:3], v[96:99], v[28:31]
    s_add_u32 m0, s58, 12288
    s_add_u32 s61, s61, s62
    v_mfma_f32_16x16x32_bf16 v[40:43], a[4:7], v[96:99], v[28:31]
    v_cvt_pk_bf16_f32 v92, v44, v45
    v_cvt_pk_bf16_f32 v93, v46, v47
    v_mfma_f32_16x16x32_bf16 a[68:71], v[84:87], v[84:87], a[68:71]
    v_cvt_pk_bf16_f32 v94, v48, v49
    v_cvt_pk_bf16_f32 v95, v50, v51
    v_mfma_f32_16x16x32_bf16 v[44:47], a[0:3], v[100:103], v[28:31]
    buffer_load_dwordx4 v4, s[4:7], s61 offen offset:0 lds
    v_mfma_f32_16x16x32_bf16 v[48:51], a[4:7], v[100:103], v[28:31]
    v_cvt_pk_bf16_f32 v96, v36, v37
    v_cvt_pk_bf16_f32 v97, v38, v39
    v_mfma_f32_16x16x32_bf16 a[68:71], v[88:91], v[88:91], a[68:71]
    v_cvt_pk_bf16_f32 v98, v40, v41
    v_cvt_pk_bf16_f32 v99, v42, v43
    v_mfma_f32_16x16x32_bf16 v[36:39], a[0:3], v[104:107], v[28:31]
    s_waitcnt vmcnt(7)
    buffer_load_dwordx4 v5, s[4:7], s61 offen offset:1024 lds
    v_mfma_f32_16x16x32_bf16 v[40:43], a[4:7], v[104:107], v[28:31]
    ds_read_b128 v[176:179], v26 offset:256
    ds_read_b128 v[180:183], v27 offset:256
    v_cvt_pk_bf16_f32 v100, v44, v45
    v_cvt_pk_bf16_f32 v101, v46, v47
    v_mfma_f32_16x16x32_bf16 a[68:71], v[92:95], v[92:95], a[68:71]
    v_cvt_pk_bf16_f32 v102, v48, v49
    v_cvt_pk_bf16_f32 v103, v50, v51
    v_mfma_f32_16x16x32_bf16 v[44:47], a[0:3], v[108:111], v[28:31]
    ds_read_b128 v[160:163], v26 offset:0
    ds_read_b128 v[164:167], v27 offset:0
    v_mfma_f32_16x16x32_bf16 v[48:51], a[4:7], v[108:111], v[28:31]
    v_cvt_pk_bf16_f32 v104, v36, v37
    v_cvt_pk_bf16_f32 v105, v38, v39
    v_mfma_f32_16x16x32_bf16 a[68:71], v[96:99], v[96:99], a[68:71]
    v_cvt_pk_bf16_f32 v106, v40, v41
    v_cvt_pk_bf16_f32 v107, v42, v43
    v_mfma_f32_16x16x32_bf16 a[68:71], v[100:103], v[100:103], a[68:71]
    s_nop 1
    v_cvt_pk_bf16_f32 v108, v44, v45
    v_cvt_pk_bf16_f32 v109, v46, v47
    v_mfma_f32_16x16x32_bf16 a[68:71], v[104:107], v[104:107], a[68:71]
    v_cvt_pk_bf16_f32 v110, v48, v49
    v_cvt_pk_bf16_f32 v111, v50, v51
    s_nop 1
    v_mfma_f32_16x16x32_bf16 a[68:71], v[108:111], v[108:111], a[68:71]
    ds_read_b128 v[168:171], v26 offset:128
    ds_read_b128 v[172:175], v27 offset:128
    s_waitcnt lgkmcnt(3)
    v_mfma_f32_16x16x32_bf16 a[24:27], a[8:11], v[160:163], a[24:27]
    buffer_load_dwordx4 v6, s[4:7], s61 offen offset:2048 lds
    s_waitcnt lgkmcnt(2)
    v_mfma_f32_16x16x32_bf16 a[24:27], a[8:11], v[164:167], a[24:27]
    s_waitcnt lgkmcnt(1)
    v_mfma_f32_16x16x32_bf16 a[24:27], a[8:11], v[168:171], a[24:27]
    buffer_load_dwordx4 v7, s[4:7], s61 offen offset:3072 lds
    s_waitcnt lgkmcnt(0)
    v_mfma_f32_16x16x32_bf16 a[24:27], a[8:11], v[172:175], a[24:27]
    v_mfma_f32_16x16x32_bf16 a[24:27], a[8:11], v[176:179], a[24:27]
    s_add_u32 m0, s58, 16384
    v_mfma_f32_16x16x32_bf16 a[24:27], a[8:11], v[180:183], a[24:27]
    buffer_load_dwordx4 v8, s[4:7], s61 offen offset:0 lds
    s_nop 6
    v_accvgpr_read_b32 v32, a24
    v_mul_f32 v32, 0xbae38e39, v32
    v_cvt_pk_bf16_f32 v32, v32, v32
    v_lshlrev_b32 v28, 16, v32
    v_lshlrev_b32 v29, 16, v32
    v_lshlrev_b32 v30, 16, v32
    v_lshlrev_b32 v31, 16, v32
    s_nop 1
    v_mfma_f32_16x16x32_bf16 v[36:39], a[0:3], v[112:115], v[28:31]
    buffer_load_dwordx4 v9, s[4:7], s61 offen offset:1024 lds
    v_mfma_f32_16x16x32_bf16 v[40:43], a[4:7], v[112:115], v[28:31]
    v_mfma_f32_16x16x32_bf16 v[44:47], a[0:3], v[116:119], v[28:31]
    s_mul_i32 s61, s74, 384
    s_add_u32 m0, s58, 18432
    s_add_u32 s61, s61, s62
    v_mfma_f32_16x16x32_bf16 v[48:51], a[4:7], v[116:119], v[28:31]
    s_nop 0
    v_cvt_pk_bf16_f32 v112, v36, v37
    v_cvt_pk_bf16_f32 v113, v38, v39
    v_cvt_pk_bf16_f32 v114, v40, v41
    v_cvt_pk_bf16_f32 v115, v42, v43
    v_mfma_f32_16x16x32_bf16 v[36:39], a[0:3], v[120:123], v[28:31]
    buffer_load_dwordx4 v4, s[4:7], s61 offen offset:0 lds
    v_mfma_f32_16x16x32_bf16 v[40:43], a[4:7], v[120:123], v[28:31]
    v_cvt_pk_bf16_f32 v116, v44, v45
    v_cvt_pk_bf16_f32 v117, v46, v47
    v_cvt_pk_bf16_f32 v118, v48, v49
    v_cvt_pk_bf16_f32 v119, v50, v51
    v_mfma_f32_16x16x32_bf16 v[44:47], a[0:3], v[124:127], v[28:31]
    buffer_load_dwordx4 v5, s[4:7], s61 offen offset:1024 lds
    v_mfma_f32_16x16x32_bf16 v[48:51], a[4:7], v[124:127], v[28:31]
    v_cvt_pk_bf16_f32 v120, v36, v37
    v_cvt_pk_bf16_f32 v121, v38, v39
    v_mfma_f32_16x16x32_bf16 a[72:75], v[112:115], v[112:115], 0
    v_cvt_pk_bf16_f32 v122, v40, v41
    v_cvt_pk_bf16_f32 v123, v42, v43
    v_mfma_f32_16x16x32_bf16 v[36:39], a[0:3], v[128:131], v[28:31]
    s_waitcnt vmcnt(8)
    buffer_load_dwordx4 v6, s[4:7], s61 offen offset:2048 lds
    v_mfma_f32_16x16x32_bf16 v[40:43], a[4:7], v[128:131], v[28:31]
    ds_read_b128 v[200:203], v26 offset:6400
    ds_read_b128 v[204:207], v27 offset:6400
    v_cvt_pk_bf16_f32 v124, v44, v45
    v_cvt_pk_bf16_f32 v125, v46, v47
    v_mfma_f32_16x16x32_bf16 a[72:75], v[116:119], v[116:119], a[72:75]
    v_cvt_pk_bf16_f32 v126, v48, v49
    v_cvt_pk_bf16_f32 v127, v50, v51
    v_mfma_f32_16x16x32_bf16 v[44:47], a[0:3], v[132:135], v[28:31]
    ds_read_b128 v[184:187], v26 offset:6144
    ds_read_b128 v[188:191], v27 offset:6144
    v_mfma_f32_16x16x32_bf16 v[48:51], a[4:7], v[132:135], v[28:31]
    v_cvt_pk_bf16_f32 v128, v36, v37
    v_cvt_pk_bf16_f32 v129, v38, v39
    v_mfma_f32_16x16x32_bf16 a[72:75], v[120:123], v[120:123], a[72:75]
    v_cvt_pk_bf16_f32 v130, v40, v41
    v_cvt_pk_bf16_f32 v131, v42, v43
    v_mfma_f32_16x16x32_bf16 v[36:39], a[0:3], v[136:139], v[28:31]
    ds_read_b128 v[192:195], v26 offset:6272
    ds_read_b128 v[196:199], v27 offset:6272
    v_mfma_f32_16x16x32_bf16 v[40:43], a[4:7], v[136:139], v[28:31]
    v_cvt_pk_bf16_f32 v132, v44, v45
    v_cvt_pk_bf16_f32 v133, v46, v47
    v_mfma_f32_16x16x32_bf16 a[72:75], v[124:127], v[124:127], a[72:75]
    v_cvt_pk_bf16_f32 v134, v48, v49
    v_cvt_pk_bf16_f32 v135, v50, v51
    s_waitcnt lgkmcnt(3)
    v_mfma_f32_16x16x32_bf16 a[28:31], a[8:11], v[184:187], 0
    buffer_load_dwordx4 v7, s[4:7], s61 offen offset:3072 lds
    s_waitcnt lgkmcnt(2)
    v_mfma_f32_16x16x32_bf16 a[28:31], a[8:11], v[188:191], a[28:31]
    s_waitcnt lgkmcnt(1)
    v_mfma_f32_16x16x32_bf16 a[28:31], a[8:11], v[192:195], a[28:31]
    s_add_u32 m0, s58, 22528
    s_waitcnt lgkmcnt(0)
    v_mfma_f32_16x16x32_bf16 a[28:31], a[8:11], v[196:199], a[28:31]
    buffer_load_dwordx4 v8, s[4:7], s61 offen offset:0 lds
    v_mfma_f32_16x16x32_bf16 a[28:31], a[8:11], v[200:203], a[28:31]
    v_mfma_f32_16x16x32_bf16 a[28:31], a[8:11], v[204:207], a[28:31]
    buffer_load_dwordx4 v9, s[4:7], s61 offen offset:1024 lds
    v_mfma_f32_16x16x32_bf16 v[44:47], a[0:3], v[140:143], v[28:31]
    s_add_u32 m0, s63, 0
    s_mul_i32 s56, s72, 1769472
    s_add_u32 s56, s56, s53
    v_mfma_f32_16x16x32_bf16 v[48:51], a[4:7], v[140:143], v[28:31]
    v_cvt_pk_bf16_f32 v136, v36, v37
    v_cvt_pk_bf16_f32 v137, v38, v39
    v_mfma_f32_16x16x32_bf16 a[72:75], v[128:131], v[128:131], a[72:75]
    v_cvt_pk_bf16_f32 v138, v40, v41
    v_cvt_pk_bf16_f32 v139, v42, v43
    v_mfma_f32_16x16x32_bf16 v[36:39], a[0:3], v[144:147], v[28:31]
    buffer_load_dwordx4 v11, s[12:15], s56 offen nt lds
    v_mfma_f32_16x16x32_bf16 v[40:43], a[4:7], v[144:147], v[28:31]
    v_cvt_pk_bf16_f32 v140, v44, v45
    v_cvt_pk_bf16_f32 v141, v46, v47
    v_mfma_f32_16x16x32_bf16 a[72:75], v[132:135], v[132:135], a[72:75]
    v_cvt_pk_bf16_f32 v142, v48, v49
    v_cvt_pk_bf16_f32 v143, v50, v51
    v_mfma_f32_16x16x32_bf16 v[44:47], a[0:3], v[148:151], v[28:31]
    buffer_load_dwordx4 v12, s[12:15], s56 offen offset:1024 nt lds
    v_mfma_f32_16x16x32_bf16 v[48:51], a[4:7], v[148:151], v[28:31]
    v_cvt_pk_bf16_f32 v144, v36, v37
    v_cvt_pk_bf16_f32 v145, v38, v39
    v_mfma_f32_16x16x32_bf16 a[72:75], v[136:139], v[136:139], a[72:75]
    s_add_u32 m0, s63, 8192
    v_cvt_pk_bf16_f32 v146, v40, v41
    v_cvt_pk_bf16_f32 v147, v42, v43
    v_mfma_f32_16x16x32_bf16 v[36:39], a[0:3], v[152:155], v[28:31]
    s_waitcnt vmcnt(8)
    s_add_u32 s56, s56, 294912
    buffer_load_dwordx4 v11, s[12:15], s56 offen nt lds
    v_mfma_f32_16x16x32_bf16 v[40:43], a[4:7], v[152:155], v[28:31]
    ds_read_b128 v[224:227], v26 offset:12544
    ds_read_b128 v[228:231], v27 offset:12544
    v_cvt_pk_bf16_f32 v148, v44, v45
    v_cvt_pk_bf16_f32 v149, v46, v47
    v_mfma_f32_16x16x32_bf16 a[72:75], v[140:143], v[140:143], a[72:75]
    v_cvt_pk_bf16_f32 v150, v48, v49
    v_cvt_pk_bf16_f32 v151, v50, v51
    v_mfma_f32_16x16x32_bf16 v[44:47], a[0:3], v[156:159], v[28:31]
    ds_read_b128 v[208:211], v26 offset:12288
    ds_read_b128 v[212:215], v27 offset:12288
    v_mfma_f32_16x16x32_bf16 v[48:51], a[4:7], v[156:159], v[28:31]
    v_cvt_pk_bf16_f32 v152, v36, v37
    v_cvt_pk_bf16_f32 v153, v38, v39
    v_mfma_f32_16x16x32_bf16 a[72:75], v[144:147], v[144:147], a[72:75]
    v_cvt_pk_bf16_f32 v154, v40, v41
    v_cvt_pk_bf16_f32 v155, v42, v43
    v_mfma_f32_16x16x32_bf16 v[36:39], a[0:3], v[160:163], v[28:31]
    ds_read_b128 v[216:219], v26 offset:12416
    ds_read_b128 v[220:223], v27 offset:12416
    v_mfma_f32_16x16x32_bf16 v[40:43], a[4:7], v[160:163], v[28:31]
    v_cvt_pk_bf16_f32 v156, v44, v45
    v_cvt_pk_bf16_f32 v157, v46, v47
    v_mfma_f32_16x16x32_bf16 a[72:75], v[148:151], v[148:151], a[72:75]
    v_cvt_pk_bf16_f32 v158, v48, v49
    v_cvt_pk_bf16_f32 v159, v50, v51
    s_waitcnt lgkmcnt(3)
    v_mfma_f32_16x16x32_bf16 a[28:31], a[8:11], v[208:211], a[28:31]
    buffer_load_dwordx4 v12, s[12:15], s56 offen offset:1024 nt lds
    s_waitcnt lgkmcnt(2)
    v_mfma_f32_16x16x32_bf16 a[28:31], a[8:11], v[212:215], a[28:31]
    s_waitcnt lgkmcnt(1)
    v_mfma_f32_16x16x32_bf16 a[28:31], a[8:11], v[216:219], a[28:31]
    s_add_u32 m0, s63, 16384
    s_add_u32 s56, s56, 294912
    s_waitcnt lgkmcnt(0)
    v_mfma_f32_16x16x32_bf16 a[28:31], a[8:11], v[220:223], a[28:31]
    buffer_load_dwordx4 v11, s[12:15], s56 offen nt lds
    v_mfma_f32_16x16x32_bf16 a[28:31], a[8:11], v[224:227], a[28:31]
    v_mfma_f32_16x16x32_bf16 a[28:31], a[8:11], v[228:231], a[28:31]
    buffer_load_dwordx4 v12, s[12:15], s56 offen offset:1024 nt lds
    v_mfma_f32_16x16x32_bf16 v[44:47], a[0:3], v[164:167], v[28:31]
    s_add_u32 m0, s63, 24576
    s_add_u32 s56, s56, 294912
    v_mfma_f32_16x16x32_bf16 v[48:51], a[4:7], v[164:167], v[28:31]
    v_cvt_pk_bf16_f32 v160, v36, v37
    v_cvt_pk_bf16_f32 v161, v38, v39
    v_mfma_f32_16x16x32_bf16 a[72:75], v[152:155], v[152:155], a[72:75]
    v_cvt_pk_bf16_f32 v162, v40, v41
    v_cvt_pk_bf16_f32 v163, v42, v43
    v_mfma_f32_16x16x32_bf16 v[36:39], a[0:3], v[168:171], v[28:31]
    buffer_load_dwordx4 v11, s[12:15], s56 offen nt lds
    v_mfma_f32_16x16x32_bf16 v[40:43], a[4:7], v[168:171], v[28:31]
    v_cvt_pk_bf16_f32 v164, v44, v45
    v_cvt_pk_bf16_f32 v165, v46, v47
    v_mfma_f32_16x16x32_bf16 a[72:75], v[156:159], v[156:159], a[72:75]
    v_cvt_pk_bf16_f32 v166, v48, v49
    v_cvt_pk_bf16_f32 v167, v50, v51
    v_mfma_f32_16x16x32_bf16 v[44:47], a[0:3], v[172:175], v[28:31]
    buffer_load_dwordx4 v12, s[12:15], s56 offen offset:1024 nt lds
    v_mfma_f32_16x16x32_bf16 v[48:51], a[4:7], v[172:175], v[28:31]
    v_cvt_pk_bf16_f32 v168, v36, v37
    v_cvt_pk_bf16_f32 v169, v38, v39
    v_mfma_f32_16x16x32_bf16 a[72:75], v[160:163], v[160:163], a[72:75]
    s_add_u32 m0, s63, 32768
    v_cvt_pk_bf16_f32 v170, v40, v41
    v_cvt_pk_bf16_f32 v171, v42, v43
    v_mfma_f32_16x16x32_bf16 v[36:39], a[0:3], v[176:179], v[28:31]
    s_waitcnt vmcnt(8)
    s_add_u32 s56, s56, 294912
    buffer_load_dwordx4 v11, s[12:15], s56 offen nt lds
    v_mfma_f32_16x16x32_bf16 v[40:43], a[4:7], v[176:179], v[28:31]
    ds_read_b128 v[248:251], v26 offset:18688
    ds_read_b128 v[252:255], v27 offset:18688
    v_cvt_pk_bf16_f32 v172, v44, v45
    v_cvt_pk_bf16_f32 v173, v46, v47
    v_mfma_f32_16x16x32_bf16 a[72:75], v[164:167], v[164:167], a[72:75]
    v_cvt_pk_bf16_f32 v174, v48, v49
    v_cvt_pk_bf16_f32 v175, v50, v51
    v_mfma_f32_16x16x32_bf16 v[44:47], a[0:3], v[180:183], v[28:31]
    ds_read_b128 v[232:235], v26 offset:18432
    ds_read_b128 v[236:239], v27 offset:18432
    v_mfma_f32_16x16x32_bf16 v[48:51], a[4:7], v[180:183], v[28:31]
    v_cvt_pk_bf16_f32 v176, v36, v37
    v_cvt_pk_bf16_f32 v177, v38, v39
    v_mfma_f32_16x16x32_bf16 a[72:75], v[168:171], v[168:171], a[72:75]
    v_cvt_pk_bf16_f32 v178, v40, v41
    v_cvt_pk_bf16_f32 v179, v42, v43
    v_mfma_f32_16x16x32_bf16 a[72:75], v[172:175], v[172:175], a[72:75]
    s_nop 1
    v_cvt_pk_bf16_f32 v180, v44, v45
    v_cvt_pk_bf16_f32 v181, v46, v47
    v_mfma_f32_16x16x32_bf16 a[72:75], v[176:179], v[176:179], a[72:75]
    v_cvt_pk_bf16_f32 v182, v48, v49
    v_cvt_pk_bf16_f32 v183, v50, v51
    s_nop 1
    v_mfma_f32_16x16x32_bf16 a[72:75], v[180:183], v[180:183], a[72:75]
    ds_read_b128 v[240:243], v26 offset:18560
    ds_read_b128 v[244:247], v27 offset:18560
    s_waitcnt lgkmcnt(3)
    v_mfma_f32_16x16x32_bf16 a[28:31], a[8:11], v[232:235], a[28:31]
    buffer_load_dwordx4 v12, s[12:15], s56 offen offset:1024 nt lds
    s_waitcnt lgkmcnt(2)
    v_mfma_f32_16x16x32_bf16 a[28:31], a[8:11], v[236:239], a[28:31]
    s_waitcnt lgkmcnt(1)
    v_mfma_f32_16x16x32_bf16 a[28:31], a[8:11], v[240:243], a[28:31]
    s_add_u32 m0, s63, 40960
    s_add_u32 s56, s56, 294912
    s_waitcnt lgkmcnt(0)
    v_mfma_f32_16x16x32_bf16 a[28:31], a[8:11], v[244:247], a[28:31]
    buffer_load_dwordx4 v11, s[12:15], s56 offen nt lds
    v_mfma_f32_16x16x32_bf16 a[28:31], a[8:11], v[248:251], a[28:31]
    v_mfma_f32_16x16x32_bf16 a[28:31], a[8:11], v[252:255], a[28:31]
    buffer_load_dwordx4 v12, s[12:15], s56 offen offset:1024 nt lds
    s_barrier
    s_nop 5
    v_accvgpr_read_b32 v32, a28
    v_mul_f32 v32, 0xbae38e39, v32
    v_cvt_pk_bf16_f32 v32, v32, v32
    v_lshlrev_b32 v28, 16, v32
    v_lshlrev_b32 v29, 16, v32
    v_lshlrev_b32 v30, 16, v32
    v_lshlrev_b32 v31, 16, v32
    s_nop 1
    v_mfma_f32_16x16x32_bf16 v[36:39], a[0:3], v[184:187], v[28:31]
    s_add_u32 m0, s63, 49152
    s_mul_i32 s56, s73, 1769472
    s_add_u32 s56, s56, s53
    v_mfma_f32_16x16x32_bf16 v[40:43], a[4:7], v[184:187], v[28:31]
    buffer_load_dwordx4 v11, s[12:15], s56 offen nt lds
    v_mfma_f32_16x16x32_bf16 v[44:47], a[0:3], v[188:191], v[28:31]
    v_mfma_f32_16x16x32_bf16 v[48:51], a[4:7], v[188:191], v[28:31]
    s_nop 0
    v_cvt_pk_bf16_f32 v184, v36, v37
    v_cvt_pk_bf16_f32 v185, v38, v39
    s_nop 1
    v_cvt_pk_bf16_f32 v186, v40, v41
    v_cvt_pk_bf16_f32 v187, v42, v43
    v_mfma_f32_16x16x32_bf16 v[36:39], a[0:3], v[192:195], v[28:31]
    buffer_load_dwordx4 v12, s[12:15], s56 offen offset:1024 nt lds
    v_mfma_f32_16x16x32_bf16 v[40:43], a[4:7], v[192:195], v[28:31]
    v_cvt_pk_bf16_f32 v188, v44, v45
    v_cvt_pk_bf16_f32 v189, v46, v47
    v_cvt_pk_bf16_f32 v190, v48, v49
    v_cvt_pk_bf16_f32 v191, v50, v51
    v_mfma_f32_16x16x32_bf16 v[44:47], a[0:3], v[196:199], v[28:31]
    s_add_u32 m0, s63, 57344
    s_add_u32 s56, s56, 294912
    v_mfma_f32_16x16x32_bf16 v[48:51], a[4:7], v[196:199], v[28:31]
    v_cvt_pk_bf16_f32 v192, v36, v37
    v_cvt_pk_bf16_f32 v193, v38, v39
    v_mfma_f32_16x16x32_bf16 a[76:79], v[184:187], v[184:187], 0
    v_cvt_pk_bf16_f32 v194, v40, v41
    v_cvt_pk_bf16_f32 v195, v42, v43
    v_mfma_f32_16x16x32_bf16 v[36:39], a[0:3], v[200:203], v[28:31]
    buffer_load_dwordx4 v11, s[12:15], s56 offen nt lds
    v_mfma_f32_16x16x32_bf16 v[40:43], a[4:7], v[200:203], v[28:31]
    v_cvt_pk_bf16_f32 v196, v44, v45
    v_cvt_pk_bf16_f32 v197, v46, v47
    v_mfma_f32_16x16x32_bf16 a[76:79], v[188:191], v[188:191], a[76:79]
    v_cvt_pk_bf16_f32 v198, v48, v49
    v_cvt_pk_bf16_f32 v199, v50, v51
    v_mfma_f32_16x16x32_bf16 v[44:47], a[0:3], v[204:207], v[28:31]
    buffer_load_dwordx4 v12, s[12:15], s56 offen offset:1024 nt lds
    v_mfma_f32_16x16x32_bf16 v[48:51], a[4:7], v[204:207], v[28:31]
    v_cvt_pk_bf16_f32 v200, v36, v37
    v_cvt_pk_bf16_f32 v201, v38, v39
    v_mfma_f32_16x16x32_bf16 a[76:79], v[192:195], v[192:195], a[76:79]
    s_add_u32 m0, s63, 65536
    v_cvt_pk_bf16_f32 v202, v40, v41
    v_cvt_pk_bf16_f32 v203, v42, v43
    v_mfma_f32_16x16x32_bf16 v[36:39], a[0:3], v[208:211], v[28:31]
    s_add_u32 s56, s56, 294912
    buffer_load_dwordx4 v11, s[12:15], s56 offen nt lds
    v_mfma_f32_16x16x32_bf16 v[40:43], a[4:7], v[208:211], v[28:31]
    v_cvt_pk_bf16_f32 v204, v44, v45
    v_cvt_pk_bf16_f32 v205, v46, v47
    v_mfma_f32_16x16x32_bf16 a[76:79], v[196:199], v[196:199], a[76:79]
    v_cvt_pk_bf16_f32 v206, v48, v49
    v_cvt_pk_bf16_f32 v207, v50, v51
    v_mfma_f32_16x16x32_bf16 v[44:47], a[0:3], v[212:215], v[28:31]
    buffer_load_dwordx4 v12, s[12:15], s56 offen offset:1024 nt lds
    v_mfma_f32_16x16x32_bf16 v[48:51], a[4:7], v[212:215], v[28:31]
    v_cvt_pk_bf16_f32 v208, v36, v37
    v_cvt_pk_bf16_f32 v209, v38, v39
    v_mfma_f32_16x16x32_bf16 a[76:79], v[200:203], v[200:203], a[76:79]
    s_add_u32 m0, s63, 73728
    v_cvt_pk_bf16_f32 v210, v40, v41
    v_cvt_pk_bf16_f32 v211, v42, v43
    v_mfma_f32_16x16x32_bf16 v[36:39], a[0:3], v[216:219], v[28:31]
    s_add_u32 s56, s56, 294912
    buffer_load_dwordx4 v11, s[12:15], s56 offen nt lds
    v_mfma_f32_16x16x32_bf16 v[40:43], a[4:7], v[216:219], v[28:31]
    v_cvt_pk_bf16_f32 v212, v44, v45
    v_cvt_pk_bf16_f32 v213, v46, v47
    v_mfma_f32_16x16x32_bf16 a[76:79], v[204:207], v[204:207], a[76:79]
    v_cvt_pk_bf16_f32 v214, v48, v49
    v_cvt_pk_bf16_f32 v215, v50, v51
    v_mfma_f32_16x16x32_bf16 v[44:47], a[0:3], v[220:223], v[28:31]
    buffer_load_dwordx4 v12, s[12:15], s56 offen offset:1024 nt lds
    v_mfma_f32_16x16x32_bf16 v[48:51], a[4:7], v[220:223], v[28:31]
    v_cvt_pk_bf16_f32 v216, v36, v37
    v_cvt_pk_bf16_f32 v217, v38, v39
    v_mfma_f32_16x16x32_bf16 a[76:79], v[208:211], v[208:211], a[76:79]
    s_add_u32 m0, s63, 81920
    v_cvt_pk_bf16_f32 v218, v40, v41
    v_cvt_pk_bf16_f32 v219, v42, v43
    v_mfma_f32_16x16x32_bf16 v[36:39], a[0:3], v[224:227], v[28:31]
    s_add_u32 s56, s56, 294912
    buffer_load_dwordx4 v11, s[12:15], s56 offen nt lds
    v_mfma_f32_16x16x32_bf16 v[40:43], a[4:7], v[224:227], v[28:31]
    v_cvt_pk_bf16_f32 v220, v44, v45
    v_cvt_pk_bf16_f32 v221, v46, v47
    v_mfma_f32_16x16x32_bf16 a[76:79], v[212:215], v[212:215], a[76:79]
    v_cvt_pk_bf16_f32 v222, v48, v49
    v_cvt_pk_bf16_f32 v223, v50, v51
    v_mfma_f32_16x16x32_bf16 v[44:47], a[0:3], v[228:231], v[28:31]
    s_waitcnt vmcnt(9)
    buffer_load_dwordx4 v12, s[12:15], s56 offen offset:1024 nt lds
    v_mfma_f32_16x16x32_bf16 v[48:51], a[4:7], v[228:231], v[28:31]
    s_barrier
    v_cvt_pk_bf16_f32 v224, v36, v37
    v_cvt_pk_bf16_f32 v225, v38, v39
    v_mfma_f32_16x16x32_bf16 a[76:79], v[216:219], v[216:219], a[76:79]
    s_add_u32 m0, s63, 90112
    v_cvt_pk_bf16_f32 v226, v40, v41
    v_cvt_pk_bf16_f32 v227, v42, v43
    v_mfma_f32_16x16x32_bf16 v[36:39], a[0:3], v[232:235], v[28:31]
    s_add_u32 s56, s56, 294912
    buffer_load_dwordx4 v11, s[12:15], s56 offen nt lds
    ds_read_b64_tr_b16 a[128:129], v14 offset:0
    v_mfma_f32_16x16x32_bf16 v[40:43], a[4:7], v[232:235], v[28:31]
    v_cvt_pk_bf16_f32 v228, v44, v45
    v_cvt_pk_bf16_f32 v229, v46, v47
    v_mfma_f32_16x16x32_bf16 a[76:79], v[220:223], v[220:223], a[76:79]
    v_cvt_pk_bf16_f32 v230, v48, v49
    v_cvt_pk_bf16_f32 v231, v50, v51
    v_mfma_f32_16x16x32_bf16 v[44:47], a[0:3], v[236:239], v[28:31]
    ds_read_b64_tr_b16 a[130:131], v14 offset:512
    ds_read_b64_tr_b16 a[132:133], v14 offset:8192
    v_mfma_f32_16x16x32_bf16 v[48:51], a[4:7], v[236:239], v[28:31]
    v_cvt_pk_bf16_f32 v232, v36, v37
    v_cvt_pk_bf16_f32 v233, v38, v39
    v_mfma_f32_16x16x32_bf16 a[76:79], v[224:227], v[224:227], a[76:79]
    v_cvt_pk_bf16_f32 v234, v40, v41
    v_cvt_pk_bf16_f32 v235, v42, v43
    v_mfma_f32_16x16x32_bf16 v[36:39], a[0:3], v[240:243], v[28:31]
    ds_read_b64_tr_b16 a[134:135], v14 offset:8704
    ds_read_b64_tr_b16 a[136:137], v14 offset:16384
    v_mfma_f32_16x16x32_bf16 v[40:43], a[4:7], v[240:243], v[28:31]
    v_cvt_pk_bf16_f32 v236, v44, v45
    v_cvt_pk_bf16_f32 v237, v46, v47
    v_mfma_f32_16x16x32_bf16 a[76:79], v[228:231], v[228:231], a[76:79]
    v_cvt_pk_bf16_f32 v238, v48, v49
    v_cvt_pk_bf16_f32 v239, v50, v51
    v_mfma_f32_16x16x32_bf16 v[44:47], a[0:3], v[244:247], v[28:31]
    ds_read_b64_tr_b16 a[138:139], v14 offset:16896
    ds_read_b64_tr_b16 a[140:141], v14 offset:24576
    v_mfma_f32_16x16x32_bf16 v[48:51], a[4:7], v[244:247], v[28:31]
    v_cvt_pk_bf16_f32 v240, v36, v37
    v_cvt_pk_bf16_f32 v241, v38, v39
    v_mfma_f32_16x16x32_bf16 a[76:79], v[232:235], v[232:235], a[76:79]
    v_cvt_pk_bf16_f32 v242, v40, v41
    v_cvt_pk_bf16_f32 v243, v42, v43
    v_mfma_f32_16x16x32_bf16 v[36:39], a[0:3], v[248:251], v[28:31]
    ds_read_b64_tr_b16 a[142:143], v14 offset:25088
    ds_read_b64_tr_b16 a[144:145], v14 offset:32768
    v_mfma_f32_16x16x32_bf16 v[40:43], a[4:7], v[248:251], v[28:31]
    v_cvt_pk_bf16_f32 v244, v44, v45
    v_cvt_pk_bf16_f32 v245, v46, v47
    v_mfma_f32_16x16x32_bf16 a[76:79], v[236:239], v[236:239], a[76:79]
    v_cvt_pk_bf16_f32 v246, v48, v49
    v_cvt_pk_bf16_f32 v247, v50, v51
    v_mfma_f32_16x16x32_bf16 v[44:47], a[0:3], v[252:255], v[28:31]
    ds_read_b64_tr_b16 a[146:147], v14 offset:33280
    ds_read_b64_tr_b16 a[148:149], v14 offset:40960
    v_mfma_f32_16x16x32_bf16 v[48:51], a[4:7], v[252:255], v[28:31]
    v_cvt_pk_bf16_f32 v248, v36, v37
    v_cvt_pk_bf16_f32 v249, v38, v39
    v_mfma_f32_16x16x32_bf16 a[76:79], v[240:243], v[240:243], a[76:79]
    v_cvt_pk_bf16_f32 v250, v40, v41
    v_cvt_pk_bf16_f32 v251, v42, v43
    v_mfma_f32_16x16x32_bf16 a[76:79], v[244:247], v[244:247], a[76:79]
    s_nop 1
    v_cvt_pk_bf16_f32 v252, v44, v45
    v_cvt_pk_bf16_f32 v253, v46, v47
    v_mfma_f32_16x16x32_bf16 a[76:79], v[248:251], v[248:251], a[76:79]
    v_cvt_pk_bf16_f32 v254, v48, v49
    v_cvt_pk_bf16_f32 v255, v50, v51
    s_nop 1
    v_mfma_f32_16x16x32_bf16 a[76:79], v[252:255], v[252:255], a[76:79]
    ds_read_b64_tr_b16 a[150:151], v14 offset:41472
    buffer_load_dwordx4 v12, s[12:15], s56 offen offset:1024 nt lds
L_p1_code:
    s_waitcnt lgkmcnt(10)
    v_mfma_f32_16x16x32_bf16 a[0:3], a[128:131], a[168:171], 0
    s_add_u32 m0, s63, 98304
    ds_read_b64_tr_b16 a[152:153], v15 offset:0
    ds_read_b64_tr_b16 a[154:155], v15 offset:512
    s_waitcnt lgkmcnt(10)
    v_mfma_f32_16x16x32_bf16 a[0:3], a[132:135], a[172:175], a[0:3]
    s_mul_i32 s56, s74, 1769472
    s_add_u32 s56, s56, s53
    s_waitcnt lgkmcnt(8)
    v_mfma_f32_16x16x32_bf16 a[0:3], a[136:139], a[176:179], a[0:3]
    ds_read_b64_tr_b16 a[156:157], v15 offset:8192
    ds_read_b64_tr_b16 a[158:159], v15 offset:8704
    s_waitcnt lgkmcnt(8)
    v_mfma_f32_16x16x32_bf16 a[0:3], a[140:143], a[180:183], a[0:3]
    buffer_load_dwordx4 v11, s[12:15], s56 offen nt lds
    v_and_b32 v52, 3, v1
    s_waitcnt lgkmcnt(6)
    v_mfma_f32_16x16x32_bf16 a[0:3], a[144:147], a[184:187], a[0:3]
    ds_read_b64_tr_b16 a[160:161], v15 offset:16384
    ds_read_b64_tr_b16 a[162:163], v15 offset:16896
    s_waitcnt lgkmcnt(6)
    v_mfma_f32_16x16x32_bf16 a[0:3], a[148:151], a[188:191], a[0:3]
    v_and_b32 v53, 15, v1
    v_lshrrev_b32 v54, 2, v53
    v_mfma_f32_16x16x32_bf16 a[16:19], a[148:151], v[60:63], 0
    ds_read_b64_tr_b16 a[164:165], v15 offset:24576
    ds_read_b64_tr_b16 a[166:167], v15 offset:25088
    v_mfma_f32_16x16x32_bf16 a[16:19], a[144:147], v[56:59], a[16:19]
    v_lshl_add_u32 v53, v54, 4, v53
    v_lshlrev_b32 v53, 2, v53
    v_mfma_f32_16x16x32_bf16 a[16:19], a[140:143], a[252:255], a[16:19]
    ds_read_b64_tr_b16 v[28:29], v15 offset:32768
    ds_read_b64_tr_b16 v[30:31], v15 offset:33280
    v_mfma_f32_16x16x32_bf16 a[16:19], a[136:139], a[248:251], a[16:19]
    buffer_load_dwordx4 v12, s[12:15], s56 offen offset:1024 nt lds
    v_cmp_eq_u32 s[66:67], 1, v52
    v_mfma_f32_16x16x32_bf16 a[16:19], a[132:135], a[244:247], a[16:19]
    ds_read_b64_tr_b16 v[32:33], v15 offset:40960
    ds_read_b64_tr_b16 v[34:35], v15 offset:41472
    v_mfma_f32_16x16x32_bf16 a[16:19], a[128:131], a[240:243], a[16:19]
    v_cmp_eq_u32 s[68:69], 2, v52
    v_cmp_eq_u32 s[70:71], 3, v52
    v_mfma_f32_16x16x32_bf16 a[32:35], a[128:131], v[112:115], 0
    v_accvgpr_read_b32 v36, a64
    v_accvgpr_read_b32 v37, a65
    v_mfma_f32_16x16x32_bf16 a[32:35], a[132:135], v[116:119], a[32:35]
    v_accvgpr_read_b32 v38, a66
    v_accvgpr_read_b32 v39, a67
    v_mfma_f32_16x16x32_bf16 a[32:35], a[136:139], v[120:123], a[32:35]
    v_accvgpr_read_b32 v40, a68
    v_accvgpr_read_b32 v41, a69
    v_mfma_f32_16x16x32_bf16 a[32:35], a[140:143], v[124:127], a[32:35]
    v_accvgpr_read_b32 v42, a70
    v_accvgpr_read_b32 v43, a71
    v_mfma_f32_16x16x32_bf16 a[32:35], a[144:147], v[128:131], a[32:35]
    v_accvgpr_read_b32 v44, a72
    v_accvgpr_read_b32 v45, a73
    v_mfma_f32_16x16x32_bf16 a[32:35], a[148:151], v[132:135], a[32:35]
    v_accvgpr_read_b32 v46, a74
    v_accvgpr_read_b32 v47, a75
    v_mfma_f32_16x16x32_bf16 a[48:51], a[148:151], v[204:207], 0
    s_add_u32 m0, s63, 106496
    s_add_u32 s56, s56, 294912
    v_accvgpr_read_b32 v48, a76
    v_mfma_f32_16x16x32_bf16 a[48:51], a[144:147], v[200:203], a[48:51]
    buffer_load_dwordx4 v11, s[12:15], s56 offen nt lds
    v_accvgpr_read_b32 v49, a77
    v_mfma_f32_16x16x32_bf16 a[48:51], a[140:143], v[196:199], a[48:51]
    v_accvgpr_read_b32 v50, a78
    v_accvgpr_read_b32 v51, a79
    v_mfma_f32_16x16x32_bf16 a[48:51], a[136:139], v[192:195], a[48:51]
    v_cndmask_b32 v36, v36, v37, s[66:67]
    v_cndmask_b32 v40, v40, v41, s[66:67]
    v_mfma_f32_16x16x32_bf16 a[48:51], a[132:135], v[188:191], a[48:51]
    v_cndmask_b32 v44, v44, v45, s[66:67]
    v_cndmask_b32 v48, v48, v49, s[66:67]
    v_mfma_f32_16x16x32_bf16 a[48:51], a[128:131], v[184:187], a[48:51]
    s_waitcnt lgkmcnt(0)
    v_cndmask_b32 v36, v36, v38, s[68:69]
    v_cndmask_b32 v40, v40, v42, s[68:69]
    v_mfma_f32_16x16x32_bf16 a[4:7], a[152:155], a[168:171], 0
    ds_read_b64_tr_b16 a[128:129], v14 offset:4096
    ds_read_b64_tr_b16 a[130:131], v14 offset:4608
    v_mfma_f32_16x16x32_bf16 a[4:7], a[156:159], a[172:175], a[4:7]
    v_cndmask_b32 v44, v44, v46, s[68:69]
    v_cndmask_b32 v48, v48, v50, s[68:69]
    v_mfma_f32_16x16x32_bf16 a[4:7], a[160:163], a[176:179], a[4:7]
    ds_read_b64_tr_b16 a[132:133], v14 offset:12288
    ds_read_b64_tr_b16 a[134:135], v14 offset:12800
    v_mfma_f32_16x16x32_bf16 a[4:7], a[164:167], a[180:183], a[4:7]
    buffer_load_dwordx4 v12, s[12:15], s56 offen offset:1024 nt lds
    v_cndmask_b32 v36, v36, v39, s[70:71]
    v_mfma_f32_16x16x32_bf16 a[4:7], v[28:31], a[184:187], a[4:7]
    ds_read_b64_tr_b16 a[136:137], v14 offset:20480
    ds_read_b64_tr_b16 a[138:139], v14 offset:20992
    v_mfma_f32_16x16x32_bf16 a[4:7], v[32:35], a[188:191], a[4:7]
    v_cndmask_b32 v40, v40, v43, s[70:71]
    v_cndmask_b32 v44, v44, v47, s[70:71]
    v_mfma_f32_16x16x32_bf16 a[20:23], v[32:35], v[60:63], 0
    ds_read_b64_tr_b16 a[140:141], v14 offset:28672
    ds_read_b64_tr_b16 a[142:143], v14 offset:29184
    v_mfma_f32_16x16x32_bf16 a[20:23], v[28:31], v[56:59], a[20:23]
    ds_bpermute_b32 v36, v53, v36
    v_cndmask_b32 v48, v48, v51, s[70:71]
    v_mfma_f32_16x16x32_bf16 a[20:23], a[164:167], a[252:255], a[20:23]
    ds_read_b64_tr_b16 a[144:145], v14 offset:36864
    ds_read_b64_tr_b16 a[146:147], v14 offset:37376
    v_mfma_f32_16x16x32_bf16 a[20:23], a[160:163], a[248:251], a[20:23]
    ds_bpermute_b32 v40, v53, v40
    ds_bpermute_b32 v44, v53, v44
    v_mfma_f32_16x16x32_bf16 a[20:23], a[156:159], a[244:247], a[20:23]
    ds_read_b64_tr_b16 a[148:149], v14 offset:45056
    ds_read_b64_tr_b16 a[150:151], v14 offset:45568
    v_mfma_f32_16x16x32_bf16 a[20:23], a[152:155], a[240:243], a[20:23]
    ds_bpermute_b32 v48, v53, v48
    s_waitcnt lgkmcnt(7)
    v_mul_f32 v36, 0x3ae38e39, v36
    v_mfma_f32_16x16x32_bf16 a[36:39], a[152:155], v[112:115], 0
    s_add_u32 m0, s63, 114688
    s_add_u32 s56, s56, 294912
    s_waitcnt lgkmcnt(4)
    v_mul_f32 v40, 0x3ae38e39, v40
    v_mfma_f32_16x16x32_bf16 a[36:39], a[156:159], v[116:119], a[36:39]
    buffer_load_dwordx4 v11, s[12:15], s56 offen nt lds
    s_waitcnt lgkmcnt(3)
    v_mul_f32 v44, 0x3ae38e39, v44
    v_mfma_f32_16x16x32_bf16 a[36:39], a[160:163], v[120:123], a[36:39]
    s_waitcnt lgkmcnt(0)
    v_mul_f32 v48, 0x3ae38e39, v48
    v_cvt_pk_bf16_f32 v36, v36, v36
    v_mfma_f32_16x16x32_bf16 a[36:39], a[164:167], v[124:127], a[36:39]
    v_cvt_pk_bf16_f32 v40, v40, v40
    v_cvt_pk_bf16_f32 v44, v44, v44
    v_mfma_f32_16x16x32_bf16 a[36:39], v[28:31], v[128:131], a[36:39]
    v_cvt_pk_bf16_f32 v48, v48, v48
    v_lshlrev_b32 v36, 16, v36
    v_mfma_f32_16x16x32_bf16 a[36:39], v[32:35], v[132:135], a[36:39]
    v_lshlrev_b32 v40, 16, v40
    v_lshlrev_b32 v44, 16, v44
    v_mfma_f32_16x16x32_bf16 a[52:55], v[32:35], v[204:207], 0
    v_lshlrev_b32 v48, 16, v48
    v_add_f32 v36, 0x3727c5ac, v36
    v_mfma_f32_16x16x32_bf16 a[52:55], v[28:31], v[200:203], a[52:55]
    v_add_f32 v40, 0x3727c5ac, v40
    v_add_f32 v44, 0x3727c5ac, v44
    v_mfma_f32_16x16x32_bf16 a[52:55], a[164:167], v[196:199], a[52:55]
    v_add_f32 v48, 0x3727c5ac, v48
    v_cvt_pk_bf16_f32 v36, v36, v36
    v_mfma_f32_16x16x32_bf16 a[52:55], a[160:163], v[192:195], a[52:55]
    buffer_load_dwordx4 v12, s[12:15], s56 offen offset:1024 nt lds
    v_cvt_pk_bf16_f32 v40, v40, v40
    v_mfma_f32_16x16x32_bf16 a[52:55], a[156:159], v[188:191], a[52:55]
    v_cvt_pk_bf16_f32 v44, v44, v44
    v_cvt_pk_bf16_f32 v48, v48, v48
    v_mfma_f32_16x16x32_bf16 a[52:55], a[152:155], v[184:187], a[52:55]
    s_waitcnt lgkmcnt(0)
    v_lshlrev_b32 v36, 16, v36
    v_lshlrev_b32 v40, 16, v40
    v_mfma_f32_16x16x32_bf16 a[8:11], a[128:131], a[168:171], 0
    ds_read_b64_tr_b16 a[152:153], v15 offset:4096
    ds_read_b64_tr_b16 a[154:155], v15 offset:4608
    v_mfma_f32_16x16x32_bf16 a[8:11], a[132:135], a[172:175], a[8:11]
    v_lshlrev_b32 v44, 16, v44
    v_lshlrev_b32 v48, 16, v48
    v_mfma_f32_16x16x32_bf16 a[8:11], a[136:139], a[176:179], a[8:11]
    ds_read_b64_tr_b16 a[156:157], v15 offset:12288
    ds_read_b64_tr_b16 a[158:159], v15 offset:12800
    v_mfma_f32_16x16x32_bf16 a[8:11], a[140:143], a[180:183], a[8:11]
    v_sqrt_f32 v36, v36
    v_mfma_f32_16x16x32_bf16 a[8:11], a[144:147], a[184:187], a[8:11]
    ds_read_b64_tr_b16 a[160:161], v15 offset:20480
    ds_read_b64_tr_b16 a[162:163], v15 offset:20992
    v_mfma_f32_16x16x32_bf16 a[8:11], a[148:151], a[188:191], a[8:11]
    v_sqrt_f32 v40, v40
    v_mfma_f32_16x16x32_bf16 a[24:27], a[148:151], v[60:63], 0
    ds_read_b64_tr_b16 a[164:165], v15 offset:28672
    ds_read_b64_tr_b16 a[166:167], v15 offset:29184
    v_mfma_f32_16x16x32_bf16 a[24:27], a[144:147], v[56:59], a[24:27]
    s_add_u32 m0, s63, 122880
    s_add_u32 s56, s56, 294912
    v_mfma_f32_16x16x32_bf16 a[24:27], a[140:143], a[252:255], a[24:27]
    ds_read_b64_tr_b16 v[28:29], v15 offset:36864
    ds_read_b64_tr_b16 v[30:31], v15 offset:37376
    v_mfma_f32_16x16x32_bf16 a[24:27], a[136:139], a[248:251], a[24:27]
    buffer_load_dwordx4 v11, s[12:15], s56 offen nt lds
    v_mfma_f32_16x16x32_bf16 a[24:27], a[132:135], a[244:247], a[24:27]
    ds_read_b64_tr_b16 v[32:33], v15 offset:45056
    ds_read_b64_tr_b16 v[34:35], v15 offset:45568
    v_mfma_f32_16x16x32_bf16 a[24:27], a[128:131], a[240:243], a[24:27]
    v_sqrt_f32 v44, v44
    v_mfma_f32_16x16x32_bf16 a[40:43], a[128:131], v[112:115], 0
    v_sqrt_f32 v48, v48
    v_mfma_f32_16x16x32_bf16 a[40:43], a[132:135], v[116:119], a[40:43]
    v_cvt_pk_bf16_f32 v36, v36, v36
    v_cvt_pk_bf16_f32 v40, v40, v40
    v_mfma_f32_16x16x32_bf16 a[40:43], a[136:139], v[120:123], a[40:43]
    v_cvt_pk_bf16_f32 v44, v44, v44
    v_cvt_pk_bf16_f32 v48, v48, v48
    v_mfma_f32_16x16x32_bf16 a[40:43], a[140:143], v[124:127], a[40:43]
    v_lshlrev_b32 v36, 16, v36
    v_lshlrev_b32 v40, 16, v40
    v_mfma_f32_16x16x32_bf16 a[40:43], a[144:147], v[128:131], a[40:43]
    buffer_load_dwordx4 v12, s[12:15], s56 offen offset:1024 nt lds
    v_lshlrev_b32 v44, 16, v44
    v_mfma_f32_16x16x32_bf16 a[40:43], a[148:151], v[132:135], a[40:43]
    v_lshlrev_b32 v48, 16, v48
    v_mfma_f32_16x16x32_bf16 a[56:59], a[148:151], v[204:207], 0
    v_rcp_f32 v37, v36
    v_mfma_f32_16x16x32_bf16 a[56:59], a[144:147], v[200:203], a[56:59]
    v_rcp_f32 v41, v40
    v_mfma_f32_16x16x32_bf16 a[56:59], a[140:143], v[196:199], a[56:59]
    v_rcp_f32 v45, v44
    v_mfma_f32_16x16x32_bf16 a[56:59], a[136:139], v[192:195], a[56:59]
    v_rcp_f32 v49, v48
    v_mfma_f32_16x16x32_bf16 a[56:59], a[132:135], v[188:191], a[56:59]
    v_mul_f32 v22, v36, v36
    v_mul_f32 v23, v40, v40
    v_mfma_f32_16x16x32_bf16 a[56:59], a[128:131], v[184:187], a[56:59]
    s_waitcnt lgkmcnt(0)
    v_mul_f32 v24, v44, v44
    v_mul_f32 v25, v48, v48
    v_mfma_f32_16x16x32_bf16 a[12:15], a[152:155], a[168:171], 0
    s_waitcnt vmcnt(8)
    v_mul_f32 v18, 0xbfb8aa3b, v37
    v_mul_f32 v19, 0xbfb8aa3b, v41
    v_mfma_f32_16x16x32_bf16 a[12:15], a[156:159], a[172:175], a[12:15]
    s_barrier
    s_add_u32 m0, s63, 131072
    v_add_u32 v14, 49152, v14
    v_mfma_f32_16x16x32_bf16 a[12:15], a[160:163], a[176:179], a[12:15]
    s_add_u32 s56, s56, 294912
    ds_read_b64_tr_b16 a[128:129], v14 offset:0
    ds_read_b64_tr_b16 a[130:131], v14 offset:512
    v_mfma_f32_16x16x32_bf16 a[12:15], a[164:167], a[180:183], a[12:15]
    buffer_load_dwordx4 v11, s[12:15], s56 offen nt lds
    v_mul_f32 v20, 0xbfb8aa3b, v45
    v_mfma_f32_16x16x32_bf16 a[12:15], v[28:31], a[184:187], a[12:15]
    ds_read_b64_tr_b16 a[132:133], v14 offset:8192
    ds_read_b64_tr_b16 a[134:135], v14 offset:8704
    v_mfma_f32_16x16x32_bf16 a[12:15], v[32:35], a[188:191], a[12:15]
    v_mul_f32 v21, 0xbfb8aa3b, v49
    v_and_b32 v52, 15, v1
    v_mfma_f32_16x16x32_bf16 a[28:31], v[32:35], v[60:63], 0
    ds_read_b64_tr_b16 a[136:137], v14 offset:16384
    ds_read_b64_tr_b16 a[138:139], v14 offset:16896
    v_mfma_f32_16x16x32_bf16 a[28:31], v[28:31], v[56:59], a[28:31]
    v_lshrrev_b32 v53, 4, v1
    v_add_u32 v54, 0, v53
    v_mfma_f32_16x16x32_bf16 a[28:31], a[164:167], a[252:255], a[28:31]
    ds_read_b64_tr_b16 a[140:141], v14 offset:24576
    ds_read_b64_tr_b16 a[142:143], v14 offset:25088
    v_mfma_f32_16x16x32_bf16 a[28:31], a[160:163], a[248:251], a[28:31]
    v_xor_b32 v54, v54, v52
    v_lshlrev_b32 v54, 4, v54
    v_mfma_f32_16x16x32_bf16 a[28:31], a[156:159], a[244:247], a[28:31]
    ds_read_b64_tr_b16 a[144:145], v14 offset:32768
    ds_read_b64_tr_b16 a[146:147], v14 offset:33280
    v_mfma_f32_16x16x32_bf16 a[28:31], a[152:155], a[240:243], a[28:31]
    buffer_load_dwordx4 v12, s[12:15], s56 offen offset:1024 nt lds
    v_lshl_add_u32 v4, v53, 8, v54
    v_mfma_f32_16x16x32_bf16 a[44:47], a[152:155], v[112:115], 0
    ds_read_b64_tr_b16 a[148:149], v14 offset:40960
    ds_read_b64_tr_b16 a[150:151], v14 offset:41472
    v_mfma_f32_16x16x32_bf16 a[44:47], a[156:159], v[116:119], a[44:47]
    v_add_u32 v54, 4, v53
    v_xor_b32 v54, v54, v52
    v_mfma_f32_16x16x32_bf16 a[44:47], a[160:163], v[120:123], a[44:47]
    v_lshlrev_b32 v54, 4, v54
    v_lshl_add_u32 v5, v53, 8, v54
    v_mfma_f32_16x16x32_bf16 a[44:47], a[164:167], v[124:127], a[44:47]
    v_add_u32 v54, 8, v53
    v_xor_b32 v54, v54, v52
    v_mfma_f32_16x16x32_bf16 a[44:47], v[28:31], v[128:131], a[44:47]
    v_lshlrev_b32 v54, 4, v54
    v_lshl_add_u32 v6, v53, 8, v54
    v_mfma_f32_16x16x32_bf16 a[44:47], v[32:35], v[132:135], a[44:47]
    v_add_u32 v54, 12, v53
    v_xor_b32 v54, v54, v52
    v_mfma_f32_16x16x32_bf16 a[60:63], v[32:35], v[204:207], 0
    v_lshlrev_b32 v54, 4, v54
    v_lshl_add_u32 v7, v53, 8, v54
    v_mfma_f32_16x16x32_bf16 a[60:63], v[28:31], v[200:203], a[60:63]
    s_add_u32 m0, s63, 139264
    s_add_u32 s56, s56, 294912
    v_add_u32 v54, 0, v53
    v_mfma_f32_16x16x32_bf16 a[60:63], a[164:167], v[196:199], a[60:63]
    buffer_load_dwordx4 v11, s[12:15], s56 offen nt lds
    v_lshlrev_b32 v54, 1, v54
    v_mfma_f32_16x16x32_bf16 a[60:63], a[160:163], v[192:195], a[60:63]
    v_xor_b32 v54, v54, v52
    v_lshlrev_b32 v54, 4, v54
    v_mfma_f32_16x16x32_bf16 a[60:63], a[156:159], v[188:191], a[60:63]
    v_lshl_add_u32 v8, v53, 8, v54
    v_add_u32 v54, 4, v53
    v_mfma_f32_16x16x32_bf16 a[60:63], a[152:155], v[184:187], a[60:63]
    s_waitcnt lgkmcnt(0)
    v_lshlrev_b32 v54, 1, v54
    v_xor_b32 v54, v54, v52
    v_mfma_f32_16x16x32_bf16 a[0:3], a[128:131], a[192:195], a[0:3]
    v_add_u32 v15, 49152, v15
    v_lshlrev_b32 v54, 4, v54
    v_mfma_f32_16x16x32_bf16 a[0:3], a[132:135], a[196:199], a[0:3]
    ds_read_b64_tr_b16 a[152:153], v15 offset:0
    ds_read_b64_tr_b16 a[154:155], v15 offset:512
    v_mfma_f32_16x16x32_bf16 a[0:3], a[136:139], a[200:203], a[0:3]
    v_lshl_add_u32 v9, v53, 8, v54
    v_mfma_f32_16x16x32_bf16 a[0:3], a[140:143], a[204:207], a[0:3]
    ds_read_b64_tr_b16 a[156:157], v15 offset:8192
    ds_read_b64_tr_b16 a[158:159], v15 offset:8704
    v_mfma_f32_16x16x32_bf16 a[0:3], a[144:147], a[208:211], a[0:3]
    buffer_load_dwordx4 v12, s[12:15], s56 offen offset:1024 nt lds
    v_mfma_f32_16x16x32_bf16 a[0:3], a[148:151], a[212:215], a[0:3]
    ds_read_b64_tr_b16 a[160:161], v15 offset:16384
    ds_read_b64_tr_b16 a[162:163], v15 offset:16896
    v_mfma_f32_16x16x32_bf16 a[16:19], a[148:151], v[84:87], a[16:19]
    v_mfma_f32_16x16x32_bf16 a[16:19], a[144:147], v[80:83], a[16:19]
    ds_read_b64_tr_b16 a[164:165], v15 offset:24576
    ds_read_b64_tr_b16 a[166:167], v15 offset:25088
    v_mfma_f32_16x16x32_bf16 a[16:19], a[140:143], v[76:79], a[16:19]
    v_mfma_f32_16x16x32_bf16 a[16:19], a[136:139], v[72:75], a[16:19]
    ds_read_b64_tr_b16 v[28:29], v15 offset:32768
    ds_read_b64_tr_b16 v[30:31], v15 offset:33280
    v_mfma_f32_16x16x32_bf16 a[16:19], a[132:135], v[68:71], a[16:19]
    v_mfma_f32_16x16x32_bf16 a[16:19], a[128:131], v[64:67], a[16:19]
    ds_read_b64_tr_b16 v[32:33], v15 offset:40960
    ds_read_b64_tr_b16 v[34:35], v15 offset:41472
    v_mfma_f32_16x16x32_bf16 a[32:35], a[128:131], v[136:139], a[32:35]
    v_mfma_f32_16x16x32_bf16 a[32:35], a[132:135], v[140:143], a[32:35]
    v_mfma_f32_16x16x32_bf16 a[32:35], a[136:139], v[144:147], a[32:35]
    v_mfma_f32_16x16x32_bf16 a[32:35], a[140:143], v[148:151], a[32:35]
    v_mfma_f32_16x16x32_bf16 a[32:35], a[144:147], v[152:155], a[32:35]
    v_mfma_f32_16x16x32_bf16 a[32:35], a[148:151], v[156:159], a[32:35]
    v_mfma_f32_16x16x32_bf16 a[48:51], a[148:151], v[228:231], a[48:51]
    v_mfma_f32_16x16x32_bf16 a[48:51], a[144:147], v[224:227], a[48:51]
    v_mfma_f32_16x16x32_bf16 a[48:51], a[140:143], v[220:223], a[48:51]
    v_mfma_f32_16x16x32_bf16 a[48:51], a[136:139], v[216:219], a[48:51]
    v_mfma_f32_16x16x32_bf16 a[48:51], a[132:135], v[212:215], a[48:51]
    v_mfma_f32_16x16x32_bf16 a[48:51], a[128:131], v[208:211], a[48:51]
    s_waitcnt lgkmcnt(0)
    v_mfma_f32_16x16x32_bf16 a[4:7], a[152:155], a[192:195], a[4:7]
    ds_read_b64_tr_b16 a[128:129], v14 offset:4096
    ds_read_b64_tr_b16 a[130:131], v14 offset:4608
    v_mfma_f32_16x16x32_bf16 a[4:7], a[156:159], a[196:199], a[4:7]
    v_mfma_f32_16x16x32_bf16 a[4:7], a[160:163], a[200:203], a[4:7]
    ds_read_b64_tr_b16 a[132:133], v14 offset:12288
    ds_read_b64_tr_b16 a[134:135], v14 offset:12800
    v_mfma_f32_16x16x32_bf16 a[4:7], a[164:167], a[204:207], a[4:7]
    v_mfma_f32_16x16x32_bf16 a[4:7], v[28:31], a[208:211], a[4:7]
    ds_read_b64_tr_b16 a[136:137], v14 offset:20480
    ds_read_b64_tr_b16 a[138:139], v14 offset:20992
    v_mfma_f32_16x16x32_bf16 a[4:7], v[32:35], a[212:215], a[4:7]
    v_mfma_f32_16x16x32_bf16 a[20:23], v[32:35], v[84:87], a[20:23]
    ds_read_b64_tr_b16 a[140:141], v14 offset:28672
    ds_read_b64_tr_b16 a[142:143], v14 offset:29184
    v_mfma_f32_16x16x32_bf16 a[20:23], v[28:31], v[80:83], a[20:23]
    v_mfma_f32_16x16x32_bf16 a[20:23], a[164:167], v[76:79], a[20:23]
    ds_read_b64_tr_b16 a[144:145], v14 offset:36864
    ds_read_b64_tr_b16 a[146:147], v14 offset:37376
    v_mfma_f32_16x16x32_bf16 a[20:23], a[160:163], v[72:75], a[20:23]
    v_mfma_f32_16x16x32_bf16 a[20:23], a[156:159], v[68:71], a[20:23]
    ds_read_b64_tr_b16 a[148:149], v14 offset:45056
    ds_read_b64_tr_b16 a[150:151], v14 offset:45568
    v_mfma_f32_16x16x32_bf16 a[20:23], a[152:155], v[64:67], a[20:23]
    v_mfma_f32_16x16x32_bf16 a[36:39], a[152:155], v[136:139], a[36:39]
    v_mfma_f32_16x16x32_bf16 a[36:39], a[156:159], v[140:143], a[36:39]
    v_mfma_f32_16x16x32_bf16 a[36:39], a[160:163], v[144:147], a[36:39]
    v_mfma_f32_16x16x32_bf16 a[36:39], a[164:167], v[148:151], a[36:39]
    v_mfma_f32_16x16x32_bf16 a[36:39], v[28:31], v[152:155], a[36:39]
    v_mfma_f32_16x16x32_bf16 a[36:39], v[32:35], v[156:159], a[36:39]
    v_mfma_f32_16x16x32_bf16 a[52:55], v[32:35], v[228:231], a[52:55]
    v_mfma_f32_16x16x32_bf16 a[52:55], v[28:31], v[224:227], a[52:55]
    v_mfma_f32_16x16x32_bf16 a[52:55], a[164:167], v[220:223], a[52:55]
    v_mfma_f32_16x16x32_bf16 a[52:55], a[160:163], v[216:219], a[52:55]
    v_mfma_f32_16x16x32_bf16 a[52:55], a[156:159], v[212:215], a[52:55]
    v_mfma_f32_16x16x32_bf16 a[52:55], a[152:155], v[208:211], a[52:55]
    s_waitcnt lgkmcnt(0)
    v_mfma_f32_16x16x32_bf16 a[8:11], a[128:131], a[192:195], a[8:11]
    ds_read_b64_tr_b16 a[152:153], v15 offset:4096
    ds_read_b64_tr_b16 a[154:155], v15 offset:4608
    v_mfma_f32_16x16x32_bf16 a[8:11], a[132:135], a[196:199], a[8:11]
    v_mfma_f32_16x16x32_bf16 a[8:11], a[136:139], a[200:203], a[8:11]
    ds_read_b64_tr_b16 a[156:157], v15 offset:12288
    ds_read_b64_tr_b16 a[158:159], v15 offset:12800
    v_mfma_f32_16x16x32_bf16 a[8:11], a[140:143], a[204:207], a[8:11]
    v_mfma_f32_16x16x32_bf16 a[8:11], a[144:147], a[208:211], a[8:11]
    ds_read_b64_tr_b16 a[160:161], v15 offset:20480
    ds_read_b64_tr_b16 a[162:163], v15 offset:20992
    v_mfma_f32_16x16x32_bf16 a[8:11], a[148:151], a[212:215], a[8:11]
    v_mfma_f32_16x16x32_bf16 a[24:27], a[148:151], v[84:87], a[24:27]
    ds_read_b64_tr_b16 a[164:165], v15 offset:28672
    ds_read_b64_tr_b16 a[166:167], v15 offset:29184
    v_mfma_f32_16x16x32_bf16 a[24:27], a[144:147], v[80:83], a[24:27]
    v_mfma_f32_16x16x32_bf16 a[24:27], a[140:143], v[76:79], a[24:27]
    ds_read_b64_tr_b16 v[28:29], v15 offset:36864
    ds_read_b64_tr_b16 v[30:31], v15 offset:37376
    v_mfma_f32_16x16x32_bf16 a[24:27], a[136:139], v[72:75], a[24:27]
    v_mfma_f32_16x16x32_bf16 a[24:27], a[132:135], v[68:71], a[24:27]
    ds_read_b64_tr_b16 v[32:33], v15 offset:45056
    ds_read_b64_tr_b16 v[34:35], v15 offset:45568
    v_mfma_f32_16x16x32_bf16 a[24:27], a[128:131], v[64:67], a[24:27]
    v_mfma_f32_16x16x32_bf16 a[40:43], a[128:131], v[136:139], a[40:43]
    v_mfma_f32_16x16x32_bf16 a[40:43], a[132:135], v[140:143], a[40:43]
    v_mfma_f32_16x16x32_bf16 a[40:43], a[136:139], v[144:147], a[40:43]
    v_mfma_f32_16x16x32_bf16 a[40:43], a[140:143], v[148:151], a[40:43]
    v_mfma_f32_16x16x32_bf16 a[40:43], a[144:147], v[152:155], a[40:43]
    v_mfma_f32_16x16x32_bf16 a[40:43], a[148:151], v[156:159], a[40:43]
    v_mfma_f32_16x16x32_bf16 a[56:59], a[148:151], v[228:231], a[56:59]
    v_mfma_f32_16x16x32_bf16 a[56:59], a[144:147], v[224:227], a[56:59]
    v_mfma_f32_16x16x32_bf16 a[56:59], a[140:143], v[220:223], a[56:59]
    v_mfma_f32_16x16x32_bf16 a[56:59], a[136:139], v[216:219], a[56:59]
    v_mfma_f32_16x16x32_bf16 a[56:59], a[132:135], v[212:215], a[56:59]
    v_mfma_f32_16x16x32_bf16 a[56:59], a[128:131], v[208:211], a[56:59]
    s_waitcnt lgkmcnt(0)
    v_mfma_f32_16x16x32_bf16 a[12:15], a[152:155], a[192:195], a[12:15]
    s_waitcnt vmcnt(0)
    v_mfma_f32_16x16x32_bf16 a[12:15], a[156:159], a[196:199], a[12:15]
    s_barrier
    v_add_u32 v14, 49152, v14
    v_mfma_f32_16x16x32_bf16 a[12:15], a[160:163], a[200:203], a[12:15]
    ds_read_b64_tr_b16 a[128:129], v14 offset:0
    ds_read_b64_tr_b16 a[130:131], v14 offset:512
    v_mfma_f32_16x16x32_bf16 a[12:15], a[164:167], a[204:207], a[12:15]
    v_mfma_f32_16x16x32_bf16 a[12:15], v[28:31], a[208:211], a[12:15]
    ds_read_b64_tr_b16 a[132:133], v14 offset:8192
    ds_read_b64_tr_b16 a[134:135], v14 offset:8704
    v_mfma_f32_16x16x32_bf16 a[12:15], v[32:35], a[212:215], a[12:15]
    v_mfma_f32_16x16x32_bf16 a[28:31], v[32:35], v[84:87], a[28:31]
    ds_read_b64_tr_b16 a[136:137], v14 offset:16384
    ds_read_b64_tr_b16 a[138:139], v14 offset:16896
    v_mfma_f32_16x16x32_bf16 a[28:31], v[28:31], v[80:83], a[28:31]
    v_mfma_f32_16x16x32_bf16 a[28:31], a[164:167], v[76:79], a[28:31]
    ds_read_b64_tr_b16 a[140:141], v14 offset:24576
    ds_read_b64_tr_b16 a[142:143], v14 offset:25088
    v_mfma_f32_16x16x32_bf16 a[28:31], a[160:163], v[72:75], a[28:31]
    v_mfma_f32_16x16x32_bf16 a[28:31], a[156:159], v[68:71], a[28:31]
    ds_read_b64_tr_b16 a[144:145], v14 offset:32768
    ds_read_b64_tr_b16 a[146:147], v14 offset:33280
    v_mfma_f32_16x16x32_bf16 a[28:31], a[152:155], v[64:67], a[28:31]
    v_mfma_f32_16x16x32_bf16 a[44:47], a[152:155], v[136:139], a[44:47]
    ds_read_b64_tr_b16 a[148:149], v14 offset:40960
    ds_read_b64_tr_b16 a[150:151], v14 offset:41472
    v_mfma_f32_16x16x32_bf16 a[44:47], a[156:159], v[140:143], a[44:47]
    v_mfma_f32_16x16x32_bf16 a[44:47], a[160:163], v[144:147], a[44:47]
    v_mfma_f32_16x16x32_bf16 a[44:47], a[164:167], v[148:151], a[44:47]
    v_mfma_f32_16x16x32_bf16 a[44:47], v[28:31], v[152:155], a[44:47]
    v_mfma_f32_16x16x32_bf16 a[44:47], v[32:35], v[156:159], a[44:47]
    v_mfma_f32_16x16x32_bf16 a[60:63], v[32:35], v[228:231], a[60:63]
    v_mfma_f32_16x16x32_bf16 a[60:63], v[28:31], v[224:227], a[60:63]
    v_mfma_f32_16x16x32_bf16 a[60:63], a[164:167], v[220:223], a[60:63]
    v_mfma_f32_16x16x32_bf16 a[60:63], a[160:163], v[216:219], a[60:63]
    v_mfma_f32_16x16x32_bf16 a[60:63], a[156:159], v[212:215], a[60:63]
    v_mfma_f32_16x16x32_bf16 a[60:63], a[152:155], v[208:211], a[60:63]
    s_waitcnt lgkmcnt(0)
    v_mfma_f32_16x16x32_bf16 a[0:3], a[128:131], a[216:219], a[0:3]
    v_add_u32 v15, 49152, v15
    v_mfma_f32_16x16x32_bf16 a[0:3], a[132:135], a[220:223], a[0:3]
    ds_read_b64_tr_b16 a[152:153], v15 offset:0
    ds_read_b64_tr_b16 a[154:155], v15 offset:512
    v_mfma_f32_16x16x32_bf16 a[0:3], a[136:139], a[224:227], a[0:3]
    v_mfma_f32_16x16x32_bf16 a[0:3], a[140:143], a[228:231], a[0:3]
    ds_read_b64_tr_b16 a[156:157], v15 offset:8192
    ds_read_b64_tr_b16 a[158:159], v15 offset:8704
    v_mfma_f32_16x16x32_bf16 a[0:3], a[144:147], a[232:235], a[0:3]
    v_mfma_f32_16x16x32_bf16 a[0:3], a[148:151], a[236:239], a[0:3]
    ds_read_b64_tr_b16 a[160:161], v15 offset:16384
    ds_read_b64_tr_b16 a[162:163], v15 offset:16896
    v_mfma_f32_16x16x32_bf16 a[16:19], a[148:151], v[108:111], a[16:19]
    v_mfma_f32_16x16x32_bf16 a[16:19], a[144:147], v[104:107], a[16:19]
    ds_read_b64_tr_b16 a[164:165], v15 offset:24576
    ds_read_b64_tr_b16 a[166:167], v15 offset:25088
    v_mfma_f32_16x16x32_bf16 a[16:19], a[140:143], v[100:103], a[16:19]
    v_mfma_f32_16x16x32_bf16 a[16:19], a[136:139], v[96:99], a[16:19]
    ds_read_b64_tr_b16 v[28:29], v15 offset:32768
    ds_read_b64_tr_b16 v[30:31], v15 offset:33280
    v_mfma_f32_16x16x32_bf16 a[16:19], a[132:135], v[92:95], a[16:19]
    v_mfma_f32_16x16x32_bf16 a[16:19], a[128:131], v[88:91], a[16:19]
    ds_read_b64_tr_b16 v[32:33], v15 offset:40960
    ds_read_b64_tr_b16 v[34:35], v15 offset:41472
    v_mfma_f32_16x16x32_bf16 a[32:35], a[128:131], v[160:163], a[32:35]
    v_mfma_f32_16x16x32_bf16 a[32:35], a[132:135], v[164:167], a[32:35]
    v_mfma_f32_16x16x32_bf16 a[32:35], a[136:139], v[168:171], a[32:35]
    v_mfma_f32_16x16x32_bf16 a[32:35], a[140:143], v[172:175], a[32:35]
    v_mfma_f32_16x16x32_bf16 a[32:35], a[144:147], v[176:179], a[32:35]
    v_mfma_f32_16x16x32_bf16 a[32:35], a[148:151], v[180:183], a[32:35]
    v_mfma_f32_16x16x32_bf16 a[48:51], a[148:151], v[252:255], a[48:51]
    v_mfma_f32_16x16x32_bf16 a[48:51], a[144:147], v[248:251], a[48:51]
    v_mfma_f32_16x16x32_bf16 a[48:51], a[140:143], v[244:247], a[48:51]
    v_mfma_f32_16x16x32_bf16 a[48:51], a[136:139], v[240:243], a[48:51]
    v_mfma_f32_16x16x32_bf16 a[48:51], a[132:135], v[236:239], a[48:51]
    v_mfma_f32_16x16x32_bf16 a[48:51], a[128:131], v[232:235], a[48:51]
    s_waitcnt lgkmcnt(0)
    v_mfma_f32_16x16x32_bf16 a[4:7], a[152:155], a[216:219], a[4:7]
    ds_read_b64_tr_b16 a[128:129], v14 offset:4096
    ds_read_b64_tr_b16 a[130:131], v14 offset:4608
    v_mfma_f32_16x16x32_bf16 a[4:7], a[156:159], a[220:223], a[4:7]
    v_mfma_f32_16x16x32_bf16 a[4:7], a[160:163], a[224:227], a[4:7]
    ds_read_b64_tr_b16 a[132:133], v14 offset:12288
    ds_read_b64_tr_b16 a[134:135], v14 offset:12800
    v_mfma_f32_16x16x32_bf16 a[4:7], a[164:167], a[228:231], a[4:7]
    v_mfma_f32_16x16x32_bf16 a[4:7], v[28:31], a[232:235], a[4:7]
    ds_read_b64_tr_b16 a[136:137], v14 offset:20480
    ds_read_b64_tr_b16 a[138:139], v14 offset:20992
    v_mfma_f32_16x16x32_bf16 a[4:7], v[32:35], a[236:239], a[4:7]
    v_mfma_f32_16x16x32_bf16 a[20:23], v[32:35], v[108:111], a[20:23]
    ds_read_b64_tr_b16 a[140:141], v14 offset:28672
    ds_read_b64_tr_b16 a[142:143], v14 offset:29184
    v_mfma_f32_16x16x32_bf16 a[20:23], v[28:31], v[104:107], a[20:23]
    v_mfma_f32_16x16x32_bf16 a[20:23], a[164:167], v[100:103], a[20:23]
    ds_read_b64_tr_b16 a[144:145], v14 offset:36864
    ds_read_b64_tr_b16 a[146:147], v14 offset:37376
    v_mfma_f32_16x16x32_bf16 a[20:23], a[160:163], v[96:99], a[20:23]
    v_mfma_f32_16x16x32_bf16 a[20:23], a[156:159], v[92:95], a[20:23]
    ds_read_b64_tr_b16 a[148:149], v14 offset:45056
    ds_read_b64_tr_b16 a[150:151], v14 offset:45568
    v_mfma_f32_16x16x32_bf16 a[20:23], a[152:155], v[88:91], a[20:23]
    v_mfma_f32_16x16x32_bf16 a[36:39], a[152:155], v[160:163], a[36:39]
    v_mfma_f32_16x16x32_bf16 a[36:39], a[156:159], v[164:167], a[36:39]
    v_mfma_f32_16x16x32_bf16 a[36:39], a[160:163], v[168:171], a[36:39]
    v_mfma_f32_16x16x32_bf16 a[36:39], a[164:167], v[172:175], a[36:39]
    v_mfma_f32_16x16x32_bf16 a[36:39], v[28:31], v[176:179], a[36:39]
    v_mfma_f32_16x16x32_bf16 a[36:39], v[32:35], v[180:183], a[36:39]
    v_mfma_f32_16x16x32_bf16 a[52:55], v[32:35], v[252:255], a[52:55]
    v_mfma_f32_16x16x32_bf16 a[52:55], v[28:31], v[248:251], a[52:55]
    v_mfma_f32_16x16x32_bf16 a[52:55], a[164:167], v[244:247], a[52:55]
    v_mfma_f32_16x16x32_bf16 a[52:55], a[160:163], v[240:243], a[52:55]
    v_mfma_f32_16x16x32_bf16 a[52:55], a[156:159], v[236:239], a[52:55]
    v_mfma_f32_16x16x32_bf16 a[52:55], a[152:155], v[232:235], a[52:55]
    s_waitcnt lgkmcnt(0)
    v_mfma_f32_16x16x32_bf16 a[8:11], a[128:131], a[216:219], a[8:11]
    ds_read_b64_tr_b16 a[152:153], v15 offset:4096
    ds_read_b64_tr_b16 a[154:155], v15 offset:4608
    v_mfma_f32_16x16x32_bf16 a[8:11], a[132:135], a[220:223], a[8:11]
    v_mfma_f32_16x16x32_bf16 a[8:11], a[136:139], a[224:227], a[8:11]
    ds_read_b64_tr_b16 a[156:157], v15 offset:12288
    ds_read_b64_tr_b16 a[158:159], v15 offset:12800
    v_mfma_f32_16x16x32_bf16 a[8:11], a[140:143], a[228:231], a[8:11]
    v_mfma_f32_16x16x32_bf16 a[8:11], a[144:147], a[232:235], a[8:11]
    ds_read_b64_tr_b16 a[160:161], v15 offset:20480
    ds_read_b64_tr_b16 a[162:163], v15 offset:20992
    v_mfma_f32_16x16x32_bf16 a[8:11], a[148:151], a[236:239], a[8:11]
    v_mfma_f32_16x16x32_bf16 a[24:27], a[148:151], v[108:111], a[24:27]
    ds_read_b64_tr_b16 a[164:165], v15 offset:28672
    ds_read_b64_tr_b16 a[166:167], v15 offset:29184
    v_mfma_f32_16x16x32_bf16 a[24:27], a[144:147], v[104:107], a[24:27]
    v_mfma_f32_16x16x32_bf16 a[24:27], a[140:143], v[100:103], a[24:27]
    ds_read_b64_tr_b16 v[28:29], v15 offset:36864
    ds_read_b64_tr_b16 v[30:31], v15 offset:37376
    v_mfma_f32_16x16x32_bf16 a[24:27], a[136:139], v[96:99], a[24:27]
    v_mfma_f32_16x16x32_bf16 a[24:27], a[132:135], v[92:95], a[24:27]
    ds_read_b64_tr_b16 v[32:33], v15 offset:45056
    ds_read_b64_tr_b16 v[34:35], v15 offset:45568
    v_mfma_f32_16x16x32_bf16 a[24:27], a[128:131], v[88:91], a[24:27]
    v_mfma_f32_16x16x32_bf16 a[40:43], a[128:131], v[160:163], a[40:43]
    v_mfma_f32_16x16x32_bf16 a[40:43], a[132:135], v[164:167], a[40:43]
    v_mfma_f32_16x16x32_bf16 a[40:43], a[136:139], v[168:171], a[40:43]
    v_mfma_f32_16x16x32_bf16 a[40:43], a[140:143], v[172:175], a[40:43]
    v_mfma_f32_16x16x32_bf16 a[40:43], a[144:147], v[176:179], a[40:43]
    v_mfma_f32_16x16x32_bf16 a[40:43], a[148:151], v[180:183], a[40:43]
    v_mfma_f32_16x16x32_bf16 a[56:59], a[148:151], v[252:255], a[56:59]
    v_mfma_f32_16x16x32_bf16 a[56:59], a[144:147], v[248:251], a[56:59]
    v_mfma_f32_16x16x32_bf16 a[56:59], a[140:143], v[244:247], a[56:59]
    v_mfma_f32_16x16x32_bf16 a[56:59], a[136:139], v[240:243], a[56:59]
    v_mfma_f32_16x16x32_bf16 a[56:59], a[132:135], v[236:239], a[56:59]
    v_mfma_f32_16x16x32_bf16 a[56:59], a[128:131], v[232:235], a[56:59]
    s_waitcnt lgkmcnt(0)
    v_mfma_f32_16x16x32_bf16 a[12:15], a[152:155], a[216:219], a[12:15]
    v_subrev_u32 v14, 98304, v14
    v_xor_b32 v14, 64, v14
    v_mfma_f32_16x16x32_bf16 a[12:15], a[156:159], a[220:223], a[12:15]
    ds_read_b64_tr_b16 a[128:129], v14 offset:0
    ds_read_b64_tr_b16 a[130:131], v14 offset:512
    v_mfma_f32_16x16x32_bf16 a[12:15], a[160:163], a[224:227], a[12:15]
    v_mfma_f32_16x16x32_bf16 a[12:15], a[164:167], a[228:231], a[12:15]
    ds_read_b64_tr_b16 a[132:133], v14 offset:8192
    ds_read_b64_tr_b16 a[134:135], v14 offset:8704
    v_mfma_f32_16x16x32_bf16 a[12:15], v[28:31], a[232:235], a[12:15]
    v_mfma_f32_16x16x32_bf16 a[12:15], v[32:35], a[236:239], a[12:15]
    ds_read_b64_tr_b16 a[136:137], v14 offset:16384
    ds_read_b64_tr_b16 a[138:139], v14 offset:16896
    v_mfma_f32_16x16x32_bf16 a[28:31], v[32:35], v[108:111], a[28:31]
    v_mfma_f32_16x16x32_bf16 a[28:31], v[28:31], v[104:107], a[28:31]
    ds_read_b64_tr_b16 a[140:141], v14 offset:24576
    ds_read_b64_tr_b16 a[142:143], v14 offset:25088
    v_mfma_f32_16x16x32_bf16 a[28:31], a[164:167], v[100:103], a[28:31]
    v_mfma_f32_16x16x32_bf16 a[28:31], a[160:163], v[96:99], a[28:31]
    ds_read_b64_tr_b16 a[144:145], v14 offset:32768
    ds_read_b64_tr_b16 a[146:147], v14 offset:33280
    v_mfma_f32_16x16x32_bf16 a[28:31], a[156:159], v[92:95], a[28:31]
    v_mfma_f32_16x16x32_bf16 a[28:31], a[152:155], v[88:91], a[28:31]
    ds_read_b64_tr_b16 a[148:149], v14 offset:40960
    ds_read_b64_tr_b16 a[150:151], v14 offset:41472
    v_mfma_f32_16x16x32_bf16 a[44:47], a[152:155], v[160:163], a[44:47]
    v_mfma_f32_16x16x32_bf16 a[44:47], a[156:159], v[164:167], a[44:47]
    v_mfma_f32_16x16x32_bf16 a[44:47], a[160:163], v[168:171], a[44:47]
    v_mfma_f32_16x16x32_bf16 a[44:47], a[164:167], v[172:175], a[44:47]
    v_mfma_f32_16x16x32_bf16 a[44:47], v[28:31], v[176:179], a[44:47]
    v_mfma_f32_16x16x32_bf16 a[44:47], v[32:35], v[180:183], a[44:47]
    v_mfma_f32_16x16x32_bf16 a[60:63], v[32:35], v[252:255], a[60:63]
    v_mfma_f32_16x16x32_bf16 a[60:63], v[28:31], v[248:251], a[60:63]
    v_mfma_f32_16x16x32_bf16 a[60:63], a[164:167], v[244:247], a[60:63]
    v_mfma_f32_16x16x32_bf16 a[60:63], a[160:163], v[240:243], a[60:63]
    v_mfma_f32_16x16x32_bf16 a[60:63], a[156:159], v[236:239], a[60:63]
    v_mfma_f32_16x16x32_bf16 a[60:63], a[152:155], v[232:235], a[60:63]
    s_waitcnt lgkmcnt(0)
    v_mfma_f32_16x16x32_bf16 a[64:67], a[128:131], a[168:171], 0
    v_subrev_u32 v15, 98304, v15
    v_xor_b32 v15, 64, v15
    v_mfma_f32_16x16x32_bf16 a[64:67], a[132:135], a[172:175], a[64:67]
    ds_read_b64_tr_b16 a[152:153], v15 offset:0
    ds_read_b64_tr_b16 a[154:155], v15 offset:512
    v_mfma_f32_16x16x32_bf16 a[64:67], a[136:139], a[176:179], a[64:67]
    v_mfma_f32_16x16x32_bf16 a[64:67], a[140:143], a[180:183], a[64:67]
    ds_read_b64_tr_b16 a[156:157], v15 offset:8192
    ds_read_b64_tr_b16 a[158:159], v15 offset:8704
    v_mfma_f32_16x16x32_bf16 a[64:67], a[144:147], a[184:187], a[64:67]
    v_accvgpr_read_b32 v36, a0
    v_accvgpr_read_b32 v37, a1
    v_mfma_f32_16x16x32_bf16 a[64:67], a[148:151], a[188:191], a[64:67]
    ds_read_b64_tr_b16 a[160:161], v15 offset:16384
    ds_read_b64_tr_b16 a[162:163], v15 offset:16896
    v_mfma_f32_16x16x32_bf16 a[80:83], a[148:151], v[60:63], 0
    v_accvgpr_read_b32 v38, a2
    v_accvgpr_read_b32 v39, a3
    v_mfma_f32_16x16x32_bf16 a[80:83], a[144:147], v[56:59], a[80:83]
    ds_read_b64_tr_b16 a[164:165], v15 offset:24576
    ds_read_b64_tr_b16 a[166:167], v15 offset:25088
    v_mfma_f32_16x16x32_bf16 a[80:83], a[140:143], a[252:255], a[80:83]
    v_accvgpr_read_b32 v40, a8
    v_accvgpr_read_b32 v41, a9
    v_mfma_f32_16x16x32_bf16 a[80:83], a[136:139], a[248:251], a[80:83]
    ds_read_b64_tr_b16 v[28:29], v15 offset:32768
    ds_read_b64_tr_b16 v[30:31], v15 offset:33280
    v_mfma_f32_16x16x32_bf16 a[80:83], a[132:135], a[244:247], a[80:83]
    v_accvgpr_read_b32 v42, a10
    v_accvgpr_read_b32 v43, a11
    v_mfma_f32_16x16x32_bf16 a[80:83], a[128:131], a[240:243], a[80:83]
    ds_read_b64_tr_b16 v[32:33], v15 offset:40960
    ds_read_b64_tr_b16 v[34:35], v15 offset:41472
    v_mfma_f32_16x16x32_bf16 a[96:99], a[128:131], v[112:115], 0
    v_mul_f32 v44, v18, v36
    v_mul_f32 v45, v18, v37
    v_mfma_f32_16x16x32_bf16 a[96:99], a[132:135], v[116:119], a[96:99]
    v_mul_f32 v46, v18, v38
    v_mul_f32 v47, v18, v39
    v_mfma_f32_16x16x32_bf16 a[96:99], a[136:139], v[120:123], a[96:99]
    v_exp_f32 v44, v44
    v_mfma_f32_16x16x32_bf16 a[96:99], a[140:143], v[124:127], a[96:99]
    v_exp_f32 v45, v45
    v_mfma_f32_16x16x32_bf16 a[96:99], a[144:147], v[128:131], a[96:99]
    v_exp_f32 v46, v46
    v_mfma_f32_16x16x32_bf16 a[96:99], a[148:151], v[132:135], a[96:99]
    v_exp_f32 v47, v47
    v_mfma_f32_16x16x32_bf16 a[112:115], a[148:151], v[204:207], 0
    v_mul_f32 v36, v36, v40
    v_mul_f32 v37, v37, v41
    v_mfma_f32_16x16x32_bf16 a[112:115], a[144:147], v[200:203], a[112:115]
    v_mul_f32 v38, v38, v42
    v_mul_f32 v39, v39, v43
    v_mfma_f32_16x16x32_bf16 a[112:115], a[140:143], v[196:199], a[112:115]
    v_fma_f32 v44, v44, v22, v22
    v_fma_f32 v45, v45, v22, v22
    v_mfma_f32_16x16x32_bf16 a[112:115], a[136:139], v[192:195], a[112:115]
    v_fma_f32 v46, v46, v22, v22
    v_fma_f32 v47, v47, v22, v22
    v_mfma_f32_16x16x32_bf16 a[112:115], a[132:135], v[188:191], a[112:115]
    v_rcp_f32 v44, v44
    v_mfma_f32_16x16x32_bf16 a[112:115], a[128:131], v[184:187], a[112:115]
    s_waitcnt lgkmcnt(0)
    v_rcp_f32 v45, v45
    v_mfma_f32_16x16x32_bf16 a[68:71], a[152:155], a[168:171], 0
    ds_read_b64_tr_b16 a[128:129], v14 offset:4096
    ds_read_b64_tr_b16 a[130:131], v14 offset:4608
    v_mfma_f32_16x16x32_bf16 a[68:71], a[156:159], a[172:175], a[68:71]
    v_rcp_f32 v46, v46
    v_mfma_f32_16x16x32_bf16 a[68:71], a[160:163], a[176:179], a[68:71]
    ds_read_b64_tr_b16 a[132:133], v14 offset:12288
    ds_read_b64_tr_b16 a[134:135], v14 offset:12800
    v_mfma_f32_16x16x32_bf16 a[68:71], a[164:167], a[180:183], a[68:71]
    v_rcp_f32 v47, v47
    v_mfma_f32_16x16x32_bf16 a[68:71], v[28:31], a[184:187], a[68:71]
    ds_read_b64_tr_b16 a[136:137], v14 offset:20480
    ds_read_b64_tr_b16 a[138:139], v14 offset:20992
    v_mfma_f32_16x16x32_bf16 a[68:71], v[32:35], a[188:191], a[68:71]
    v_mul_f32 v36, v36, v44
    v_mul_f32 v37, v37, v45
    v_mfma_f32_16x16x32_bf16 a[84:87], v[32:35], v[60:63], 0
    ds_read_b64_tr_b16 a[140:141], v14 offset:28672
    ds_read_b64_tr_b16 a[142:143], v14 offset:29184
    v_mfma_f32_16x16x32_bf16 a[84:87], v[28:31], v[56:59], a[84:87]
    v_mul_f32 v38, v38, v46
    v_mul_f32 v39, v39, v47
    v_mfma_f32_16x16x32_bf16 a[84:87], a[164:167], a[252:255], a[84:87]
    ds_read_b64_tr_b16 a[144:145], v14 offset:36864
    ds_read_b64_tr_b16 a[146:147], v14 offset:37376
    v_mfma_f32_16x16x32_bf16 a[84:87], a[160:163], a[248:251], a[84:87]
    v_cvt_pk_bf16_f32 v48, v36, v37
    v_cvt_pk_bf16_f32 v49, v38, v39
    v_mfma_f32_16x16x32_bf16 a[84:87], a[156:159], a[244:247], a[84:87]
    ds_read_b64_tr_b16 a[148:149], v14 offset:45056
    ds_read_b64_tr_b16 a[150:151], v14 offset:45568
    v_mfma_f32_16x16x32_bf16 a[84:87], a[152:155], a[240:243], a[84:87]
    v_accvgpr_read_b32 v36, a4
    v_accvgpr_read_b32 v37, a5
    v_mfma_f32_16x16x32_bf16 a[100:103], a[152:155], v[112:115], 0
    v_accvgpr_read_b32 v38, a6
    v_accvgpr_read_b32 v39, a7
    v_mfma_f32_16x16x32_bf16 a[100:103], a[156:159], v[116:119], a[100:103]
    v_accvgpr_read_b32 v40, a12
    v_accvgpr_read_b32 v41, a13
    v_mfma_f32_16x16x32_bf16 a[100:103], a[160:163], v[120:123], a[100:103]
    v_accvgpr_read_b32 v42, a14
    v_accvgpr_read_b32 v43, a15
    v_mfma_f32_16x16x32_bf16 a[100:103], a[164:167], v[124:127], a[100:103]
    v_mul_f32 v44, v18, v36
    v_mul_f32 v45, v18, v37
    v_mfma_f32_16x16x32_bf16 a[100:103], v[28:31], v[128:131], a[100:103]
    v_mul_f32 v46, v18, v38
    v_mul_f32 v47, v18, v39
    v_mfma_f32_16x16x32_bf16 a[100:103], v[32:35], v[132:135], a[100:103]
    v_exp_f32 v44, v44
    v_mfma_f32_16x16x32_bf16 a[116:119], v[32:35], v[204:207], 0
    v_exp_f32 v45, v45
    v_mfma_f32_16x16x32_bf16 a[116:119], v[28:31], v[200:203], a[116:119]
    v_exp_f32 v46, v46
    v_mfma_f32_16x16x32_bf16 a[116:119], a[164:167], v[196:199], a[116:119]
    v_exp_f32 v47, v47
    v_mfma_f32_16x16x32_bf16 a[116:119], a[160:163], v[192:195], a[116:119]
    v_mul_f32 v36, v36, v40
    v_mul_f32 v37, v37, v41
    v_mfma_f32_16x16x32_bf16 a[116:119], a[156:159], v[188:191], a[116:119]
    v_mul_f32 v38, v38, v42
    v_mul_f32 v39, v39, v43
    v_mfma_f32_16x16x32_bf16 a[116:119], a[152:155], v[184:187], a[116:119]
    s_waitcnt lgkmcnt(0)
    v_fma_f32 v44, v44, v22, v22
    v_fma_f32 v45, v45, v22, v22
    v_mfma_f32_16x16x32_bf16 a[72:75], a[128:131], a[168:171], 0
    ds_read_b64_tr_b16 a[152:153], v15 offset:4096
    ds_read_b64_tr_b16 a[154:155], v15 offset:4608
    v_mfma_f32_16x16x32_bf16 a[72:75], a[132:135], a[172:175], a[72:75]
    v_fma_f32 v46, v46, v22, v22
    v_fma_f32 v47, v47, v22, v22
    v_mfma_f32_16x16x32_bf16 a[72:75], a[136:139], a[176:179], a[72:75]
    ds_read_b64_tr_b16 a[156:157], v15 offset:12288
    ds_read_b64_tr_b16 a[158:159], v15 offset:12800
    v_mfma_f32_16x16x32_bf16 a[72:75], a[140:143], a[180:183], a[72:75]
    v_rcp_f32 v44, v44
    v_mfma_f32_16x16x32_bf16 a[72:75], a[144:147], a[184:187], a[72:75]
    ds_read_b64_tr_b16 a[160:161], v15 offset:20480
    ds_read_b64_tr_b16 a[162:163], v15 offset:20992
    v_mfma_f32_16x16x32_bf16 a[72:75], a[148:151], a[188:191], a[72:75]
    v_rcp_f32 v45, v45
    v_mfma_f32_16x16x32_bf16 a[88:91], a[148:151], v[60:63], 0
    ds_read_b64_tr_b16 a[164:165], v15 offset:28672
    ds_read_b64_tr_b16 a[166:167], v15 offset:29184
    v_mfma_f32_16x16x32_bf16 a[88:91], a[144:147], v[56:59], a[88:91]
    v_rcp_f32 v46, v46
    v_mfma_f32_16x16x32_bf16 a[88:91], a[140:143], a[252:255], a[88:91]
    ds_read_b64_tr_b16 v[28:29], v15 offset:36864
    ds_read_b64_tr_b16 v[30:31], v15 offset:37376
    v_mfma_f32_16x16x32_bf16 a[88:91], a[136:139], a[248:251], a[88:91]
    v_rcp_f32 v47, v47
    v_mfma_f32_16x16x32_bf16 a[88:91], a[132:135], a[244:247], a[88:91]
    ds_read_b64_tr_b16 v[32:33], v15 offset:45056
    ds_read_b64_tr_b16 v[34:35], v15 offset:45568
    v_mfma_f32_16x16x32_bf16 a[88:91], a[128:131], a[240:243], a[88:91]
    v_mul_f32 v36, v36, v44
    v_mul_f32 v37, v37, v45
    v_mfma_f32_16x16x32_bf16 a[104:107], a[128:131], v[112:115], 0
    v_mul_f32 v38, v38, v46
    v_mul_f32 v39, v39, v47
    v_mfma_f32_16x16x32_bf16 a[104:107], a[132:135], v[116:119], a[104:107]
    s_add_u32 s71, s3, 0
    v_cvt_pk_bf16_f32 v50, v36, v37
    v_cvt_pk_bf16_f32 v51, v38, v39
    v_mfma_f32_16x16x32_bf16 a[104:107], a[136:139], v[120:123], a[104:107]
    s_and_b32 s71, s71, 3
    s_mul_i32 s71, s71, 4096
    s_add_u32 s71, s71, s59
    v_mfma_f32_16x16x32_bf16 a[104:107], a[140:143], v[124:127], a[104:107]
    buffer_store_dwordx4 v[48:51], v2, s[28:31], s71 offen offset:0 sc1
    v_accvgpr_read_b32 v36, a16
    v_mfma_f32_16x16x32_bf16 a[104:107], a[144:147], v[128:131], a[104:107]
    v_accvgpr_read_b32 v37, a17
    v_accvgpr_read_b32 v38, a18
    v_mfma_f32_16x16x32_bf16 a[104:107], a[148:151], v[132:135], a[104:107]
    v_accvgpr_read_b32 v39, a19
    v_accvgpr_read_b32 v40, a24
    v_mfma_f32_16x16x32_bf16 a[120:123], a[148:151], v[204:207], 0
    v_accvgpr_read_b32 v41, a25
    v_accvgpr_read_b32 v42, a26
    v_mfma_f32_16x16x32_bf16 a[120:123], a[144:147], v[200:203], a[120:123]
    v_accvgpr_read_b32 v43, a27
    v_mul_f32 v44, v19, v36
    v_mfma_f32_16x16x32_bf16 a[120:123], a[140:143], v[196:199], a[120:123]
    v_mul_f32 v45, v19, v37
    v_mul_f32 v46, v19, v38
    v_mfma_f32_16x16x32_bf16 a[120:123], a[136:139], v[192:195], a[120:123]
    v_mul_f32 v47, v19, v39
    v_mfma_f32_16x16x32_bf16 a[120:123], a[132:135], v[188:191], a[120:123]
    v_exp_f32 v44, v44
    v_mfma_f32_16x16x32_bf16 a[120:123], a[128:131], v[184:187], a[120:123]
    s_waitcnt lgkmcnt(0)
    v_exp_f32 v45, v45
    v_mfma_f32_16x16x32_bf16 a[76:79], a[152:155], a[168:171], 0
    v_exp_f32 v46, v46
    v_mfma_f32_16x16x32_bf16 a[76:79], a[156:159], a[172:175], a[76:79]
    s_barrier
    v_add_u32 v14, 49152, v14
    v_mfma_f32_16x16x32_bf16 a[76:79], a[160:163], a[176:179], a[76:79]
    s_add_u32 m0, s63, 0
    ds_read_b64_tr_b16 a[128:129], v14 offset:0
    ds_read_b64_tr_b16 a[130:131], v14 offset:512
    v_mfma_f32_16x16x32_bf16 a[76:79], a[164:167], a[180:183], a[76:79]
    s_mul_i32 s56, s72, 1769472
    s_add_u32 s56, s56, s53
    s_add_u32 s56, s56, 128
    v_mfma_f32_16x16x32_bf16 a[76:79], v[28:31], a[184:187], a[76:79]
    ds_read_b64_tr_b16 a[132:133], v14 offset:8192
    ds_read_b64_tr_b16 a[134:135], v14 offset:8704
    v_mfma_f32_16x16x32_bf16 a[76:79], v[32:35], a[188:191], a[76:79]
    buffer_load_dwordx4 v11, s[12:15], s56 offen nt lds
    v_mfma_f32_16x16x32_bf16 a[92:95], v[32:35], v[60:63], 0
    ds_read_b64_tr_b16 a[136:137], v14 offset:16384
    ds_read_b64_tr_b16 a[138:139], v14 offset:16896
    v_mfma_f32_16x16x32_bf16 a[92:95], v[28:31], v[56:59], a[92:95]
    v_exp_f32 v47, v47
    v_mfma_f32_16x16x32_bf16 a[92:95], a[164:167], a[252:255], a[92:95]
    ds_read_b64_tr_b16 a[140:141], v14 offset:24576
    ds_read_b64_tr_b16 a[142:143], v14 offset:25088
    v_mfma_f32_16x16x32_bf16 a[92:95], a[160:163], a[248:251], a[92:95]
    v_mul_f32 v36, v36, v40
    v_mul_f32 v37, v37, v41
    v_mfma_f32_16x16x32_bf16 a[92:95], a[156:159], a[244:247], a[92:95]
    ds_read_b64_tr_b16 a[144:145], v14 offset:32768
    ds_read_b64_tr_b16 a[146:147], v14 offset:33280
    v_mfma_f32_16x16x32_bf16 a[92:95], a[152:155], a[240:243], a[92:95]
    buffer_load_dwordx4 v12, s[12:15], s56 offen offset:1024 nt lds
    v_mul_f32 v38, v38, v42
    v_mfma_f32_16x16x32_bf16 a[108:111], a[152:155], v[112:115], 0
    ds_read_b64_tr_b16 a[148:149], v14 offset:40960
    ds_read_b64_tr_b16 a[150:151], v14 offset:41472
    v_mfma_f32_16x16x32_bf16 a[108:111], a[156:159], v[116:119], a[108:111]
    v_mul_f32 v39, v39, v43
    v_fma_f32 v44, v44, v23, v23
    v_mfma_f32_16x16x32_bf16 a[108:111], a[160:163], v[120:123], a[108:111]
    v_fma_f32 v45, v45, v23, v23
    v_fma_f32 v46, v46, v23, v23
    v_mfma_f32_16x16x32_bf16 a[108:111], a[164:167], v[124:127], a[108:111]
    v_fma_f32 v47, v47, v23, v23
    v_mfma_f32_16x16x32_bf16 a[108:111], v[28:31], v[128:131], a[108:111]
    v_rcp_f32 v44, v44
    v_mfma_f32_16x16x32_bf16 a[108:111], v[32:35], v[132:135], a[108:111]
    v_rcp_f32 v45, v45
    v_mfma_f32_16x16x32_bf16 a[124:127], v[32:35], v[204:207], 0
    v_rcp_f32 v46, v46
    v_mfma_f32_16x16x32_bf16 a[124:127], v[28:31], v[200:203], a[124:127]
    v_rcp_f32 v47, v47
    v_mfma_f32_16x16x32_bf16 a[124:127], a[164:167], v[196:199], a[124:127]
    s_add_u32 m0, s63, 8192
    s_add_u32 s56, s56, 294912
    v_mul_f32 v36, v36, v44
    v_mfma_f32_16x16x32_bf16 a[124:127], a[160:163], v[192:195], a[124:127]
    buffer_load_dwordx4 v11, s[12:15], s56 offen nt lds
    v_mul_f32 v37, v37, v45
    v_mfma_f32_16x16x32_bf16 a[124:127], a[156:159], v[188:191], a[124:127]
    v_mul_f32 v38, v38, v46
    v_mul_f32 v39, v39, v47
    v_mfma_f32_16x16x32_bf16 a[124:127], a[152:155], v[184:187], a[124:127]
    s_waitcnt lgkmcnt(0)
    v_cvt_pk_bf16_f32 v52, v36, v37
    v_cvt_pk_bf16_f32 v53, v38, v39
    v_mfma_f32_16x16x32_bf16 a[64:67], a[128:131], a[192:195], a[64:67]
    v_add_u32 v15, 49152, v15
    v_accvgpr_read_b32 v36, a20
    v_mfma_f32_16x16x32_bf16 a[64:67], a[132:135], a[196:199], a[64:67]
    ds_read_b64_tr_b16 a[152:153], v15 offset:0
    ds_read_b64_tr_b16 a[154:155], v15 offset:512
    v_mfma_f32_16x16x32_bf16 a[64:67], a[136:139], a[200:203], a[64:67]
    v_accvgpr_read_b32 v37, a21
    v_accvgpr_read_b32 v38, a22
    v_mfma_f32_16x16x32_bf16 a[64:67], a[140:143], a[204:207], a[64:67]
    ds_read_b64_tr_b16 a[156:157], v15 offset:8192
    ds_read_b64_tr_b16 a[158:159], v15 offset:8704
    v_mfma_f32_16x16x32_bf16 a[64:67], a[144:147], a[208:211], a[64:67]
    v_accvgpr_read_b32 v39, a23
    v_accvgpr_read_b32 v40, a28
    v_mfma_f32_16x16x32_bf16 a[64:67], a[148:151], a[212:215], a[64:67]
    ds_read_b64_tr_b16 a[160:161], v15 offset:16384
    ds_read_b64_tr_b16 a[162:163], v15 offset:16896
    v_mfma_f32_16x16x32_bf16 a[80:83], a[148:151], v[84:87], a[80:83]
    buffer_load_dwordx4 v12, s[12:15], s56 offen offset:1024 nt lds
    v_accvgpr_read_b32 v41, a29
    v_mfma_f32_16x16x32_bf16 a[80:83], a[144:147], v[80:83], a[80:83]
    ds_read_b64_tr_b16 a[164:165], v15 offset:24576
    ds_read_b64_tr_b16 a[166:167], v15 offset:25088
    v_mfma_f32_16x16x32_bf16 a[80:83], a[140:143], v[76:79], a[80:83]
    v_accvgpr_read_b32 v42, a30
    v_accvgpr_read_b32 v43, a31
    v_mfma_f32_16x16x32_bf16 a[80:83], a[136:139], v[72:75], a[80:83]
    ds_read_b64_tr_b16 v[28:29], v15 offset:32768
    ds_read_b64_tr_b16 v[30:31], v15 offset:33280
    v_mfma_f32_16x16x32_bf16 a[80:83], a[132:135], v[68:71], a[80:83]
    v_mul_f32 v44, v19, v36
    v_mul_f32 v45, v19, v37
    v_mfma_f32_16x16x32_bf16 a[80:83], a[128:131], v[64:67], a[80:83]
    ds_read_b64_tr_b16 v[32:33], v15 offset:40960
    ds_read_b64_tr_b16 v[34:35], v15 offset:41472
    v_mfma_f32_16x16x32_bf16 a[96:99], a[128:131], v[136:139], a[96:99]
    v_mul_f32 v46, v19, v38
    v_mul_f32 v47, v19, v39
    v_mfma_f32_16x16x32_bf16 a[96:99], a[132:135], v[140:143], a[96:99]
    v_exp_f32 v44, v44
    v_mfma_f32_16x16x32_bf16 a[96:99], a[136:139], v[144:147], a[96:99]
    s_add_u32 m0, s63, 16384
    s_add_u32 s56, s56, 294912
    v_mfma_f32_16x16x32_bf16 a[96:99], a[140:143], v[148:151], a[96:99]
    buffer_load_dwordx4 v11, s[12:15], s56 offen nt lds
    v_mfma_f32_16x16x32_bf16 a[96:99], a[144:147], v[152:155], a[96:99]
    v_exp_f32 v45, v45
    v_mfma_f32_16x16x32_bf16 a[96:99], a[148:151], v[156:159], a[96:99]
    v_exp_f32 v46, v46
    v_mfma_f32_16x16x32_bf16 a[112:115], a[148:151], v[228:231], a[112:115]
    v_exp_f32 v47, v47
    v_mfma_f32_16x16x32_bf16 a[112:115], a[144:147], v[224:227], a[112:115]
    v_mul_f32 v36, v36, v40
    v_mul_f32 v37, v37, v41
    v_mfma_f32_16x16x32_bf16 a[112:115], a[140:143], v[220:223], a[112:115]
    v_mul_f32 v38, v38, v42
    v_mul_f32 v39, v39, v43
    v_mfma_f32_16x16x32_bf16 a[112:115], a[136:139], v[216:219], a[112:115]
    v_fma_f32 v44, v44, v23, v23
    v_fma_f32 v45, v45, v23, v23
    v_mfma_f32_16x16x32_bf16 a[112:115], a[132:135], v[212:215], a[112:115]
    v_fma_f32 v46, v46, v23, v23
    v_fma_f32 v47, v47, v23, v23
    v_mfma_f32_16x16x32_bf16 a[112:115], a[128:131], v[208:211], a[112:115]
    s_waitcnt lgkmcnt(0)
    buffer_load_dwordx4 v12, s[12:15], s56 offen offset:1024 nt lds
    v_mfma_f32_16x16x32_bf16 a[68:71], a[152:155], a[192:195], a[68:71]
    ds_read_b64_tr_b16 a[128:129], v14 offset:4096
    ds_read_b64_tr_b16 a[130:131], v14 offset:4608
    v_mfma_f32_16x16x32_bf16 a[68:71], a[156:159], a[196:199], a[68:71]
    v_rcp_f32 v44, v44
    v_mfma_f32_16x16x32_bf16 a[68:71], a[160:163], a[200:203], a[68:71]
    ds_read_b64_tr_b16 a[132:133], v14 offset:12288
    ds_read_b64_tr_b16 a[134:135], v14 offset:12800
    v_mfma_f32_16x16x32_bf16 a[68:71], a[164:167], a[204:207], a[68:71]
    v_rcp_f32 v45, v45
    v_mfma_f32_16x16x32_bf16 a[68:71], v[28:31], a[208:211], a[68:71]
    ds_read_b64_tr_b16 a[136:137], v14 offset:20480
    ds_read_b64_tr_b16 a[138:139], v14 offset:20992
    v_mfma_f32_16x16x32_bf16 a[68:71], v[32:35], a[212:215], a[68:71]
    v_rcp_f32 v46, v46
    v_mfma_f32_16x16x32_bf16 a[84:87], v[32:35], v[84:87], a[84:87]
    ds_read_b64_tr_b16 a[140:141], v14 offset:28672
    ds_read_b64_tr_b16 a[142:143], v14 offset:29184
    v_mfma_f32_16x16x32_bf16 a[84:87], v[28:31], v[80:83], a[84:87]
    v_rcp_f32 v47, v47
    v_mfma_f32_16x16x32_bf16 a[84:87], a[164:167], v[76:79], a[84:87]
    s_add_u32 m0, s63, 24576
    ds_read_b64_tr_b16 a[144:145], v14 offset:36864
    ds_read_b64_tr_b16 a[146:147], v14 offset:37376
    v_mfma_f32_16x16x32_bf16 a[84:87], a[160:163], v[72:75], a[84:87]
    s_add_u32 s56, s56, 294912
    v_mul_f32 v36, v36, v44
    v_mul_f32 v37, v37, v45
    v_mfma_f32_16x16x32_bf16 a[84:87], a[156:159], v[68:71], a[84:87]
    ds_read_b64_tr_b16 a[148:149], v14 offset:45056
    ds_read_b64_tr_b16 a[150:151], v14 offset:45568
    v_mfma_f32_16x16x32_bf16 a[84:87], a[152:155], v[64:67], a[84:87]
    buffer_load_dwordx4 v11, s[12:15], s56 offen nt lds
    v_mul_f32 v38, v38, v46
    v_mfma_f32_16x16x32_bf16 a[100:103], a[152:155], v[136:139], a[100:103]
    v_mul_f32 v39, v39, v47
    v_cvt_pk_bf16_f32 v54, v36, v37
    v_mfma_f32_16x16x32_bf16 a[100:103], a[156:159], v[140:143], a[100:103]
    s_add_u32 s71, s3, 1
    s_and_b32 s71, s71, 3
    v_cvt_pk_bf16_f32 v55, v38, v39
    v_mfma_f32_16x16x32_bf16 a[100:103], a[160:163], v[144:147], a[100:103]
    s_mul_i32 s71, s71, 4096
    s_add_u32 s71, s71, s59
    buffer_store_dwordx4 v[52:55], v2, s[28:31], s71 offen offset:0 sc1
    v_mfma_f32_16x16x32_bf16 a[100:103], a[164:167], v[148:151], a[100:103]
    v_accvgpr_read_b32 v36, a32
    v_accvgpr_read_b32 v37, a33
    v_mfma_f32_16x16x32_bf16 a[100:103], v[28:31], v[152:155], a[100:103]
    v_accvgpr_read_b32 v38, a34
    v_accvgpr_read_b32 v39, a35
    v_mfma_f32_16x16x32_bf16 a[100:103], v[32:35], v[156:159], a[100:103]
    buffer_load_dwordx4 v12, s[12:15], s56 offen offset:1024 nt lds
    v_accvgpr_read_b32 v40, a40
    v_mfma_f32_16x16x32_bf16 a[116:119], v[32:35], v[228:231], a[116:119]
    v_accvgpr_read_b32 v41, a41
    v_accvgpr_read_b32 v42, a42
    v_mfma_f32_16x16x32_bf16 a[116:119], v[28:31], v[224:227], a[116:119]
    v_accvgpr_read_b32 v43, a43
    v_mul_f32 v44, v20, v36
    v_mfma_f32_16x16x32_bf16 a[116:119], a[164:167], v[220:223], a[116:119]
    v_mul_f32 v45, v20, v37
    v_mul_f32 v46, v20, v38
    v_mfma_f32_16x16x32_bf16 a[116:119], a[160:163], v[216:219], a[116:119]
    v_mul_f32 v47, v20, v39
    v_mfma_f32_16x16x32_bf16 a[116:119], a[156:159], v[212:215], a[116:119]
    v_exp_f32 v44, v44
    v_mfma_f32_16x16x32_bf16 a[116:119], a[152:155], v[208:211], a[116:119]
    s_waitcnt lgkmcnt(0)
    v_exp_f32 v45, v45
    v_mfma_f32_16x16x32_bf16 a[72:75], a[128:131], a[192:195], a[72:75]
    ds_read_b64_tr_b16 a[152:153], v15 offset:4096
    ds_read_b64_tr_b16 a[154:155], v15 offset:4608
    v_mfma_f32_16x16x32_bf16 a[72:75], a[132:135], a[196:199], a[72:75]
    v_exp_f32 v46, v46
    v_mfma_f32_16x16x32_bf16 a[72:75], a[136:139], a[200:203], a[72:75]
    s_add_u32 m0, s63, 32768
    ds_read_b64_tr_b16 a[156:157], v15 offset:12288
    ds_read_b64_tr_b16 a[158:159], v15 offset:12800
    v_mfma_f32_16x16x32_bf16 a[72:75], a[140:143], a[204:207], a[72:75]
    s_add_u32 s56, s56, 294912
    v_exp_f32 v47, v47
    v_mfma_f32_16x16x32_bf16 a[72:75], a[144:147], a[208:211], a[72:75]
    ds_read_b64_tr_b16 a[160:161], v15 offset:20480
    ds_read_b64_tr_b16 a[162:163], v15 offset:20992
    v_mfma_f32_16x16x32_bf16 a[72:75], a[148:151], a[212:215], a[72:75]
    buffer_load_dwordx4 v11, s[12:15], s56 offen nt lds
    v_mul_f32 v36, v36, v40
    v_mfma_f32_16x16x32_bf16 a[88:91], a[148:151], v[84:87], a[88:91]
    ds_read_b64_tr_b16 a[164:165], v15 offset:28672
    ds_read_b64_tr_b16 a[166:167], v15 offset:29184
    v_mfma_f32_16x16x32_bf16 a[88:91], a[144:147], v[80:83], a[88:91]
    v_mul_f32 v37, v37, v41
    v_mul_f32 v38, v38, v42
    v_mfma_f32_16x16x32_bf16 a[88:91], a[140:143], v[76:79], a[88:91]
    ds_read_b64_tr_b16 v[28:29], v15 offset:36864
    ds_read_b64_tr_b16 v[30:31], v15 offset:37376
    v_mfma_f32_16x16x32_bf16 a[88:91], a[136:139], v[72:75], a[88:91]
    v_mul_f32 v39, v39, v43
    v_fma_f32 v44, v44, v24, v24
    v_mfma_f32_16x16x32_bf16 a[88:91], a[132:135], v[68:71], a[88:91]
    ds_read_b64_tr_b16 v[32:33], v15 offset:45056
    ds_read_b64_tr_b16 v[34:35], v15 offset:45568
    v_mfma_f32_16x16x32_bf16 a[88:91], a[128:131], v[64:67], a[88:91]
    buffer_load_dwordx4 v12, s[12:15], s56 offen offset:1024 nt lds
    v_fma_f32 v45, v45, v24, v24
    v_mfma_f32_16x16x32_bf16 a[104:107], a[128:131], v[136:139], a[104:107]
    v_fma_f32 v46, v46, v24, v24
    v_fma_f32 v47, v47, v24, v24
    v_mfma_f32_16x16x32_bf16 a[104:107], a[132:135], v[140:143], a[104:107]
    v_rcp_f32 v44, v44
    v_mfma_f32_16x16x32_bf16 a[104:107], a[136:139], v[144:147], a[104:107]
    v_rcp_f32 v45, v45
    v_mfma_f32_16x16x32_bf16 a[104:107], a[140:143], v[148:151], a[104:107]
    v_rcp_f32 v46, v46
    v_mfma_f32_16x16x32_bf16 a[104:107], a[144:147], v[152:155], a[104:107]
    v_rcp_f32 v47, v47
    v_mfma_f32_16x16x32_bf16 a[104:107], a[148:151], v[156:159], a[104:107]
    v_mul_f32 v36, v36, v44
    v_mul_f32 v37, v37, v45
    v_mfma_f32_16x16x32_bf16 a[120:123], a[148:151], v[228:231], a[120:123]
    v_mul_f32 v38, v38, v46
    v_mul_f32 v39, v39, v47
    v_mfma_f32_16x16x32_bf16 a[120:123], a[144:147], v[224:227], a[120:123]
    v_cvt_pk_bf16_f32 v48, v36, v37
    v_cvt_pk_bf16_f32 v49, v38, v39
    v_mfma_f32_16x16x32_bf16 a[120:123], a[140:143], v[220:223], a[120:123]
    s_add_u32 m0, s63, 40960
    s_add_u32 s56, s56, 294912
    v_accvgpr_read_b32 v36, a36
    v_mfma_f32_16x16x32_bf16 a[120:123], a[136:139], v[216:219], a[120:123]
    buffer_load_dwordx4 v11, s[12:15], s56 offen nt lds
    v_accvgpr_read_b32 v37, a37
    v_mfma_f32_16x16x32_bf16 a[120:123], a[132:135], v[212:215], a[120:123]
    v_accvgpr_read_b32 v38, a38
    v_accvgpr_read_b32 v39, a39
    v_mfma_f32_16x16x32_bf16 a[120:123], a[128:131], v[208:211], a[120:123]
    s_waitcnt lgkmcnt(0)
    v_accvgpr_read_b32 v40, a44
    v_accvgpr_read_b32 v41, a45
    v_mfma_f32_16x16x32_bf16 a[76:79], a[152:155], a[192:195], a[76:79]
    v_accvgpr_read_b32 v42, a46
    v_accvgpr_read_b32 v43, a47
    v_mfma_f32_16x16x32_bf16 a[76:79], a[156:159], a[196:199], a[76:79]
    s_barrier
    v_add_u32 v14, 49152, v14
    v_mul_f32 v44, v20, v36
    v_mfma_f32_16x16x32_bf16 a[76:79], a[160:163], a[200:203], a[76:79]
    ds_read_b64_tr_b16 a[128:129], v14 offset:0
    ds_read_b64_tr_b16 a[130:131], v14 offset:512
    v_mfma_f32_16x16x32_bf16 a[76:79], a[164:167], a[204:207], a[76:79]
    v_mul_f32 v45, v20, v37
    v_mul_f32 v46, v20, v38
    v_mfma_f32_16x16x32_bf16 a[76:79], v[28:31], a[208:211], a[76:79]
    ds_read_b64_tr_b16 a[132:133], v14 offset:8192
    ds_read_b64_tr_b16 a[134:135], v14 offset:8704
    v_mfma_f32_16x16x32_bf16 a[76:79], v[32:35], a[212:215], a[76:79]
    buffer_load_dwordx4 v12, s[12:15], s56 offen offset:1024 nt lds
    v_mul_f32 v47, v20, v39
    v_mfma_f32_16x16x32_bf16 a[92:95], v[32:35], v[84:87], a[92:95]
    s_add_u32 m0, s63, 49152
    ds_read_b64_tr_b16 a[136:137], v14 offset:16384
    ds_read_b64_tr_b16 a[138:139], v14 offset:16896
    v_mfma_f32_16x16x32_bf16 a[92:95], v[28:31], v[80:83], a[92:95]
    s_mul_i32 s56, s73, 1769472
    s_add_u32 s56, s56, s53
    s_add_u32 s56, s56, 128
    v_mfma_f32_16x16x32_bf16 a[92:95], a[164:167], v[76:79], a[92:95]
    ds_read_b64_tr_b16 a[140:141], v14 offset:24576
    ds_read_b64_tr_b16 a[142:143], v14 offset:25088
    v_mfma_f32_16x16x32_bf16 a[92:95], a[160:163], v[72:75], a[92:95]
    buffer_load_dwordx4 v11, s[12:15], s56 offen nt lds
    v_mfma_f32_16x16x32_bf16 a[92:95], a[156:159], v[68:71], a[92:95]
    ds_read_b64_tr_b16 a[144:145], v14 offset:32768
    ds_read_b64_tr_b16 a[146:147], v14 offset:33280
    v_mfma_f32_16x16x32_bf16 a[92:95], a[152:155], v[64:67], a[92:95]
    buffer_load_dwordx4 v12, s[12:15], s56 offen offset:1024 nt lds
    v_mfma_f32_16x16x32_bf16 a[108:111], a[152:155], v[136:139], a[108:111]
    ds_read_b64_tr_b16 a[148:149], v14 offset:40960
    ds_read_b64_tr_b16 a[150:151], v14 offset:41472
    v_mfma_f32_16x16x32_bf16 a[108:111], a[156:159], v[140:143], a[108:111]
    v_exp_f32 v44, v44
    v_mfma_f32_16x16x32_bf16 a[108:111], a[160:163], v[144:147], a[108:111]
    v_exp_f32 v45, v45
    v_mfma_f32_16x16x32_bf16 a[108:111], a[164:167], v[148:151], a[108:111]
    v_exp_f32 v46, v46
    v_mfma_f32_16x16x32_bf16 a[108:111], v[28:31], v[152:155], a[108:111]
    v_exp_f32 v47, v47
    v_mfma_f32_16x16x32_bf16 a[108:111], v[32:35], v[156:159], a[108:111]
    v_mul_f32 v36, v36, v40
    v_mul_f32 v37, v37, v41
    v_mfma_f32_16x16x32_bf16 a[124:127], v[32:35], v[228:231], a[124:127]
    v_mul_f32 v38, v38, v42
    v_mul_f32 v39, v39, v43
    v_mfma_f32_16x16x32_bf16 a[124:127], v[28:31], v[224:227], a[124:127]
    v_fma_f32 v44, v44, v24, v24
    v_fma_f32 v45, v45, v24, v24
    v_mfma_f32_16x16x32_bf16 a[124:127], a[164:167], v[220:223], a[124:127]
    s_add_u32 m0, s63, 57344
    s_add_u32 s56, s56, 294912
    v_fma_f32 v46, v46, v24, v24
    v_mfma_f32_16x16x32_bf16 a[124:127], a[160:163], v[216:219], a[124:127]
    buffer_load_dwordx4 v11, s[12:15], s56 offen nt lds
    v_fma_f32 v47, v47, v24, v24
    v_mfma_f32_16x16x32_bf16 a[124:127], a[156:159], v[212:215], a[124:127]
    v_rcp_f32 v44, v44
    v_mfma_f32_16x16x32_bf16 a[124:127], a[152:155], v[208:211], a[124:127]
    s_waitcnt lgkmcnt(0)
    v_rcp_f32 v45, v45
    v_mfma_f32_16x16x32_bf16 a[64:67], a[128:131], a[216:219], a[64:67]
    v_add_u32 v15, 49152, v15
    v_mfma_f32_16x16x32_bf16 a[64:67], a[132:135], a[220:223], a[64:67]
    ds_read_b64_tr_b16 a[152:153], v15 offset:0
    ds_read_b64_tr_b16 a[154:155], v15 offset:512
    v_mfma_f32_16x16x32_bf16 a[64:67], a[136:139], a[224:227], a[64:67]
    v_rcp_f32 v46, v46
    v_mfma_f32_16x16x32_bf16 a[64:67], a[140:143], a[228:231], a[64:67]
    ds_read_b64_tr_b16 a[156:157], v15 offset:8192
    ds_read_b64_tr_b16 a[158:159], v15 offset:8704
    v_mfma_f32_16x16x32_bf16 a[64:67], a[144:147], a[232:235], a[64:67]
    v_rcp_f32 v47, v47
    v_mfma_f32_16x16x32_bf16 a[64:67], a[148:151], a[236:239], a[64:67]
    ds_read_b64_tr_b16 a[160:161], v15 offset:16384
    ds_read_b64_tr_b16 a[162:163], v15 offset:16896
    v_mfma_f32_16x16x32_bf16 a[80:83], a[148:151], v[108:111], a[80:83]
    buffer_load_dwordx4 v12, s[12:15], s56 offen offset:1024 nt lds
    v_mul_f32 v36, v36, v44
    v_mfma_f32_16x16x32_bf16 a[80:83], a[144:147], v[104:107], a[80:83]
    ds_read_b64_tr_b16 a[164:165], v15 offset:24576
    ds_read_b64_tr_b16 a[166:167], v15 offset:25088
    v_mfma_f32_16x16x32_bf16 a[80:83], a[140:143], v[100:103], a[80:83]
    v_mul_f32 v37, v37, v45
    v_mul_f32 v38, v38, v46
    v_mfma_f32_16x16x32_bf16 a[80:83], a[136:139], v[96:99], a[80:83]
    ds_read_b64_tr_b16 v[28:29], v15 offset:32768
    ds_read_b64_tr_b16 v[30:31], v15 offset:33280
    v_mfma_f32_16x16x32_bf16 a[80:83], a[132:135], v[92:95], a[80:83]
    v_mul_f32 v39, v39, v47
    v_cvt_pk_bf16_f32 v50, v36, v37
    v_mfma_f32_16x16x32_bf16 a[80:83], a[128:131], v[88:91], a[80:83]
    ds_read_b64_tr_b16 v[32:33], v15 offset:40960
    ds_read_b64_tr_b16 v[34:35], v15 offset:41472
    v_mfma_f32_16x16x32_bf16 a[96:99], a[128:131], v[160:163], a[96:99]
    s_add_u32 s71, s3, 2
    s_and_b32 s71, s71, 3
    v_cvt_pk_bf16_f32 v51, v38, v39
    v_mfma_f32_16x16x32_bf16 a[96:99], a[132:135], v[164:167], a[96:99]
    s_mul_i32 s71, s71, 4096
    s_add_u32 s71, s71, s59
    buffer_store_dwordx4 v[48:51], v2, s[28:31], s71 offen offset:0 sc1
    v_mfma_f32_16x16x32_bf16 a[96:99], a[136:139], v[168:171], a[96:99]
    s_add_u32 m0, s63, 65536
    s_add_u32 s56, s56, 294912
    v_accvgpr_read_b32 v36, a48
    v_mfma_f32_16x16x32_bf16 a[96:99], a[140:143], v[172:175], a[96:99]
    buffer_load_dwordx4 v11, s[12:15], s56 offen nt lds
    v_accvgpr_read_b32 v37, a49
    v_mfma_f32_16x16x32_bf16 a[96:99], a[144:147], v[176:179], a[96:99]
    v_accvgpr_read_b32 v38, a50
    v_accvgpr_read_b32 v39, a51
    v_mfma_f32_16x16x32_bf16 a[96:99], a[148:151], v[180:183], a[96:99]
    v_accvgpr_read_b32 v40, a56
    v_accvgpr_read_b32 v41, a57
    v_mfma_f32_16x16x32_bf16 a[112:115], a[148:151], v[252:255], a[112:115]
    v_accvgpr_read_b32 v42, a58
    v_accvgpr_read_b32 v43, a59
    v_mfma_f32_16x16x32_bf16 a[112:115], a[144:147], v[248:251], a[112:115]
    v_mul_f32 v44, v21, v36
    v_mul_f32 v45, v21, v37
    v_mfma_f32_16x16x32_bf16 a[112:115], a[140:143], v[244:247], a[112:115]
    v_mul_f32 v46, v21, v38
    v_mul_f32 v47, v21, v39
    v_mfma_f32_16x16x32_bf16 a[112:115], a[136:139], v[240:243], a[112:115]
    v_exp_f32 v44, v44
    v_mfma_f32_16x16x32_bf16 a[112:115], a[132:135], v[236:239], a[112:115]
    v_exp_f32 v45, v45
    v_mfma_f32_16x16x32_bf16 a[112:115], a[128:131], v[232:235], a[112:115]
    s_waitcnt lgkmcnt(0)
    buffer_load_dwordx4 v12, s[12:15], s56 offen offset:1024 nt lds
    v_mfma_f32_16x16x32_bf16 a[68:71], a[152:155], a[216:219], a[68:71]
    ds_read_b64_tr_b16 a[128:129], v14 offset:4096
    ds_read_b64_tr_b16 a[130:131], v14 offset:4608
    v_mfma_f32_16x16x32_bf16 a[68:71], a[156:159], a[220:223], a[68:71]
    v_exp_f32 v46, v46
    v_mfma_f32_16x16x32_bf16 a[68:71], a[160:163], a[224:227], a[68:71]
    ds_read_b64_tr_b16 a[132:133], v14 offset:12288
    ds_read_b64_tr_b16 a[134:135], v14 offset:12800
    v_mfma_f32_16x16x32_bf16 a[68:71], a[164:167], a[228:231], a[68:71]
    v_exp_f32 v47, v47
    v_mfma_f32_16x16x32_bf16 a[68:71], v[28:31], a[232:235], a[68:71]
    ds_read_b64_tr_b16 a[136:137], v14 offset:20480
    ds_read_b64_tr_b16 a[138:139], v14 offset:20992
    v_mfma_f32_16x16x32_bf16 a[68:71], v[32:35], a[236:239], a[68:71]
    v_mul_f32 v36, v36, v40
    v_mul_f32 v37, v37, v41
    v_mfma_f32_16x16x32_bf16 a[84:87], v[32:35], v[108:111], a[84:87]
    ds_read_b64_tr_b16 a[140:141], v14 offset:28672
    ds_read_b64_tr_b16 a[142:143], v14 offset:29184
    v_mfma_f32_16x16x32_bf16 a[84:87], v[28:31], v[104:107], a[84:87]
    v_mul_f32 v38, v38, v42
    v_mul_f32 v39, v39, v43
    v_mfma_f32_16x16x32_bf16 a[84:87], a[164:167], v[100:103], a[84:87]
    s_add_u32 m0, s63, 73728
    ds_read_b64_tr_b16 a[144:145], v14 offset:36864
    ds_read_b64_tr_b16 a[146:147], v14 offset:37376
    v_mfma_f32_16x16x32_bf16 a[84:87], a[160:163], v[96:99], a[84:87]
    s_add_u32 s56, s56, 294912
    v_fma_f32 v44, v44, v25, v25
    v_fma_f32 v45, v45, v25, v25
    v_mfma_f32_16x16x32_bf16 a[84:87], a[156:159], v[92:95], a[84:87]
    ds_read_b64_tr_b16 a[148:149], v14 offset:45056
    ds_read_b64_tr_b16 a[150:151], v14 offset:45568
    v_mfma_f32_16x16x32_bf16 a[84:87], a[152:155], v[88:91], a[84:87]
    buffer_load_dwordx4 v11, s[12:15], s56 offen nt lds
    v_fma_f32 v46, v46, v25, v25
    v_mfma_f32_16x16x32_bf16 a[100:103], a[152:155], v[160:163], a[100:103]
    v_fma_f32 v47, v47, v25, v25
    v_mfma_f32_16x16x32_bf16 a[100:103], a[156:159], v[164:167], a[100:103]
    v_rcp_f32 v44, v44
    v_mfma_f32_16x16x32_bf16 a[100:103], a[160:163], v[168:171], a[100:103]
    v_rcp_f32 v45, v45
    v_mfma_f32_16x16x32_bf16 a[100:103], a[164:167], v[172:175], a[100:103]
    v_rcp_f32 v46, v46
    v_mfma_f32_16x16x32_bf16 a[100:103], v[28:31], v[176:179], a[100:103]
    v_rcp_f32 v47, v47
    v_mfma_f32_16x16x32_bf16 a[100:103], v[32:35], v[180:183], a[100:103]
    buffer_load_dwordx4 v12, s[12:15], s56 offen offset:1024 nt lds
    v_mul_f32 v36, v36, v44
    v_mfma_f32_16x16x32_bf16 a[116:119], v[32:35], v[252:255], a[116:119]
    v_mul_f32 v37, v37, v45
    v_mul_f32 v38, v38, v46
    v_mfma_f32_16x16x32_bf16 a[116:119], v[28:31], v[248:251], a[116:119]
    v_mul_f32 v39, v39, v47
    v_cvt_pk_bf16_f32 v52, v36, v37
    v_mfma_f32_16x16x32_bf16 a[116:119], a[164:167], v[244:247], a[116:119]
    v_cvt_pk_bf16_f32 v53, v38, v39
    v_accvgpr_read_b32 v36, a52
    v_mfma_f32_16x16x32_bf16 a[116:119], a[160:163], v[240:243], a[116:119]
    v_accvgpr_read_b32 v37, a53
    v_accvgpr_read_b32 v38, a54
    v_mfma_f32_16x16x32_bf16 a[116:119], a[156:159], v[236:239], a[116:119]
    v_accvgpr_read_b32 v39, a55
    v_accvgpr_read_b32 v40, a60
    v_mfma_f32_16x16x32_bf16 a[116:119], a[152:155], v[232:235], a[116:119]
    s_waitcnt lgkmcnt(0)
    v_accvgpr_read_b32 v41, a61
    v_accvgpr_read_b32 v42, a62
    v_mfma_f32_16x16x32_bf16 a[72:75], a[128:131], a[216:219], a[72:75]
    ds_read_b64_tr_b16 a[152:153], v15 offset:4096
    ds_read_b64_tr_b16 a[154:155], v15 offset:4608
    v_mfma_f32_16x16x32_bf16 a[72:75], a[132:135], a[220:223], a[72:75]
    v_accvgpr_read_b32 v43, a63
    v_mul_f32 v44, v21, v36
    v_mfma_f32_16x16x32_bf16 a[72:75], a[136:139], a[224:227], a[72:75]
    s_add_u32 m0, s63, 81920
    ds_read_b64_tr_b16 a[156:157], v15 offset:12288
    ds_read_b64_tr_b16 a[158:159], v15 offset:12800
    v_mfma_f32_16x16x32_bf16 a[72:75], a[140:143], a[228:231], a[72:75]
    s_add_u32 s56, s56, 294912
    v_mul_f32 v45, v21, v37
    v_mul_f32 v46, v21, v38
    v_mfma_f32_16x16x32_bf16 a[72:75], a[144:147], a[232:235], a[72:75]
    ds_read_b64_tr_b16 a[160:161], v15 offset:20480
    ds_read_b64_tr_b16 a[162:163], v15 offset:20992
    v_mfma_f32_16x16x32_bf16 a[72:75], a[148:151], a[236:239], a[72:75]
    buffer_load_dwordx4 v11, s[12:15], s56 offen nt lds
    v_mul_f32 v47, v21, v39
    v_mfma_f32_16x16x32_bf16 a[88:91], a[148:151], v[108:111], a[88:91]
    ds_read_b64_tr_b16 a[164:165], v15 offset:28672
    ds_read_b64_tr_b16 a[166:167], v15 offset:29184
    v_mfma_f32_16x16x32_bf16 a[88:91], a[144:147], v[104:107], a[88:91]
    v_exp_f32 v44, v44
    v_mfma_f32_16x16x32_bf16 a[88:91], a[140:143], v[100:103], a[88:91]
    ds_read_b64_tr_b16 v[28:29], v15 offset:36864
    ds_read_b64_tr_b16 v[30:31], v15 offset:37376
    v_mfma_f32_16x16x32_bf16 a[88:91], a[136:139], v[96:99], a[88:91]
    v_exp_f32 v45, v45
    v_mfma_f32_16x16x32_bf16 a[88:91], a[132:135], v[92:95], a[88:91]
    ds_read_b64_tr_b16 v[32:33], v15 offset:45056
    ds_read_b64_tr_b16 v[34:35], v15 offset:45568
    v_mfma_f32_16x16x32_bf16 a[88:91], a[128:131], v[88:91], a[88:91]
    buffer_load_dwordx4 v12, s[12:15], s56 offen offset:1024 nt lds
    v_mfma_f32_16x16x32_bf16 a[104:107], a[128:131], v[160:163], a[104:107]
    v_exp_f32 v46, v46
    v_mfma_f32_16x16x32_bf16 a[104:107], a[132:135], v[164:167], a[104:107]
    v_exp_f32 v47, v47
    v_mfma_f32_16x16x32_bf16 a[104:107], a[136:139], v[168:171], a[104:107]
    v_mul_f32 v36, v36, v40
    v_mul_f32 v37, v37, v41
    v_mfma_f32_16x16x32_bf16 a[104:107], a[140:143], v[172:175], a[104:107]
    v_mul_f32 v38, v38, v42
    v_mul_f32 v39, v39, v43
    v_mfma_f32_16x16x32_bf16 a[104:107], a[144:147], v[176:179], a[104:107]
    v_fma_f32 v44, v44, v25, v25
    v_fma_f32 v45, v45, v25, v25
    v_mfma_f32_16x16x32_bf16 a[104:107], a[148:151], v[180:183], a[104:107]
    v_fma_f32 v46, v46, v25, v25
    v_fma_f32 v47, v47, v25, v25
    v_mfma_f32_16x16x32_bf16 a[120:123], a[148:151], v[252:255], a[120:123]
    v_rcp_f32 v44, v44
    v_mfma_f32_16x16x32_bf16 a[120:123], a[144:147], v[248:251], a[120:123]
    v_rcp_f32 v45, v45
    v_mfma_f32_16x16x32_bf16 a[120:123], a[140:143], v[244:247], a[120:123]
    s_add_u32 m0, s63, 90112
    s_add_u32 s56, s56, 294912
    v_mfma_f32_16x16x32_bf16 a[120:123], a[136:139], v[240:243], a[120:123]
    buffer_load_dwordx4 v11, s[12:15], s56 offen nt lds
    v_mfma_f32_16x16x32_bf16 a[120:123], a[132:135], v[236:239], a[120:123]
    v_rcp_f32 v46, v46
    v_mfma_f32_16x16x32_bf16 a[120:123], a[128:131], v[232:235], a[120:123]
    s_waitcnt lgkmcnt(0)
    v_rcp_f32 v47, v47
    v_mfma_f32_16x16x32_bf16 a[76:79], a[152:155], a[216:219], a[76:79]
    s_waitcnt vmcnt(12)
    v_mul_f32 v36, v36, v44
    v_mul_f32 v37, v37, v45
    v_mfma_f32_16x16x32_bf16 a[76:79], a[156:159], a[220:223], a[76:79]
    s_barrier
    v_subrev_u32 v14, 98304, v14
    v_xor_b32 v14, 64, v14
    v_mfma_f32_16x16x32_bf16 a[76:79], a[160:163], a[224:227], a[76:79]
    ds_read_b64_tr_b16 a[128:129], v14 offset:0
    ds_read_b64_tr_b16 a[130:131], v14 offset:512
    v_mfma_f32_16x16x32_bf16 a[76:79], a[164:167], a[228:231], a[76:79]
    v_mul_f32 v38, v38, v46
    v_mul_f32 v39, v39, v47
    v_mfma_f32_16x16x32_bf16 a[76:79], v[28:31], a[232:235], a[76:79]
    ds_read_b64_tr_b16 a[132:133], v14 offset:8192
    ds_read_b64_tr_b16 a[134:135], v14 offset:8704
    v_mfma_f32_16x16x32_bf16 a[76:79], v[32:35], a[236:239], a[76:79]
    buffer_load_dwordx4 v12, s[12:15], s56 offen offset:1024 nt lds
    v_cvt_pk_bf16_f32 v54, v36, v37
    v_mfma_f32_16x16x32_bf16 a[92:95], v[32:35], v[108:111], a[92:95]
    s_add_u32 m0, s63, 98304
    ds_read_b64_tr_b16 a[136:137], v14 offset:16384
    ds_read_b64_tr_b16 a[138:139], v14 offset:16896
    v_mfma_f32_16x16x32_bf16 a[92:95], v[28:31], v[104:107], a[92:95]
    s_mul_i32 s56, s74, 1769472
    s_add_u32 s56, s56, s53
    s_add_u32 s56, s56, 128
    v_mfma_f32_16x16x32_bf16 a[92:95], a[164:167], v[100:103], a[92:95]
    ds_read_b64_tr_b16 a[140:141], v14 offset:24576
    ds_read_b64_tr_b16 a[142:143], v14 offset:25088
    v_mfma_f32_16x16x32_bf16 a[92:95], a[160:163], v[96:99], a[92:95]
    s_add_u32 s71, s3, 3
    buffer_load_dwordx4 v11, s[12:15], s56 offen nt lds
    v_cvt_pk_bf16_f32 v55, v38, v39
    v_mfma_f32_16x16x32_bf16 a[92:95], a[156:159], v[92:95], a[92:95]
    s_and_b32 s71, s71, 3
    ds_read_b64_tr_b16 a[144:145], v14 offset:32768
    ds_read_b64_tr_b16 a[146:147], v14 offset:33280
    v_mfma_f32_16x16x32_bf16 a[92:95], a[152:155], v[88:91], a[92:95]
    s_mul_i32 s71, s71, 4096
    s_add_u32 s71, s71, s59
    buffer_load_dwordx4 v12, s[12:15], s56 offen offset:1024 nt lds
    v_mfma_f32_16x16x32_bf16 a[108:111], a[152:155], v[160:163], a[108:111]
    ds_read_b64_tr_b16 a[148:149], v14 offset:40960
    ds_read_b64_tr_b16 a[150:151], v14 offset:41472
    v_mfma_f32_16x16x32_bf16 a[108:111], a[156:159], v[164:167], a[108:111]
    buffer_store_dwordx4 v[52:55], v2, s[28:31], s71 offen offset:0 sc1
    v_mfma_f32_16x16x32_bf16 a[108:111], a[160:163], v[168:171], a[108:111]
    v_mfma_f32_16x16x32_bf16 a[108:111], a[164:167], v[172:175], a[108:111]
    v_mfma_f32_16x16x32_bf16 a[108:111], v[28:31], v[176:179], a[108:111]
    v_mfma_f32_16x16x32_bf16 a[108:111], v[32:35], v[180:183], a[108:111]
    v_mfma_f32_16x16x32_bf16 a[124:127], v[32:35], v[252:255], a[124:127]
    v_mfma_f32_16x16x32_bf16 a[124:127], v[28:31], v[248:251], a[124:127]
    v_mfma_f32_16x16x32_bf16 a[124:127], a[164:167], v[244:247], a[124:127]
    s_add_u32 m0, s63, 106496
    s_add_u32 s56, s56, 294912
    v_mfma_f32_16x16x32_bf16 a[124:127], a[160:163], v[240:243], a[124:127]
    buffer_load_dwordx4 v11, s[12:15], s56 offen nt lds
    v_mfma_f32_16x16x32_bf16 a[124:127], a[156:159], v[236:239], a[124:127]
    v_mfma_f32_16x16x32_bf16 a[124:127], a[152:155], v[232:235], a[124:127]
    s_waitcnt lgkmcnt(0)
    v_mfma_f32_16x16x32_bf16 a[0:3], a[128:131], a[168:171], 0
    v_subrev_u32 v15, 98304, v15
    v_xor_b32 v15, 64, v15
    v_mfma_f32_16x16x32_bf16 a[0:3], a[132:135], a[172:175], a[0:3]
    ds_read_b64_tr_b16 a[152:153], v15 offset:0
    ds_read_b64_tr_b16 a[154:155], v15 offset:512
    v_mfma_f32_16x16x32_bf16 a[0:3], a[136:139], a[176:179], a[0:3]
    v_mfma_f32_16x16x32_bf16 a[0:3], a[140:143], a[180:183], a[0:3]
    ds_read_b64_tr_b16 a[156:157], v15 offset:8192
    ds_read_b64_tr_b16 a[158:159], v15 offset:8704
    v_mfma_f32_16x16x32_bf16 a[0:3], a[144:147], a[184:187], a[0:3]
    v_accvgpr_read_b32 v36, a64
    v_accvgpr_read_b32 v37, a65
    v_mfma_f32_16x16x32_bf16 a[0:3], a[148:151], a[188:191], a[0:3]
    ds_read_b64_tr_b16 a[160:161], v15 offset:16384
    ds_read_b64_tr_b16 a[162:163], v15 offset:16896
    v_mfma_f32_16x16x32_bf16 a[16:19], a[148:151], v[60:63], 0
    buffer_load_dwordx4 v12, s[12:15], s56 offen offset:1024 nt lds
    v_accvgpr_read_b32 v38, a66
    v_mfma_f32_16x16x32_bf16 a[16:19], a[144:147], v[56:59], a[16:19]
    ds_read_b64_tr_b16 a[164:165], v15 offset:24576
    ds_read_b64_tr_b16 a[166:167], v15 offset:25088
    v_mfma_f32_16x16x32_bf16 a[16:19], a[140:143], a[252:255], a[16:19]
    v_accvgpr_read_b32 v39, a67
    v_accvgpr_read_b32 v40, a72
    v_mfma_f32_16x16x32_bf16 a[16:19], a[136:139], a[248:251], a[16:19]
    ds_read_b64_tr_b16 v[28:29], v15 offset:32768
    ds_read_b64_tr_b16 v[30:31], v15 offset:33280
    v_mfma_f32_16x16x32_bf16 a[16:19], a[132:135], a[244:247], a[16:19]
    v_accvgpr_read_b32 v41, a73
    v_accvgpr_read_b32 v42, a74
    v_mfma_f32_16x16x32_bf16 a[16:19], a[128:131], a[240:243], a[16:19]
    ds_read_b64_tr_b16 v[32:33], v15 offset:40960
    ds_read_b64_tr_b16 v[34:35], v15 offset:41472
    v_mfma_f32_16x16x32_bf16 a[32:35], a[128:131], v[112:115], 0
    v_accvgpr_read_b32 v43, a75
    v_mul_f32 v44, v18, v36
    v_mfma_f32_16x16x32_bf16 a[32:35], a[132:135], v[116:119], a[32:35]
    v_mul_f32 v45, v18, v37
    v_mul_f32 v46, v18, v38
    v_mfma_f32_16x16x32_bf16 a[32:35], a[136:139], v[120:123], a[32:35]
    s_add_u32 m0, s63, 114688
    s_add_u32 s56, s56, 294912
    v_mul_f32 v47, v18, v39
    v_mfma_f32_16x16x32_bf16 a[32:35], a[140:143], v[124:127], a[32:35]
    buffer_load_dwordx4 v11, s[12:15], s56 offen nt lds
    v_mfma_f32_16x16x32_bf16 a[32:35], a[144:147], v[128:131], a[32:35]
    v_exp_f32 v44, v44
    v_mfma_f32_16x16x32_bf16 a[32:35], a[148:151], v[132:135], a[32:35]
    v_exp_f32 v45, v45
    v_mfma_f32_16x16x32_bf16 a[48:51], a[148:151], v[204:207], 0
    v_exp_f32 v46, v46
    v_mfma_f32_16x16x32_bf16 a[48:51], a[144:147], v[200:203], a[48:51]
    v_exp_f32 v47, v47
    v_mfma_f32_16x16x32_bf16 a[48:51], a[140:143], v[196:199], a[48:51]
    v_mul_f32 v36, v36, v40
    v_mul_f32 v37, v37, v41
    v_mfma_f32_16x16x32_bf16 a[48:51], a[136:139], v[192:195], a[48:51]
    v_mul_f32 v38, v38, v42
    v_mul_f32 v39, v39, v43
    v_mfma_f32_16x16x32_bf16 a[48:51], a[132:135], v[188:191], a[48:51]
    v_fma_f32 v44, v44, v22, v22
    v_fma_f32 v45, v45, v22, v22
    v_mfma_f32_16x16x32_bf16 a[48:51], a[128:131], v[184:187], a[48:51]
    s_waitcnt lgkmcnt(0)
    buffer_load_dwordx4 v12, s[12:15], s56 offen offset:1024 nt lds
    v_fma_f32 v46, v46, v22, v22
    v_mfma_f32_16x16x32_bf16 a[4:7], a[152:155], a[168:171], 0
    ds_read_b64_tr_b16 a[128:129], v14 offset:4096
    ds_read_b64_tr_b16 a[130:131], v14 offset:4608
    v_mfma_f32_16x16x32_bf16 a[4:7], a[156:159], a[172:175], a[4:7]
    v_fma_f32 v47, v47, v22, v22
    v_mfma_f32_16x16x32_bf16 a[4:7], a[160:163], a[176:179], a[4:7]
    ds_read_b64_tr_b16 a[132:133], v14 offset:12288
    ds_read_b64_tr_b16 a[134:135], v14 offset:12800
    v_mfma_f32_16x16x32_bf16 a[4:7], a[164:167], a[180:183], a[4:7]
    v_rcp_f32 v44, v44
    v_mfma_f32_16x16x32_bf16 a[4:7], v[28:31], a[184:187], a[4:7]
    ds_read_b64_tr_b16 a[136:137], v14 offset:20480
    ds_read_b64_tr_b16 a[138:139], v14 offset:20992
    v_mfma_f32_16x16x32_bf16 a[4:7], v[32:35], a[188:191], a[4:7]
    v_rcp_f32 v45, v45
    v_mfma_f32_16x16x32_bf16 a[20:23], v[32:35], v[60:63], 0
    ds_read_b64_tr_b16 a[140:141], v14 offset:28672
    ds_read_b64_tr_b16 a[142:143], v14 offset:29184
    v_mfma_f32_16x16x32_bf16 a[20:23], v[28:31], v[56:59], a[20:23]
    v_rcp_f32 v46, v46
    v_mfma_f32_16x16x32_bf16 a[20:23], a[164:167], a[252:255], a[20:23]
    s_add_u32 m0, s63, 122880
    ds_read_b64_tr_b16 a[144:145], v14 offset:36864
    ds_read_b64_tr_b16 a[146:147], v14 offset:37376
    v_mfma_f32_16x16x32_bf16 a[20:23], a[160:163], a[248:251], a[20:23]
    s_add_u32 s56, s56, 294912
    v_rcp_f32 v47, v47
    v_mfma_f32_16x16x32_bf16 a[20:23], a[156:159], a[244:247], a[20:23]
    ds_read_b64_tr_b16 a[148:149], v14 offset:45056
    ds_read_b64_tr_b16 a[150:151], v14 offset:45568
    v_mfma_f32_16x16x32_bf16 a[20:23], a[152:155], a[240:243], a[20:23]
    buffer_load_dwordx4 v11, s[12:15], s56 offen nt lds
    v_mul_f32 v36, v36, v44
    v_mfma_f32_16x16x32_bf16 a[36:39], a[152:155], v[112:115], 0
    v_mul_f32 v37, v37, v45
    v_mul_f32 v38, v38, v46
    v_mfma_f32_16x16x32_bf16 a[36:39], a[156:159], v[116:119], a[36:39]
    v_mul_f32 v39, v39, v47
    v_cvt_pk_bf16_f32 v48, v36, v37
    v_mfma_f32_16x16x32_bf16 a[36:39], a[160:163], v[120:123], a[36:39]
    v_cvt_pk_bf16_f32 v49, v38, v39
    v_accvgpr_read_b32 v36, a68
    v_mfma_f32_16x16x32_bf16 a[36:39], a[164:167], v[124:127], a[36:39]
    v_accvgpr_read_b32 v37, a69
    v_accvgpr_read_b32 v38, a70
    v_mfma_f32_16x16x32_bf16 a[36:39], v[28:31], v[128:131], a[36:39]
    v_accvgpr_read_b32 v39, a71
    v_accvgpr_read_b32 v40, a76
    v_mfma_f32_16x16x32_bf16 a[36:39], v[32:35], v[132:135], a[36:39]
    buffer_load_dwordx4 v12, s[12:15], s56 offen offset:1024 nt lds
    v_accvgpr_read_b32 v41, a77
    v_mfma_f32_16x16x32_bf16 a[52:55], v[32:35], v[204:207], 0
    v_accvgpr_read_b32 v42, a78
    v_accvgpr_read_b32 v43, a79
    v_mfma_f32_16x16x32_bf16 a[52:55], v[28:31], v[200:203], a[52:55]
    v_mul_f32 v44, v18, v36
    v_mul_f32 v45, v18, v37
    v_mfma_f32_16x16x32_bf16 a[52:55], a[164:167], v[196:199], a[52:55]
    v_mul_f32 v46, v18, v38
    v_mul_f32 v47, v18, v39
    v_mfma_f32_16x16x32_bf16 a[52:55], a[160:163], v[192:195], a[52:55]
    v_exp_f32 v44, v44
    v_mfma_f32_16x16x32_bf16 a[52:55], a[156:159], v[188:191], a[52:55]
    v_exp_f32 v45, v45
    v_mfma_f32_16x16x32_bf16 a[52:55], a[152:155], v[184:187], a[52:55]
    s_waitcnt lgkmcnt(0)
    v_exp_f32 v46, v46
    v_mfma_f32_16x16x32_bf16 a[8:11], a[128:131], a[168:171], 0
    ds_read_b64_tr_b16 a[152:153], v15 offset:4096
    ds_read_b64_tr_b16 a[154:155], v15 offset:4608
    v_mfma_f32_16x16x32_bf16 a[8:11], a[132:135], a[172:175], a[8:11]
    v_exp_f32 v47, v47
    v_mfma_f32_16x16x32_bf16 a[8:11], a[136:139], a[176:179], a[8:11]
    s_add_u32 m0, s63, 131072
    ds_read_b64_tr_b16 a[156:157], v15 offset:12288
    ds_read_b64_tr_b16 a[158:159], v15 offset:12800
    v_mfma_f32_16x16x32_bf16 a[8:11], a[140:143], a[180:183], a[8:11]
    s_add_u32 s56, s56, 294912
    v_mul_f32 v36, v36, v40
    v_mul_f32 v37, v37, v41
    v_mfma_f32_16x16x32_bf16 a[8:11], a[144:147], a[184:187], a[8:11]
    ds_read_b64_tr_b16 a[160:161], v15 offset:20480
    ds_read_b64_tr_b16 a[162:163], v15 offset:20992
    v_mfma_f32_16x16x32_bf16 a[8:11], a[148:151], a[188:191], a[8:11]
    buffer_load_dwordx4 v11, s[12:15], s56 offen nt lds
    v_mul_f32 v38, v38, v42
    v_mfma_f32_16x16x32_bf16 a[24:27], a[148:151], v[60:63], 0
    ds_read_b64_tr_b16 a[164:165], v15 offset:28672
    ds_read_b64_tr_b16 a[166:167], v15 offset:29184
    v_mfma_f32_16x16x32_bf16 a[24:27], a[144:147], v[56:59], a[24:27]
    v_mul_f32 v39, v39, v43
    v_fma_f32 v44, v44, v22, v22
    v_mfma_f32_16x16x32_bf16 a[24:27], a[140:143], a[252:255], a[24:27]
    ds_read_b64_tr_b16 v[28:29], v15 offset:36864
    ds_read_b64_tr_b16 v[30:31], v15 offset:37376
    v_mfma_f32_16x16x32_bf16 a[24:27], a[136:139], a[248:251], a[24:27]
    v_fma_f32 v45, v45, v22, v22
    v_fma_f32 v46, v46, v22, v22
    v_mfma_f32_16x16x32_bf16 a[24:27], a[132:135], a[244:247], a[24:27]
    ds_read_b64_tr_b16 v[32:33], v15 offset:45056
    ds_read_b64_tr_b16 v[34:35], v15 offset:45568
    v_mfma_f32_16x16x32_bf16 a[24:27], a[128:131], a[240:243], a[24:27]
    buffer_load_dwordx4 v12, s[12:15], s56 offen offset:1024 nt lds
    v_fma_f32 v47, v47, v22, v22
    v_mfma_f32_16x16x32_bf16 a[40:43], a[128:131], v[112:115], 0
    v_rcp_f32 v44, v44
    v_mfma_f32_16x16x32_bf16 a[40:43], a[132:135], v[116:119], a[40:43]
    v_rcp_f32 v45, v45
    v_mfma_f32_16x16x32_bf16 a[40:43], a[136:139], v[120:123], a[40:43]
    v_rcp_f32 v46, v46
    v_mfma_f32_16x16x32_bf16 a[40:43], a[140:143], v[124:127], a[40:43]
    v_rcp_f32 v47, v47
    v_mfma_f32_16x16x32_bf16 a[40:43], a[144:147], v[128:131], a[40:43]
    v_mul_f32 v36, v36, v44
    v_mul_f32 v37, v37, v45
    v_mfma_f32_16x16x32_bf16 a[40:43], a[148:151], v[132:135], a[40:43]
    v_mul_f32 v38, v38, v46
    v_mul_f32 v39, v39, v47
    v_mfma_f32_16x16x32_bf16 a[56:59], a[148:151], v[204:207], 0
    s_add_u32 s71, s3, 0
    v_cvt_pk_bf16_f32 v50, v36, v37
    v_cvt_pk_bf16_f32 v51, v38, v39
    v_mfma_f32_16x16x32_bf16 a[56:59], a[144:147], v[200:203], a[56:59]
    s_and_b32 s71, s71, 3
    s_mul_i32 s71, s71, 4096
    s_add_u32 s71, s71, s59
    v_mfma_f32_16x16x32_bf16 a[56:59], a[140:143], v[196:199], a[56:59]
    s_add_u32 m0, s63, 139264
    s_add_u32 s56, s56, 294912
    buffer_store_dwordx4 v[48:51], v2, s[28:31], s71 offen offset:1024 sc1
    v_mfma_f32_16x16x32_bf16 a[56:59], a[136:139], v[192:195], a[56:59]
    buffer_load_dwordx4 v11, s[12:15], s56 offen nt lds
    v_accvgpr_read_b32 v36, a80
    v_mfma_f32_16x16x32_bf16 a[56:59], a[132:135], v[188:191], a[56:59]
    v_accvgpr_read_b32 v37, a81
    v_accvgpr_read_b32 v38, a82
    v_mfma_f32_16x16x32_bf16 a[56:59], a[128:131], v[184:187], a[56:59]
    s_waitcnt lgkmcnt(0)
    v_accvgpr_read_b32 v39, a83
    v_accvgpr_read_b32 v40, a88
    v_mfma_f32_16x16x32_bf16 a[12:15], a[152:155], a[168:171], 0
    s_waitcnt vmcnt(13)
    v_accvgpr_read_b32 v41, a89
    v_accvgpr_read_b32 v42, a90
    v_mfma_f32_16x16x32_bf16 a[12:15], a[156:159], a[172:175], a[12:15]
    s_barrier
    v_add_u32 v14, 49152, v14
    v_accvgpr_read_b32 v43, a91
    v_mfma_f32_16x16x32_bf16 a[12:15], a[160:163], a[176:179], a[12:15]
    ds_read_b64_tr_b16 a[128:129], v14 offset:0
    ds_read_b64_tr_b16 a[130:131], v14 offset:512
    v_mfma_f32_16x16x32_bf16 a[12:15], a[164:167], a[180:183], a[12:15]
    v_mul_f32 v44, v19, v36
    v_mul_f32 v45, v19, v37
    v_mfma_f32_16x16x32_bf16 a[12:15], v[28:31], a[184:187], a[12:15]
    ds_read_b64_tr_b16 a[132:133], v14 offset:8192
    ds_read_b64_tr_b16 a[134:135], v14 offset:8704
    v_mfma_f32_16x16x32_bf16 a[12:15], v[32:35], a[188:191], a[12:15]
    buffer_load_dwordx4 v12, s[12:15], s56 offen offset:1024 nt lds
    v_mul_f32 v46, v19, v38
    v_mfma_f32_16x16x32_bf16 a[28:31], v[32:35], v[60:63], 0
    ds_read_b64_tr_b16 a[136:137], v14 offset:16384
    ds_read_b64_tr_b16 a[138:139], v14 offset:16896
    v_mfma_f32_16x16x32_bf16 a[28:31], v[28:31], v[56:59], a[28:31]
    v_lshrrev_b32 v12, 4, v1
    v_lshlrev_b32 v11, 2, v12
    v_mfma_f32_16x16x32_bf16 a[28:31], a[164:167], a[252:255], a[28:31]
    ds_read_b64_tr_b16 a[140:141], v14 offset:24576
    ds_read_b64_tr_b16 a[142:143], v14 offset:25088
    v_mfma_f32_16x16x32_bf16 a[28:31], a[160:163], a[248:251], a[28:31]
    v_xor_b32 v11, v11, v1
    v_and_b32 v11, 15, v11
    v_mfma_f32_16x16x32_bf16 a[28:31], a[156:159], a[244:247], a[28:31]
    ds_read_b64_tr_b16 a[144:145], v14 offset:32768
    ds_read_b64_tr_b16 a[146:147], v14 offset:33280
    v_mfma_f32_16x16x32_bf16 a[28:31], a[152:155], a[240:243], a[28:31]
    v_lshlrev_b32 v11, 4, v11
    v_lshl_add_u32 v11, v12, 13, v11
    v_mfma_f32_16x16x32_bf16 a[44:47], a[152:155], v[112:115], 0
    ds_read_b64_tr_b16 a[148:149], v14 offset:40960
    ds_read_b64_tr_b16 a[150:151], v14 offset:41472
    v_mfma_f32_16x16x32_bf16 a[44:47], a[156:159], v[116:119], a[44:47]
    v_add_u32 v12, 31744, v11
    v_mul_f32 v47, v19, v39
    v_mfma_f32_16x16x32_bf16 a[44:47], a[160:163], v[120:123], a[44:47]
    v_exp_f32 v44, v44
    v_mfma_f32_16x16x32_bf16 a[44:47], a[164:167], v[124:127], a[44:47]
    v_exp_f32 v45, v45
    v_mfma_f32_16x16x32_bf16 a[44:47], v[28:31], v[128:131], a[44:47]
    v_exp_f32 v46, v46
    v_mfma_f32_16x16x32_bf16 a[44:47], v[32:35], v[132:135], a[44:47]
    v_exp_f32 v47, v47
    v_mfma_f32_16x16x32_bf16 a[60:63], v[32:35], v[204:207], 0
    v_mul_f32 v36, v36, v40
    v_mul_f32 v37, v37, v41
    v_mfma_f32_16x16x32_bf16 a[60:63], v[28:31], v[200:203], a[60:63]
    v_mul_f32 v38, v38, v42
    v_mul_f32 v39, v39, v43
    v_mfma_f32_16x16x32_bf16 a[60:63], a[164:167], v[196:199], a[60:63]
    v_fma_f32 v44, v44, v23, v23
    v_fma_f32 v45, v45, v23, v23
    v_mfma_f32_16x16x32_bf16 a[60:63], a[160:163], v[192:195], a[60:63]
    v_fma_f32 v46, v46, v23, v23
    v_fma_f32 v47, v47, v23, v23
    v_mfma_f32_16x16x32_bf16 a[60:63], a[156:159], v[188:191], a[60:63]
    v_rcp_f32 v44, v44
    v_mfma_f32_16x16x32_bf16 a[60:63], a[152:155], v[184:187], a[60:63]
    s_waitcnt lgkmcnt(0)
    v_rcp_f32 v45, v45
    v_mfma_f32_16x16x32_bf16 a[0:3], a[128:131], a[192:195], a[0:3]
    v_add_u32 v15, 49152, v15
    v_mfma_f32_16x16x32_bf16 a[0:3], a[132:135], a[196:199], a[0:3]
    ds_read_b64_tr_b16 a[152:153], v15 offset:0
    ds_read_b64_tr_b16 a[154:155], v15 offset:512
    v_mfma_f32_16x16x32_bf16 a[0:3], a[136:139], a[200:203], a[0:3]
    v_rcp_f32 v46, v46
    v_mfma_f32_16x16x32_bf16 a[0:3], a[140:143], a[204:207], a[0:3]
    ds_read_b64_tr_b16 a[156:157], v15 offset:8192
    ds_read_b64_tr_b16 a[158:159], v15 offset:8704
    v_mfma_f32_16x16x32_bf16 a[0:3], a[144:147], a[208:211], a[0:3]
    v_rcp_f32 v47, v47
    v_mfma_f32_16x16x32_bf16 a[0:3], a[148:151], a[212:215], a[0:3]
    ds_read_b64_tr_b16 a[160:161], v15 offset:16384
    ds_read_b64_tr_b16 a[162:163], v15 offset:16896
    v_mfma_f32_16x16x32_bf16 a[16:19], a[148:151], v[84:87], a[16:19]
    v_mul_f32 v36, v36, v44
    v_mul_f32 v37, v37, v45
    v_mfma_f32_16x16x32_bf16 a[16:19], a[144:147], v[80:83], a[16:19]
    ds_read_b64_tr_b16 a[164:165], v15 offset:24576
    ds_read_b64_tr_b16 a[166:167], v15 offset:25088
    v_mfma_f32_16x16x32_bf16 a[16:19], a[140:143], v[76:79], a[16:19]
    v_mul_f32 v38, v38, v46
    v_mul_f32 v39, v39, v47
    v_mfma_f32_16x16x32_bf16 a[16:19], a[136:139], v[72:75], a[16:19]
    ds_read_b64_tr_b16 v[28:29], v15 offset:32768
    ds_read_b64_tr_b16 v[30:31], v15 offset:33280
    v_mfma_f32_16x16x32_bf16 a[16:19], a[132:135], v[68:71], a[16:19]
    v_cvt_pk_bf16_f32 v52, v36, v37
    v_cvt_pk_bf16_f32 v53, v38, v39
    v_mfma_f32_16x16x32_bf16 a[16:19], a[128:131], v[64:67], a[16:19]
    ds_read_b64_tr_b16 v[32:33], v15 offset:40960
    ds_read_b64_tr_b16 v[34:35], v15 offset:41472
    v_mfma_f32_16x16x32_bf16 a[32:35], a[128:131], v[136:139], a[32:35]
    v_accvgpr_read_b32 v36, a84
    v_accvgpr_read_b32 v37, a85
    v_mfma_f32_16x16x32_bf16 a[32:35], a[132:135], v[140:143], a[32:35]
    v_accvgpr_read_b32 v38, a86
    v_accvgpr_read_b32 v39, a87
    v_mfma_f32_16x16x32_bf16 a[32:35], a[136:139], v[144:147], a[32:35]
    v_accvgpr_read_b32 v40, a92
    v_accvgpr_read_b32 v41, a93
    v_mfma_f32_16x16x32_bf16 a[32:35], a[140:143], v[148:151], a[32:35]
    v_accvgpr_read_b32 v42, a94
    v_accvgpr_read_b32 v43, a95
    v_mfma_f32_16x16x32_bf16 a[32:35], a[144:147], v[152:155], a[32:35]
    v_mul_f32 v44, v19, v36
    v_mul_f32 v45, v19, v37
    v_mfma_f32_16x16x32_bf16 a[32:35], a[148:151], v[156:159], a[32:35]
    v_mul_f32 v46, v19, v38
    v_mul_f32 v47, v19, v39
    v_mfma_f32_16x16x32_bf16 a[48:51], a[148:151], v[228:231], a[48:51]
    v_exp_f32 v44, v44
    v_mfma_f32_16x16x32_bf16 a[48:51], a[144:147], v[224:227], a[48:51]
    v_exp_f32 v45, v45
    v_mfma_f32_16x16x32_bf16 a[48:51], a[140:143], v[220:223], a[48:51]
    v_exp_f32 v46, v46
    v_mfma_f32_16x16x32_bf16 a[48:51], a[136:139], v[216:219], a[48:51]
    v_exp_f32 v47, v47
    v_mfma_f32_16x16x32_bf16 a[48:51], a[132:135], v[212:215], a[48:51]
    v_mul_f32 v36, v36, v40
    v_mul_f32 v37, v37, v41
    v_mfma_f32_16x16x32_bf16 a[48:51], a[128:131], v[208:211], a[48:51]
    s_waitcnt lgkmcnt(0)
    v_mul_f32 v38, v38, v42
    v_mul_f32 v39, v39, v43
    v_mfma_f32_16x16x32_bf16 a[4:7], a[152:155], a[192:195], a[4:7]
    ds_read_b64_tr_b16 a[128:129], v14 offset:4096
    ds_read_b64_tr_b16 a[130:131], v14 offset:4608
    v_mfma_f32_16x16x32_bf16 a[4:7], a[156:159], a[196:199], a[4:7]
    v_fma_f32 v44, v44, v23, v23
    v_fma_f32 v45, v45, v23, v23
    v_mfma_f32_16x16x32_bf16 a[4:7], a[160:163], a[200:203], a[4:7]
    ds_read_b64_tr_b16 a[132:133], v14 offset:12288
    ds_read_b64_tr_b16 a[134:135], v14 offset:12800
    v_mfma_f32_16x16x32_bf16 a[4:7], a[164:167], a[204:207], a[4:7]
    v_fma_f32 v46, v46, v23, v23
    v_fma_f32 v47, v47, v23, v23
    v_mfma_f32_16x16x32_bf16 a[4:7], v[28:31], a[208:211], a[4:7]
    ds_read_b64_tr_b16 a[136:137], v14 offset:20480
    ds_read_b64_tr_b16 a[138:139], v14 offset:20992
    v_mfma_f32_16x16x32_bf16 a[4:7], v[32:35], a[212:215], a[4:7]
    v_rcp_f32 v44, v44
    v_mfma_f32_16x16x32_bf16 a[20:23], v[32:35], v[84:87], a[20:23]
    ds_read_b64_tr_b16 a[140:141], v14 offset:28672
    ds_read_b64_tr_b16 a[142:143], v14 offset:29184
    v_mfma_f32_16x16x32_bf16 a[20:23], v[28:31], v[80:83], a[20:23]
    v_rcp_f32 v45, v45
    v_mfma_f32_16x16x32_bf16 a[20:23], a[164:167], v[76:79], a[20:23]
    ds_read_b64_tr_b16 a[144:145], v14 offset:36864
    ds_read_b64_tr_b16 a[146:147], v14 offset:37376
    v_mfma_f32_16x16x32_bf16 a[20:23], a[160:163], v[72:75], a[20:23]
    v_rcp_f32 v46, v46
    v_mfma_f32_16x16x32_bf16 a[20:23], a[156:159], v[68:71], a[20:23]
    ds_read_b64_tr_b16 a[148:149], v14 offset:45056
    ds_read_b64_tr_b16 a[150:151], v14 offset:45568
    v_mfma_f32_16x16x32_bf16 a[20:23], a[152:155], v[64:67], a[20:23]
    v_rcp_f32 v47, v47
    v_mfma_f32_16x16x32_bf16 a[36:39], a[152:155], v[136:139], a[36:39]
    v_mul_f32 v36, v36, v44
    v_mul_f32 v37, v37, v45
    v_mfma_f32_16x16x32_bf16 a[36:39], a[156:159], v[140:143], a[36:39]
    v_mul_f32 v38, v38, v46
    v_mul_f32 v39, v39, v47
    v_mfma_f32_16x16x32_bf16 a[36:39], a[160:163], v[144:147], a[36:39]
    s_add_u32 s71, s3, 1
    v_cvt_pk_bf16_f32 v54, v36, v37
    v_cvt_pk_bf16_f32 v55, v38, v39
    v_mfma_f32_16x16x32_bf16 a[36:39], a[164:167], v[148:151], a[36:39]
    s_and_b32 s71, s71, 3
    s_mul_i32 s71, s71, 4096
    s_add_u32 s71, s71, s59
    v_mfma_f32_16x16x32_bf16 a[36:39], v[28:31], v[152:155], a[36:39]
    buffer_store_dwordx4 v[52:55], v2, s[28:31], s71 offen offset:1024 sc1
    v_accvgpr_read_b32 v36, a96
    v_mfma_f32_16x16x32_bf16 a[36:39], v[32:35], v[156:159], a[36:39]
    v_accvgpr_read_b32 v37, a97
    v_accvgpr_read_b32 v38, a98
    v_mfma_f32_16x16x32_bf16 a[52:55], v[32:35], v[228:231], a[52:55]
    v_accvgpr_read_b32 v39, a99
    v_accvgpr_read_b32 v40, a104
    v_mfma_f32_16x16x32_bf16 a[52:55], v[28:31], v[224:227], a[52:55]
    v_accvgpr_read_b32 v41, a105
    v_accvgpr_read_b32 v42, a106
    v_mfma_f32_16x16x32_bf16 a[52:55], a[164:167], v[220:223], a[52:55]
    v_accvgpr_read_b32 v43, a107
    v_mul_f32 v44, v20, v36
    v_mfma_f32_16x16x32_bf16 a[52:55], a[160:163], v[216:219], a[52:55]
    v_mul_f32 v45, v20, v37
    v_mul_f32 v46, v20, v38
    v_mfma_f32_16x16x32_bf16 a[52:55], a[156:159], v[212:215], a[52:55]
    v_mul_f32 v47, v20, v39
    v_mfma_f32_16x16x32_bf16 a[52:55], a[152:155], v[208:211], a[52:55]
    s_waitcnt lgkmcnt(0)
    v_exp_f32 v44, v44
    v_mfma_f32_16x16x32_bf16 a[8:11], a[128:131], a[192:195], a[8:11]
    ds_read_b64_tr_b16 a[152:153], v15 offset:4096
    ds_read_b64_tr_b16 a[154:155], v15 offset:4608
    v_mfma_f32_16x16x32_bf16 a[8:11], a[132:135], a[196:199], a[8:11]
    v_exp_f32 v45, v45
    v_mfma_f32_16x16x32_bf16 a[8:11], a[136:139], a[200:203], a[8:11]
    ds_read_b64_tr_b16 a[156:157], v15 offset:12288
    ds_read_b64_tr_b16 a[158:159], v15 offset:12800
    v_mfma_f32_16x16x32_bf16 a[8:11], a[140:143], a[204:207], a[8:11]
    v_exp_f32 v46, v46
    v_mfma_f32_16x16x32_bf16 a[8:11], a[144:147], a[208:211], a[8:11]
    ds_read_b64_tr_b16 a[160:161], v15 offset:20480
    ds_read_b64_tr_b16 a[162:163], v15 offset:20992
    v_mfma_f32_16x16x32_bf16 a[8:11], a[148:151], a[212:215], a[8:11]
    v_exp_f32 v47, v47
    v_mfma_f32_16x16x32_bf16 a[24:27], a[148:151], v[84:87], a[24:27]
    ds_read_b64_tr_b16 a[164:165], v15 offset:28672
    ds_read_b64_tr_b16 a[166:167], v15 offset:29184
    v_mfma_f32_16x16x32_bf16 a[24:27], a[144:147], v[80:83], a[24:27]
    v_mul_f32 v36, v36, v40
    v_mul_f32 v37, v37, v41
    v_mfma_f32_16x16x32_bf16 a[24:27], a[140:143], v[76:79], a[24:27]
    ds_read_b64_tr_b16 v[28:29], v15 offset:36864
    ds_read_b64_tr_b16 v[30:31], v15 offset:37376
    v_mfma_f32_16x16x32_bf16 a[24:27], a[136:139], v[72:75], a[24:27]
    v_mul_f32 v38, v38, v42
    v_mul_f32 v39, v39, v43
    v_mfma_f32_16x16x32_bf16 a[24:27], a[132:135], v[68:71], a[24:27]
    ds_read_b64_tr_b16 v[32:33], v15 offset:45056
    ds_read_b64_tr_b16 v[34:35], v15 offset:45568
    v_mfma_f32_16x16x32_bf16 a[24:27], a[128:131], v[64:67], a[24:27]
    v_fma_f32 v44, v44, v24, v24
    v_fma_f32 v45, v45, v24, v24
    v_mfma_f32_16x16x32_bf16 a[40:43], a[128:131], v[136:139], a[40:43]
    v_fma_f32 v46, v46, v24, v24
    v_fma_f32 v47, v47, v24, v24
    v_mfma_f32_16x16x32_bf16 a[40:43], a[132:135], v[140:143], a[40:43]
    v_rcp_f32 v44, v44
    v_mfma_f32_16x16x32_bf16 a[40:43], a[136:139], v[144:147], a[40:43]
    v_rcp_f32 v45, v45
    v_mfma_f32_16x16x32_bf16 a[40:43], a[140:143], v[148:151], a[40:43]
    v_rcp_f32 v46, v46
    v_mfma_f32_16x16x32_bf16 a[40:43], a[144:147], v[152:155], a[40:43]
    v_rcp_f32 v47, v47
    v_mfma_f32_16x16x32_bf16 a[40:43], a[148:151], v[156:159], a[40:43]
    v_mul_f32 v36, v36, v44
    v_mul_f32 v37, v37, v45
    v_mfma_f32_16x16x32_bf16 a[56:59], a[148:151], v[228:231], a[56:59]
    v_mul_f32 v38, v38, v46
    v_mul_f32 v39, v39, v47
    v_mfma_f32_16x16x32_bf16 a[56:59], a[144:147], v[224:227], a[56:59]
    v_cvt_pk_bf16_f32 v48, v36, v37
    v_cvt_pk_bf16_f32 v49, v38, v39
    v_mfma_f32_16x16x32_bf16 a[56:59], a[140:143], v[220:223], a[56:59]
    v_accvgpr_read_b32 v36, a100
    v_accvgpr_read_b32 v37, a101
    v_mfma_f32_16x16x32_bf16 a[56:59], a[136:139], v[216:219], a[56:59]
    v_accvgpr_read_b32 v38, a102
    v_accvgpr_read_b32 v39, a103
    v_mfma_f32_16x16x32_bf16 a[56:59], a[132:135], v[212:215], a[56:59]
    v_accvgpr_read_b32 v40, a108
    v_accvgpr_read_b32 v41, a109
    v_mfma_f32_16x16x32_bf16 a[56:59], a[128:131], v[208:211], a[56:59]
    s_waitcnt lgkmcnt(0)
    v_accvgpr_read_b32 v42, a110
    v_accvgpr_read_b32 v43, a111
    v_mfma_f32_16x16x32_bf16 a[12:15], a[152:155], a[192:195], a[12:15]
    s_waitcnt vmcnt(1)
    v_mul_f32 v44, v20, v36
    v_mul_f32 v45, v20, v37
    v_mfma_f32_16x16x32_bf16 a[12:15], a[156:159], a[196:199], a[12:15]
    s_barrier
    v_add_u32 v14, 49152, v14
    v_mul_f32 v46, v20, v38
    v_mfma_f32_16x16x32_bf16 a[12:15], a[160:163], a[200:203], a[12:15]
    ds_read_b64_tr_b16 a[128:129], v14 offset:0
    ds_read_b64_tr_b16 a[130:131], v14 offset:512
    v_mfma_f32_16x16x32_bf16 a[12:15], a[164:167], a[204:207], a[12:15]
    v_mul_f32 v47, v20, v39
    v_mfma_f32_16x16x32_bf16 a[12:15], v[28:31], a[208:211], a[12:15]
    ds_read_b64_tr_b16 a[132:133], v14 offset:8192
    ds_read_b64_tr_b16 a[134:135], v14 offset:8704
    v_mfma_f32_16x16x32_bf16 a[12:15], v[32:35], a[212:215], a[12:15]
    v_exp_f32 v44, v44
    v_mfma_f32_16x16x32_bf16 a[28:31], v[32:35], v[84:87], a[28:31]
    ds_read_b64_tr_b16 a[136:137], v14 offset:16384
    ds_read_b64_tr_b16 a[138:139], v14 offset:16896
    v_mfma_f32_16x16x32_bf16 a[28:31], v[28:31], v[80:83], a[28:31]
    v_exp_f32 v45, v45
    v_mfma_f32_16x16x32_bf16 a[28:31], a[164:167], v[76:79], a[28:31]
    ds_read_b64_tr_b16 a[140:141], v14 offset:24576
    ds_read_b64_tr_b16 a[142:143], v14 offset:25088
    v_mfma_f32_16x16x32_bf16 a[28:31], a[160:163], v[72:75], a[28:31]
    v_exp_f32 v46, v46
    v_mfma_f32_16x16x32_bf16 a[28:31], a[156:159], v[68:71], a[28:31]
    ds_read_b64_tr_b16 a[144:145], v14 offset:32768
    ds_read_b64_tr_b16 a[146:147], v14 offset:33280
    v_mfma_f32_16x16x32_bf16 a[28:31], a[152:155], v[64:67], a[28:31]
    v_exp_f32 v47, v47
    v_mfma_f32_16x16x32_bf16 a[44:47], a[152:155], v[136:139], a[44:47]
    ds_read_b64_tr_b16 a[148:149], v14 offset:40960
    ds_read_b64_tr_b16 a[150:151], v14 offset:41472
    v_mfma_f32_16x16x32_bf16 a[44:47], a[156:159], v[140:143], a[44:47]
    v_mul_f32 v36, v36, v40
    v_mul_f32 v37, v37, v41
    v_mfma_f32_16x16x32_bf16 a[44:47], a[160:163], v[144:147], a[44:47]
    v_mul_f32 v38, v38, v42
    v_mul_f32 v39, v39, v43
    v_mfma_f32_16x16x32_bf16 a[44:47], a[164:167], v[148:151], a[44:47]
    v_fma_f32 v44, v44, v24, v24
    v_fma_f32 v45, v45, v24, v24
    v_mfma_f32_16x16x32_bf16 a[44:47], v[28:31], v[152:155], a[44:47]
    v_fma_f32 v46, v46, v24, v24
    v_fma_f32 v47, v47, v24, v24
    v_mfma_f32_16x16x32_bf16 a[44:47], v[32:35], v[156:159], a[44:47]
    v_rcp_f32 v44, v44
    v_mfma_f32_16x16x32_bf16 a[60:63], v[32:35], v[228:231], a[60:63]
    v_rcp_f32 v45, v45
    v_mfma_f32_16x16x32_bf16 a[60:63], v[28:31], v[224:227], a[60:63]
    v_rcp_f32 v46, v46
    v_mfma_f32_16x16x32_bf16 a[60:63], a[164:167], v[220:223], a[60:63]
    v_rcp_f32 v47, v47
    v_mfma_f32_16x16x32_bf16 a[60:63], a[160:163], v[216:219], a[60:63]
    v_mul_f32 v36, v36, v44
    v_mul_f32 v37, v37, v45
    v_mfma_f32_16x16x32_bf16 a[60:63], a[156:159], v[212:215], a[60:63]
    v_mul_f32 v38, v38, v46
    v_mul_f32 v39, v39, v47
    v_mfma_f32_16x16x32_bf16 a[60:63], a[152:155], v[208:211], a[60:63]
    s_waitcnt lgkmcnt(0)
    v_cvt_pk_bf16_f32 v50, v36, v37
    v_cvt_pk_bf16_f32 v51, v38, v39
    v_mfma_f32_16x16x32_bf16 a[0:3], a[128:131], a[216:219], a[0:3]
    s_add_u32 s71, s3, 2
    s_and_b32 s71, s71, 3
    v_add_u32 v15, 49152, v15
    v_mfma_f32_16x16x32_bf16 a[0:3], a[132:135], a[220:223], a[0:3]
    s_mul_i32 s71, s71, 4096
    ds_read_b64_tr_b16 a[152:153], v15 offset:0
    ds_read_b64_tr_b16 a[154:155], v15 offset:512
    v_mfma_f32_16x16x32_bf16 a[0:3], a[136:139], a[224:227], a[0:3]
    s_add_u32 s71, s71, s59
    buffer_store_dwordx4 v[48:51], v2, s[28:31], s71 offen offset:1024 sc1
    v_accvgpr_read_b32 v36, a112
    v_mfma_f32_16x16x32_bf16 a[0:3], a[140:143], a[228:231], a[0:3]
    ds_read_b64_tr_b16 a[156:157], v15 offset:8192
    ds_read_b64_tr_b16 a[158:159], v15 offset:8704
    v_mfma_f32_16x16x32_bf16 a[0:3], a[144:147], a[232:235], a[0:3]
    v_accvgpr_read_b32 v37, a113
    v_accvgpr_read_b32 v38, a114
    v_mfma_f32_16x16x32_bf16 a[0:3], a[148:151], a[236:239], a[0:3]
    ds_read_b64_tr_b16 a[160:161], v15 offset:16384
    ds_read_b64_tr_b16 a[162:163], v15 offset:16896
    v_mfma_f32_16x16x32_bf16 a[16:19], a[148:151], v[108:111], a[16:19]
    v_accvgpr_read_b32 v39, a115
    v_accvgpr_read_b32 v40, a120
    v_mfma_f32_16x16x32_bf16 a[16:19], a[144:147], v[104:107], a[16:19]
    ds_read_b64_tr_b16 a[164:165], v15 offset:24576
    ds_read_b64_tr_b16 a[166:167], v15 offset:25088
    v_mfma_f32_16x16x32_bf16 a[16:19], a[140:143], v[100:103], a[16:19]
    v_accvgpr_read_b32 v41, a121
    v_accvgpr_read_b32 v42, a122
    v_mfma_f32_16x16x32_bf16 a[16:19], a[136:139], v[96:99], a[16:19]
    ds_read_b64_tr_b16 v[28:29], v15 offset:32768
    ds_read_b64_tr_b16 v[30:31], v15 offset:33280
    v_mfma_f32_16x16x32_bf16 a[16:19], a[132:135], v[92:95], a[16:19]
    v_accvgpr_read_b32 v43, a123
    v_mul_f32 v44, v21, v36
    v_mfma_f32_16x16x32_bf16 a[16:19], a[128:131], v[88:91], a[16:19]
    ds_read_b64_tr_b16 v[32:33], v15 offset:40960
    ds_read_b64_tr_b16 v[34:35], v15 offset:41472
    v_mfma_f32_16x16x32_bf16 a[32:35], a[128:131], v[160:163], a[32:35]
    v_mul_f32 v45, v21, v37
    v_mul_f32 v46, v21, v38
    v_mfma_f32_16x16x32_bf16 a[32:35], a[132:135], v[164:167], a[32:35]
    v_mul_f32 v47, v21, v39
    v_mfma_f32_16x16x32_bf16 a[32:35], a[136:139], v[168:171], a[32:35]
    v_exp_f32 v44, v44
    v_mfma_f32_16x16x32_bf16 a[32:35], a[140:143], v[172:175], a[32:35]
    v_exp_f32 v45, v45
    v_mfma_f32_16x16x32_bf16 a[32:35], a[144:147], v[176:179], a[32:35]
    v_exp_f32 v46, v46
    v_mfma_f32_16x16x32_bf16 a[32:35], a[148:151], v[180:183], a[32:35]
    v_exp_f32 v47, v47
    v_mfma_f32_16x16x32_bf16 a[48:51], a[148:151], v[252:255], a[48:51]
    v_mul_f32 v36, v36, v40
    v_mul_f32 v37, v37, v41
    v_mfma_f32_16x16x32_bf16 a[48:51], a[144:147], v[248:251], a[48:51]
    v_mul_f32 v38, v38, v42
    v_mul_f32 v39, v39, v43
    v_mfma_f32_16x16x32_bf16 a[48:51], a[140:143], v[244:247], a[48:51]
    v_fma_f32 v44, v44, v25, v25
    v_fma_f32 v45, v45, v25, v25
    v_mfma_f32_16x16x32_bf16 a[48:51], a[136:139], v[240:243], a[48:51]
    v_fma_f32 v46, v46, v25, v25
    v_fma_f32 v47, v47, v25, v25
    v_mfma_f32_16x16x32_bf16 a[48:51], a[132:135], v[236:239], a[48:51]
    v_rcp_f32 v44, v44
    v_mfma_f32_16x16x32_bf16 a[48:51], a[128:131], v[232:235], a[48:51]
    s_waitcnt lgkmcnt(0)
    v_rcp_f32 v45, v45
    v_mfma_f32_16x16x32_bf16 a[4:7], a[152:155], a[216:219], a[4:7]
    ds_read_b64_tr_b16 a[128:129], v14 offset:4096
    ds_read_b64_tr_b16 a[130:131], v14 offset:4608
    v_mfma_f32_16x16x32_bf16 a[4:7], a[156:159], a[220:223], a[4:7]
    v_rcp_f32 v46, v46
    v_mfma_f32_16x16x32_bf16 a[4:7], a[160:163], a[224:227], a[4:7]
    ds_read_b64_tr_b16 a[132:133], v14 offset:12288
    ds_read_b64_tr_b16 a[134:135], v14 offset:12800
    v_mfma_f32_16x16x32_bf16 a[4:7], a[164:167], a[228:231], a[4:7]
    v_rcp_f32 v47, v47
    v_mfma_f32_16x16x32_bf16 a[4:7], v[28:31], a[232:235], a[4:7]
    ds_read_b64_tr_b16 a[136:137], v14 offset:20480
    ds_read_b64_tr_b16 a[138:139], v14 offset:20992
    v_mfma_f32_16x16x32_bf16 a[4:7], v[32:35], a[236:239], a[4:7]
    v_mul_f32 v36, v36, v44
    v_mul_f32 v37, v37, v45
    v_mfma_f32_16x16x32_bf16 a[20:23], v[32:35], v[108:111], a[20:23]
    ds_read_b64_tr_b16 a[140:141], v14 offset:28672
    ds_read_b64_tr_b16 a[142:143], v14 offset:29184
    v_mfma_f32_16x16x32_bf16 a[20:23], v[28:31], v[104:107], a[20:23]
    v_mul_f32 v38, v38, v46
    v_mul_f32 v39, v39, v47
    v_mfma_f32_16x16x32_bf16 a[20:23], a[164:167], v[100:103], a[20:23]
    ds_read_b64_tr_b16 a[144:145], v14 offset:36864
    ds_read_b64_tr_b16 a[146:147], v14 offset:37376
    v_mfma_f32_16x16x32_bf16 a[20:23], a[160:163], v[96:99], a[20:23]
    v_cvt_pk_bf16_f32 v52, v36, v37
    v_cvt_pk_bf16_f32 v53, v38, v39
    v_mfma_f32_16x16x32_bf16 a[20:23], a[156:159], v[92:95], a[20:23]
    ds_read_b64_tr_b16 a[148:149], v14 offset:45056
    ds_read_b64_tr_b16 a[150:151], v14 offset:45568
    v_mfma_f32_16x16x32_bf16 a[20:23], a[152:155], v[88:91], a[20:23]
    v_accvgpr_read_b32 v36, a116
    v_accvgpr_read_b32 v37, a117
    v_mfma_f32_16x16x32_bf16 a[36:39], a[152:155], v[160:163], a[36:39]
    v_accvgpr_read_b32 v38, a118
    v_accvgpr_read_b32 v39, a119
    v_mfma_f32_16x16x32_bf16 a[36:39], a[156:159], v[164:167], a[36:39]
    v_accvgpr_read_b32 v40, a124
    v_accvgpr_read_b32 v41, a125
    v_mfma_f32_16x16x32_bf16 a[36:39], a[160:163], v[168:171], a[36:39]
    v_accvgpr_read_b32 v42, a126
    v_accvgpr_read_b32 v43, a127
    v_mfma_f32_16x16x32_bf16 a[36:39], a[164:167], v[172:175], a[36:39]
    v_mul_f32 v44, v21, v36
    v_mul_f32 v45, v21, v37
    v_mfma_f32_16x16x32_bf16 a[36:39], v[28:31], v[176:179], a[36:39]
    v_mul_f32 v46, v21, v38
    v_mul_f32 v47, v21, v39
    v_mfma_f32_16x16x32_bf16 a[36:39], v[32:35], v[180:183], a[36:39]
    v_exp_f32 v44, v44
    v_mfma_f32_16x16x32_bf16 a[52:55], v[32:35], v[252:255], a[52:55]
    v_exp_f32 v45, v45
    v_mfma_f32_16x16x32_bf16 a[52:55], v[28:31], v[248:251], a[52:55]
    v_exp_f32 v46, v46
    v_mfma_f32_16x16x32_bf16 a[52:55], a[164:167], v[244:247], a[52:55]
    v_exp_f32 v47, v47
    v_mfma_f32_16x16x32_bf16 a[52:55], a[160:163], v[240:243], a[52:55]
    v_mul_f32 v36, v36, v40
    v_mul_f32 v37, v37, v41
    v_mfma_f32_16x16x32_bf16 a[52:55], a[156:159], v[236:239], a[52:55]
    v_mul_f32 v38, v38, v42
    v_mul_f32 v39, v39, v43
    v_mfma_f32_16x16x32_bf16 a[52:55], a[152:155], v[232:235], a[52:55]
    s_waitcnt lgkmcnt(0)
    v_fma_f32 v44, v44, v25, v25
    v_fma_f32 v45, v45, v25, v25
    v_mfma_f32_16x16x32_bf16 a[8:11], a[128:131], a[216:219], a[8:11]
    ds_read_b64_tr_b16 a[152:153], v15 offset:4096
    ds_read_b64_tr_b16 a[154:155], v15 offset:4608
    v_mfma_f32_16x16x32_bf16 a[8:11], a[132:135], a[220:223], a[8:11]
    v_fma_f32 v46, v46, v25, v25
    v_fma_f32 v47, v47, v25, v25
    v_mfma_f32_16x16x32_bf16 a[8:11], a[136:139], a[224:227], a[8:11]
    ds_read_b64_tr_b16 a[156:157], v15 offset:12288
    ds_read_b64_tr_b16 a[158:159], v15 offset:12800
    v_mfma_f32_16x16x32_bf16 a[8:11], a[140:143], a[228:231], a[8:11]
    v_rcp_f32 v44, v44
    v_mfma_f32_16x16x32_bf16 a[8:11], a[144:147], a[232:235], a[8:11]
    ds_read_b64_tr_b16 a[160:161], v15 offset:20480
    ds_read_b64_tr_b16 a[162:163], v15 offset:20992
    v_mfma_f32_16x16x32_bf16 a[8:11], a[148:151], a[236:239], a[8:11]
    v_rcp_f32 v45, v45
    v_mfma_f32_16x16x32_bf16 a[24:27], a[148:151], v[108:111], a[24:27]
    ds_read_b64_tr_b16 a[164:165], v15 offset:28672
    ds_read_b64_tr_b16 a[166:167], v15 offset:29184
    v_mfma_f32_16x16x32_bf16 a[24:27], a[144:147], v[104:107], a[24:27]
    v_rcp_f32 v46, v46
    v_mfma_f32_16x16x32_bf16 a[24:27], a[140:143], v[100:103], a[24:27]
    ds_read_b64_tr_b16 v[28:29], v15 offset:36864
    ds_read_b64_tr_b16 v[30:31], v15 offset:37376
    v_mfma_f32_16x16x32_bf16 a[24:27], a[136:139], v[96:99], a[24:27]
    v_rcp_f32 v47, v47
    v_mfma_f32_16x16x32_bf16 a[24:27], a[132:135], v[92:95], a[24:27]
    ds_read_b64_tr_b16 v[32:33], v15 offset:45056
    ds_read_b64_tr_b16 v[34:35], v15 offset:45568
    v_mfma_f32_16x16x32_bf16 a[24:27], a[128:131], v[88:91], a[24:27]
    v_mul_f32 v36, v36, v44
    v_mul_f32 v37, v37, v45
    v_mfma_f32_16x16x32_bf16 a[40:43], a[128:131], v[160:163], a[40:43]
    v_mul_f32 v38, v38, v46
    v_mul_f32 v39, v39, v47
    v_mfma_f32_16x16x32_bf16 a[40:43], a[132:135], v[164:167], a[40:43]
    s_add_u32 s71, s3, 3
    v_cvt_pk_bf16_f32 v54, v36, v37
    v_cvt_pk_bf16_f32 v55, v38, v39
    v_mfma_f32_16x16x32_bf16 a[40:43], a[136:139], v[168:171], a[40:43]
    s_and_b32 s71, s71, 3
    s_mul_i32 s71, s71, 4096
    s_add_u32 s71, s71, s59
    v_mfma_f32_16x16x32_bf16 a[40:43], a[140:143], v[172:175], a[40:43]
    buffer_store_dwordx4 v[52:55], v2, s[28:31], s71 offen offset:1024 sc1
    v_mfma_f32_16x16x32_bf16 a[40:43], a[144:147], v[176:179], a[40:43]
    v_mfma_f32_16x16x32_bf16 a[40:43], a[148:151], v[180:183], a[40:43]
    v_mfma_f32_16x16x32_bf16 a[56:59], a[148:151], v[252:255], a[56:59]
    v_mfma_f32_16x16x32_bf16 a[56:59], a[144:147], v[248:251], a[56:59]
    v_mfma_f32_16x16x32_bf16 a[56:59], a[140:143], v[244:247], a[56:59]
    v_mfma_f32_16x16x32_bf16 a[56:59], a[136:139], v[240:243], a[56:59]
    v_mfma_f32_16x16x32_bf16 a[56:59], a[132:135], v[236:239], a[56:59]
    v_mfma_f32_16x16x32_bf16 a[56:59], a[128:131], v[232:235], a[56:59]
    s_waitcnt lgkmcnt(0)
    v_mfma_f32_16x16x32_bf16 a[12:15], a[152:155], a[216:219], a[12:15]
    v_subrev_u32 v14, 98304, v14
    v_xor_b32 v14, 64, v14
    v_mfma_f32_16x16x32_bf16 a[12:15], a[156:159], a[220:223], a[12:15]
    ds_read_b64_tr_b16 a[128:129], v14 offset:0
    ds_read_b64_tr_b16 a[130:131], v14 offset:512
    v_mfma_f32_16x16x32_bf16 a[12:15], a[160:163], a[224:227], a[12:15]
    v_mfma_f32_16x16x32_bf16 a[12:15], a[164:167], a[228:231], a[12:15]
    ds_read_b64_tr_b16 a[132:133], v14 offset:8192
    ds_read_b64_tr_b16 a[134:135], v14 offset:8704
    v_mfma_f32_16x16x32_bf16 a[12:15], v[28:31], a[232:235], a[12:15]
    v_mfma_f32_16x16x32_bf16 a[12:15], v[32:35], a[236:239], a[12:15]
    ds_read_b64_tr_b16 a[136:137], v14 offset:16384
    ds_read_b64_tr_b16 a[138:139], v14 offset:16896
    v_mfma_f32_16x16x32_bf16 a[28:31], v[32:35], v[108:111], a[28:31]
    v_mfma_f32_16x16x32_bf16 a[28:31], v[28:31], v[104:107], a[28:31]
    ds_read_b64_tr_b16 a[140:141], v14 offset:24576
    ds_read_b64_tr_b16 a[142:143], v14 offset:25088
    v_mfma_f32_16x16x32_bf16 a[28:31], a[164:167], v[100:103], a[28:31]
    v_mfma_f32_16x16x32_bf16 a[28:31], a[160:163], v[96:99], a[28:31]
    ds_read_b64_tr_b16 a[144:145], v14 offset:32768
    ds_read_b64_tr_b16 a[146:147], v14 offset:33280
    v_mfma_f32_16x16x32_bf16 a[28:31], a[156:159], v[92:95], a[28:31]
    v_mfma_f32_16x16x32_bf16 a[28:31], a[152:155], v[88:91], a[28:31]
    ds_read_b64_tr_b16 a[148:149], v14 offset:40960
    ds_read_b64_tr_b16 a[150:151], v14 offset:41472
    v_mfma_f32_16x16x32_bf16 a[44:47], a[152:155], v[160:163], a[44:47]
    v_mfma_f32_16x16x32_bf16 a[44:47], a[156:159], v[164:167], a[44:47]
    v_mfma_f32_16x16x32_bf16 a[44:47], a[160:163], v[168:171], a[44:47]
    v_mfma_f32_16x16x32_bf16 a[44:47], a[164:167], v[172:175], a[44:47]
    v_mfma_f32_16x16x32_bf16 a[44:47], v[28:31], v[176:179], a[44:47]
    v_mfma_f32_16x16x32_bf16 a[44:47], v[32:35], v[180:183], a[44:47]
    v_mfma_f32_16x16x32_bf16 a[60:63], v[32:35], v[252:255], a[60:63]
    v_mfma_f32_16x16x32_bf16 a[60:63], v[28:31], v[248:251], a[60:63]
    v_mfma_f32_16x16x32_bf16 a[60:63], a[164:167], v[244:247], a[60:63]
    v_mfma_f32_16x16x32_bf16 a[60:63], a[160:163], v[240:243], a[60:63]
    v_mfma_f32_16x16x32_bf16 a[60:63], a[156:159], v[236:239], a[60:63]
    v_mfma_f32_16x16x32_bf16 a[60:63], a[152:155], v[232:235], a[60:63]
    s_waitcnt lgkmcnt(0)
    v_mfma_f32_16x16x32_bf16 a[64:67], a[128:131], a[168:171], 0
    v_subrev_u32 v15, 98304, v15
    v_xor_b32 v15, 64, v15
    v_mfma_f32_16x16x32_bf16 a[64:67], a[132:135], a[172:175], a[64:67]
    ds_read_b64_tr_b16 a[152:153], v15 offset:0
    ds_read_b64_tr_b16 a[154:155], v15 offset:512
    v_mfma_f32_16x16x32_bf16 a[64:67], a[136:139], a[176:179], a[64:67]
    v_mfma_f32_16x16x32_bf16 a[64:67], a[140:143], a[180:183], a[64:67]
    ds_read_b64_tr_b16 a[156:157], v15 offset:8192
    ds_read_b64_tr_b16 a[158:159], v15 offset:8704
    v_mfma_f32_16x16x32_bf16 a[64:67], a[144:147], a[184:187], a[64:67]
    v_accvgpr_read_b32 v36, a0
    v_accvgpr_read_b32 v37, a1
    v_mfma_f32_16x16x32_bf16 a[64:67], a[148:151], a[188:191], a[64:67]
    ds_read_b64_tr_b16 a[160:161], v15 offset:16384
    ds_read_b64_tr_b16 a[162:163], v15 offset:16896
    v_mfma_f32_16x16x32_bf16 a[80:83], a[148:151], v[60:63], 0
    v_accvgpr_read_b32 v38, a2
    v_accvgpr_read_b32 v39, a3
    v_mfma_f32_16x16x32_bf16 a[80:83], a[144:147], v[56:59], a[80:83]
    ds_read_b64_tr_b16 a[164:165], v15 offset:24576
    ds_read_b64_tr_b16 a[166:167], v15 offset:25088
    v_mfma_f32_16x16x32_bf16 a[80:83], a[140:143], a[252:255], a[80:83]
    v_accvgpr_read_b32 v40, a8
    v_accvgpr_read_b32 v41, a9
    v_mfma_f32_16x16x32_bf16 a[80:83], a[136:139], a[248:251], a[80:83]
    ds_read_b64_tr_b16 v[28:29], v15 offset:32768
    ds_read_b64_tr_b16 v[30:31], v15 offset:33280
    v_mfma_f32_16x16x32_bf16 a[80:83], a[132:135], a[244:247], a[80:83]
    v_accvgpr_read_b32 v42, a10
    v_accvgpr_read_b32 v43, a11
    v_mfma_f32_16x16x32_bf16 a[80:83], a[128:131], a[240:243], a[80:83]
    ds_read_b64_tr_b16 v[32:33], v15 offset:40960
    ds_read_b64_tr_b16 v[34:35], v15 offset:41472
    v_mfma_f32_16x16x32_bf16 a[96:99], a[128:131], v[112:115], 0
    v_mul_f32 v44, v18, v36
    v_mul_f32 v45, v18, v37
    v_mfma_f32_16x16x32_bf16 a[96:99], a[132:135], v[116:119], a[96:99]
    v_mul_f32 v46, v18, v38
    v_mul_f32 v47, v18, v39
    v_mfma_f32_16x16x32_bf16 a[96:99], a[136:139], v[120:123], a[96:99]
    v_exp_f32 v44, v44
    v_mfma_f32_16x16x32_bf16 a[96:99], a[140:143], v[124:127], a[96:99]
    v_exp_f32 v45, v45
    v_mfma_f32_16x16x32_bf16 a[96:99], a[144:147], v[128:131], a[96:99]
    v_exp_f32 v46, v46
    v_mfma_f32_16x16x32_bf16 a[96:99], a[148:151], v[132:135], a[96:99]
    v_exp_f32 v47, v47
    v_mfma_f32_16x16x32_bf16 a[112:115], a[148:151], v[204:207], 0
    v_mul_f32 v36, v36, v40
    v_mul_f32 v37, v37, v41
    v_mfma_f32_16x16x32_bf16 a[112:115], a[144:147], v[200:203], a[112:115]
    v_mul_f32 v38, v38, v42
    v_mul_f32 v39, v39, v43
    v_mfma_f32_16x16x32_bf16 a[112:115], a[140:143], v[196:199], a[112:115]
    v_fma_f32 v44, v44, v22, v22
    v_fma_f32 v45, v45, v22, v22
    v_mfma_f32_16x16x32_bf16 a[112:115], a[136:139], v[192:195], a[112:115]
    v_fma_f32 v46, v46, v22, v22
    v_fma_f32 v47, v47, v22, v22
    v_mfma_f32_16x16x32_bf16 a[112:115], a[132:135], v[188:191], a[112:115]
    v_rcp_f32 v44, v44
    v_mfma_f32_16x16x32_bf16 a[112:115], a[128:131], v[184:187], a[112:115]
    s_waitcnt lgkmcnt(0)
    v_rcp_f32 v45, v45
    v_mfma_f32_16x16x32_bf16 a[68:71], a[152:155], a[168:171], 0
    ds_read_b64_tr_b16 a[128:129], v14 offset:4096
    ds_read_b64_tr_b16 a[130:131], v14 offset:4608
    v_mfma_f32_16x16x32_bf16 a[68:71], a[156:159], a[172:175], a[68:71]
    v_rcp_f32 v46, v46
    v_mfma_f32_16x16x32_bf16 a[68:71], a[160:163], a[176:179], a[68:71]
    ds_read_b64_tr_b16 a[132:133], v14 offset:12288
    ds_read_b64_tr_b16 a[134:135], v14 offset:12800
    v_mfma_f32_16x16x32_bf16 a[68:71], a[164:167], a[180:183], a[68:71]
    v_rcp_f32 v47, v47
    v_mfma_f32_16x16x32_bf16 a[68:71], v[28:31], a[184:187], a[68:71]
    ds_read_b64_tr_b16 a[136:137], v14 offset:20480
    ds_read_b64_tr_b16 a[138:139], v14 offset:20992
    v_mfma_f32_16x16x32_bf16 a[68:71], v[32:35], a[188:191], a[68:71]
    v_mul_f32 v36, v36, v44
    v_mul_f32 v37, v37, v45
    v_mfma_f32_16x16x32_bf16 a[84:87], v[32:35], v[60:63], 0
    ds_read_b64_tr_b16 a[140:141], v14 offset:28672
    ds_read_b64_tr_b16 a[142:143], v14 offset:29184
    v_mfma_f32_16x16x32_bf16 a[84:87], v[28:31], v[56:59], a[84:87]
    v_mul_f32 v38, v38, v46
    v_mul_f32 v39, v39, v47
    v_mfma_f32_16x16x32_bf16 a[84:87], a[164:167], a[252:255], a[84:87]
    ds_read_b64_tr_b16 a[144:145], v14 offset:36864
    ds_read_b64_tr_b16 a[146:147], v14 offset:37376
    v_mfma_f32_16x16x32_bf16 a[84:87], a[160:163], a[248:251], a[84:87]
    v_cvt_pk_bf16_f32 v48, v36, v37
    v_cvt_pk_bf16_f32 v49, v38, v39
    v_mfma_f32_16x16x32_bf16 a[84:87], a[156:159], a[244:247], a[84:87]
    ds_read_b64_tr_b16 a[148:149], v14 offset:45056
    ds_read_b64_tr_b16 a[150:151], v14 offset:45568
    v_mfma_f32_16x16x32_bf16 a[84:87], a[152:155], a[240:243], a[84:87]
    v_accvgpr_read_b32 v36, a4
    v_accvgpr_read_b32 v37, a5
    v_mfma_f32_16x16x32_bf16 a[100:103], a[152:155], v[112:115], 0
    v_accvgpr_read_b32 v38, a6
    v_accvgpr_read_b32 v39, a7
    v_mfma_f32_16x16x32_bf16 a[100:103], a[156:159], v[116:119], a[100:103]
    v_accvgpr_read_b32 v40, a12
    v_accvgpr_read_b32 v41, a13
    v_mfma_f32_16x16x32_bf16 a[100:103], a[160:163], v[120:123], a[100:103]
    v_accvgpr_read_b32 v42, a14
    v_accvgpr_read_b32 v43, a15
    v_mfma_f32_16x16x32_bf16 a[100:103], a[164:167], v[124:127], a[100:103]
    v_mul_f32 v44, v18, v36
    v_mul_f32 v45, v18, v37
    v_mfma_f32_16x16x32_bf16 a[100:103], v[28:31], v[128:131], a[100:103]
    v_mul_f32 v46, v18, v38
    v_mul_f32 v47, v18, v39
    v_mfma_f32_16x16x32_bf16 a[100:103], v[32:35], v[132:135], a[100:103]
    v_exp_f32 v44, v44
    v_mfma_f32_16x16x32_bf16 a[116:119], v[32:35], v[204:207], 0
    v_exp_f32 v45, v45
    v_mfma_f32_16x16x32_bf16 a[116:119], v[28:31], v[200:203], a[116:119]
    v_exp_f32 v46, v46
    v_mfma_f32_16x16x32_bf16 a[116:119], a[164:167], v[196:199], a[116:119]
    v_exp_f32 v47, v47
    v_mfma_f32_16x16x32_bf16 a[116:119], a[160:163], v[192:195], a[116:119]
    v_mul_f32 v36, v36, v40
    v_mul_f32 v37, v37, v41
    v_mfma_f32_16x16x32_bf16 a[116:119], a[156:159], v[188:191], a[116:119]
    v_mul_f32 v38, v38, v42
    v_mul_f32 v39, v39, v43
    v_mfma_f32_16x16x32_bf16 a[116:119], a[152:155], v[184:187], a[116:119]
    s_waitcnt lgkmcnt(0)
    v_fma_f32 v44, v44, v22, v22
    v_fma_f32 v45, v45, v22, v22
    v_mfma_f32_16x16x32_bf16 a[72:75], a[128:131], a[168:171], 0
    ds_read_b64_tr_b16 a[152:153], v15 offset:4096
    ds_read_b64_tr_b16 a[154:155], v15 offset:4608
    v_mfma_f32_16x16x32_bf16 a[72:75], a[132:135], a[172:175], a[72:75]
    v_fma_f32 v46, v46, v22, v22
    v_fma_f32 v47, v47, v22, v22
    v_mfma_f32_16x16x32_bf16 a[72:75], a[136:139], a[176:179], a[72:75]
    ds_read_b64_tr_b16 a[156:157], v15 offset:12288
    ds_read_b64_tr_b16 a[158:159], v15 offset:12800
    v_mfma_f32_16x16x32_bf16 a[72:75], a[140:143], a[180:183], a[72:75]
    v_rcp_f32 v44, v44
    v_mfma_f32_16x16x32_bf16 a[72:75], a[144:147], a[184:187], a[72:75]
    ds_read_b64_tr_b16 a[160:161], v15 offset:20480
    ds_read_b64_tr_b16 a[162:163], v15 offset:20992
    v_mfma_f32_16x16x32_bf16 a[72:75], a[148:151], a[188:191], a[72:75]
    v_rcp_f32 v45, v45
    v_mfma_f32_16x16x32_bf16 a[88:91], a[148:151], v[60:63], 0
    ds_read_b64_tr_b16 a[164:165], v15 offset:28672
    ds_read_b64_tr_b16 a[166:167], v15 offset:29184
    v_mfma_f32_16x16x32_bf16 a[88:91], a[144:147], v[56:59], a[88:91]
    v_rcp_f32 v46, v46
    v_mfma_f32_16x16x32_bf16 a[88:91], a[140:143], a[252:255], a[88:91]
    ds_read_b64_tr_b16 v[28:29], v15 offset:36864
    ds_read_b64_tr_b16 v[30:31], v15 offset:37376
    v_mfma_f32_16x16x32_bf16 a[88:91], a[136:139], a[248:251], a[88:91]
    v_rcp_f32 v47, v47
    v_mfma_f32_16x16x32_bf16 a[88:91], a[132:135], a[244:247], a[88:91]
    ds_read_b64_tr_b16 v[32:33], v15 offset:45056
    ds_read_b64_tr_b16 v[34:35], v15 offset:45568
    v_mfma_f32_16x16x32_bf16 a[88:91], a[128:131], a[240:243], a[88:91]
    v_mul_f32 v36, v36, v44
    v_mul_f32 v37, v37, v45
    v_mfma_f32_16x16x32_bf16 a[104:107], a[128:131], v[112:115], 0
    v_mul_f32 v38, v38, v46
    v_mul_f32 v39, v39, v47
    v_mfma_f32_16x16x32_bf16 a[104:107], a[132:135], v[116:119], a[104:107]
    s_add_u32 s71, s3, 0
    v_cvt_pk_bf16_f32 v50, v36, v37
    v_cvt_pk_bf16_f32 v51, v38, v39
    v_mfma_f32_16x16x32_bf16 a[104:107], a[136:139], v[120:123], a[104:107]
    s_and_b32 s71, s71, 3
    s_mul_i32 s71, s71, 4096
    s_add_u32 s71, s71, s59
    v_mfma_f32_16x16x32_bf16 a[104:107], a[140:143], v[124:127], a[104:107]
    buffer_store_dwordx4 v[48:51], v2, s[28:31], s71 offen offset:2048 sc1
    v_accvgpr_read_b32 v36, a16
    v_mfma_f32_16x16x32_bf16 a[104:107], a[144:147], v[128:131], a[104:107]
    v_accvgpr_read_b32 v37, a17
    v_accvgpr_read_b32 v38, a18
    v_mfma_f32_16x16x32_bf16 a[104:107], a[148:151], v[132:135], a[104:107]
    v_accvgpr_read_b32 v39, a19
    v_accvgpr_read_b32 v40, a24
    v_mfma_f32_16x16x32_bf16 a[120:123], a[148:151], v[204:207], 0
    v_accvgpr_read_b32 v41, a25
    v_accvgpr_read_b32 v42, a26
    v_mfma_f32_16x16x32_bf16 a[120:123], a[144:147], v[200:203], a[120:123]
    v_accvgpr_read_b32 v43, a27
    v_mul_f32 v44, v19, v36
    v_mfma_f32_16x16x32_bf16 a[120:123], a[140:143], v[196:199], a[120:123]
    v_mul_f32 v45, v19, v37
    v_mul_f32 v46, v19, v38
    v_mfma_f32_16x16x32_bf16 a[120:123], a[136:139], v[192:195], a[120:123]
    v_mul_f32 v47, v19, v39
    v_mfma_f32_16x16x32_bf16 a[120:123], a[132:135], v[188:191], a[120:123]
    v_exp_f32 v44, v44
    v_mfma_f32_16x16x32_bf16 a[120:123], a[128:131], v[184:187], a[120:123]
    s_waitcnt lgkmcnt(0)
    v_exp_f32 v45, v45
    v_mfma_f32_16x16x32_bf16 a[76:79], a[152:155], a[168:171], 0
    v_exp_f32 v46, v46
    v_mfma_f32_16x16x32_bf16 a[76:79], a[156:159], a[172:175], a[76:79]
    s_barrier
    v_add_u32 v14, 49152, v14
    v_mfma_f32_16x16x32_bf16 a[76:79], a[160:163], a[176:179], a[76:79]
    s_add_u32 m0, s63, 0
    ds_read_b64_tr_b16 a[128:129], v14 offset:0
    ds_read_b64_tr_b16 a[130:131], v14 offset:512
    v_mfma_f32_16x16x32_bf16 a[76:79], a[164:167], a[180:183], a[76:79]
    s_mul_i32 s56, s72, 1572864
    s_add_u32 s56, s56, s55
    v_mfma_f32_16x16x32_bf16 a[76:79], v[28:31], a[184:187], a[76:79]
    ds_read_b64_tr_b16 a[132:133], v14 offset:8192
    ds_read_b64_tr_b16 a[134:135], v14 offset:8704
    v_mfma_f32_16x16x32_bf16 a[76:79], v[32:35], a[188:191], a[76:79]
    buffer_load_dwordx4 v11, s[8:11], s56 offen nt lds
    v_mfma_f32_16x16x32_bf16 a[92:95], v[32:35], v[60:63], 0
    ds_read_b64_tr_b16 a[136:137], v14 offset:16384
    ds_read_b64_tr_b16 a[138:139], v14 offset:16896
    v_mfma_f32_16x16x32_bf16 a[92:95], v[28:31], v[56:59], a[92:95]
    v_exp_f32 v47, v47
    v_mfma_f32_16x16x32_bf16 a[92:95], a[164:167], a[252:255], a[92:95]
    ds_read_b64_tr_b16 a[140:141], v14 offset:24576
    ds_read_b64_tr_b16 a[142:143], v14 offset:25088
    v_mfma_f32_16x16x32_bf16 a[92:95], a[160:163], a[248:251], a[92:95]
    v_mul_f32 v36, v36, v40
    v_mul_f32 v37, v37, v41
    v_mfma_f32_16x16x32_bf16 a[92:95], a[156:159], a[244:247], a[92:95]
    ds_read_b64_tr_b16 a[144:145], v14 offset:32768
    ds_read_b64_tr_b16 a[146:147], v14 offset:33280
    v_mfma_f32_16x16x32_bf16 a[92:95], a[152:155], a[240:243], a[92:95]
    buffer_load_dwordx4 v12, s[8:11], s56 offen offset:1024 nt lds
    v_mul_f32 v38, v38, v42
    v_mfma_f32_16x16x32_bf16 a[108:111], a[152:155], v[112:115], 0
    ds_read_b64_tr_b16 a[148:149], v14 offset:40960
    ds_read_b64_tr_b16 a[150:151], v14 offset:41472
    v_mfma_f32_16x16x32_bf16 a[108:111], a[156:159], v[116:119], a[108:111]
    v_mul_f32 v39, v39, v43
    v_fma_f32 v44, v44, v23, v23
    v_mfma_f32_16x16x32_bf16 a[108:111], a[160:163], v[120:123], a[108:111]
    v_fma_f32 v45, v45, v23, v23
    v_fma_f32 v46, v46, v23, v23
    v_mfma_f32_16x16x32_bf16 a[108:111], a[164:167], v[124:127], a[108:111]
    v_fma_f32 v47, v47, v23, v23
    v_mfma_f32_16x16x32_bf16 a[108:111], v[28:31], v[128:131], a[108:111]
    v_rcp_f32 v44, v44
    v_mfma_f32_16x16x32_bf16 a[108:111], v[32:35], v[132:135], a[108:111]
    v_rcp_f32 v45, v45
    v_mfma_f32_16x16x32_bf16 a[124:127], v[32:35], v[204:207], 0
    v_rcp_f32 v46, v46
    v_mfma_f32_16x16x32_bf16 a[124:127], v[28:31], v[200:203], a[124:127]
    v_rcp_f32 v47, v47
    v_mfma_f32_16x16x32_bf16 a[124:127], a[164:167], v[196:199], a[124:127]
    s_add_u32 m0, s63, 8192
    s_add_u32 s56, s56, 262144
    v_mul_f32 v36, v36, v44
    v_mfma_f32_16x16x32_bf16 a[124:127], a[160:163], v[192:195], a[124:127]
    buffer_load_dwordx4 v11, s[8:11], s56 offen nt lds
    v_mul_f32 v37, v37, v45
    v_mfma_f32_16x16x32_bf16 a[124:127], a[156:159], v[188:191], a[124:127]
    v_mul_f32 v38, v38, v46
    v_mul_f32 v39, v39, v47
    v_mfma_f32_16x16x32_bf16 a[124:127], a[152:155], v[184:187], a[124:127]
    s_waitcnt lgkmcnt(0)
    v_cvt_pk_bf16_f32 v52, v36, v37
    v_cvt_pk_bf16_f32 v53, v38, v39
    v_mfma_f32_16x16x32_bf16 a[64:67], a[128:131], a[192:195], a[64:67]
    v_add_u32 v15, 49152, v15
    v_accvgpr_read_b32 v36, a20
    v_mfma_f32_16x16x32_bf16 a[64:67], a[132:135], a[196:199], a[64:67]
    ds_read_b64_tr_b16 a[152:153], v15 offset:0
    ds_read_b64_tr_b16 a[154:155], v15 offset:512
    v_mfma_f32_16x16x32_bf16 a[64:67], a[136:139], a[200:203], a[64:67]
    v_accvgpr_read_b32 v37, a21
    v_accvgpr_read_b32 v38, a22
    v_mfma_f32_16x16x32_bf16 a[64:67], a[140:143], a[204:207], a[64:67]
    ds_read_b64_tr_b16 a[156:157], v15 offset:8192
    ds_read_b64_tr_b16 a[158:159], v15 offset:8704
    v_mfma_f32_16x16x32_bf16 a[64:67], a[144:147], a[208:211], a[64:67]
    v_accvgpr_read_b32 v39, a23
    v_accvgpr_read_b32 v40, a28
    v_mfma_f32_16x16x32_bf16 a[64:67], a[148:151], a[212:215], a[64:67]
    ds_read_b64_tr_b16 a[160:161], v15 offset:16384
    ds_read_b64_tr_b16 a[162:163], v15 offset:16896
    v_mfma_f32_16x16x32_bf16 a[80:83], a[148:151], v[84:87], a[80:83]
    buffer_load_dwordx4 v12, s[8:11], s56 offen offset:1024 nt lds
    v_accvgpr_read_b32 v41, a29
    v_mfma_f32_16x16x32_bf16 a[80:83], a[144:147], v[80:83], a[80:83]
    ds_read_b64_tr_b16 a[164:165], v15 offset:24576
    ds_read_b64_tr_b16 a[166:167], v15 offset:25088
    v_mfma_f32_16x16x32_bf16 a[80:83], a[140:143], v[76:79], a[80:83]
    v_accvgpr_read_b32 v42, a30
    v_accvgpr_read_b32 v43, a31
    v_mfma_f32_16x16x32_bf16 a[80:83], a[136:139], v[72:75], a[80:83]
    ds_read_b64_tr_b16 v[28:29], v15 offset:32768
    ds_read_b64_tr_b16 v[30:31], v15 offset:33280
    v_mfma_f32_16x16x32_bf16 a[80:83], a[132:135], v[68:71], a[80:83]
    v_mul_f32 v44, v19, v36
    v_mul_f32 v45, v19, v37
    v_mfma_f32_16x16x32_bf16 a[80:83], a[128:131], v[64:67], a[80:83]
    ds_read_b64_tr_b16 v[32:33], v15 offset:40960
    ds_read_b64_tr_b16 v[34:35], v15 offset:41472
    v_mfma_f32_16x16x32_bf16 a[96:99], a[128:131], v[136:139], a[96:99]
    v_mul_f32 v46, v19, v38
    v_mul_f32 v47, v19, v39
    v_mfma_f32_16x16x32_bf16 a[96:99], a[132:135], v[140:143], a[96:99]
    v_exp_f32 v44, v44
    v_mfma_f32_16x16x32_bf16 a[96:99], a[136:139], v[144:147], a[96:99]
    s_add_u32 m0, s63, 16384
    s_add_u32 s56, s56, 262144
    v_mfma_f32_16x16x32_bf16 a[96:99], a[140:143], v[148:151], a[96:99]
    buffer_load_dwordx4 v11, s[8:11], s56 offen nt lds
    v_mfma_f32_16x16x32_bf16 a[96:99], a[144:147], v[152:155], a[96:99]
    v_exp_f32 v45, v45
    v_mfma_f32_16x16x32_bf16 a[96:99], a[148:151], v[156:159], a[96:99]
    v_exp_f32 v46, v46
    v_mfma_f32_16x16x32_bf16 a[112:115], a[148:151], v[228:231], a[112:115]
    v_exp_f32 v47, v47
    v_mfma_f32_16x16x32_bf16 a[112:115], a[144:147], v[224:227], a[112:115]
    v_mul_f32 v36, v36, v40
    v_mul_f32 v37, v37, v41
    v_mfma_f32_16x16x32_bf16 a[112:115], a[140:143], v[220:223], a[112:115]
    v_mul_f32 v38, v38, v42
    v_mul_f32 v39, v39, v43
    v_mfma_f32_16x16x32_bf16 a[112:115], a[136:139], v[216:219], a[112:115]
    v_fma_f32 v44, v44, v23, v23
    v_fma_f32 v45, v45, v23, v23
    v_mfma_f32_16x16x32_bf16 a[112:115], a[132:135], v[212:215], a[112:115]
    v_fma_f32 v46, v46, v23, v23
    v_fma_f32 v47, v47, v23, v23
    v_mfma_f32_16x16x32_bf16 a[112:115], a[128:131], v[208:211], a[112:115]
    s_waitcnt lgkmcnt(0)
    buffer_load_dwordx4 v12, s[8:11], s56 offen offset:1024 nt lds
    v_mfma_f32_16x16x32_bf16 a[68:71], a[152:155], a[192:195], a[68:71]
    ds_read_b64_tr_b16 a[128:129], v14 offset:4096
    ds_read_b64_tr_b16 a[130:131], v14 offset:4608
    v_mfma_f32_16x16x32_bf16 a[68:71], a[156:159], a[196:199], a[68:71]
    v_rcp_f32 v44, v44
    v_mfma_f32_16x16x32_bf16 a[68:71], a[160:163], a[200:203], a[68:71]
    ds_read_b64_tr_b16 a[132:133], v14 offset:12288
    ds_read_b64_tr_b16 a[134:135], v14 offset:12800
    v_mfma_f32_16x16x32_bf16 a[68:71], a[164:167], a[204:207], a[68:71]
    v_rcp_f32 v45, v45
    v_mfma_f32_16x16x32_bf16 a[68:71], v[28:31], a[208:211], a[68:71]
    ds_read_b64_tr_b16 a[136:137], v14 offset:20480
    ds_read_b64_tr_b16 a[138:139], v14 offset:20992
    v_mfma_f32_16x16x32_bf16 a[68:71], v[32:35], a[212:215], a[68:71]
    v_rcp_f32 v46, v46
    v_mfma_f32_16x16x32_bf16 a[84:87], v[32:35], v[84:87], a[84:87]
    ds_read_b64_tr_b16 a[140:141], v14 offset:28672
    ds_read_b64_tr_b16 a[142:143], v14 offset:29184
    v_mfma_f32_16x16x32_bf16 a[84:87], v[28:31], v[80:83], a[84:87]
    v_rcp_f32 v47, v47
    v_mfma_f32_16x16x32_bf16 a[84:87], a[164:167], v[76:79], a[84:87]
    s_add_u32 m0, s63, 24576
    ds_read_b64_tr_b16 a[144:145], v14 offset:36864
    ds_read_b64_tr_b16 a[146:147], v14 offset:37376
    v_mfma_f32_16x16x32_bf16 a[84:87], a[160:163], v[72:75], a[84:87]
    s_add_u32 s56, s56, 262144
    v_mul_f32 v36, v36, v44
    v_mul_f32 v37, v37, v45
    v_mfma_f32_16x16x32_bf16 a[84:87], a[156:159], v[68:71], a[84:87]
    ds_read_b64_tr_b16 a[148:149], v14 offset:45056
    ds_read_b64_tr_b16 a[150:151], v14 offset:45568
    v_mfma_f32_16x16x32_bf16 a[84:87], a[152:155], v[64:67], a[84:87]
    buffer_load_dwordx4 v11, s[8:11], s56 offen nt lds
    v_mul_f32 v38, v38, v46
    v_mfma_f32_16x16x32_bf16 a[100:103], a[152:155], v[136:139], a[100:103]
    v_mul_f32 v39, v39, v47
    v_cvt_pk_bf16_f32 v54, v36, v37
    v_mfma_f32_16x16x32_bf16 a[100:103], a[156:159], v[140:143], a[100:103]
    s_add_u32 s71, s3, 1
    s_and_b32 s71, s71, 3
    v_cvt_pk_bf16_f32 v55, v38, v39
    v_mfma_f32_16x16x32_bf16 a[100:103], a[160:163], v[144:147], a[100:103]
    s_mul_i32 s71, s71, 4096
    s_add_u32 s71, s71, s59
    buffer_store_dwordx4 v[52:55], v2, s[28:31], s71 offen offset:2048 sc1
    v_mfma_f32_16x16x32_bf16 a[100:103], a[164:167], v[148:151], a[100:103]
    v_accvgpr_read_b32 v36, a32
    v_accvgpr_read_b32 v37, a33
    v_mfma_f32_16x16x32_bf16 a[100:103], v[28:31], v[152:155], a[100:103]
    v_accvgpr_read_b32 v38, a34
    v_accvgpr_read_b32 v39, a35
    v_mfma_f32_16x16x32_bf16 a[100:103], v[32:35], v[156:159], a[100:103]
    buffer_load_dwordx4 v12, s[8:11], s56 offen offset:1024 nt lds
    v_accvgpr_read_b32 v40, a40
    v_mfma_f32_16x16x32_bf16 a[116:119], v[32:35], v[228:231], a[116:119]
    v_accvgpr_read_b32 v41, a41
    v_accvgpr_read_b32 v42, a42
    v_mfma_f32_16x16x32_bf16 a[116:119], v[28:31], v[224:227], a[116:119]
    v_accvgpr_read_b32 v43, a43
    v_mul_f32 v44, v20, v36
    v_mfma_f32_16x16x32_bf16 a[116:119], a[164:167], v[220:223], a[116:119]
    v_mul_f32 v45, v20, v37
    v_mul_f32 v46, v20, v38
    v_mfma_f32_16x16x32_bf16 a[116:119], a[160:163], v[216:219], a[116:119]
    v_mul_f32 v47, v20, v39
    v_mfma_f32_16x16x32_bf16 a[116:119], a[156:159], v[212:215], a[116:119]
    v_exp_f32 v44, v44
    v_mfma_f32_16x16x32_bf16 a[116:119], a[152:155], v[208:211], a[116:119]
    s_waitcnt lgkmcnt(0)
    v_exp_f32 v45, v45
    v_mfma_f32_16x16x32_bf16 a[72:75], a[128:131], a[192:195], a[72:75]
    ds_read_b64_tr_b16 a[152:153], v15 offset:4096
    ds_read_b64_tr_b16 a[154:155], v15 offset:4608
    v_mfma_f32_16x16x32_bf16 a[72:75], a[132:135], a[196:199], a[72:75]
    v_exp_f32 v46, v46
    v_mfma_f32_16x16x32_bf16 a[72:75], a[136:139], a[200:203], a[72:75]
    s_add_u32 m0, s63, 32768
    ds_read_b64_tr_b16 a[156:157], v15 offset:12288
    ds_read_b64_tr_b16 a[158:159], v15 offset:12800
    v_mfma_f32_16x16x32_bf16 a[72:75], a[140:143], a[204:207], a[72:75]
    s_add_u32 s56, s56, 262144
    v_exp_f32 v47, v47
    v_mfma_f32_16x16x32_bf16 a[72:75], a[144:147], a[208:211], a[72:75]
    ds_read_b64_tr_b16 a[160:161], v15 offset:20480
    ds_read_b64_tr_b16 a[162:163], v15 offset:20992
    v_mfma_f32_16x16x32_bf16 a[72:75], a[148:151], a[212:215], a[72:75]
    buffer_load_dwordx4 v11, s[8:11], s56 offen nt lds
    v_mul_f32 v36, v36, v40
    v_mfma_f32_16x16x32_bf16 a[88:91], a[148:151], v[84:87], a[88:91]
    ds_read_b64_tr_b16 a[164:165], v15 offset:28672
    ds_read_b64_tr_b16 a[166:167], v15 offset:29184
    v_mfma_f32_16x16x32_bf16 a[88:91], a[144:147], v[80:83], a[88:91]
    v_mul_f32 v37, v37, v41
    v_mul_f32 v38, v38, v42
    v_mfma_f32_16x16x32_bf16 a[88:91], a[140:143], v[76:79], a[88:91]
    ds_read_b64_tr_b16 v[28:29], v15 offset:36864
    ds_read_b64_tr_b16 v[30:31], v15 offset:37376
    v_mfma_f32_16x16x32_bf16 a[88:91], a[136:139], v[72:75], a[88:91]
    v_mul_f32 v39, v39, v43
    v_fma_f32 v44, v44, v24, v24
    v_mfma_f32_16x16x32_bf16 a[88:91], a[132:135], v[68:71], a[88:91]
    ds_read_b64_tr_b16 v[32:33], v15 offset:45056
    ds_read_b64_tr_b16 v[34:35], v15 offset:45568
    v_mfma_f32_16x16x32_bf16 a[88:91], a[128:131], v[64:67], a[88:91]
    buffer_load_dwordx4 v12, s[8:11], s56 offen offset:1024 nt lds
    v_fma_f32 v45, v45, v24, v24
    v_mfma_f32_16x16x32_bf16 a[104:107], a[128:131], v[136:139], a[104:107]
    v_fma_f32 v46, v46, v24, v24
    v_fma_f32 v47, v47, v24, v24
    v_mfma_f32_16x16x32_bf16 a[104:107], a[132:135], v[140:143], a[104:107]
    v_rcp_f32 v44, v44
    v_mfma_f32_16x16x32_bf16 a[104:107], a[136:139], v[144:147], a[104:107]
    v_rcp_f32 v45, v45
    v_mfma_f32_16x16x32_bf16 a[104:107], a[140:143], v[148:151], a[104:107]
    v_rcp_f32 v46, v46
    v_mfma_f32_16x16x32_bf16 a[104:107], a[144:147], v[152:155], a[104:107]
    v_rcp_f32 v47, v47
    v_mfma_f32_16x16x32_bf16 a[104:107], a[148:151], v[156:159], a[104:107]
    v_mul_f32 v36, v36, v44
    v_mul_f32 v37, v37, v45
    v_mfma_f32_16x16x32_bf16 a[120:123], a[148:151], v[228:231], a[120:123]
    v_mul_f32 v38, v38, v46
    v_mul_f32 v39, v39, v47
    v_mfma_f32_16x16x32_bf16 a[120:123], a[144:147], v[224:227], a[120:123]
    v_cvt_pk_bf16_f32 v48, v36, v37
    v_cvt_pk_bf16_f32 v49, v38, v39
    v_mfma_f32_16x16x32_bf16 a[120:123], a[140:143], v[220:223], a[120:123]
    s_add_u32 m0, s63, 40960
    s_add_u32 s56, s56, 262144
    v_accvgpr_read_b32 v36, a36
    v_mfma_f32_16x16x32_bf16 a[120:123], a[136:139], v[216:219], a[120:123]
    buffer_load_dwordx4 v11, s[8:11], s56 offen nt lds
    v_accvgpr_read_b32 v37, a37
    v_mfma_f32_16x16x32_bf16 a[120:123], a[132:135], v[212:215], a[120:123]
    v_accvgpr_read_b32 v38, a38
    v_accvgpr_read_b32 v39, a39
    v_mfma_f32_16x16x32_bf16 a[120:123], a[128:131], v[208:211], a[120:123]
    s_waitcnt lgkmcnt(0)
    v_accvgpr_read_b32 v40, a44
    v_accvgpr_read_b32 v41, a45
    v_mfma_f32_16x16x32_bf16 a[76:79], a[152:155], a[192:195], a[76:79]
    v_accvgpr_read_b32 v42, a46
    v_accvgpr_read_b32 v43, a47
    v_mfma_f32_16x16x32_bf16 a[76:79], a[156:159], a[196:199], a[76:79]
    s_barrier
    v_add_u32 v14, 49152, v14
    v_mul_f32 v44, v20, v36
    v_mfma_f32_16x16x32_bf16 a[76:79], a[160:163], a[200:203], a[76:79]
    ds_read_b64_tr_b16 a[128:129], v14 offset:0
    ds_read_b64_tr_b16 a[130:131], v14 offset:512
    v_mfma_f32_16x16x32_bf16 a[76:79], a[164:167], a[204:207], a[76:79]
    v_mul_f32 v45, v20, v37
    v_mul_f32 v46, v20, v38
    v_mfma_f32_16x16x32_bf16 a[76:79], v[28:31], a[208:211], a[76:79]
    ds_read_b64_tr_b16 a[132:133], v14 offset:8192
    ds_read_b64_tr_b16 a[134:135], v14 offset:8704
    v_mfma_f32_16x16x32_bf16 a[76:79], v[32:35], a[212:215], a[76:79]
    buffer_load_dwordx4 v12, s[8:11], s56 offen offset:1024 nt lds
    v_mul_f32 v47, v20, v39
    v_mfma_f32_16x16x32_bf16 a[92:95], v[32:35], v[84:87], a[92:95]
    s_add_u32 m0, s63, 49152
    ds_read_b64_tr_b16 a[136:137], v14 offset:16384
    ds_read_b64_tr_b16 a[138:139], v14 offset:16896
    v_mfma_f32_16x16x32_bf16 a[92:95], v[28:31], v[80:83], a[92:95]
    s_mul_i32 s56, s73, 1572864
    s_add_u32 s56, s56, s55
    v_mfma_f32_16x16x32_bf16 a[92:95], a[164:167], v[76:79], a[92:95]
    ds_read_b64_tr_b16 a[140:141], v14 offset:24576
    ds_read_b64_tr_b16 a[142:143], v14 offset:25088
    v_mfma_f32_16x16x32_bf16 a[92:95], a[160:163], v[72:75], a[92:95]
    buffer_load_dwordx4 v11, s[8:11], s56 offen nt lds
    v_mfma_f32_16x16x32_bf16 a[92:95], a[156:159], v[68:71], a[92:95]
    ds_read_b64_tr_b16 a[144:145], v14 offset:32768
    ds_read_b64_tr_b16 a[146:147], v14 offset:33280
    v_mfma_f32_16x16x32_bf16 a[92:95], a[152:155], v[64:67], a[92:95]
    buffer_load_dwordx4 v12, s[8:11], s56 offen offset:1024 nt lds
    v_mfma_f32_16x16x32_bf16 a[108:111], a[152:155], v[136:139], a[108:111]
    ds_read_b64_tr_b16 a[148:149], v14 offset:40960
    ds_read_b64_tr_b16 a[150:151], v14 offset:41472
    v_mfma_f32_16x16x32_bf16 a[108:111], a[156:159], v[140:143], a[108:111]
    v_exp_f32 v44, v44
    v_mfma_f32_16x16x32_bf16 a[108:111], a[160:163], v[144:147], a[108:111]
    v_exp_f32 v45, v45
    v_mfma_f32_16x16x32_bf16 a[108:111], a[164:167], v[148:151], a[108:111]
    v_exp_f32 v46, v46
    v_mfma_f32_16x16x32_bf16 a[108:111], v[28:31], v[152:155], a[108:111]
    v_exp_f32 v47, v47
    v_mfma_f32_16x16x32_bf16 a[108:111], v[32:35], v[156:159], a[108:111]
    v_mul_f32 v36, v36, v40
    v_mul_f32 v37, v37, v41
    v_mfma_f32_16x16x32_bf16 a[124:127], v[32:35], v[228:231], a[124:127]
    v_mul_f32 v38, v38, v42
    v_mul_f32 v39, v39, v43
    v_mfma_f32_16x16x32_bf16 a[124:127], v[28:31], v[224:227], a[124:127]
    v_fma_f32 v44, v44, v24, v24
    v_fma_f32 v45, v45, v24, v24
    v_mfma_f32_16x16x32_bf16 a[124:127], a[164:167], v[220:223], a[124:127]
    s_add_u32 m0, s63, 57344
    s_add_u32 s56, s56, 262144
    v_fma_f32 v46, v46, v24, v24
    v_mfma_f32_16x16x32_bf16 a[124:127], a[160:163], v[216:219], a[124:127]
    buffer_load_dwordx4 v11, s[8:11], s56 offen nt lds
    v_fma_f32 v47, v47, v24, v24
    v_mfma_f32_16x16x32_bf16 a[124:127], a[156:159], v[212:215], a[124:127]
    v_rcp_f32 v44, v44
    v_mfma_f32_16x16x32_bf16 a[124:127], a[152:155], v[208:211], a[124:127]
    s_waitcnt lgkmcnt(0)
    v_rcp_f32 v45, v45
    v_mfma_f32_16x16x32_bf16 a[64:67], a[128:131], a[216:219], a[64:67]
    v_add_u32 v15, 49152, v15
    v_mfma_f32_16x16x32_bf16 a[64:67], a[132:135], a[220:223], a[64:67]
    ds_read_b64_tr_b16 a[152:153], v15 offset:0
    ds_read_b64_tr_b16 a[154:155], v15 offset:512
    v_mfma_f32_16x16x32_bf16 a[64:67], a[136:139], a[224:227], a[64:67]
    v_rcp_f32 v46, v46
    v_mfma_f32_16x16x32_bf16 a[64:67], a[140:143], a[228:231], a[64:67]
    ds_read_b64_tr_b16 a[156:157], v15 offset:8192
    ds_read_b64_tr_b16 a[158:159], v15 offset:8704
    v_mfma_f32_16x16x32_bf16 a[64:67], a[144:147], a[232:235], a[64:67]
    v_rcp_f32 v47, v47
    v_mfma_f32_16x16x32_bf16 a[64:67], a[148:151], a[236:239], a[64:67]
    ds_read_b64_tr_b16 a[160:161], v15 offset:16384
    ds_read_b64_tr_b16 a[162:163], v15 offset:16896
    v_mfma_f32_16x16x32_bf16 a[80:83], a[148:151], v[108:111], a[80:83]
    buffer_load_dwordx4 v12, s[8:11], s56 offen offset:1024 nt lds
    v_mul_f32 v36, v36, v44
    v_mfma_f32_16x16x32_bf16 a[80:83], a[144:147], v[104:107], a[80:83]
    ds_read_b64_tr_b16 a[164:165], v15 offset:24576
    ds_read_b64_tr_b16 a[166:167], v15 offset:25088
    v_mfma_f32_16x16x32_bf16 a[80:83], a[140:143], v[100:103], a[80:83]
    v_mul_f32 v37, v37, v45
    v_mul_f32 v38, v38, v46
    v_mfma_f32_16x16x32_bf16 a[80:83], a[136:139], v[96:99], a[80:83]
    ds_read_b64_tr_b16 v[28:29], v15 offset:32768
    ds_read_b64_tr_b16 v[30:31], v15 offset:33280
    v_mfma_f32_16x16x32_bf16 a[80:83], a[132:135], v[92:95], a[80:83]
    v_mul_f32 v39, v39, v47
    v_cvt_pk_bf16_f32 v50, v36, v37
    v_mfma_f32_16x16x32_bf16 a[80:83], a[128:131], v[88:91], a[80:83]
    ds_read_b64_tr_b16 v[32:33], v15 offset:40960
    ds_read_b64_tr_b16 v[34:35], v15 offset:41472
    v_mfma_f32_16x16x32_bf16 a[96:99], a[128:131], v[160:163], a[96:99]
    s_add_u32 s71, s3, 2
    s_and_b32 s71, s71, 3
    v_cvt_pk_bf16_f32 v51, v38, v39
    v_mfma_f32_16x16x32_bf16 a[96:99], a[132:135], v[164:167], a[96:99]
    s_mul_i32 s71, s71, 4096
    s_add_u32 s71, s71, s59
    buffer_store_dwordx4 v[48:51], v2, s[28:31], s71 offen offset:2048 sc1
    v_mfma_f32_16x16x32_bf16 a[96:99], a[136:139], v[168:171], a[96:99]
    s_add_u32 m0, s63, 65536
    s_add_u32 s56, s56, 262144
    v_accvgpr_read_b32 v36, a48
    v_mfma_f32_16x16x32_bf16 a[96:99], a[140:143], v[172:175], a[96:99]
    buffer_load_dwordx4 v11, s[8:11], s56 offen nt lds
    v_accvgpr_read_b32 v37, a49
    v_mfma_f32_16x16x32_bf16 a[96:99], a[144:147], v[176:179], a[96:99]
    v_accvgpr_read_b32 v38, a50
    v_accvgpr_read_b32 v39, a51
    v_mfma_f32_16x16x32_bf16 a[96:99], a[148:151], v[180:183], a[96:99]
    v_accvgpr_read_b32 v40, a56
    v_accvgpr_read_b32 v41, a57
    v_mfma_f32_16x16x32_bf16 a[112:115], a[148:151], v[252:255], a[112:115]
    v_accvgpr_read_b32 v42, a58
    v_accvgpr_read_b32 v43, a59
    v_mfma_f32_16x16x32_bf16 a[112:115], a[144:147], v[248:251], a[112:115]
    v_mul_f32 v44, v21, v36
    v_mul_f32 v45, v21, v37
    v_mfma_f32_16x16x32_bf16 a[112:115], a[140:143], v[244:247], a[112:115]
    v_mul_f32 v46, v21, v38
    v_mul_f32 v47, v21, v39
    v_mfma_f32_16x16x32_bf16 a[112:115], a[136:139], v[240:243], a[112:115]
    v_exp_f32 v44, v44
    v_mfma_f32_16x16x32_bf16 a[112:115], a[132:135], v[236:239], a[112:115]
    v_exp_f32 v45, v45
    v_mfma_f32_16x16x32_bf16 a[112:115], a[128:131], v[232:235], a[112:115]
    s_waitcnt lgkmcnt(0)
    buffer_load_dwordx4 v12, s[8:11], s56 offen offset:1024 nt lds
    v_mfma_f32_16x16x32_bf16 a[68:71], a[152:155], a[216:219], a[68:71]
    ds_read_b64_tr_b16 a[128:129], v14 offset:4096
    ds_read_b64_tr_b16 a[130:131], v14 offset:4608
    v_mfma_f32_16x16x32_bf16 a[68:71], a[156:159], a[220:223], a[68:71]
    v_exp_f32 v46, v46
    v_mfma_f32_16x16x32_bf16 a[68:71], a[160:163], a[224:227], a[68:71]
    ds_read_b64_tr_b16 a[132:133], v14 offset:12288
    ds_read_b64_tr_b16 a[134:135], v14 offset:12800
    v_mfma_f32_16x16x32_bf16 a[68:71], a[164:167], a[228:231], a[68:71]
    v_exp_f32 v47, v47
    v_mfma_f32_16x16x32_bf16 a[68:71], v[28:31], a[232:235], a[68:71]
    ds_read_b64_tr_b16 a[136:137], v14 offset:20480
    ds_read_b64_tr_b16 a[138:139], v14 offset:20992
    v_mfma_f32_16x16x32_bf16 a[68:71], v[32:35], a[236:239], a[68:71]
    v_mul_f32 v36, v36, v40
    v_mul_f32 v37, v37, v41
    v_mfma_f32_16x16x32_bf16 a[84:87], v[32:35], v[108:111], a[84:87]
    ds_read_b64_tr_b16 a[140:141], v14 offset:28672
    ds_read_b64_tr_b16 a[142:143], v14 offset:29184
    v_mfma_f32_16x16x32_bf16 a[84:87], v[28:31], v[104:107], a[84:87]
    v_mul_f32 v38, v38, v42
    v_mul_f32 v39, v39, v43
    v_mfma_f32_16x16x32_bf16 a[84:87], a[164:167], v[100:103], a[84:87]
    s_add_u32 m0, s63, 73728
    ds_read_b64_tr_b16 a[144:145], v14 offset:36864
    ds_read_b64_tr_b16 a[146:147], v14 offset:37376
    v_mfma_f32_16x16x32_bf16 a[84:87], a[160:163], v[96:99], a[84:87]
    s_add_u32 s56, s56, 262144
    v_fma_f32 v44, v44, v25, v25
    v_fma_f32 v45, v45, v25, v25
    v_mfma_f32_16x16x32_bf16 a[84:87], a[156:159], v[92:95], a[84:87]
    ds_read_b64_tr_b16 a[148:149], v14 offset:45056
    ds_read_b64_tr_b16 a[150:151], v14 offset:45568
    v_mfma_f32_16x16x32_bf16 a[84:87], a[152:155], v[88:91], a[84:87]
    buffer_load_dwordx4 v11, s[8:11], s56 offen nt lds
    v_fma_f32 v46, v46, v25, v25
    v_mfma_f32_16x16x32_bf16 a[100:103], a[152:155], v[160:163], a[100:103]
    v_fma_f32 v47, v47, v25, v25
    v_mfma_f32_16x16x32_bf16 a[100:103], a[156:159], v[164:167], a[100:103]
    v_rcp_f32 v44, v44
    v_mfma_f32_16x16x32_bf16 a[100:103], a[160:163], v[168:171], a[100:103]
    v_rcp_f32 v45, v45
    v_mfma_f32_16x16x32_bf16 a[100:103], a[164:167], v[172:175], a[100:103]
    v_rcp_f32 v46, v46
    v_mfma_f32_16x16x32_bf16 a[100:103], v[28:31], v[176:179], a[100:103]
    v_rcp_f32 v47, v47
    v_mfma_f32_16x16x32_bf16 a[100:103], v[32:35], v[180:183], a[100:103]
    buffer_load_dwordx4 v12, s[8:11], s56 offen offset:1024 nt lds
    v_mul_f32 v36, v36, v44
    v_mfma_f32_16x16x32_bf16 a[116:119], v[32:35], v[252:255], a[116:119]
    v_mul_f32 v37, v37, v45
    v_mul_f32 v38, v38, v46
    v_mfma_f32_16x16x32_bf16 a[116:119], v[28:31], v[248:251], a[116:119]
    v_mul_f32 v39, v39, v47
    v_cvt_pk_bf16_f32 v52, v36, v37
    v_mfma_f32_16x16x32_bf16 a[116:119], a[164:167], v[244:247], a[116:119]
    v_cvt_pk_bf16_f32 v53, v38, v39
    v_accvgpr_read_b32 v36, a52
    v_mfma_f32_16x16x32_bf16 a[116:119], a[160:163], v[240:243], a[116:119]
    v_accvgpr_read_b32 v37, a53
    v_accvgpr_read_b32 v38, a54
    v_mfma_f32_16x16x32_bf16 a[116:119], a[156:159], v[236:239], a[116:119]
    v_accvgpr_read_b32 v39, a55
    v_accvgpr_read_b32 v40, a60
    v_mfma_f32_16x16x32_bf16 a[116:119], a[152:155], v[232:235], a[116:119]
    s_waitcnt lgkmcnt(0)
    v_accvgpr_read_b32 v41, a61
    v_accvgpr_read_b32 v42, a62
    v_mfma_f32_16x16x32_bf16 a[72:75], a[128:131], a[216:219], a[72:75]
    ds_read_b64_tr_b16 a[152:153], v15 offset:4096
    ds_read_b64_tr_b16 a[154:155], v15 offset:4608
    v_mfma_f32_16x16x32_bf16 a[72:75], a[132:135], a[220:223], a[72:75]
    v_accvgpr_read_b32 v43, a63
    v_mul_f32 v44, v21, v36
    v_mfma_f32_16x16x32_bf16 a[72:75], a[136:139], a[224:227], a[72:75]
    s_add_u32 m0, s63, 81920
    ds_read_b64_tr_b16 a[156:157], v15 offset:12288
    ds_read_b64_tr_b16 a[158:159], v15 offset:12800
    v_mfma_f32_16x16x32_bf16 a[72:75], a[140:143], a[228:231], a[72:75]
    s_add_u32 s56, s56, 262144
    v_mul_f32 v45, v21, v37
    v_mul_f32 v46, v21, v38
    v_mfma_f32_16x16x32_bf16 a[72:75], a[144:147], a[232:235], a[72:75]
    ds_read_b64_tr_b16 a[160:161], v15 offset:20480
    ds_read_b64_tr_b16 a[162:163], v15 offset:20992
    v_mfma_f32_16x16x32_bf16 a[72:75], a[148:151], a[236:239], a[72:75]
    buffer_load_dwordx4 v11, s[8:11], s56 offen nt lds
    v_mul_f32 v47, v21, v39
    v_mfma_f32_16x16x32_bf16 a[88:91], a[148:151], v[108:111], a[88:91]
    ds_read_b64_tr_b16 a[164:165], v15 offset:28672
    ds_read_b64_tr_b16 a[166:167], v15 offset:29184
    v_mfma_f32_16x16x32_bf16 a[88:91], a[144:147], v[104:107], a[88:91]
    v_exp_f32 v44, v44
    v_mfma_f32_16x16x32_bf16 a[88:91], a[140:143], v[100:103], a[88:91]
    ds_read_b64_tr_b16 v[28:29], v15 offset:36864
    ds_read_b64_tr_b16 v[30:31], v15 offset:37376
    v_mfma_f32_16x16x32_bf16 a[88:91], a[136:139], v[96:99], a[88:91]
    v_exp_f32 v45, v45
    v_mfma_f32_16x16x32_bf16 a[88:91], a[132:135], v[92:95], a[88:91]
    ds_read_b64_tr_b16 v[32:33], v15 offset:45056
    ds_read_b64_tr_b16 v[34:35], v15 offset:45568
    v_mfma_f32_16x16x32_bf16 a[88:91], a[128:131], v[88:91], a[88:91]
    buffer_load_dwordx4 v12, s[8:11], s56 offen offset:1024 nt lds
    v_mfma_f32_16x16x32_bf16 a[104:107], a[128:131], v[160:163], a[104:107]
    v_exp_f32 v46, v46
    v_mfma_f32_16x16x32_bf16 a[104:107], a[132:135], v[164:167], a[104:107]
    v_exp_f32 v47, v47
    v_mfma_f32_16x16x32_bf16 a[104:107], a[136:139], v[168:171], a[104:107]
    v_mul_f32 v36, v36, v40
    v_mul_f32 v37, v37, v41
    v_mfma_f32_16x16x32_bf16 a[104:107], a[140:143], v[172:175], a[104:107]
    v_mul_f32 v38, v38, v42
    v_mul_f32 v39, v39, v43
    v_mfma_f32_16x16x32_bf16 a[104:107], a[144:147], v[176:179], a[104:107]
    v_fma_f32 v44, v44, v25, v25
    v_fma_f32 v45, v45, v25, v25
    v_mfma_f32_16x16x32_bf16 a[104:107], a[148:151], v[180:183], a[104:107]
    v_fma_f32 v46, v46, v25, v25
    v_fma_f32 v47, v47, v25, v25
    v_mfma_f32_16x16x32_bf16 a[120:123], a[148:151], v[252:255], a[120:123]
    v_rcp_f32 v44, v44
    v_mfma_f32_16x16x32_bf16 a[120:123], a[144:147], v[248:251], a[120:123]
    v_rcp_f32 v45, v45
    v_mfma_f32_16x16x32_bf16 a[120:123], a[140:143], v[244:247], a[120:123]
    s_add_u32 m0, s63, 90112
    s_add_u32 s56, s56, 262144
    v_mfma_f32_16x16x32_bf16 a[120:123], a[136:139], v[240:243], a[120:123]
    buffer_load_dwordx4 v11, s[8:11], s56 offen nt lds
    v_mfma_f32_16x16x32_bf16 a[120:123], a[132:135], v[236:239], a[120:123]
    v_rcp_f32 v46, v46
    v_mfma_f32_16x16x32_bf16 a[120:123], a[128:131], v[232:235], a[120:123]
    s_waitcnt lgkmcnt(0)
    v_rcp_f32 v47, v47
    v_mfma_f32_16x16x32_bf16 a[76:79], a[152:155], a[216:219], a[76:79]
    s_waitcnt vmcnt(12)
    v_mul_f32 v36, v36, v44
    v_mul_f32 v37, v37, v45
    v_mfma_f32_16x16x32_bf16 a[76:79], a[156:159], a[220:223], a[76:79]
    s_barrier
    ds_read_b64_tr_b16 a[128:129], v16 offset:0
    ds_read_b64_tr_b16 a[130:131], v16 offset:1024
    v_mfma_f32_16x16x32_bf16 a[76:79], a[160:163], a[224:227], a[76:79]
    v_mul_f32 v38, v38, v46
    v_mul_f32 v39, v39, v47
    v_mfma_f32_16x16x32_bf16 a[76:79], a[164:167], a[228:231], a[76:79]
    ds_read_b64_tr_b16 a[132:133], v16 offset:8192
    ds_read_b64_tr_b16 a[134:135], v16 offset:9216
    v_mfma_f32_16x16x32_bf16 a[76:79], v[28:31], a[232:235], a[76:79]
    s_add_u32 s71, s3, 3
    v_cvt_pk_bf16_f32 v54, v36, v37
    v_cvt_pk_bf16_f32 v55, v38, v39
    v_mfma_f32_16x16x32_bf16 a[76:79], v[32:35], a[236:239], a[76:79]
    s_and_b32 s71, s71, 3
    ds_read_b64_tr_b16 a[136:137], v16 offset:16384
    ds_read_b64_tr_b16 a[138:139], v16 offset:17408
    v_mfma_f32_16x16x32_bf16 a[92:95], v[32:35], v[108:111], a[92:95]
    s_mul_i32 s71, s71, 4096
    s_add_u32 s71, s71, s59
    buffer_load_dwordx4 v12, s[8:11], s56 offen offset:1024 nt lds
    v_mfma_f32_16x16x32_bf16 a[92:95], v[28:31], v[104:107], a[92:95]
    s_add_u32 m0, s63, 98304
    ds_read_b64_tr_b16 a[140:141], v16 offset:24576
    ds_read_b64_tr_b16 a[142:143], v16 offset:25600
    v_mfma_f32_16x16x32_bf16 a[92:95], a[164:167], v[100:103], a[92:95]
    s_mul_i32 s56, s74, 1572864
    s_add_u32 s56, s56, s55
    buffer_store_dwordx4 v[52:55], v2, s[28:31], s71 offen offset:2048 sc1
    v_mfma_f32_16x16x32_bf16 a[92:95], a[160:163], v[96:99], a[92:95]
    ds_read_b64_tr_b16 a[144:145], v16 offset:32768
    ds_read_b64_tr_b16 a[146:147], v16 offset:33792
    v_mfma_f32_16x16x32_bf16 a[92:95], a[156:159], v[92:95], a[92:95]
    buffer_load_dwordx4 v11, s[8:11], s56 offen nt lds
    v_mfma_f32_16x16x32_bf16 a[92:95], a[152:155], v[88:91], a[92:95]
    ds_read_b64_tr_b16 a[148:149], v16 offset:40960
    ds_read_b64_tr_b16 a[150:151], v16 offset:41984
    v_mfma_f32_16x16x32_bf16 a[108:111], a[152:155], v[160:163], a[108:111]
    buffer_load_dwordx4 v12, s[8:11], s56 offen offset:1024 nt lds
    v_mfma_f32_16x16x32_bf16 a[108:111], a[156:159], v[164:167], a[108:111]
    v_mfma_f32_16x16x32_bf16 a[108:111], a[160:163], v[168:171], a[108:111]
    v_mfma_f32_16x16x32_bf16 a[108:111], a[164:167], v[172:175], a[108:111]
    v_mfma_f32_16x16x32_bf16 a[108:111], v[28:31], v[176:179], a[108:111]
    v_mfma_f32_16x16x32_bf16 a[108:111], v[32:35], v[180:183], a[108:111]
    v_mfma_f32_16x16x32_bf16 a[124:127], v[32:35], v[252:255], a[124:127]
    v_mfma_f32_16x16x32_bf16 a[124:127], v[28:31], v[248:251], a[124:127]
    v_mfma_f32_16x16x32_bf16 a[124:127], a[164:167], v[244:247], a[124:127]
    s_add_u32 m0, s63, 106496
    s_add_u32 s56, s56, 262144
    v_mfma_f32_16x16x32_bf16 a[124:127], a[160:163], v[240:243], a[124:127]
    buffer_load_dwordx4 v11, s[8:11], s56 offen nt lds
    v_mfma_f32_16x16x32_bf16 a[124:127], a[156:159], v[236:239], a[124:127]
    v_mfma_f32_16x16x32_bf16 a[124:127], a[152:155], v[232:235], a[124:127]
    s_waitcnt lgkmcnt(0)
    v_mfma_f32_16x16x32_bf16 a[0:3], a[128:131], a[168:171], 0
    ds_read_b64_tr_b16 a[152:153], v16 offset:8
    ds_read_b64_tr_b16 a[154:155], v16 offset:1032
    v_mfma_f32_16x16x32_bf16 a[0:3], a[132:135], a[172:175], a[0:3]
    v_mfma_f32_16x16x32_bf16 a[0:3], a[136:139], a[176:179], a[0:3]
    ds_read_b64_tr_b16 a[156:157], v16 offset:8200
    ds_read_b64_tr_b16 a[158:159], v16 offset:9224
    v_mfma_f32_16x16x32_bf16 a[0:3], a[140:143], a[180:183], a[0:3]
    v_mfma_f32_16x16x32_bf16 a[0:3], a[144:147], a[184:187], a[0:3]
    ds_read_b64_tr_b16 a[160:161], v16 offset:16392
    ds_read_b64_tr_b16 a[162:163], v16 offset:17416
    v_mfma_f32_16x16x32_bf16 a[0:3], a[148:151], a[188:191], a[0:3]
    buffer_load_dwordx4 v12, s[8:11], s56 offen offset:1024 nt lds
    v_accvgpr_read_b32 v36, a64
    v_mfma_f32_16x16x32_bf16 a[16:19], a[148:151], v[60:63], 0
    ds_read_b64_tr_b16 a[164:165], v16 offset:24584
    ds_read_b64_tr_b16 a[166:167], v16 offset:25608
    v_mfma_f32_16x16x32_bf16 a[16:19], a[144:147], v[56:59], a[16:19]
    v_accvgpr_read_b32 v37, a65
    v_accvgpr_read_b32 v38, a66
    v_mfma_f32_16x16x32_bf16 a[16:19], a[140:143], a[252:255], a[16:19]
    ds_read_b64_tr_b16 v[28:29], v16 offset:32776
    ds_read_b64_tr_b16 v[30:31], v16 offset:33800
    v_mfma_f32_16x16x32_bf16 a[16:19], a[136:139], a[248:251], a[16:19]
    v_accvgpr_read_b32 v39, a67
    v_accvgpr_read_b32 v40, a72
    v_mfma_f32_16x16x32_bf16 a[16:19], a[132:135], a[244:247], a[16:19]
    ds_read_b64_tr_b16 v[32:33], v16 offset:40968
    ds_read_b64_tr_b16 v[34:35], v16 offset:41992
    v_mfma_f32_16x16x32_bf16 a[16:19], a[128:131], a[240:243], a[16:19]
    v_accvgpr_read_b32 v41, a73
    v_accvgpr_read_b32 v42, a74
    v_mfma_f32_16x16x32_bf16 a[32:35], a[128:131], v[112:115], 0
    v_accvgpr_read_b32 v43, a75
    v_mul_f32 v44, v18, v36
    v_mfma_f32_16x16x32_bf16 a[32:35], a[132:135], v[116:119], a[32:35]
    v_mul_f32 v45, v18, v37
    v_mul_f32 v46, v18, v38
    v_mfma_f32_16x16x32_bf16 a[32:35], a[136:139], v[120:123], a[32:35]
    s_add_u32 m0, s63, 114688
    s_add_u32 s56, s56, 262144
    v_mul_f32 v47, v18, v39
    v_mfma_f32_16x16x32_bf16 a[32:35], a[140:143], v[124:127], a[32:35]
    buffer_load_dwordx4 v11, s[8:11], s56 offen nt lds
    v_mfma_f32_16x16x32_bf16 a[32:35], a[144:147], v[128:131], a[32:35]
    v_exp_f32 v44, v44
    v_mfma_f32_16x16x32_bf16 a[32:35], a[148:151], v[132:135], a[32:35]
    v_exp_f32 v45, v45
    v_mfma_f32_16x16x32_bf16 a[48:51], a[148:151], v[204:207], 0
    v_exp_f32 v46, v46
    v_mfma_f32_16x16x32_bf16 a[48:51], a[144:147], v[200:203], a[48:51]
    v_exp_f32 v47, v47
    v_mfma_f32_16x16x32_bf16 a[48:51], a[140:143], v[196:199], a[48:51]
    v_mul_f32 v36, v36, v40
    v_mul_f32 v37, v37, v41
    v_mfma_f32_16x16x32_bf16 a[48:51], a[136:139], v[192:195], a[48:51]
    v_mul_f32 v38, v38, v42
    v_mul_f32 v39, v39, v43
    v_mfma_f32_16x16x32_bf16 a[48:51], a[132:135], v[188:191], a[48:51]
    v_fma_f32 v44, v44, v22, v22
    v_fma_f32 v45, v45, v22, v22
    v_mfma_f32_16x16x32_bf16 a[48:51], a[128:131], v[184:187], a[48:51]
    s_waitcnt lgkmcnt(0)
    buffer_load_dwordx4 v12, s[8:11], s56 offen offset:1024 nt lds
    v_fma_f32 v46, v46, v22, v22
    v_mfma_f32_16x16x32_bf16 a[4:7], a[152:155], a[168:171], 0
    ds_read_b64_tr_b16 a[128:129], v17 offset:0
    ds_read_b64_tr_b16 a[130:131], v17 offset:1024
    v_mfma_f32_16x16x32_bf16 a[4:7], a[156:159], a[172:175], a[4:7]
    v_fma_f32 v47, v47, v22, v22
    v_mfma_f32_16x16x32_bf16 a[4:7], a[160:163], a[176:179], a[4:7]
    ds_read_b64_tr_b16 a[132:133], v17 offset:8192
    ds_read_b64_tr_b16 a[134:135], v17 offset:9216
    v_mfma_f32_16x16x32_bf16 a[4:7], a[164:167], a[180:183], a[4:7]
    v_rcp_f32 v44, v44
    v_mfma_f32_16x16x32_bf16 a[4:7], v[28:31], a[184:187], a[4:7]
    ds_read_b64_tr_b16 a[136:137], v17 offset:16384
    ds_read_b64_tr_b16 a[138:139], v17 offset:17408
    v_mfma_f32_16x16x32_bf16 a[4:7], v[32:35], a[188:191], a[4:7]
    v_rcp_f32 v45, v45
    v_mfma_f32_16x16x32_bf16 a[20:23], v[32:35], v[60:63], 0
    ds_read_b64_tr_b16 a[140:141], v17 offset:24576
    ds_read_b64_tr_b16 a[142:143], v17 offset:25600
    v_mfma_f32_16x16x32_bf16 a[20:23], v[28:31], v[56:59], a[20:23]
    v_rcp_f32 v46, v46
    v_mfma_f32_16x16x32_bf16 a[20:23], a[164:167], a[252:255], a[20:23]
    s_add_u32 m0, s63, 122880
    ds_read_b64_tr_b16 a[144:145], v17 offset:32768
    ds_read_b64_tr_b16 a[146:147], v17 offset:33792
    v_mfma_f32_16x16x32_bf16 a[20:23], a[160:163], a[248:251], a[20:23]
    s_add_u32 s56, s56, 262144
    v_rcp_f32 v47, v47
    v_mfma_f32_16x16x32_bf16 a[20:23], a[156:159], a[244:247], a[20:23]
    ds_read_b64_tr_b16 a[148:149], v17 offset:40960
    ds_read_b64_tr_b16 a[150:151], v17 offset:41984
    v_mfma_f32_16x16x32_bf16 a[20:23], a[152:155], a[240:243], a[20:23]
    buffer_load_dwordx4 v11, s[8:11], s56 offen nt lds
    v_mul_f32 v36, v36, v44
    v_mfma_f32_16x16x32_bf16 a[36:39], a[152:155], v[112:115], 0
    v_mul_f32 v37, v37, v45
    v_mul_f32 v38, v38, v46
    v_mfma_f32_16x16x32_bf16 a[36:39], a[156:159], v[116:119], a[36:39]
    v_mul_f32 v39, v39, v47
    v_cvt_pk_bf16_f32 v48, v36, v37
    v_mfma_f32_16x16x32_bf16 a[36:39], a[160:163], v[120:123], a[36:39]
    v_cvt_pk_bf16_f32 v49, v38, v39
    v_accvgpr_read_b32 v36, a68
    v_mfma_f32_16x16x32_bf16 a[36:39], a[164:167], v[124:127], a[36:39]
    v_accvgpr_read_b32 v37, a69
    v_accvgpr_read_b32 v38, a70
    v_mfma_f32_16x16x32_bf16 a[36:39], v[28:31], v[128:131], a[36:39]
    v_accvgpr_read_b32 v39, a71
    v_accvgpr_read_b32 v40, a76
    v_mfma_f32_16x16x32_bf16 a[36:39], v[32:35], v[132:135], a[36:39]
    buffer_load_dwordx4 v12, s[8:11], s56 offen offset:1024 nt lds
    v_accvgpr_read_b32 v41, a77
    v_mfma_f32_16x16x32_bf16 a[52:55], v[32:35], v[204:207], 0
    v_accvgpr_read_b32 v42, a78
    v_accvgpr_read_b32 v43, a79
    v_mfma_f32_16x16x32_bf16 a[52:55], v[28:31], v[200:203], a[52:55]
    v_mul_f32 v44, v18, v36
    v_mul_f32 v45, v18, v37
    v_mfma_f32_16x16x32_bf16 a[52:55], a[164:167], v[196:199], a[52:55]
    v_mul_f32 v46, v18, v38
    v_mul_f32 v47, v18, v39
    v_mfma_f32_16x16x32_bf16 a[52:55], a[160:163], v[192:195], a[52:55]
    v_exp_f32 v44, v44
    v_mfma_f32_16x16x32_bf16 a[52:55], a[156:159], v[188:191], a[52:55]
    v_exp_f32 v45, v45
    v_mfma_f32_16x16x32_bf16 a[52:55], a[152:155], v[184:187], a[52:55]
    s_waitcnt lgkmcnt(0)
    v_exp_f32 v46, v46
    v_mfma_f32_16x16x32_bf16 a[8:11], a[128:131], a[168:171], 0
    ds_read_b64_tr_b16 a[152:153], v17 offset:8
    ds_read_b64_tr_b16 a[154:155], v17 offset:1032
    v_mfma_f32_16x16x32_bf16 a[8:11], a[132:135], a[172:175], a[8:11]
    v_exp_f32 v47, v47
    v_mfma_f32_16x16x32_bf16 a[8:11], a[136:139], a[176:179], a[8:11]
    s_add_u32 m0, s63, 131072
    ds_read_b64_tr_b16 a[156:157], v17 offset:8200
    ds_read_b64_tr_b16 a[158:159], v17 offset:9224
    v_mfma_f32_16x16x32_bf16 a[8:11], a[140:143], a[180:183], a[8:11]
    s_add_u32 s56, s56, 262144
    v_mul_f32 v36, v36, v40
    v_mul_f32 v37, v37, v41
    v_mfma_f32_16x16x32_bf16 a[8:11], a[144:147], a[184:187], a[8:11]
    ds_read_b64_tr_b16 a[160:161], v17 offset:16392
    ds_read_b64_tr_b16 a[162:163], v17 offset:17416
    v_mfma_f32_16x16x32_bf16 a[8:11], a[148:151], a[188:191], a[8:11]
    buffer_load_dwordx4 v11, s[8:11], s56 offen nt lds
    v_mul_f32 v38, v38, v42
    v_mfma_f32_16x16x32_bf16 a[24:27], a[148:151], v[60:63], 0
    ds_read_b64_tr_b16 a[164:165], v17 offset:24584
    ds_read_b64_tr_b16 a[166:167], v17 offset:25608
    v_mfma_f32_16x16x32_bf16 a[24:27], a[144:147], v[56:59], a[24:27]
    v_mul_f32 v39, v39, v43
    v_fma_f32 v44, v44, v22, v22
    v_mfma_f32_16x16x32_bf16 a[24:27], a[140:143], a[252:255], a[24:27]
    ds_read_b64_tr_b16 v[28:29], v17 offset:32776
    ds_read_b64_tr_b16 v[30:31], v17 offset:33800
    v_mfma_f32_16x16x32_bf16 a[24:27], a[136:139], a[248:251], a[24:27]
    v_fma_f32 v45, v45, v22, v22
    v_fma_f32 v46, v46, v22, v22
    v_mfma_f32_16x16x32_bf16 a[24:27], a[132:135], a[244:247], a[24:27]
    ds_read_b64_tr_b16 v[32:33], v17 offset:40968
    ds_read_b64_tr_b16 v[34:35], v17 offset:41992
    v_mfma_f32_16x16x32_bf16 a[24:27], a[128:131], a[240:243], a[24:27]
    buffer_load_dwordx4 v12, s[8:11], s56 offen offset:1024 nt lds
    v_fma_f32 v47, v47, v22, v22
    v_mfma_f32_16x16x32_bf16 a[40:43], a[128:131], v[112:115], 0
    v_rcp_f32 v44, v44
    v_mfma_f32_16x16x32_bf16 a[40:43], a[132:135], v[116:119], a[40:43]
    v_rcp_f32 v45, v45
    v_mfma_f32_16x16x32_bf16 a[40:43], a[136:139], v[120:123], a[40:43]
    v_rcp_f32 v46, v46
    v_mfma_f32_16x16x32_bf16 a[40:43], a[140:143], v[124:127], a[40:43]
    v_rcp_f32 v47, v47
    v_mfma_f32_16x16x32_bf16 a[40:43], a[144:147], v[128:131], a[40:43]
    v_mul_f32 v36, v36, v44
    v_mul_f32 v37, v37, v45
    v_mfma_f32_16x16x32_bf16 a[40:43], a[148:151], v[132:135], a[40:43]
    v_mul_f32 v38, v38, v46
    v_mul_f32 v39, v39, v47
    v_mfma_f32_16x16x32_bf16 a[56:59], a[148:151], v[204:207], 0
    s_add_u32 s71, s3, 0
    v_cvt_pk_bf16_f32 v50, v36, v37
    v_cvt_pk_bf16_f32 v51, v38, v39
    v_mfma_f32_16x16x32_bf16 a[56:59], a[144:147], v[200:203], a[56:59]
    s_and_b32 s71, s71, 3
    s_mul_i32 s71, s71, 4096
    s_add_u32 s71, s71, s59
    v_mfma_f32_16x16x32_bf16 a[56:59], a[140:143], v[196:199], a[56:59]
    s_add_u32 m0, s63, 139264
    s_add_u32 s56, s56, 262144
    buffer_store_dwordx4 v[48:51], v2, s[28:31], s71 offen offset:3072 sc1
    v_mfma_f32_16x16x32_bf16 a[56:59], a[136:139], v[192:195], a[56:59]
    buffer_load_dwordx4 v11, s[8:11], s56 offen nt lds
    v_accvgpr_read_b32 v36, a80
    v_mfma_f32_16x16x32_bf16 a[56:59], a[132:135], v[188:191], a[56:59]
    v_accvgpr_read_b32 v37, a81
    v_accvgpr_read_b32 v38, a82
    v_mfma_f32_16x16x32_bf16 a[56:59], a[128:131], v[184:187], a[56:59]
    s_waitcnt lgkmcnt(0)
    v_accvgpr_read_b32 v39, a83
    v_accvgpr_read_b32 v40, a88
    v_mfma_f32_16x16x32_bf16 a[12:15], a[152:155], a[168:171], 0
    s_waitcnt vmcnt(13)
    v_accvgpr_read_b32 v41, a89
    v_accvgpr_read_b32 v42, a90
    v_mfma_f32_16x16x32_bf16 a[12:15], a[156:159], a[172:175], a[12:15]
    s_barrier
    v_add_u32 v16, 49152, v16
    v_accvgpr_read_b32 v43, a91
    v_mfma_f32_16x16x32_bf16 a[12:15], a[160:163], a[176:179], a[12:15]
    ds_read_b64_tr_b16 a[128:129], v16 offset:0
    ds_read_b64_tr_b16 a[130:131], v16 offset:1024
    v_mfma_f32_16x16x32_bf16 a[12:15], a[164:167], a[180:183], a[12:15]
    v_mul_f32 v44, v19, v36
    v_mul_f32 v45, v19, v37
    v_mfma_f32_16x16x32_bf16 a[12:15], v[28:31], a[184:187], a[12:15]
    ds_read_b64_tr_b16 a[132:133], v16 offset:8192
    ds_read_b64_tr_b16 a[134:135], v16 offset:9216
    v_mfma_f32_16x16x32_bf16 a[12:15], v[32:35], a[188:191], a[12:15]
    buffer_load_dwordx4 v12, s[8:11], s56 offen offset:1024 nt lds
    v_mul_f32 v46, v19, v38
    v_mfma_f32_16x16x32_bf16 a[28:31], v[32:35], v[60:63], 0
    ds_read_b64_tr_b16 a[136:137], v16 offset:16384
    ds_read_b64_tr_b16 a[138:139], v16 offset:17408
    v_mfma_f32_16x16x32_bf16 a[28:31], v[28:31], v[56:59], a[28:31]
    v_mul_f32 v47, v19, v39
    v_mfma_f32_16x16x32_bf16 a[28:31], a[164:167], a[252:255], a[28:31]
    ds_read_b64_tr_b16 a[140:141], v16 offset:24576
    ds_read_b64_tr_b16 a[142:143], v16 offset:25600
    v_mfma_f32_16x16x32_bf16 a[28:31], a[160:163], a[248:251], a[28:31]
    v_exp_f32 v44, v44
    v_mfma_f32_16x16x32_bf16 a[28:31], a[156:159], a[244:247], a[28:31]
    ds_read_b64_tr_b16 a[144:145], v16 offset:32768
    ds_read_b64_tr_b16 a[146:147], v16 offset:33792
    v_mfma_f32_16x16x32_bf16 a[28:31], a[152:155], a[240:243], a[28:31]
    v_exp_f32 v45, v45
    v_mfma_f32_16x16x32_bf16 a[44:47], a[152:155], v[112:115], 0
    ds_read_b64_tr_b16 a[148:149], v16 offset:40960
    ds_read_b64_tr_b16 a[150:151], v16 offset:41984
    v_mfma_f32_16x16x32_bf16 a[44:47], a[156:159], v[116:119], a[44:47]
    v_exp_f32 v46, v46
    v_mfma_f32_16x16x32_bf16 a[44:47], a[160:163], v[120:123], a[44:47]
    v_exp_f32 v47, v47
    v_mfma_f32_16x16x32_bf16 a[44:47], a[164:167], v[124:127], a[44:47]
    v_mul_f32 v36, v36, v40
    v_mul_f32 v37, v37, v41
    v_mfma_f32_16x16x32_bf16 a[44:47], v[28:31], v[128:131], a[44:47]
    v_mul_f32 v38, v38, v42
    v_mul_f32 v39, v39, v43
    v_mfma_f32_16x16x32_bf16 a[44:47], v[32:35], v[132:135], a[44:47]
    v_fma_f32 v44, v44, v23, v23
    v_fma_f32 v45, v45, v23, v23
    v_mfma_f32_16x16x32_bf16 a[60:63], v[32:35], v[204:207], 0
    v_fma_f32 v46, v46, v23, v23
    v_fma_f32 v47, v47, v23, v23
    v_mfma_f32_16x16x32_bf16 a[60:63], v[28:31], v[200:203], a[60:63]
    v_rcp_f32 v44, v44
    v_mfma_f32_16x16x32_bf16 a[60:63], a[164:167], v[196:199], a[60:63]
    v_rcp_f32 v45, v45
    v_mfma_f32_16x16x32_bf16 a[60:63], a[160:163], v[192:195], a[60:63]
    v_rcp_f32 v46, v46
    v_mfma_f32_16x16x32_bf16 a[60:63], a[156:159], v[188:191], a[60:63]
    v_rcp_f32 v47, v47
    v_mfma_f32_16x16x32_bf16 a[60:63], a[152:155], v[184:187], a[60:63]
    s_waitcnt lgkmcnt(0)
    v_mul_f32 v36, v36, v44
    v_mul_f32 v37, v37, v45
    v_mfma_f32_16x16x32_bf16 a[0:3], a[128:131], a[192:195], a[0:3]
    ds_read_b64_tr_b16 a[152:153], v16 offset:8
    ds_read_b64_tr_b16 a[154:155], v16 offset:1032
    v_mfma_f32_16x16x32_bf16 a[0:3], a[132:135], a[196:199], a[0:3]
    v_mul_f32 v38, v38, v46
    v_mul_f32 v39, v39, v47
    v_mfma_f32_16x16x32_bf16 a[0:3], a[136:139], a[200:203], a[0:3]
    ds_read_b64_tr_b16 a[156:157], v16 offset:8200
    ds_read_b64_tr_b16 a[158:159], v16 offset:9224
    v_mfma_f32_16x16x32_bf16 a[0:3], a[140:143], a[204:207], a[0:3]
    v_cvt_pk_bf16_f32 v52, v36, v37
    v_cvt_pk_bf16_f32 v53, v38, v39
    v_mfma_f32_16x16x32_bf16 a[0:3], a[144:147], a[208:211], a[0:3]
    ds_read_b64_tr_b16 a[160:161], v16 offset:16392
    ds_read_b64_tr_b16 a[162:163], v16 offset:17416
    v_mfma_f32_16x16x32_bf16 a[0:3], a[148:151], a[212:215], a[0:3]
    v_accvgpr_read_b32 v36, a84
    v_accvgpr_read_b32 v37, a85
    v_mfma_f32_16x16x32_bf16 a[16:19], a[148:151], v[84:87], a[16:19]
    ds_read_b64_tr_b16 a[164:165], v16 offset:24584
    ds_read_b64_tr_b16 a[166:167], v16 offset:25608
    v_mfma_f32_16x16x32_bf16 a[16:19], a[144:147], v[80:83], a[16:19]
    v_accvgpr_read_b32 v38, a86
    v_accvgpr_read_b32 v39, a87
    v_mfma_f32_16x16x32_bf16 a[16:19], a[140:143], v[76:79], a[16:19]
    ds_read_b64_tr_b16 v[28:29], v16 offset:32776
    ds_read_b64_tr_b16 v[30:31], v16 offset:33800
    v_mfma_f32_16x16x32_bf16 a[16:19], a[136:139], v[72:75], a[16:19]
    v_accvgpr_read_b32 v40, a92
    v_accvgpr_read_b32 v41, a93
    v_mfma_f32_16x16x32_bf16 a[16:19], a[132:135], v[68:71], a[16:19]
    ds_read_b64_tr_b16 v[32:33], v16 offset:40968
    ds_read_b64_tr_b16 v[34:35], v16 offset:41992
    v_mfma_f32_16x16x32_bf16 a[16:19], a[128:131], v[64:67], a[16:19]
    v_accvgpr_read_b32 v42, a94
    v_accvgpr_read_b32 v43, a95
    v_mfma_f32_16x16x32_bf16 a[32:35], a[128:131], v[136:139], a[32:35]
    v_mul_f32 v44, v19, v36
    v_mul_f32 v45, v19, v37
    v_mfma_f32_16x16x32_bf16 a[32:35], a[132:135], v[140:143], a[32:35]
    v_mul_f32 v46, v19, v38
    v_mul_f32 v47, v19, v39
    v_mfma_f32_16x16x32_bf16 a[32:35], a[136:139], v[144:147], a[32:35]
    v_exp_f32 v44, v44
    v_mfma_f32_16x16x32_bf16 a[32:35], a[140:143], v[148:151], a[32:35]
    v_exp_f32 v45, v45
    v_mfma_f32_16x16x32_bf16 a[32:35], a[144:147], v[152:155], a[32:35]
    v_exp_f32 v46, v46
    v_mfma_f32_16x16x32_bf16 a[32:35], a[148:151], v[156:159], a[32:35]
    v_exp_f32 v47, v47
    v_mfma_f32_16x16x32_bf16 a[48:51], a[148:151], v[228:231], a[48:51]
    v_mul_f32 v36, v36, v40
    v_mul_f32 v37, v37, v41
    v_mfma_f32_16x16x32_bf16 a[48:51], a[144:147], v[224:227], a[48:51]
    v_mul_f32 v38, v38, v42
    v_mul_f32 v39, v39, v43
    v_mfma_f32_16x16x32_bf16 a[48:51], a[140:143], v[220:223], a[48:51]
    v_fma_f32 v44, v44, v23, v23
    v_fma_f32 v45, v45, v23, v23
    v_mfma_f32_16x16x32_bf16 a[48:51], a[136:139], v[216:219], a[48:51]
    v_fma_f32 v46, v46, v23, v23
    v_fma_f32 v47, v47, v23, v23
    v_mfma_f32_16x16x32_bf16 a[48:51], a[132:135], v[212:215], a[48:51]
    v_rcp_f32 v44, v44
    v_mfma_f32_16x16x32_bf16 a[48:51], a[128:131], v[208:211], a[48:51]
    s_waitcnt lgkmcnt(0)
    v_rcp_f32 v45, v45
    v_mfma_f32_16x16x32_bf16 a[4:7], a[152:155], a[192:195], a[4:7]
    v_add_u32 v17, 49152, v17
    v_mfma_f32_16x16x32_bf16 a[4:7], a[156:159], a[196:199], a[4:7]
    ds_read_b64_tr_b16 a[128:129], v17 offset:0
    ds_read_b64_tr_b16 a[130:131], v17 offset:1024
    v_mfma_f32_16x16x32_bf16 a[4:7], a[160:163], a[200:203], a[4:7]
    v_rcp_f32 v46, v46
    v_mfma_f32_16x16x32_bf16 a[4:7], a[164:167], a[204:207], a[4:7]
    ds_read_b64_tr_b16 a[132:133], v17 offset:8192
    ds_read_b64_tr_b16 a[134:135], v17 offset:9216
    v_mfma_f32_16x16x32_bf16 a[4:7], v[28:31], a[208:211], a[4:7]
    v_rcp_f32 v47, v47
    v_mfma_f32_16x16x32_bf16 a[4:7], v[32:35], a[212:215], a[4:7]
    ds_read_b64_tr_b16 a[136:137], v17 offset:16384
    ds_read_b64_tr_b16 a[138:139], v17 offset:17408
    v_mfma_f32_16x16x32_bf16 a[20:23], v[32:35], v[84:87], a[20:23]
    v_mul_f32 v36, v36, v44
    v_mul_f32 v37, v37, v45
    v_mfma_f32_16x16x32_bf16 a[20:23], v[28:31], v[80:83], a[20:23]
    ds_read_b64_tr_b16 a[140:141], v17 offset:24576
    ds_read_b64_tr_b16 a[142:143], v17 offset:25600
    v_mfma_f32_16x16x32_bf16 a[20:23], a[164:167], v[76:79], a[20:23]
    v_mul_f32 v38, v38, v46
    v_mul_f32 v39, v39, v47
    v_mfma_f32_16x16x32_bf16 a[20:23], a[160:163], v[72:75], a[20:23]
    ds_read_b64_tr_b16 a[144:145], v17 offset:32768
    ds_read_b64_tr_b16 a[146:147], v17 offset:33792
    v_mfma_f32_16x16x32_bf16 a[20:23], a[156:159], v[68:71], a[20:23]
    s_add_u32 s71, s3, 1
    v_cvt_pk_bf16_f32 v54, v36, v37
    v_cvt_pk_bf16_f32 v55, v38, v39
    v_mfma_f32_16x16x32_bf16 a[20:23], a[152:155], v[64:67], a[20:23]
    s_and_b32 s71, s71, 3
    ds_read_b64_tr_b16 a[148:149], v17 offset:40960
    ds_read_b64_tr_b16 a[150:151], v17 offset:41984
    v_mfma_f32_16x16x32_bf16 a[36:39], a[152:155], v[136:139], a[36:39]
    s_mul_i32 s71, s71, 4096
    s_add_u32 s71, s71, s59
    buffer_store_dwordx4 v[52:55], v2, s[28:31], s71 offen offset:3072 sc1
    v_mfma_f32_16x16x32_bf16 a[36:39], a[156:159], v[140:143], a[36:39]
    v_accvgpr_read_b32 v36, a96
    v_accvgpr_read_b32 v37, a97
    v_mfma_f32_16x16x32_bf16 a[36:39], a[160:163], v[144:147], a[36:39]
    v_accvgpr_read_b32 v38, a98
    v_accvgpr_read_b32 v39, a99
    v_mfma_f32_16x16x32_bf16 a[36:39], a[164:167], v[148:151], a[36:39]
    v_accvgpr_read_b32 v40, a104
    v_accvgpr_read_b32 v41, a105
    v_mfma_f32_16x16x32_bf16 a[36:39], v[28:31], v[152:155], a[36:39]
    v_accvgpr_read_b32 v42, a106
    v_accvgpr_read_b32 v43, a107
    v_mfma_f32_16x16x32_bf16 a[36:39], v[32:35], v[156:159], a[36:39]
    v_mul_f32 v44, v20, v36
    v_mul_f32 v45, v20, v37
    v_mfma_f32_16x16x32_bf16 a[52:55], v[32:35], v[228:231], a[52:55]
    v_mul_f32 v46, v20, v38
    v_mul_f32 v47, v20, v39
    v_mfma_f32_16x16x32_bf16 a[52:55], v[28:31], v[224:227], a[52:55]
    v_exp_f32 v44, v44
    v_mfma_f32_16x16x32_bf16 a[52:55], a[164:167], v[220:223], a[52:55]
    v_exp_f32 v45, v45
    v_mfma_f32_16x16x32_bf16 a[52:55], a[160:163], v[216:219], a[52:55]
    v_exp_f32 v46, v46
    v_mfma_f32_16x16x32_bf16 a[52:55], a[156:159], v[212:215], a[52:55]
    v_exp_f32 v47, v47
    v_mfma_f32_16x16x32_bf16 a[52:55], a[152:155], v[208:211], a[52:55]
    s_waitcnt lgkmcnt(0)
    v_mul_f32 v36, v36, v40
    v_mul_f32 v37, v37, v41
    v_mfma_f32_16x16x32_bf16 a[8:11], a[128:131], a[192:195], a[8:11]
    ds_read_b64_tr_b16 a[152:153], v17 offset:8
    ds_read_b64_tr_b16 a[154:155], v17 offset:1032
    v_mfma_f32_16x16x32_bf16 a[8:11], a[132:135], a[196:199], a[8:11]
    v_mul_f32 v38, v38, v42
    v_mul_f32 v39, v39, v43
    v_mfma_f32_16x16x32_bf16 a[8:11], a[136:139], a[200:203], a[8:11]
    ds_read_b64_tr_b16 a[156:157], v17 offset:8200
    ds_read_b64_tr_b16 a[158:159], v17 offset:9224
    v_mfma_f32_16x16x32_bf16 a[8:11], a[140:143], a[204:207], a[8:11]
    v_fma_f32 v44, v44, v24, v24
    v_fma_f32 v45, v45, v24, v24
    v_mfma_f32_16x16x32_bf16 a[8:11], a[144:147], a[208:211], a[8:11]
    ds_read_b64_tr_b16 a[160:161], v17 offset:16392
    ds_read_b64_tr_b16 a[162:163], v17 offset:17416
    v_mfma_f32_16x16x32_bf16 a[8:11], a[148:151], a[212:215], a[8:11]
    v_fma_f32 v46, v46, v24, v24
    v_fma_f32 v47, v47, v24, v24
    v_mfma_f32_16x16x32_bf16 a[24:27], a[148:151], v[84:87], a[24:27]
    ds_read_b64_tr_b16 a[164:165], v17 offset:24584
    ds_read_b64_tr_b16 a[166:167], v17 offset:25608
    v_mfma_f32_16x16x32_bf16 a[24:27], a[144:147], v[80:83], a[24:27]
    v_rcp_f32 v44, v44
    v_mfma_f32_16x16x32_bf16 a[24:27], a[140:143], v[76:79], a[24:27]
    ds_read_b64_tr_b16 v[28:29], v17 offset:32776
    ds_read_b64_tr_b16 v[30:31], v17 offset:33800
    v_mfma_f32_16x16x32_bf16 a[24:27], a[136:139], v[72:75], a[24:27]
    v_rcp_f32 v45, v45
    v_mfma_f32_16x16x32_bf16 a[24:27], a[132:135], v[68:71], a[24:27]
    ds_read_b64_tr_b16 v[32:33], v17 offset:40968
    ds_read_b64_tr_b16 v[34:35], v17 offset:41992
    v_mfma_f32_16x16x32_bf16 a[24:27], a[128:131], v[64:67], a[24:27]
    v_rcp_f32 v46, v46
    v_mfma_f32_16x16x32_bf16 a[40:43], a[128:131], v[136:139], a[40:43]
    v_rcp_f32 v47, v47
    v_mfma_f32_16x16x32_bf16 a[40:43], a[132:135], v[140:143], a[40:43]
    v_mul_f32 v36, v36, v44
    v_mul_f32 v37, v37, v45
    v_mfma_f32_16x16x32_bf16 a[40:43], a[136:139], v[144:147], a[40:43]
    v_mul_f32 v38, v38, v46
    v_mul_f32 v39, v39, v47
    v_mfma_f32_16x16x32_bf16 a[40:43], a[140:143], v[148:151], a[40:43]
    v_cvt_pk_bf16_f32 v48, v36, v37
    v_cvt_pk_bf16_f32 v49, v38, v39
    v_mfma_f32_16x16x32_bf16 a[40:43], a[144:147], v[152:155], a[40:43]
    v_accvgpr_read_b32 v36, a100
    v_accvgpr_read_b32 v37, a101
    v_mfma_f32_16x16x32_bf16 a[40:43], a[148:151], v[156:159], a[40:43]
    v_accvgpr_read_b32 v38, a102
    v_accvgpr_read_b32 v39, a103
    v_mfma_f32_16x16x32_bf16 a[56:59], a[148:151], v[228:231], a[56:59]
    v_accvgpr_read_b32 v40, a108
    v_accvgpr_read_b32 v41, a109
    v_mfma_f32_16x16x32_bf16 a[56:59], a[144:147], v[224:227], a[56:59]
    v_accvgpr_read_b32 v42, a110
    v_accvgpr_read_b32 v43, a111
    v_mfma_f32_16x16x32_bf16 a[56:59], a[140:143], v[220:223], a[56:59]
    v_mul_f32 v44, v20, v36
    v_mul_f32 v45, v20, v37
    v_mfma_f32_16x16x32_bf16 a[56:59], a[136:139], v[216:219], a[56:59]
    v_mul_f32 v46, v20, v38
    v_mul_f32 v47, v20, v39
    v_mfma_f32_16x16x32_bf16 a[56:59], a[132:135], v[212:215], a[56:59]
    v_exp_f32 v44, v44
    v_mfma_f32_16x16x32_bf16 a[56:59], a[128:131], v[208:211], a[56:59]
    s_waitcnt lgkmcnt(0)
    v_exp_f32 v45, v45
    v_mfma_f32_16x16x32_bf16 a[12:15], a[152:155], a[192:195], a[12:15]
    s_waitcnt vmcnt(1)
    v_exp_f32 v46, v46
    v_mfma_f32_16x16x32_bf16 a[12:15], a[156:159], a[196:199], a[12:15]
    s_barrier
    v_add_u32 v16, 49152, v16
    v_mfma_f32_16x16x32_bf16 a[12:15], a[160:163], a[200:203], a[12:15]
    s_add_u32 m0, s51, 147456
    ds_read_b64_tr_b16 a[128:129], v16 offset:0
    ds_read_b64_tr_b16 a[130:131], v16 offset:1024
    v_mfma_f32_16x16x32_bf16 a[12:15], a[164:167], a[204:207], a[12:15]
    s_mul_i32 s56, s72, 1769472
    s_add_u32 s56, s56, s54
    v_mfma_f32_16x16x32_bf16 a[12:15], v[28:31], a[208:211], a[12:15]
    ds_read_b64_tr_b16 a[132:133], v16 offset:8192
    ds_read_b64_tr_b16 a[134:135], v16 offset:9216
    v_mfma_f32_16x16x32_bf16 a[12:15], v[32:35], a[212:215], a[12:15]
    buffer_load_dwordx4 v10, s[12:15], s56 offen nt lds
    v_mfma_f32_16x16x32_bf16 a[28:31], v[32:35], v[84:87], a[28:31]
    ds_read_b64_tr_b16 a[136:137], v16 offset:16384
    ds_read_b64_tr_b16 a[138:139], v16 offset:17408
    v_mfma_f32_16x16x32_bf16 a[28:31], v[28:31], v[80:83], a[28:31]
    v_exp_f32 v47, v47
    v_mfma_f32_16x16x32_bf16 a[28:31], a[164:167], v[76:79], a[28:31]
    ds_read_b64_tr_b16 a[140:141], v16 offset:24576
    ds_read_b64_tr_b16 a[142:143], v16 offset:25600
    v_mfma_f32_16x16x32_bf16 a[28:31], a[160:163], v[72:75], a[28:31]
    v_mul_f32 v36, v36, v40
    v_mul_f32 v37, v37, v41
    v_mfma_f32_16x16x32_bf16 a[28:31], a[156:159], v[68:71], a[28:31]
    ds_read_b64_tr_b16 a[144:145], v16 offset:32768
    ds_read_b64_tr_b16 a[146:147], v16 offset:33792
    v_mfma_f32_16x16x32_bf16 a[28:31], a[152:155], v[64:67], a[28:31]
    v_mul_f32 v38, v38, v42
    v_mul_f32 v39, v39, v43
    v_mfma_f32_16x16x32_bf16 a[44:47], a[152:155], v[136:139], a[44:47]
    ds_read_b64_tr_b16 a[148:149], v16 offset:40960
    ds_read_b64_tr_b16 a[150:151], v16 offset:41984
    v_mfma_f32_16x16x32_bf16 a[44:47], a[156:159], v[140:143], a[44:47]
    v_fma_f32 v44, v44, v24, v24
    v_fma_f32 v45, v45, v24, v24
    v_mfma_f32_16x16x32_bf16 a[44:47], a[160:163], v[144:147], a[44:47]
    v_fma_f32 v46, v46, v24, v24
    v_fma_f32 v47, v47, v24, v24
    v_mfma_f32_16x16x32_bf16 a[44:47], a[164:167], v[148:151], a[44:47]
    v_rcp_f32 v44, v44
    v_mfma_f32_16x16x32_bf16 a[44:47], v[28:31], v[152:155], a[44:47]
    v_rcp_f32 v45, v45
    v_mfma_f32_16x16x32_bf16 a[44:47], v[32:35], v[156:159], a[44:47]
    v_rcp_f32 v46, v46
    v_mfma_f32_16x16x32_bf16 a[60:63], v[32:35], v[228:231], a[60:63]
    v_rcp_f32 v47, v47
    v_mfma_f32_16x16x32_bf16 a[60:63], v[28:31], v[224:227], a[60:63]
    v_mul_f32 v36, v36, v44
    v_mul_f32 v37, v37, v45
    v_mfma_f32_16x16x32_bf16 a[60:63], a[164:167], v[220:223], a[60:63]
    v_mul_f32 v38, v38, v46
    v_mul_f32 v39, v39, v47
    v_mfma_f32_16x16x32_bf16 a[60:63], a[160:163], v[216:219], a[60:63]
    s_add_u32 m0, s51, 151552
    s_add_u32 s56, s56, 589824
    v_cvt_pk_bf16_f32 v50, v36, v37
    v_mfma_f32_16x16x32_bf16 a[60:63], a[156:159], v[212:215], a[60:63]
    s_add_u32 s71, s3, 2
    buffer_load_dwordx4 v10, s[12:15], s56 offen nt lds
    v_cvt_pk_bf16_f32 v51, v38, v39
    v_mfma_f32_16x16x32_bf16 a[60:63], a[152:155], v[208:211], a[60:63]
    s_waitcnt lgkmcnt(0)
    s_and_b32 s71, s71, 3
    s_mul_i32 s71, s71, 4096
    v_mfma_f32_16x16x32_bf16 a[0:3], a[128:131], a[216:219], a[0:3]
    s_add_u32 s71, s71, s59
    ds_read_b64_tr_b16 a[152:153], v16 offset:8
    ds_read_b64_tr_b16 a[154:155], v16 offset:1032
    v_mfma_f32_16x16x32_bf16 a[0:3], a[132:135], a[220:223], a[0:3]
    buffer_store_dwordx4 v[48:51], v2, s[28:31], s71 offen offset:3072 sc1
    v_accvgpr_read_b32 v36, a112
    v_mfma_f32_16x16x32_bf16 a[0:3], a[136:139], a[224:227], a[0:3]
    ds_read_b64_tr_b16 a[156:157], v16 offset:8200
    ds_read_b64_tr_b16 a[158:159], v16 offset:9224
    v_mfma_f32_16x16x32_bf16 a[0:3], a[140:143], a[228:231], a[0:3]
    v_accvgpr_read_b32 v37, a113
    v_accvgpr_read_b32 v38, a114
    v_mfma_f32_16x16x32_bf16 a[0:3], a[144:147], a[232:235], a[0:3]
    ds_read_b64_tr_b16 a[160:161], v16 offset:16392
    ds_read_b64_tr_b16 a[162:163], v16 offset:17416
    v_mfma_f32_16x16x32_bf16 a[0:3], a[148:151], a[236:239], a[0:3]
    v_accvgpr_read_b32 v39, a115
    v_accvgpr_read_b32 v40, a120
    v_mfma_f32_16x16x32_bf16 a[16:19], a[148:151], v[108:111], a[16:19]
    ds_read_b64_tr_b16 a[164:165], v16 offset:24584
    ds_read_b64_tr_b16 a[166:167], v16 offset:25608
    v_mfma_f32_16x16x32_bf16 a[16:19], a[144:147], v[104:107], a[16:19]
    v_accvgpr_read_b32 v41, a121
    v_accvgpr_read_b32 v42, a122
    v_mfma_f32_16x16x32_bf16 a[16:19], a[140:143], v[100:103], a[16:19]
    ds_read_b64_tr_b16 v[28:29], v16 offset:32776
    ds_read_b64_tr_b16 v[30:31], v16 offset:33800
    v_mfma_f32_16x16x32_bf16 a[16:19], a[136:139], v[96:99], a[16:19]
    v_accvgpr_read_b32 v43, a123
    v_mul_f32 v44, v21, v36
    v_mfma_f32_16x16x32_bf16 a[16:19], a[132:135], v[92:95], a[16:19]
    ds_read_b64_tr_b16 v[32:33], v16 offset:40968
    ds_read_b64_tr_b16 v[34:35], v16 offset:41992
    v_mfma_f32_16x16x32_bf16 a[16:19], a[128:131], v[88:91], a[16:19]
    v_mul_f32 v45, v21, v37
    v_mul_f32 v46, v21, v38
    v_mfma_f32_16x16x32_bf16 a[32:35], a[128:131], v[160:163], a[32:35]
    v_mul_f32 v47, v21, v39
    v_mfma_f32_16x16x32_bf16 a[32:35], a[132:135], v[164:167], a[32:35]
    v_exp_f32 v44, v44
    v_mfma_f32_16x16x32_bf16 a[32:35], a[136:139], v[168:171], a[32:35]
    v_exp_f32 v45, v45
    v_mfma_f32_16x16x32_bf16 a[32:35], a[140:143], v[172:175], a[32:35]
    v_exp_f32 v46, v46
    v_mfma_f32_16x16x32_bf16 a[32:35], a[144:147], v[176:179], a[32:35]
    v_exp_f32 v47, v47
    v_mfma_f32_16x16x32_bf16 a[32:35], a[148:151], v[180:183], a[32:35]
    s_add_u32 m0, s51, 155648
    s_add_u32 s56, s56, 589824
    v_mul_f32 v36, v36, v40
    v_mfma_f32_16x16x32_bf16 a[48:51], a[148:151], v[252:255], a[48:51]
    buffer_load_dwordx4 v10, s[12:15], s56 offen nt lds
    v_mul_f32 v37, v37, v41
    v_mfma_f32_16x16x32_bf16 a[48:51], a[144:147], v[248:251], a[48:51]
    v_mul_f32 v38, v38, v42
    v_mul_f32 v39, v39, v43
    v_mfma_f32_16x16x32_bf16 a[48:51], a[140:143], v[244:247], a[48:51]
    v_fma_f32 v44, v44, v25, v25
    v_fma_f32 v45, v45, v25, v25
    v_mfma_f32_16x16x32_bf16 a[48:51], a[136:139], v[240:243], a[48:51]
    v_fma_f32 v46, v46, v25, v25
    v_fma_f32 v47, v47, v25, v25
    v_mfma_f32_16x16x32_bf16 a[48:51], a[132:135], v[236:239], a[48:51]
    v_rcp_f32 v44, v44
    v_mfma_f32_16x16x32_bf16 a[48:51], a[128:131], v[232:235], a[48:51]
    s_waitcnt lgkmcnt(0)
    v_rcp_f32 v45, v45
    v_mfma_f32_16x16x32_bf16 a[4:7], a[152:155], a[216:219], a[4:7]
    v_add_u32 v17, 49152, v17
    v_mfma_f32_16x16x32_bf16 a[4:7], a[156:159], a[220:223], a[4:7]
    ds_read_b64_tr_b16 a[128:129], v17 offset:0
    ds_read_b64_tr_b16 a[130:131], v17 offset:1024
    v_mfma_f32_16x16x32_bf16 a[4:7], a[160:163], a[224:227], a[4:7]
    v_rcp_f32 v46, v46
    v_mfma_f32_16x16x32_bf16 a[4:7], a[164:167], a[228:231], a[4:7]
    ds_read_b64_tr_b16 a[132:133], v17 offset:8192
    ds_read_b64_tr_b16 a[134:135], v17 offset:9216
    v_mfma_f32_16x16x32_bf16 a[4:7], v[28:31], a[232:235], a[4:7]
    v_rcp_f32 v47, v47
    v_mfma_f32_16x16x32_bf16 a[4:7], v[32:35], a[236:239], a[4:7]
    ds_read_b64_tr_b16 a[136:137], v17 offset:16384
    ds_read_b64_tr_b16 a[138:139], v17 offset:17408
    v_mfma_f32_16x16x32_bf16 a[20:23], v[32:35], v[108:111], a[20:23]
    v_mul_f32 v36, v36, v44
    v_mul_f32 v37, v37, v45
    v_mfma_f32_16x16x32_bf16 a[20:23], v[28:31], v[104:107], a[20:23]
    ds_read_b64_tr_b16 a[140:141], v17 offset:24576
    ds_read_b64_tr_b16 a[142:143], v17 offset:25600
    v_mfma_f32_16x16x32_bf16 a[20:23], a[164:167], v[100:103], a[20:23]
    v_mul_f32 v38, v38, v46
    v_mul_f32 v39, v39, v47
    v_mfma_f32_16x16x32_bf16 a[20:23], a[160:163], v[96:99], a[20:23]
    ds_read_b64_tr_b16 a[144:145], v17 offset:32768
    ds_read_b64_tr_b16 a[146:147], v17 offset:33792
    v_mfma_f32_16x16x32_bf16 a[20:23], a[156:159], v[92:95], a[20:23]
    v_cvt_pk_bf16_f32 v52, v36, v37
    v_cvt_pk_bf16_f32 v53, v38, v39
    v_mfma_f32_16x16x32_bf16 a[20:23], a[152:155], v[88:91], a[20:23]
    ds_read_b64_tr_b16 a[148:149], v17 offset:40960
    ds_read_b64_tr_b16 a[150:151], v17 offset:41984
    v_mfma_f32_16x16x32_bf16 a[36:39], a[152:155], v[160:163], a[36:39]
    v_accvgpr_read_b32 v36, a116
    v_accvgpr_read_b32 v37, a117
    v_mfma_f32_16x16x32_bf16 a[36:39], a[156:159], v[164:167], a[36:39]
    v_accvgpr_read_b32 v38, a118
    v_accvgpr_read_b32 v39, a119
    v_mfma_f32_16x16x32_bf16 a[36:39], a[160:163], v[168:171], a[36:39]
    v_accvgpr_read_b32 v40, a124
    v_accvgpr_read_b32 v41, a125
    v_mfma_f32_16x16x32_bf16 a[36:39], a[164:167], v[172:175], a[36:39]
    v_accvgpr_read_b32 v42, a126
    v_accvgpr_read_b32 v43, a127
    v_mfma_f32_16x16x32_bf16 a[36:39], v[28:31], v[176:179], a[36:39]
    v_mul_f32 v44, v21, v36
    v_mul_f32 v45, v21, v37
    v_mfma_f32_16x16x32_bf16 a[36:39], v[32:35], v[180:183], a[36:39]
    v_mul_f32 v46, v21, v38
    v_mul_f32 v47, v21, v39
    v_mfma_f32_16x16x32_bf16 a[52:55], v[32:35], v[252:255], a[52:55]
    v_exp_f32 v44, v44
    v_mfma_f32_16x16x32_bf16 a[52:55], v[28:31], v[248:251], a[52:55]
    v_exp_f32 v45, v45
    v_mfma_f32_16x16x32_bf16 a[52:55], a[164:167], v[244:247], a[52:55]
    v_exp_f32 v46, v46
    v_mfma_f32_16x16x32_bf16 a[52:55], a[160:163], v[240:243], a[52:55]
    v_exp_f32 v47, v47
    v_mfma_f32_16x16x32_bf16 a[52:55], a[156:159], v[236:239], a[52:55]
    v_mul_f32 v36, v36, v40
    v_mul_f32 v37, v37, v41
    v_mfma_f32_16x16x32_bf16 a[52:55], a[152:155], v[232:235], a[52:55]
    s_waitcnt lgkmcnt(0)
    v_mul_f32 v38, v38, v42
    v_mul_f32 v39, v39, v43
    v_mfma_f32_16x16x32_bf16 a[8:11], a[128:131], a[216:219], a[8:11]
    ds_read_b64_tr_b16 a[152:153], v17 offset:8
    ds_read_b64_tr_b16 a[154:155], v17 offset:1032
    v_mfma_f32_16x16x32_bf16 a[8:11], a[132:135], a[220:223], a[8:11]
    v_fma_f32 v44, v44, v25, v25
    v_fma_f32 v45, v45, v25, v25
    v_mfma_f32_16x16x32_bf16 a[8:11], a[136:139], a[224:227], a[8:11]
    ds_read_b64_tr_b16 a[156:157], v17 offset:8200
    ds_read_b64_tr_b16 a[158:159], v17 offset:9224
    v_mfma_f32_16x16x32_bf16 a[8:11], a[140:143], a[228:231], a[8:11]
    v_fma_f32 v46, v46, v25, v25
    v_fma_f32 v47, v47, v25, v25
    v_mfma_f32_16x16x32_bf16 a[8:11], a[144:147], a[232:235], a[8:11]
    ds_read_b64_tr_b16 a[160:161], v17 offset:16392
    ds_read_b64_tr_b16 a[162:163], v17 offset:17416
    v_mfma_f32_16x16x32_bf16 a[8:11], a[148:151], a[236:239], a[8:11]
    v_rcp_f32 v44, v44
    v_mfma_f32_16x16x32_bf16 a[24:27], a[148:151], v[108:111], a[24:27]
    ds_read_b64_tr_b16 a[164:165], v17 offset:24584
    ds_read_b64_tr_b16 a[166:167], v17 offset:25608
    v_mfma_f32_16x16x32_bf16 a[24:27], a[144:147], v[104:107], a[24:27]
    v_rcp_f32 v45, v45
    v_mfma_f32_16x16x32_bf16 a[24:27], a[140:143], v[100:103], a[24:27]
    ds_read_b64_tr_b16 v[28:29], v17 offset:32776
    ds_read_b64_tr_b16 v[30:31], v17 offset:33800
    v_mfma_f32_16x16x32_bf16 a[24:27], a[136:139], v[96:99], a[24:27]
    v_rcp_f32 v46, v46
    v_mfma_f32_16x16x32_bf16 a[24:27], a[132:135], v[92:95], a[24:27]
    ds_read_b64_tr_b16 v[32:33], v17 offset:40968
    ds_read_b64_tr_b16 v[34:35], v17 offset:41992
    v_mfma_f32_16x16x32_bf16 a[24:27], a[128:131], v[88:91], a[24:27]
    v_rcp_f32 v47, v47
    v_mfma_f32_16x16x32_bf16 a[40:43], a[128:131], v[160:163], a[40:43]
    v_mul_f32 v36, v36, v44
    v_mul_f32 v37, v37, v45
    v_mfma_f32_16x16x32_bf16 a[40:43], a[132:135], v[164:167], a[40:43]
    v_mul_f32 v38, v38, v46
    v_mul_f32 v39, v39, v47
    v_mfma_f32_16x16x32_bf16 a[40:43], a[136:139], v[168:171], a[40:43]
    s_add_u32 s71, s3, 3
    v_cvt_pk_bf16_f32 v54, v36, v37
    v_cvt_pk_bf16_f32 v55, v38, v39
    v_mfma_f32_16x16x32_bf16 a[40:43], a[140:143], v[172:175], a[40:43]
    s_and_b32 s71, s71, 3
    s_mul_i32 s71, s71, 4096
    s_add_u32 s71, s71, s59
    v_mfma_f32_16x16x32_bf16 a[40:43], a[144:147], v[176:179], a[40:43]
    buffer_store_dwordx4 v[52:55], v2, s[28:31], s71 offen offset:3072 sc1
    v_mfma_f32_16x16x32_bf16 a[40:43], a[148:151], v[180:183], a[40:43]
    v_mfma_f32_16x16x32_bf16 a[56:59], a[148:151], v[252:255], a[56:59]
    v_mfma_f32_16x16x32_bf16 a[56:59], a[144:147], v[248:251], a[56:59]
    v_mfma_f32_16x16x32_bf16 a[56:59], a[140:143], v[244:247], a[56:59]
    v_mfma_f32_16x16x32_bf16 a[56:59], a[136:139], v[240:243], a[56:59]
    v_mfma_f32_16x16x32_bf16 a[56:59], a[132:135], v[236:239], a[56:59]
    v_mfma_f32_16x16x32_bf16 a[56:59], a[128:131], v[232:235], a[56:59]
    s_waitcnt lgkmcnt(0)
    v_mfma_f32_16x16x32_bf16 a[12:15], a[152:155], a[216:219], a[12:15]
    v_subrev_u32 v16, 98304, v16
    v_xor_b32 v16, 128, v16
    v_mfma_f32_16x16x32_bf16 a[12:15], a[156:159], a[220:223], a[12:15]
    ds_read_b64_tr_b16 a[128:129], v16 offset:0
    ds_read_b64_tr_b16 a[130:131], v16 offset:1024
    v_mfma_f32_16x16x32_bf16 a[12:15], a[160:163], a[224:227], a[12:15]
    v_mfma_f32_16x16x32_bf16 a[12:15], a[164:167], a[228:231], a[12:15]
    ds_read_b64_tr_b16 a[132:133], v16 offset:8192
    ds_read_b64_tr_b16 a[134:135], v16 offset:9216
    v_mfma_f32_16x16x32_bf16 a[12:15], v[28:31], a[232:235], a[12:15]
    v_mfma_f32_16x16x32_bf16 a[12:15], v[32:35], a[236:239], a[12:15]
    ds_read_b64_tr_b16 a[136:137], v16 offset:16384
    ds_read_b64_tr_b16 a[138:139], v16 offset:17408
    v_mfma_f32_16x16x32_bf16 a[28:31], v[32:35], v[108:111], a[28:31]
    v_mfma_f32_16x16x32_bf16 a[28:31], v[28:31], v[104:107], a[28:31]
    ds_read_b64_tr_b16 a[140:141], v16 offset:24576
    ds_read_b64_tr_b16 a[142:143], v16 offset:25600
    v_mfma_f32_16x16x32_bf16 a[28:31], a[164:167], v[100:103], a[28:31]
    v_mfma_f32_16x16x32_bf16 a[28:31], a[160:163], v[96:99], a[28:31]
    ds_read_b64_tr_b16 a[144:145], v16 offset:32768
    ds_read_b64_tr_b16 a[146:147], v16 offset:33792
    v_mfma_f32_16x16x32_bf16 a[28:31], a[156:159], v[92:95], a[28:31]
    v_mfma_f32_16x16x32_bf16 a[28:31], a[152:155], v[88:91], a[28:31]
    ds_read_b64_tr_b16 a[148:149], v16 offset:40960
    ds_read_b64_tr_b16 a[150:151], v16 offset:41984
    v_mfma_f32_16x16x32_bf16 a[44:47], a[152:155], v[160:163], a[44:47]
    v_mfma_f32_16x16x32_bf16 a[44:47], a[156:159], v[164:167], a[44:47]
    v_mfma_f32_16x16x32_bf16 a[44:47], a[160:163], v[168:171], a[44:47]
    v_mfma_f32_16x16x32_bf16 a[44:47], a[164:167], v[172:175], a[44:47]
    v_mfma_f32_16x16x32_bf16 a[44:47], v[28:31], v[176:179], a[44:47]
    v_mfma_f32_16x16x32_bf16 a[44:47], v[32:35], v[180:183], a[44:47]
    v_mfma_f32_16x16x32_bf16 a[60:63], v[32:35], v[252:255], a[60:63]
    v_mfma_f32_16x16x32_bf16 a[60:63], v[28:31], v[248:251], a[60:63]
    v_mfma_f32_16x16x32_bf16 a[60:63], a[164:167], v[244:247], a[60:63]
    v_mfma_f32_16x16x32_bf16 a[60:63], a[160:163], v[240:243], a[60:63]
    v_mfma_f32_16x16x32_bf16 a[60:63], a[156:159], v[236:239], a[60:63]
    v_mfma_f32_16x16x32_bf16 a[60:63], a[152:155], v[232:235], a[60:63]
    s_waitcnt lgkmcnt(0)
    v_mfma_f32_16x16x32_bf16 a[64:67], a[128:131], a[168:171], 0
    ds_read_b64_tr_b16 a[152:153], v16 offset:8
    ds_read_b64_tr_b16 a[154:155], v16 offset:1032
    v_mfma_f32_16x16x32_bf16 a[64:67], a[132:135], a[172:175], a[64:67]
    v_mfma_f32_16x16x32_bf16 a[64:67], a[136:139], a[176:179], a[64:67]
    ds_read_b64_tr_b16 a[156:157], v16 offset:8200
    ds_read_b64_tr_b16 a[158:159], v16 offset:9224
    v_mfma_f32_16x16x32_bf16 a[64:67], a[140:143], a[180:183], a[64:67]
    v_mfma_f32_16x16x32_bf16 a[64:67], a[144:147], a[184:187], a[64:67]
    ds_read_b64_tr_b16 a[160:161], v16 offset:16392
    ds_read_b64_tr_b16 a[162:163], v16 offset:17416
    v_mfma_f32_16x16x32_bf16 a[64:67], a[148:151], a[188:191], a[64:67]
    v_mul_f32 v18, 0xbdb504f3, v18
    v_mul_f32 v19, 0xbdb504f3, v19
    v_mfma_f32_16x16x32_bf16 a[80:83], a[148:151], v[60:63], 0
    ds_read_b64_tr_b16 a[164:165], v16 offset:24584
    ds_read_b64_tr_b16 a[166:167], v16 offset:25608
    v_mfma_f32_16x16x32_bf16 a[80:83], a[144:147], v[56:59], a[80:83]
    v_mul_f32 v20, 0xbdb504f3, v20
    v_mul_f32 v21, 0xbdb504f3, v21
    v_mfma_f32_16x16x32_bf16 a[80:83], a[140:143], a[252:255], a[80:83]
    ds_read_b64_tr_b16 v[28:29], v16 offset:32776
    ds_read_b64_tr_b16 v[30:31], v16 offset:33800
    v_mfma_f32_16x16x32_bf16 a[80:83], a[136:139], a[248:251], a[80:83]
    v_accvgpr_read_b32 v36, a0
    v_accvgpr_read_b32 v37, a1
    v_mfma_f32_16x16x32_bf16 a[80:83], a[132:135], a[244:247], a[80:83]
    ds_read_b64_tr_b16 v[32:33], v16 offset:40968
    ds_read_b64_tr_b16 v[34:35], v16 offset:41992
    v_mfma_f32_16x16x32_bf16 a[80:83], a[128:131], a[240:243], a[80:83]
    v_accvgpr_read_b32 v38, a2
    v_accvgpr_read_b32 v39, a3
    v_mfma_f32_16x16x32_bf16 a[96:99], a[128:131], v[112:115], 0
    v_accvgpr_read_b32 v40, a4
    v_accvgpr_read_b32 v41, a5
    v_mfma_f32_16x16x32_bf16 a[96:99], a[132:135], v[116:119], a[96:99]
    v_accvgpr_read_b32 v42, a6
    v_accvgpr_read_b32 v43, a7
    v_mfma_f32_16x16x32_bf16 a[96:99], a[136:139], v[120:123], a[96:99]
    v_mul_f32 v36, v18, v36
    v_mul_f32 v37, v18, v37
    v_mfma_f32_16x16x32_bf16 a[96:99], a[140:143], v[124:127], a[96:99]
    v_mul_f32 v38, v18, v38
    v_mul_f32 v39, v18, v39
    v_mfma_f32_16x16x32_bf16 a[96:99], a[144:147], v[128:131], a[96:99]
    v_mul_f32 v40, v18, v40
    v_mul_f32 v41, v18, v41
    v_mfma_f32_16x16x32_bf16 a[96:99], a[148:151], v[132:135], a[96:99]
    v_mul_f32 v42, v18, v42
    v_mul_f32 v43, v18, v43
    v_mfma_f32_16x16x32_bf16 a[112:115], a[148:151], v[204:207], 0
    v_cvt_pk_bf16_f32 v52, v36, v37
    v_cvt_pk_bf16_f32 v53, v38, v39
    v_mfma_f32_16x16x32_bf16 a[112:115], a[144:147], v[200:203], a[112:115]
    v_cvt_pk_bf16_f32 v54, v40, v41
    v_cvt_pk_bf16_f32 v55, v42, v43
    v_mfma_f32_16x16x32_bf16 a[112:115], a[140:143], v[196:199], a[112:115]
    v_accvgpr_write_b32 a0, v52
    v_accvgpr_write_b32 a1, v53
    v_mfma_f32_16x16x32_bf16 a[112:115], a[136:139], v[192:195], a[112:115]
    v_accvgpr_write_b32 a2, v54
    v_accvgpr_write_b32 a3, v55
    v_mfma_f32_16x16x32_bf16 a[112:115], a[132:135], v[188:191], a[112:115]
    v_accvgpr_read_b32 v44, a8
    v_accvgpr_read_b32 v45, a9
    v_mfma_f32_16x16x32_bf16 a[112:115], a[128:131], v[184:187], a[112:115]
    s_waitcnt lgkmcnt(0)
    v_accvgpr_read_b32 v46, a10
    v_accvgpr_read_b32 v47, a11
    v_mfma_f32_16x16x32_bf16 a[68:71], a[152:155], a[168:171], 0
    v_subrev_u32 v17, 98304, v17
    v_xor_b32 v17, 128, v17
    v_mfma_f32_16x16x32_bf16 a[68:71], a[156:159], a[172:175], a[68:71]
    ds_read_b64_tr_b16 a[128:129], v17 offset:0
    ds_read_b64_tr_b16 a[130:131], v17 offset:1024
    v_mfma_f32_16x16x32_bf16 a[68:71], a[160:163], a[176:179], a[68:71]
    v_accvgpr_read_b32 v48, a12
    v_accvgpr_read_b32 v49, a13
    v_mfma_f32_16x16x32_bf16 a[68:71], a[164:167], a[180:183], a[68:71]
    ds_read_b64_tr_b16 a[132:133], v17 offset:8192
    ds_read_b64_tr_b16 a[134:135], v17 offset:9216
    v_mfma_f32_16x16x32_bf16 a[68:71], v[28:31], a[184:187], a[68:71]
    v_accvgpr_read_b32 v50, a14
    v_accvgpr_read_b32 v51, a15
    v_mfma_f32_16x16x32_bf16 a[68:71], v[32:35], a[188:191], a[68:71]
    ds_read_b64_tr_b16 a[136:137], v17 offset:16384
    ds_read_b64_tr_b16 a[138:139], v17 offset:17408
    v_mfma_f32_16x16x32_bf16 a[84:87], v[32:35], v[60:63], 0
    v_mul_f32 v44, v18, v44
    v_mul_f32 v45, v18, v45
    v_mfma_f32_16x16x32_bf16 a[84:87], v[28:31], v[56:59], a[84:87]
    ds_read_b64_tr_b16 a[140:141], v17 offset:24576
    ds_read_b64_tr_b16 a[142:143], v17 offset:25600
    v_mfma_f32_16x16x32_bf16 a[84:87], a[164:167], a[252:255], a[84:87]
    v_mul_f32 v46, v18, v46
    v_mul_f32 v47, v18, v47
    v_mfma_f32_16x16x32_bf16 a[84:87], a[160:163], a[248:251], a[84:87]
    ds_read_b64_tr_b16 a[144:145], v17 offset:32768
    ds_read_b64_tr_b16 a[146:147], v17 offset:33792
    v_mfma_f32_16x16x32_bf16 a[84:87], a[156:159], a[244:247], a[84:87]
    v_mul_f32 v48, v18, v48
    v_mul_f32 v49, v18, v49
    v_mfma_f32_16x16x32_bf16 a[84:87], a[152:155], a[240:243], a[84:87]
    ds_read_b64_tr_b16 a[148:149], v17 offset:40960
    ds_read_b64_tr_b16 a[150:151], v17 offset:41984
    v_mfma_f32_16x16x32_bf16 a[100:103], a[152:155], v[112:115], 0
    v_mul_f32 v50, v18, v50
    v_mul_f32 v51, v18, v51
    v_mfma_f32_16x16x32_bf16 a[100:103], a[156:159], v[116:119], a[100:103]
    v_cvt_pk_bf16_f32 v52, v44, v45
    v_cvt_pk_bf16_f32 v53, v46, v47
    v_mfma_f32_16x16x32_bf16 a[100:103], a[160:163], v[120:123], a[100:103]
    v_cvt_pk_bf16_f32 v54, v48, v49
    v_cvt_pk_bf16_f32 v55, v50, v51
    v_mfma_f32_16x16x32_bf16 a[100:103], a[164:167], v[124:127], a[100:103]
    v_accvgpr_write_b32 a4, v52
    v_accvgpr_write_b32 a5, v53
    v_mfma_f32_16x16x32_bf16 a[100:103], v[28:31], v[128:131], a[100:103]
    v_accvgpr_write_b32 a6, v54
    v_accvgpr_write_b32 a7, v55
    v_mfma_f32_16x16x32_bf16 a[100:103], v[32:35], v[132:135], a[100:103]
    v_accvgpr_read_b32 v36, a16
    v_accvgpr_read_b32 v37, a17
    v_mfma_f32_16x16x32_bf16 a[116:119], v[32:35], v[204:207], 0
    v_accvgpr_read_b32 v38, a18
    v_accvgpr_read_b32 v39, a19
    v_mfma_f32_16x16x32_bf16 a[116:119], v[28:31], v[200:203], a[116:119]
    v_accvgpr_read_b32 v40, a20
    v_accvgpr_read_b32 v41, a21
    v_mfma_f32_16x16x32_bf16 a[116:119], a[164:167], v[196:199], a[116:119]
    v_accvgpr_read_b32 v42, a22
    v_accvgpr_read_b32 v43, a23
    v_mfma_f32_16x16x32_bf16 a[116:119], a[160:163], v[192:195], a[116:119]
    v_mul_f32 v36, v19, v36
    v_mul_f32 v37, v19, v37
    v_mfma_f32_16x16x32_bf16 a[116:119], a[156:159], v[188:191], a[116:119]
    v_mul_f32 v38, v19, v38
    v_mul_f32 v39, v19, v39
    v_mfma_f32_16x16x32_bf16 a[116:119], a[152:155], v[184:187], a[116:119]
    s_waitcnt lgkmcnt(0)
    v_mul_f32 v40, v19, v40
    v_mul_f32 v41, v19, v41
    v_mfma_f32_16x16x32_bf16 a[72:75], a[128:131], a[168:171], 0
    ds_read_b64_tr_b16 a[152:153], v17 offset:8
    ds_read_b64_tr_b16 a[154:155], v17 offset:1032
    v_mfma_f32_16x16x32_bf16 a[72:75], a[132:135], a[172:175], a[72:75]
    v_mul_f32 v42, v19, v42
    v_mul_f32 v43, v19, v43
    v_mfma_f32_16x16x32_bf16 a[72:75], a[136:139], a[176:179], a[72:75]
    ds_read_b64_tr_b16 a[156:157], v17 offset:8200
    ds_read_b64_tr_b16 a[158:159], v17 offset:9224
    v_mfma_f32_16x16x32_bf16 a[72:75], a[140:143], a[180:183], a[72:75]
    v_cvt_pk_bf16_f32 v52, v36, v37
    v_cvt_pk_bf16_f32 v53, v38, v39
    v_mfma_f32_16x16x32_bf16 a[72:75], a[144:147], a[184:187], a[72:75]
    ds_read_b64_tr_b16 a[160:161], v17 offset:16392
    ds_read_b64_tr_b16 a[162:163], v17 offset:17416
    v_mfma_f32_16x16x32_bf16 a[72:75], a[148:151], a[188:191], a[72:75]
    v_cvt_pk_bf16_f32 v54, v40, v41
    v_cvt_pk_bf16_f32 v55, v42, v43
    v_mfma_f32_16x16x32_bf16 a[88:91], a[148:151], v[60:63], 0
    ds_read_b64_tr_b16 a[164:165], v17 offset:24584
    ds_read_b64_tr_b16 a[166:167], v17 offset:25608
    v_mfma_f32_16x16x32_bf16 a[88:91], a[144:147], v[56:59], a[88:91]
    v_accvgpr_write_b32 a8, v52
    v_accvgpr_write_b32 a9, v53
    v_mfma_f32_16x16x32_bf16 a[88:91], a[140:143], a[252:255], a[88:91]
    ds_read_b64_tr_b16 v[28:29], v17 offset:32776
    ds_read_b64_tr_b16 v[30:31], v17 offset:33800
    v_mfma_f32_16x16x32_bf16 a[88:91], a[136:139], a[248:251], a[88:91]
    v_accvgpr_write_b32 a10, v54
    v_accvgpr_write_b32 a11, v55
    v_mfma_f32_16x16x32_bf16 a[88:91], a[132:135], a[244:247], a[88:91]
    ds_read_b64_tr_b16 v[32:33], v17 offset:40968
    ds_read_b64_tr_b16 v[34:35], v17 offset:41992
    v_mfma_f32_16x16x32_bf16 a[88:91], a[128:131], a[240:243], a[88:91]
    v_accvgpr_read_b32 v44, a24
    v_accvgpr_read_b32 v45, a25
    v_mfma_f32_16x16x32_bf16 a[104:107], a[128:131], v[112:115], 0
    v_accvgpr_read_b32 v46, a26
    v_accvgpr_read_b32 v47, a27
    v_mfma_f32_16x16x32_bf16 a[104:107], a[132:135], v[116:119], a[104:107]
    v_accvgpr_read_b32 v48, a28
    v_accvgpr_read_b32 v49, a29
    v_mfma_f32_16x16x32_bf16 a[104:107], a[136:139], v[120:123], a[104:107]
    v_accvgpr_read_b32 v50, a30
    v_accvgpr_read_b32 v51, a31
    v_mfma_f32_16x16x32_bf16 a[104:107], a[140:143], v[124:127], a[104:107]
    v_mul_f32 v44, v19, v44
    v_mul_f32 v45, v19, v45
    v_mfma_f32_16x16x32_bf16 a[104:107], a[144:147], v[128:131], a[104:107]
    v_mul_f32 v46, v19, v46
    v_mul_f32 v47, v19, v47
    v_mfma_f32_16x16x32_bf16 a[104:107], a[148:151], v[132:135], a[104:107]
    v_mul_f32 v48, v19, v48
    v_mul_f32 v49, v19, v49
    v_mfma_f32_16x16x32_bf16 a[120:123], a[148:151], v[204:207], 0
    v_mul_f32 v50, v19, v50
    v_mul_f32 v51, v19, v51
    v_mfma_f32_16x16x32_bf16 a[120:123], a[144:147], v[200:203], a[120:123]
    v_cvt_pk_bf16_f32 v52, v44, v45
    v_cvt_pk_bf16_f32 v53, v46, v47
    v_mfma_f32_16x16x32_bf16 a[120:123], a[140:143], v[196:199], a[120:123]
    v_cvt_pk_bf16_f32 v54, v48, v49
    v_cvt_pk_bf16_f32 v55, v50, v51
    v_mfma_f32_16x16x32_bf16 a[120:123], a[136:139], v[192:195], a[120:123]
    v_accvgpr_write_b32 a12, v52
    v_accvgpr_write_b32 a13, v53
    v_mfma_f32_16x16x32_bf16 a[120:123], a[132:135], v[188:191], a[120:123]
    v_accvgpr_write_b32 a14, v54
    v_accvgpr_write_b32 a15, v55
    v_mfma_f32_16x16x32_bf16 a[120:123], a[128:131], v[184:187], a[120:123]
    s_waitcnt lgkmcnt(0)
    v_accvgpr_read_b32 v36, a32
    v_accvgpr_read_b32 v37, a33
    v_mfma_f32_16x16x32_bf16 a[76:79], a[152:155], a[168:171], 0
    v_accvgpr_read_b32 v38, a34
    v_accvgpr_read_b32 v39, a35
    v_mfma_f32_16x16x32_bf16 a[76:79], a[156:159], a[172:175], a[76:79]
    s_barrier
    v_add_u32 v16, 49152, v16
    v_accvgpr_read_b32 v40, a36
    v_mfma_f32_16x16x32_bf16 a[76:79], a[160:163], a[176:179], a[76:79]
    s_add_u32 m0, s51, 0
    ds_read_b64_tr_b16 a[128:129], v16 offset:0
    ds_read_b64_tr_b16 a[130:131], v16 offset:1024
    v_mfma_f32_16x16x32_bf16 a[76:79], a[164:167], a[180:183], a[76:79]
    s_mul_i32 s56, s73, 1769472
    s_add_u32 s56, s56, s54
    v_accvgpr_read_b32 v41, a37
    v_mfma_f32_16x16x32_bf16 a[76:79], v[28:31], a[184:187], a[76:79]
    ds_read_b64_tr_b16 a[132:133], v16 offset:8192
    ds_read_b64_tr_b16 a[134:135], v16 offset:9216
    v_mfma_f32_16x16x32_bf16 a[76:79], v[32:35], a[188:191], a[76:79]
    buffer_load_dwordx4 v10, s[12:15], s56 offen nt lds
    v_accvgpr_read_b32 v42, a38
    v_mfma_f32_16x16x32_bf16 a[92:95], v[32:35], v[60:63], 0
    ds_read_b64_tr_b16 a[136:137], v16 offset:16384
    ds_read_b64_tr_b16 a[138:139], v16 offset:17408
    v_mfma_f32_16x16x32_bf16 a[92:95], v[28:31], v[56:59], a[92:95]
    v_accvgpr_read_b32 v43, a39
    v_mul_f32 v36, v20, v36
    v_mfma_f32_16x16x32_bf16 a[92:95], a[164:167], a[252:255], a[92:95]
    ds_read_b64_tr_b16 a[140:141], v16 offset:24576
    ds_read_b64_tr_b16 a[142:143], v16 offset:25600
    v_mfma_f32_16x16x32_bf16 a[92:95], a[160:163], a[248:251], a[92:95]
    v_mul_f32 v37, v20, v37
    v_mul_f32 v38, v20, v38
    v_mfma_f32_16x16x32_bf16 a[92:95], a[156:159], a[244:247], a[92:95]
    ds_read_b64_tr_b16 a[144:145], v16 offset:32768
    ds_read_b64_tr_b16 a[146:147], v16 offset:33792
    v_mfma_f32_16x16x32_bf16 a[92:95], a[152:155], a[240:243], a[92:95]
    v_mul_f32 v39, v20, v39
    v_mul_f32 v40, v20, v40
    v_mfma_f32_16x16x32_bf16 a[108:111], a[152:155], v[112:115], 0
    ds_read_b64_tr_b16 a[148:149], v16 offset:40960
    ds_read_b64_tr_b16 a[150:151], v16 offset:41984
    v_mfma_f32_16x16x32_bf16 a[108:111], a[156:159], v[116:119], a[108:111]
    v_mul_f32 v41, v20, v41
    v_mul_f32 v42, v20, v42
    v_mfma_f32_16x16x32_bf16 a[108:111], a[160:163], v[120:123], a[108:111]
    v_mul_f32 v43, v20, v43
    v_cvt_pk_bf16_f32 v52, v36, v37
    v_mfma_f32_16x16x32_bf16 a[108:111], a[164:167], v[124:127], a[108:111]
    v_cvt_pk_bf16_f32 v53, v38, v39
    v_cvt_pk_bf16_f32 v54, v40, v41
    v_mfma_f32_16x16x32_bf16 a[108:111], v[28:31], v[128:131], a[108:111]
    v_cvt_pk_bf16_f32 v55, v42, v43
    v_accvgpr_write_b32 a16, v52
    v_mfma_f32_16x16x32_bf16 a[108:111], v[32:35], v[132:135], a[108:111]
    v_accvgpr_write_b32 a17, v53
    v_accvgpr_write_b32 a18, v54
    v_mfma_f32_16x16x32_bf16 a[124:127], v[32:35], v[204:207], 0
    v_accvgpr_write_b32 a19, v55
    v_accvgpr_read_b32 v44, a40
    v_mfma_f32_16x16x32_bf16 a[124:127], v[28:31], v[200:203], a[124:127]
    v_accvgpr_read_b32 v45, a41
    v_accvgpr_read_b32 v46, a42
    v_mfma_f32_16x16x32_bf16 a[124:127], a[164:167], v[196:199], a[124:127]
    v_accvgpr_read_b32 v47, a43
    v_accvgpr_read_b32 v48, a44
    v_mfma_f32_16x16x32_bf16 a[124:127], a[160:163], v[192:195], a[124:127]
    v_accvgpr_read_b32 v49, a45
    v_accvgpr_read_b32 v50, a46
    v_mfma_f32_16x16x32_bf16 a[124:127], a[156:159], v[188:191], a[124:127]
    v_accvgpr_read_b32 v51, a47
    v_mul_f32 v44, v20, v44
    v_mfma_f32_16x16x32_bf16 a[124:127], a[152:155], v[184:187], a[124:127]
    s_waitcnt lgkmcnt(0)
    s_add_u32 m0, s51, 4096
    s_add_u32 s56, s56, 589824
    v_mfma_f32_16x16x32_bf16 a[64:67], a[128:131], a[192:195], a[64:67]
    ds_read_b64_tr_b16 a[152:153], v16 offset:8
    ds_read_b64_tr_b16 a[154:155], v16 offset:1032
    v_mfma_f32_16x16x32_bf16 a[64:67], a[132:135], a[196:199], a[64:67]
    buffer_load_dwordx4 v10, s[12:15], s56 offen nt lds
    v_mul_f32 v45, v20, v45
    v_mfma_f32_16x16x32_bf16 a[64:67], a[136:139], a[200:203], a[64:67]
    ds_read_b64_tr_b16 a[156:157], v16 offset:8200
    ds_read_b64_tr_b16 a[158:159], v16 offset:9224
    v_mfma_f32_16x16x32_bf16 a[64:67], a[140:143], a[204:207], a[64:67]
    v_mul_f32 v46, v20, v46
    v_mul_f32 v47, v20, v47
    v_mfma_f32_16x16x32_bf16 a[64:67], a[144:147], a[208:211], a[64:67]
    ds_read_b64_tr_b16 a[160:161], v16 offset:16392
    ds_read_b64_tr_b16 a[162:163], v16 offset:17416
    v_mfma_f32_16x16x32_bf16 a[64:67], a[148:151], a[212:215], a[64:67]
    v_mul_f32 v48, v20, v48
    v_mul_f32 v49, v20, v49
    v_mfma_f32_16x16x32_bf16 a[80:83], a[148:151], v[84:87], a[80:83]
    ds_read_b64_tr_b16 a[164:165], v16 offset:24584
    ds_read_b64_tr_b16 a[166:167], v16 offset:25608
    v_mfma_f32_16x16x32_bf16 a[80:83], a[144:147], v[80:83], a[80:83]
    v_mul_f32 v50, v20, v50
    v_mul_f32 v51, v20, v51
    v_mfma_f32_16x16x32_bf16 a[80:83], a[140:143], v[76:79], a[80:83]
    ds_read_b64_tr_b16 v[28:29], v16 offset:32776
    ds_read_b64_tr_b16 v[30:31], v16 offset:33800
    v_mfma_f32_16x16x32_bf16 a[80:83], a[136:139], v[72:75], a[80:83]
    v_cvt_pk_bf16_f32 v52, v44, v45
    v_cvt_pk_bf16_f32 v53, v46, v47
    v_mfma_f32_16x16x32_bf16 a[80:83], a[132:135], v[68:71], a[80:83]
    ds_read_b64_tr_b16 v[32:33], v16 offset:40968
    ds_read_b64_tr_b16 v[34:35], v16 offset:41992
    v_mfma_f32_16x16x32_bf16 a[80:83], a[128:131], v[64:67], a[80:83]
    v_cvt_pk_bf16_f32 v54, v48, v49
    v_cvt_pk_bf16_f32 v55, v50, v51
    v_mfma_f32_16x16x32_bf16 a[96:99], a[128:131], v[136:139], a[96:99]
    v_accvgpr_write_b32 a20, v52
    v_accvgpr_write_b32 a21, v53
    v_mfma_f32_16x16x32_bf16 a[96:99], a[132:135], v[140:143], a[96:99]
    v_accvgpr_write_b32 a22, v54
    v_accvgpr_write_b32 a23, v55
    v_mfma_f32_16x16x32_bf16 a[96:99], a[136:139], v[144:147], a[96:99]
    v_accvgpr_read_b32 v36, a48
    v_accvgpr_read_b32 v37, a49
    v_mfma_f32_16x16x32_bf16 a[96:99], a[140:143], v[148:151], a[96:99]
    v_accvgpr_read_b32 v38, a50
    v_accvgpr_read_b32 v39, a51
    v_mfma_f32_16x16x32_bf16 a[96:99], a[144:147], v[152:155], a[96:99]
    v_accvgpr_read_b32 v40, a52
    v_accvgpr_read_b32 v41, a53
    v_mfma_f32_16x16x32_bf16 a[96:99], a[148:151], v[156:159], a[96:99]
    v_accvgpr_read_b32 v42, a54
    v_accvgpr_read_b32 v43, a55
    v_mfma_f32_16x16x32_bf16 a[112:115], a[148:151], v[228:231], a[112:115]
    v_mul_f32 v36, v21, v36
    v_mul_f32 v37, v21, v37
    v_mfma_f32_16x16x32_bf16 a[112:115], a[144:147], v[224:227], a[112:115]
    v_mul_f32 v38, v21, v38
    v_mul_f32 v39, v21, v39
    v_mfma_f32_16x16x32_bf16 a[112:115], a[140:143], v[220:223], a[112:115]
    v_mul_f32 v40, v21, v40
    v_mul_f32 v41, v21, v41
    v_mfma_f32_16x16x32_bf16 a[112:115], a[136:139], v[216:219], a[112:115]
    s_add_u32 m0, s51, 8192
    s_add_u32 s56, s56, 589824
    v_mul_f32 v42, v21, v42
    v_mfma_f32_16x16x32_bf16 a[112:115], a[132:135], v[212:215], a[112:115]
    buffer_load_dwordx4 v10, s[12:15], s56 offen nt lds
    v_mul_f32 v43, v21, v43
    v_mfma_f32_16x16x32_bf16 a[112:115], a[128:131], v[208:211], a[112:115]
    s_waitcnt lgkmcnt(0)
    v_cvt_pk_bf16_f32 v52, v36, v37
    v_cvt_pk_bf16_f32 v53, v38, v39
    v_mfma_f32_16x16x32_bf16 a[68:71], a[152:155], a[192:195], a[68:71]
    v_add_u32 v17, 49152, v17
    v_cvt_pk_bf16_f32 v54, v40, v41
    v_mfma_f32_16x16x32_bf16 a[68:71], a[156:159], a[196:199], a[68:71]
    ds_read_b64_tr_b16 a[128:129], v17 offset:0
    ds_read_b64_tr_b16 a[130:131], v17 offset:1024
    v_mfma_f32_16x16x32_bf16 a[68:71], a[160:163], a[200:203], a[68:71]
    v_cvt_pk_bf16_f32 v55, v42, v43
    v_accvgpr_write_b32 a24, v52
    v_mfma_f32_16x16x32_bf16 a[68:71], a[164:167], a[204:207], a[68:71]
    ds_read_b64_tr_b16 a[132:133], v17 offset:8192
    ds_read_b64_tr_b16 a[134:135], v17 offset:9216
    v_mfma_f32_16x16x32_bf16 a[68:71], v[28:31], a[208:211], a[68:71]
    v_accvgpr_write_b32 a25, v53
    v_accvgpr_write_b32 a26, v54
    v_mfma_f32_16x16x32_bf16 a[68:71], v[32:35], a[212:215], a[68:71]
    ds_read_b64_tr_b16 a[136:137], v17 offset:16384
    ds_read_b64_tr_b16 a[138:139], v17 offset:17408
    v_mfma_f32_16x16x32_bf16 a[84:87], v[32:35], v[84:87], a[84:87]
    v_accvgpr_write_b32 a27, v55
    v_accvgpr_read_b32 v44, a56
    v_mfma_f32_16x16x32_bf16 a[84:87], v[28:31], v[80:83], a[84:87]
    ds_read_b64_tr_b16 a[140:141], v17 offset:24576
    ds_read_b64_tr_b16 a[142:143], v17 offset:25600
    v_mfma_f32_16x16x32_bf16 a[84:87], a[164:167], v[76:79], a[84:87]
    v_accvgpr_read_b32 v45, a57
    v_accvgpr_read_b32 v46, a58
    v_mfma_f32_16x16x32_bf16 a[84:87], a[160:163], v[72:75], a[84:87]
    ds_read_b64_tr_b16 a[144:145], v17 offset:32768
    ds_read_b64_tr_b16 a[146:147], v17 offset:33792
    v_mfma_f32_16x16x32_bf16 a[84:87], a[156:159], v[68:71], a[84:87]
    v_accvgpr_read_b32 v47, a59
    v_accvgpr_read_b32 v48, a60
    v_mfma_f32_16x16x32_bf16 a[84:87], a[152:155], v[64:67], a[84:87]
    ds_read_b64_tr_b16 a[148:149], v17 offset:40960
    ds_read_b64_tr_b16 a[150:151], v17 offset:41984
    v_mfma_f32_16x16x32_bf16 a[100:103], a[152:155], v[136:139], a[100:103]
    v_accvgpr_read_b32 v49, a61
    v_accvgpr_read_b32 v50, a62
    v_mfma_f32_16x16x32_bf16 a[100:103], a[156:159], v[140:143], a[100:103]
    v_accvgpr_read_b32 v51, a63
    v_mul_f32 v44, v21, v44
    v_mfma_f32_16x16x32_bf16 a[100:103], a[160:163], v[144:147], a[100:103]
    v_mul_f32 v45, v21, v45
    v_mul_f32 v46, v21, v46
    v_mfma_f32_16x16x32_bf16 a[100:103], a[164:167], v[148:151], a[100:103]
    v_mul_f32 v47, v21, v47
    v_mul_f32 v48, v21, v48
    v_mfma_f32_16x16x32_bf16 a[100:103], v[28:31], v[152:155], a[100:103]
    v_mul_f32 v49, v21, v49
    v_mul_f32 v50, v21, v50
    v_mfma_f32_16x16x32_bf16 a[100:103], v[32:35], v[156:159], a[100:103]
    v_mul_f32 v51, v21, v51
    v_cvt_pk_bf16_f32 v52, v44, v45
    v_mfma_f32_16x16x32_bf16 a[116:119], v[32:35], v[228:231], a[116:119]
    s_add_u32 m0, s51, 12288
    s_mul_i32 s56, s74, 1769472
    s_add_u32 s56, s56, s54
    v_mfma_f32_16x16x32_bf16 a[116:119], v[28:31], v[224:227], a[116:119]
    buffer_load_dwordx4 v10, s[12:15], s56 offen nt lds
    v_cvt_pk_bf16_f32 v53, v46, v47
    v_mfma_f32_16x16x32_bf16 a[116:119], a[164:167], v[220:223], a[116:119]
    v_cvt_pk_bf16_f32 v54, v48, v49
    v_cvt_pk_bf16_f32 v55, v50, v51
    v_mfma_f32_16x16x32_bf16 a[116:119], a[160:163], v[216:219], a[116:119]
    v_accvgpr_write_b32 a28, v52
    v_accvgpr_write_b32 a29, v53
    v_mfma_f32_16x16x32_bf16 a[116:119], a[156:159], v[212:215], a[116:119]
    v_accvgpr_write_b32 a30, v54
    v_accvgpr_write_b32 a31, v55
    v_mfma_f32_16x16x32_bf16 a[116:119], a[152:155], v[208:211], a[116:119]
    s_waitcnt lgkmcnt(0)
    v_mfma_f32_16x16x32_bf16 a[72:75], a[128:131], a[192:195], a[72:75]
    ds_read_b64_tr_b16 a[152:153], v17 offset:8
    ds_read_b64_tr_b16 a[154:155], v17 offset:1032
    v_mfma_f32_16x16x32_bf16 a[72:75], a[132:135], a[196:199], a[72:75]
    v_mfma_f32_16x16x32_bf16 a[72:75], a[136:139], a[200:203], a[72:75]
    ds_read_b64_tr_b16 a[156:157], v17 offset:8200
    ds_read_b64_tr_b16 a[158:159], v17 offset:9224
    v_mfma_f32_16x16x32_bf16 a[72:75], a[140:143], a[204:207], a[72:75]
    v_mfma_f32_16x16x32_bf16 a[72:75], a[144:147], a[208:211], a[72:75]
    ds_read_b64_tr_b16 a[160:161], v17 offset:16392
    ds_read_b64_tr_b16 a[162:163], v17 offset:17416
    v_mfma_f32_16x16x32_bf16 a[72:75], a[148:151], a[212:215], a[72:75]
    v_mfma_f32_16x16x32_bf16 a[88:91], a[148:151], v[84:87], a[88:91]
    ds_read_b64_tr_b16 a[164:165], v17 offset:24584
    ds_read_b64_tr_b16 a[166:167], v17 offset:25608
    v_mfma_f32_16x16x32_bf16 a[88:91], a[144:147], v[80:83], a[88:91]
    v_mfma_f32_16x16x32_bf16 a[88:91], a[140:143], v[76:79], a[88:91]
    ds_read_b64_tr_b16 v[28:29], v17 offset:32776
    ds_read_b64_tr_b16 v[30:31], v17 offset:33800
    v_mfma_f32_16x16x32_bf16 a[88:91], a[136:139], v[72:75], a[88:91]
    v_mfma_f32_16x16x32_bf16 a[88:91], a[132:135], v[68:71], a[88:91]
    ds_read_b64_tr_b16 v[32:33], v17 offset:40968
    ds_read_b64_tr_b16 v[34:35], v17 offset:41992
    v_mfma_f32_16x16x32_bf16 a[88:91], a[128:131], v[64:67], a[88:91]
    v_mfma_f32_16x16x32_bf16 a[104:107], a[128:131], v[136:139], a[104:107]
    v_mfma_f32_16x16x32_bf16 a[104:107], a[132:135], v[140:143], a[104:107]
    v_mfma_f32_16x16x32_bf16 a[104:107], a[136:139], v[144:147], a[104:107]
    v_mfma_f32_16x16x32_bf16 a[104:107], a[140:143], v[148:151], a[104:107]
    v_mfma_f32_16x16x32_bf16 a[104:107], a[144:147], v[152:155], a[104:107]
    s_add_u32 m0, s51, 16384
    s_add_u32 s56, s56, 589824
    v_mfma_f32_16x16x32_bf16 a[104:107], a[148:151], v[156:159], a[104:107]
    buffer_load_dwordx4 v10, s[12:15], s56 offen nt lds
    v_mfma_f32_16x16x32_bf16 a[120:123], a[148:151], v[228:231], a[120:123]
    v_mfma_f32_16x16x32_bf16 a[120:123], a[144:147], v[224:227], a[120:123]
    v_mfma_f32_16x16x32_bf16 a[120:123], a[140:143], v[220:223], a[120:123]
    v_mfma_f32_16x16x32_bf16 a[120:123], a[136:139], v[216:219], a[120:123]
    v_mfma_f32_16x16x32_bf16 a[120:123], a[132:135], v[212:215], a[120:123]
    v_mfma_f32_16x16x32_bf16 a[120:123], a[128:131], v[208:211], a[120:123]
    s_waitcnt lgkmcnt(0)
    v_mfma_f32_16x16x32_bf16 a[76:79], a[152:155], a[192:195], a[76:79]
    v_mfma_f32_16x16x32_bf16 a[76:79], a[156:159], a[196:199], a[76:79]
    s_barrier
    v_add_u32 v16, 49152, v16
    v_mfma_f32_16x16x32_bf16 a[76:79], a[160:163], a[200:203], a[76:79]
    ds_read_b64_tr_b16 a[128:129], v16 offset:0
    ds_read_b64_tr_b16 a[130:131], v16 offset:1024
    v_mfma_f32_16x16x32_bf16 a[76:79], a[164:167], a[204:207], a[76:79]
    v_mfma_f32_16x16x32_bf16 a[76:79], v[28:31], a[208:211], a[76:79]
    ds_read_b64_tr_b16 a[132:133], v16 offset:8192
    ds_read_b64_tr_b16 a[134:135], v16 offset:9216
    v_mfma_f32_16x16x32_bf16 a[76:79], v[32:35], a[212:215], a[76:79]
    v_mfma_f32_16x16x32_bf16 a[92:95], v[32:35], v[84:87], a[92:95]
    ds_read_b64_tr_b16 a[136:137], v16 offset:16384
    ds_read_b64_tr_b16 a[138:139], v16 offset:17408
    v_mfma_f32_16x16x32_bf16 a[92:95], v[28:31], v[80:83], a[92:95]
    v_mfma_f32_16x16x32_bf16 a[92:95], a[164:167], v[76:79], a[92:95]
    ds_read_b64_tr_b16 a[140:141], v16 offset:24576
    ds_read_b64_tr_b16 a[142:143], v16 offset:25600
    v_mfma_f32_16x16x32_bf16 a[92:95], a[160:163], v[72:75], a[92:95]
    v_mfma_f32_16x16x32_bf16 a[92:95], a[156:159], v[68:71], a[92:95]
    ds_read_b64_tr_b16 a[144:145], v16 offset:32768
    ds_read_b64_tr_b16 a[146:147], v16 offset:33792
    v_mfma_f32_16x16x32_bf16 a[92:95], a[152:155], v[64:67], a[92:95]
    v_mfma_f32_16x16x32_bf16 a[108:111], a[152:155], v[136:139], a[108:111]
    ds_read_b64_tr_b16 a[148:149], v16 offset:40960
    ds_read_b64_tr_b16 a[150:151], v16 offset:41984
    v_mfma_f32_16x16x32_bf16 a[108:111], a[156:159], v[140:143], a[108:111]
    s_add_u32 m0, s51, 20480
    s_add_u32 s56, s56, 589824
    v_mfma_f32_16x16x32_bf16 a[108:111], a[160:163], v[144:147], a[108:111]
    buffer_load_dwordx4 v10, s[12:15], s56 offen nt lds
    v_mfma_f32_16x16x32_bf16 a[108:111], a[164:167], v[148:151], a[108:111]
    s_sub_u32 s17, s18, 8192
    s_and_b32 s17, s17, 0x7ffff
    s_add_u32 m0, s52, 32768
    v_mfma_f32_16x16x32_bf16 a[108:111], v[28:31], v[152:155], a[108:111]
    buffer_load_dwordx4 v8, s[24:27], s17 offen offset:0 nt lds
    v_mfma_f32_16x16x32_bf16 a[108:111], v[32:35], v[156:159], a[108:111]
    v_mfma_f32_16x16x32_bf16 a[124:127], v[32:35], v[228:231], a[124:127]
    v_mfma_f32_16x16x32_bf16 a[124:127], v[28:31], v[224:227], a[124:127]
    v_mfma_f32_16x16x32_bf16 a[124:127], a[164:167], v[220:223], a[124:127]
    v_mfma_f32_16x16x32_bf16 a[124:127], a[160:163], v[216:219], a[124:127]
    v_mfma_f32_16x16x32_bf16 a[124:127], a[156:159], v[212:215], a[124:127]
    v_mfma_f32_16x16x32_bf16 a[124:127], a[152:155], v[208:211], a[124:127]
    s_waitcnt lgkmcnt(0)
    buffer_load_dwordx4 v9, s[24:27], s17 offen offset:1024 nt lds
    v_mfma_f32_16x16x32_bf16 a[64:67], a[128:131], a[216:219], a[64:67]
    ds_read_b64_tr_b16 a[152:153], v16 offset:8
    ds_read_b64_tr_b16 a[154:155], v16 offset:1032
    v_mfma_f32_16x16x32_bf16 a[64:67], a[132:135], a[220:223], a[64:67]
    v_mfma_f32_16x16x32_bf16 a[64:67], a[136:139], a[224:227], a[64:67]
    ds_read_b64_tr_b16 a[156:157], v16 offset:8200
    ds_read_b64_tr_b16 a[158:159], v16 offset:9224
    v_mfma_f32_16x16x32_bf16 a[64:67], a[140:143], a[228:231], a[64:67]
    v_mfma_f32_16x16x32_bf16 a[64:67], a[144:147], a[232:235], a[64:67]
    ds_read_b64_tr_b16 a[160:161], v16 offset:16392
    ds_read_b64_tr_b16 a[162:163], v16 offset:17416
    v_mfma_f32_16x16x32_bf16 a[64:67], a[148:151], a[236:239], a[64:67]
    v_mfma_f32_16x16x32_bf16 a[80:83], a[148:151], v[108:111], a[80:83]
    ds_read_b64_tr_b16 a[164:165], v16 offset:24584
    ds_read_b64_tr_b16 a[166:167], v16 offset:25608
    v_mfma_f32_16x16x32_bf16 a[80:83], a[144:147], v[104:107], a[80:83]
    v_mfma_f32_16x16x32_bf16 a[80:83], a[140:143], v[100:103], a[80:83]
    ds_read_b64_tr_b16 v[28:29], v16 offset:32776
    ds_read_b64_tr_b16 v[30:31], v16 offset:33800
    v_mfma_f32_16x16x32_bf16 a[80:83], a[136:139], v[96:99], a[80:83]
    buffer_load_dwordx4 v8, s[24:27], s17 offen offset:2048 nt lds
    v_mfma_f32_16x16x32_bf16 a[80:83], a[132:135], v[92:95], a[80:83]
    ds_read_b64_tr_b16 v[32:33], v16 offset:40968
    ds_read_b64_tr_b16 v[34:35], v16 offset:41992
    v_mfma_f32_16x16x32_bf16 a[80:83], a[128:131], v[88:91], a[80:83]
    v_mfma_f32_16x16x32_bf16 a[96:99], a[128:131], v[160:163], a[96:99]
    v_mfma_f32_16x16x32_bf16 a[96:99], a[132:135], v[164:167], a[96:99]
    v_mfma_f32_16x16x32_bf16 a[96:99], a[136:139], v[168:171], a[96:99]
    v_mfma_f32_16x16x32_bf16 a[96:99], a[140:143], v[172:175], a[96:99]
    v_mfma_f32_16x16x32_bf16 a[96:99], a[144:147], v[176:179], a[96:99]
    v_mfma_f32_16x16x32_bf16 a[96:99], a[148:151], v[180:183], a[96:99]
    v_mfma_f32_16x16x32_bf16 a[112:115], a[148:151], v[252:255], a[112:115]
    v_mfma_f32_16x16x32_bf16 a[112:115], a[144:147], v[248:251], a[112:115]
    buffer_load_dwordx4 v9, s[24:27], s17 offen offset:3072 nt lds
    v_mfma_f32_16x16x32_bf16 a[112:115], a[140:143], v[244:247], a[112:115]
    v_mfma_f32_16x16x32_bf16 a[112:115], a[136:139], v[240:243], a[112:115]
    v_mfma_f32_16x16x32_bf16 a[112:115], a[132:135], v[236:239], a[112:115]
    v_mfma_f32_16x16x32_bf16 a[112:115], a[128:131], v[232:235], a[112:115]
    s_waitcnt lgkmcnt(0)
    v_mfma_f32_16x16x32_bf16 a[68:71], a[152:155], a[216:219], a[68:71]
    v_add_u32 v17, 49152, v17
    v_mfma_f32_16x16x32_bf16 a[68:71], a[156:159], a[220:223], a[68:71]
    ds_read_b64_tr_b16 a[128:129], v17 offset:0
    ds_read_b64_tr_b16 a[130:131], v17 offset:1024
    v_mfma_f32_16x16x32_bf16 a[68:71], a[160:163], a[224:227], a[68:71]
    v_mfma_f32_16x16x32_bf16 a[68:71], a[164:167], a[228:231], a[68:71]
    ds_read_b64_tr_b16 a[132:133], v17 offset:8192
    ds_read_b64_tr_b16 a[134:135], v17 offset:9216
    v_mfma_f32_16x16x32_bf16 a[68:71], v[28:31], a[232:235], a[68:71]
    v_mfma_f32_16x16x32_bf16 a[68:71], v[32:35], a[236:239], a[68:71]
    s_add_u32 s17, s17, 16384
    ds_read_b64_tr_b16 a[136:137], v17 offset:16384
    ds_read_b64_tr_b16 a[138:139], v17 offset:17408
    v_mfma_f32_16x16x32_bf16 a[84:87], v[32:35], v[108:111], a[84:87]
    s_and_b32 s17, s17, 0x7ffff
    s_add_u32 m0, s52, 49152
    v_mfma_f32_16x16x32_bf16 a[84:87], v[28:31], v[104:107], a[84:87]
    ds_read_b64_tr_b16 a[140:141], v17 offset:24576
    ds_read_b64_tr_b16 a[142:143], v17 offset:25600
    v_mfma_f32_16x16x32_bf16 a[84:87], a[164:167], v[100:103], a[84:87]
    buffer_load_dwordx4 v8, s[24:27], s17 offen offset:0 nt lds
    v_mfma_f32_16x16x32_bf16 a[84:87], a[160:163], v[96:99], a[84:87]
    ds_read_b64_tr_b16 a[144:145], v17 offset:32768
    ds_read_b64_tr_b16 a[146:147], v17 offset:33792
    v_mfma_f32_16x16x32_bf16 a[84:87], a[156:159], v[92:95], a[84:87]
    v_mfma_f32_16x16x32_bf16 a[84:87], a[152:155], v[88:91], a[84:87]
    ds_read_b64_tr_b16 a[148:149], v17 offset:40960
    ds_read_b64_tr_b16 a[150:151], v17 offset:41984
    v_mfma_f32_16x16x32_bf16 a[100:103], a[152:155], v[160:163], a[100:103]
    v_mfma_f32_16x16x32_bf16 a[100:103], a[156:159], v[164:167], a[100:103]
    v_mfma_f32_16x16x32_bf16 a[100:103], a[160:163], v[168:171], a[100:103]
    v_mfma_f32_16x16x32_bf16 a[100:103], a[164:167], v[172:175], a[100:103]
    buffer_load_dwordx4 v9, s[24:27], s17 offen offset:1024 nt lds
    v_mfma_f32_16x16x32_bf16 a[100:103], v[28:31], v[176:179], a[100:103]
    v_mfma_f32_16x16x32_bf16 a[100:103], v[32:35], v[180:183], a[100:103]
    v_mfma_f32_16x16x32_bf16 a[116:119], v[32:35], v[252:255], a[116:119]
    v_mfma_f32_16x16x32_bf16 a[116:119], v[28:31], v[248:251], a[116:119]
    v_mfma_f32_16x16x32_bf16 a[116:119], a[164:167], v[244:247], a[116:119]
    v_mfma_f32_16x16x32_bf16 a[116:119], a[160:163], v[240:243], a[116:119]
    v_mfma_f32_16x16x32_bf16 a[116:119], a[156:159], v[236:239], a[116:119]
    v_mfma_f32_16x16x32_bf16 a[116:119], a[152:155], v[232:235], a[116:119]
    s_waitcnt lgkmcnt(0)
    v_mfma_f32_16x16x32_bf16 a[72:75], a[128:131], a[216:219], a[72:75]
    ds_read_b64_tr_b16 a[152:153], v17 offset:8
    ds_read_b64_tr_b16 a[154:155], v17 offset:1032
    v_mfma_f32_16x16x32_bf16 a[72:75], a[132:135], a[220:223], a[72:75]
    buffer_load_dwordx4 v8, s[24:27], s17 offen offset:2048 nt lds
    v_mfma_f32_16x16x32_bf16 a[72:75], a[136:139], a[224:227], a[72:75]
    ds_read_b64_tr_b16 a[156:157], v17 offset:8200
    ds_read_b64_tr_b16 a[158:159], v17 offset:9224
    v_mfma_f32_16x16x32_bf16 a[72:75], a[140:143], a[228:231], a[72:75]
    v_mfma_f32_16x16x32_bf16 a[72:75], a[144:147], a[232:235], a[72:75]
    ds_read_b64_tr_b16 a[160:161], v17 offset:16392
    ds_read_b64_tr_b16 a[162:163], v17 offset:17416
    v_mfma_f32_16x16x32_bf16 a[72:75], a[148:151], a[236:239], a[72:75]
    v_mfma_f32_16x16x32_bf16 a[88:91], a[148:151], v[108:111], a[88:91]
    ds_read_b64_tr_b16 a[164:165], v17 offset:24584
    ds_read_b64_tr_b16 a[166:167], v17 offset:25608
    v_mfma_f32_16x16x32_bf16 a[88:91], a[144:147], v[104:107], a[88:91]
    v_mfma_f32_16x16x32_bf16 a[88:91], a[140:143], v[100:103], a[88:91]
    ds_read_b64_tr_b16 v[28:29], v17 offset:32776
    ds_read_b64_tr_b16 v[30:31], v17 offset:33800
    v_mfma_f32_16x16x32_bf16 a[88:91], a[136:139], v[96:99], a[88:91]
    v_mfma_f32_16x16x32_bf16 a[88:91], a[132:135], v[92:95], a[88:91]
    ds_read_b64_tr_b16 v[32:33], v17 offset:40968
    ds_read_b64_tr_b16 v[34:35], v17 offset:41992
    v_mfma_f32_16x16x32_bf16 a[88:91], a[128:131], v[88:91], a[88:91]
    buffer_load_dwordx4 v9, s[24:27], s17 offen offset:3072 nt lds
    v_mfma_f32_16x16x32_bf16 a[104:107], a[128:131], v[160:163], a[104:107]
    v_mfma_f32_16x16x32_bf16 a[104:107], a[132:135], v[164:167], a[104:107]
    v_mfma_f32_16x16x32_bf16 a[104:107], a[136:139], v[168:171], a[104:107]
    v_mfma_f32_16x16x32_bf16 a[104:107], a[140:143], v[172:175], a[104:107]
    v_mfma_f32_16x16x32_bf16 a[104:107], a[144:147], v[176:179], a[104:107]
    v_mfma_f32_16x16x32_bf16 a[104:107], a[148:151], v[180:183], a[104:107]
    v_mfma_f32_16x16x32_bf16 a[120:123], a[148:151], v[252:255], a[120:123]
    v_mfma_f32_16x16x32_bf16 a[120:123], a[144:147], v[248:251], a[120:123]
    v_mfma_f32_16x16x32_bf16 a[120:123], a[140:143], v[244:247], a[120:123]
    v_mfma_f32_16x16x32_bf16 a[120:123], a[136:139], v[240:243], a[120:123]
    v_mfma_f32_16x16x32_bf16 a[120:123], a[132:135], v[236:239], a[120:123]
    v_mfma_f32_16x16x32_bf16 a[120:123], a[128:131], v[232:235], a[120:123]
    s_waitcnt lgkmcnt(0)
    v_mfma_f32_16x16x32_bf16 a[76:79], a[152:155], a[216:219], a[76:79]
    s_waitcnt vmcnt(15)
    v_mfma_f32_16x16x32_bf16 a[76:79], a[156:159], a[220:223], a[76:79]
    s_barrier
    v_add_u32 v13, 147456, v13
    v_mfma_f32_16x16x32_bf16 a[76:79], a[160:163], a[224:227], a[76:79]
    s_mov_b32 s16, s18
    ds_read_b64_tr_b16 a[128:129], v13 offset:0
    ds_read_b64_tr_b16 a[130:131], v13 offset:256
    v_mfma_f32_16x16x32_bf16 a[76:79], a[164:167], a[228:231], a[76:79]
    s_add_u32 m0, s52, 98304
    v_mfma_f32_16x16x32_bf16 a[76:79], v[28:31], a[232:235], a[76:79]
    ds_read_b64_tr_b16 a[132:133], v13 offset:1024
    ds_read_b64_tr_b16 a[134:135], v13 offset:1280
    v_mfma_f32_16x16x32_bf16 a[76:79], v[32:35], a[236:239], a[76:79]
    buffer_load_dwordx4 v4, s[20:23], s16 offen offset:0 nt lds
    v_mfma_f32_16x16x32_bf16 a[92:95], v[32:35], v[108:111], a[92:95]
    ds_read_b64_tr_b16 a[136:137], v13 offset:4096
    ds_read_b64_tr_b16 a[138:139], v13 offset:4352
    v_mfma_f32_16x16x32_bf16 a[92:95], v[28:31], v[104:107], a[92:95]
    buffer_load_dwordx4 v5, s[20:23], s16 offen offset:1024 nt lds
    v_mfma_f32_16x16x32_bf16 a[92:95], a[164:167], v[100:103], a[92:95]
    ds_read_b64_tr_b16 a[140:141], v13 offset:5120
    ds_read_b64_tr_b16 a[142:143], v13 offset:5376
    v_mfma_f32_16x16x32_bf16 a[92:95], a[160:163], v[96:99], a[92:95]
    v_mfma_f32_16x16x32_bf16 a[92:95], a[156:159], v[92:95], a[92:95]
    ds_read_b64_tr_b16 a[144:145], v13 offset:8192
    ds_read_b64_tr_b16 a[146:147], v13 offset:8448
    v_mfma_f32_16x16x32_bf16 a[92:95], a[152:155], v[88:91], a[92:95]
    v_mfma_f32_16x16x32_bf16 a[108:111], a[152:155], v[160:163], a[108:111]
    ds_read_b64_tr_b16 a[148:149], v13 offset:9216
    ds_read_b64_tr_b16 a[150:151], v13 offset:9472
    v_mfma_f32_16x16x32_bf16 a[108:111], a[156:159], v[164:167], a[108:111]
    buffer_load_dwordx4 v6, s[20:23], s16 offen offset:2048 nt lds
    v_mfma_f32_16x16x32_bf16 a[108:111], a[160:163], v[168:171], a[108:111]
    v_mfma_f32_16x16x32_bf16 a[108:111], a[164:167], v[172:175], a[108:111]
    v_mfma_f32_16x16x32_bf16 a[108:111], v[28:31], v[176:179], a[108:111]
    v_mfma_f32_16x16x32_bf16 a[108:111], v[32:35], v[180:183], a[108:111]
    v_mfma_f32_16x16x32_bf16 a[124:127], v[32:35], v[252:255], a[124:127]
    buffer_load_dwordx4 v7, s[20:23], s16 offen offset:3072 nt lds
    v_mfma_f32_16x16x32_bf16 a[124:127], v[28:31], v[248:251], a[124:127]
    v_mfma_f32_16x16x32_bf16 a[124:127], a[164:167], v[244:247], a[124:127]
    v_mfma_f32_16x16x32_bf16 a[124:127], a[160:163], v[240:243], a[124:127]
    v_mfma_f32_16x16x32_bf16 a[124:127], a[156:159], v[236:239], a[124:127]
    v_mfma_f32_16x16x32_bf16 a[124:127], a[152:155], v[232:235], a[124:127]
    s_waitcnt lgkmcnt(0)
    s_add_u32 s16, s16, 16384
    s_and_b32 s16, s16, 0x7ffff
    v_mfma_f32_16x16x32_bf16 a[32:35], a[128:131], a[168:171], 0
    s_add_u32 m0, s52, 114688
    ds_read_b64_tr_b16 a[152:153], v13 offset:2048
    ds_read_b64_tr_b16 a[154:155], v13 offset:2304
    v_mfma_f32_16x16x32_bf16 a[32:35], a[132:135], a[172:175], a[32:35]
    buffer_load_dwordx4 v4, s[20:23], s16 offen offset:0 nt lds
    v_mfma_f32_16x16x32_bf16 a[32:35], a[136:139], a[176:179], a[32:35]
    ds_read_b64_tr_b16 a[156:157], v13 offset:3072
    ds_read_b64_tr_b16 a[158:159], v13 offset:3328
    v_mfma_f32_16x16x32_bf16 a[32:35], a[140:143], a[180:183], a[32:35]
    v_mfma_f32_16x16x32_bf16 a[32:35], a[144:147], a[184:187], a[32:35]
    ds_read_b64_tr_b16 a[160:161], v13 offset:6144
    ds_read_b64_tr_b16 a[162:163], v13 offset:6400
    v_mfma_f32_16x16x32_bf16 a[32:35], a[148:151], a[188:191], a[32:35]
    buffer_load_dwordx4 v5, s[20:23], s16 offen offset:1024 nt lds
    v_accvgpr_read_b32 v36, a64
    v_mfma_f32_16x16x32_bf16 a[40:43], a[148:151], v[60:63], 0
    ds_read_b64_tr_b16 a[164:165], v13 offset:7168
    ds_read_b64_tr_b16 a[166:167], v13 offset:7424
    v_mfma_f32_16x16x32_bf16 a[40:43], a[144:147], v[56:59], a[40:43]
    v_accvgpr_read_b32 v37, a65
    v_accvgpr_read_b32 v38, a66
    v_mfma_f32_16x16x32_bf16 a[40:43], a[140:143], a[252:255], a[40:43]
    ds_read_b64_tr_b16 v[28:29], v13 offset:10240
    ds_read_b64_tr_b16 v[30:31], v13 offset:10496
    v_mfma_f32_16x16x32_bf16 a[40:43], a[136:139], a[248:251], a[40:43]
    v_accvgpr_read_b32 v39, a67
    v_accvgpr_read_b32 v40, a68
    v_mfma_f32_16x16x32_bf16 a[40:43], a[132:135], a[244:247], a[40:43]
    ds_read_b64_tr_b16 v[32:33], v13 offset:11264
    ds_read_b64_tr_b16 v[34:35], v13 offset:11520
    v_mfma_f32_16x16x32_bf16 a[40:43], a[128:131], a[240:243], a[40:43]
    buffer_load_dwordx4 v6, s[20:23], s16 offen offset:2048 nt lds
    v_accvgpr_read_b32 v41, a69
    v_mfma_f32_16x16x32_bf16 a[48:51], a[128:131], v[112:115], 0
    v_accvgpr_read_b32 v42, a70
    v_accvgpr_read_b32 v43, a71
    v_mfma_f32_16x16x32_bf16 a[48:51], a[132:135], v[116:119], a[48:51]
    v_mul_f32 v36, v18, v36
    v_mul_f32 v37, v18, v37
    v_mfma_f32_16x16x32_bf16 a[48:51], a[136:139], v[120:123], a[48:51]
    v_mul_f32 v38, v18, v38
    v_mul_f32 v39, v18, v39
    v_mfma_f32_16x16x32_bf16 a[48:51], a[140:143], v[124:127], a[48:51]
    buffer_load_dwordx4 v7, s[20:23], s16 offen offset:3072 nt lds
    v_mul_f32 v40, v18, v40
    v_mfma_f32_16x16x32_bf16 a[48:51], a[144:147], v[128:131], a[48:51]
    v_mul_f32 v41, v18, v41
    v_mul_f32 v42, v18, v42
    v_mfma_f32_16x16x32_bf16 a[48:51], a[148:151], v[132:135], a[48:51]
    v_mul_f32 v43, v18, v43
    v_cvt_pk_bf16_f32 v52, v36, v37
    v_mfma_f32_16x16x32_bf16 a[56:59], a[148:151], v[204:207], 0
    v_cvt_pk_bf16_f32 v53, v38, v39
    v_cvt_pk_bf16_f32 v54, v40, v41
    v_mfma_f32_16x16x32_bf16 a[56:59], a[144:147], v[200:203], a[56:59]
    v_cvt_pk_bf16_f32 v55, v42, v43
    v_accvgpr_write_b32 a64, v52
    v_mfma_f32_16x16x32_bf16 a[56:59], a[140:143], v[196:199], a[56:59]
    v_accvgpr_write_b32 a65, v53
    v_accvgpr_write_b32 a66, v54
    v_mfma_f32_16x16x32_bf16 a[56:59], a[136:139], v[192:195], a[56:59]
    v_accvgpr_write_b32 a67, v55
    v_accvgpr_read_b32 v44, a72
    v_mfma_f32_16x16x32_bf16 a[56:59], a[132:135], v[188:191], a[56:59]
    v_accvgpr_read_b32 v45, a73
    v_accvgpr_read_b32 v46, a74
    v_mfma_f32_16x16x32_bf16 a[56:59], a[128:131], v[184:187], a[56:59]
    s_waitcnt lgkmcnt(0)
    v_accvgpr_read_b32 v47, a75
    v_accvgpr_read_b32 v48, a76
    v_mfma_f32_16x16x32_bf16 a[36:39], a[152:155], a[168:171], 0
    s_waitcnt vmcnt(16)
    v_accvgpr_read_b32 v49, a77
    v_accvgpr_read_b32 v50, a78
    v_mfma_f32_16x16x32_bf16 a[36:39], a[156:159], a[172:175], a[36:39]
    s_barrier
    v_subrev_u32 v13, 147456, v13
    v_accvgpr_read_b32 v51, a79
    v_mfma_f32_16x16x32_bf16 a[36:39], a[160:163], a[176:179], a[36:39]
    s_add_u32 s16, s16, 16384
    ds_read_b64_tr_b16 a[128:129], v13 offset:0
    ds_read_b64_tr_b16 a[130:131], v13 offset:256
    v_mfma_f32_16x16x32_bf16 a[36:39], a[164:167], a[180:183], a[36:39]
    s_and_b32 s16, s16, 0x7ffff
    s_add_u32 m0, s52, 131072
    v_mul_f32 v44, v18, v44
    v_mfma_f32_16x16x32_bf16 a[36:39], v[28:31], a[184:187], a[36:39]
    ds_read_b64_tr_b16 a[132:133], v13 offset:1024
    ds_read_b64_tr_b16 a[134:135], v13 offset:1280
    v_mfma_f32_16x16x32_bf16 a[36:39], v[32:35], a[188:191], a[36:39]
    buffer_load_dwordx4 v4, s[20:23], s16 offen offset:0 nt lds
    v_mul_f32 v45, v18, v45
    v_mfma_f32_16x16x32_bf16 a[44:47], v[32:35], v[60:63], 0
    ds_read_b64_tr_b16 a[136:137], v13 offset:4096
    ds_read_b64_tr_b16 a[138:139], v13 offset:4352
    v_mfma_f32_16x16x32_bf16 a[44:47], v[28:31], v[56:59], a[44:47]
    v_mul_f32 v46, v18, v46
    v_mul_f32 v47, v18, v47
    v_mfma_f32_16x16x32_bf16 a[44:47], a[164:167], a[252:255], a[44:47]
    ds_read_b64_tr_b16 a[140:141], v13 offset:5120
    ds_read_b64_tr_b16 a[142:143], v13 offset:5376
    v_mfma_f32_16x16x32_bf16 a[44:47], a[160:163], a[248:251], a[44:47]
    v_mul_f32 v48, v18, v48
    v_mul_f32 v49, v18, v49
    v_mfma_f32_16x16x32_bf16 a[44:47], a[156:159], a[244:247], a[44:47]
    ds_read_b64_tr_b16 a[144:145], v13 offset:8192
    ds_read_b64_tr_b16 a[146:147], v13 offset:8448
    v_mfma_f32_16x16x32_bf16 a[44:47], a[152:155], a[240:243], a[44:47]
    v_mul_f32 v50, v18, v50
    v_mul_f32 v51, v18, v51
    v_mfma_f32_16x16x32_bf16 a[52:55], a[152:155], v[112:115], 0
    ds_read_b64_tr_b16 a[148:149], v13 offset:9216
    ds_read_b64_tr_b16 a[150:151], v13 offset:9472
    v_mfma_f32_16x16x32_bf16 a[52:55], a[156:159], v[116:119], a[52:55]
    v_cvt_pk_bf16_f32 v52, v44, v45
    v_cvt_pk_bf16_f32 v53, v46, v47
    v_mfma_f32_16x16x32_bf16 a[52:55], a[160:163], v[120:123], a[52:55]
    buffer_load_dwordx4 v5, s[20:23], s16 offen offset:1024 nt lds
    v_cvt_pk_bf16_f32 v54, v48, v49
    v_mfma_f32_16x16x32_bf16 a[52:55], a[164:167], v[124:127], a[52:55]
    v_cvt_pk_bf16_f32 v55, v50, v51
    v_accvgpr_write_b32 a68, v52
    v_mfma_f32_16x16x32_bf16 a[52:55], v[28:31], v[128:131], a[52:55]
    v_accvgpr_write_b32 a69, v53
    v_accvgpr_write_b32 a70, v54
    v_mfma_f32_16x16x32_bf16 a[52:55], v[32:35], v[132:135], a[52:55]
    v_accvgpr_write_b32 a71, v55
    v_accvgpr_read_b32 v36, a80
    v_mfma_f32_16x16x32_bf16 a[60:63], v[32:35], v[204:207], 0
    v_accvgpr_read_b32 v37, a81
    v_accvgpr_read_b32 v38, a82
    v_mfma_f32_16x16x32_bf16 a[60:63], v[28:31], v[200:203], a[60:63]
    v_accvgpr_read_b32 v39, a83
    v_accvgpr_read_b32 v40, a84
    v_mfma_f32_16x16x32_bf16 a[60:63], a[164:167], v[196:199], a[60:63]
    v_accvgpr_read_b32 v41, a85
    v_accvgpr_read_b32 v42, a86
    v_mfma_f32_16x16x32_bf16 a[60:63], a[160:163], v[192:195], a[60:63]
    v_accvgpr_read_b32 v43, a87
    v_mul_f32 v36, v19, v36
    v_mfma_f32_16x16x32_bf16 a[60:63], a[156:159], v[188:191], a[60:63]
    v_mul_f32 v37, v19, v37
    v_mul_f32 v38, v19, v38
    v_mfma_f32_16x16x32_bf16 a[60:63], a[152:155], v[184:187], a[60:63]
    s_waitcnt lgkmcnt(0)
    v_mul_f32 v39, v19, v39
    v_mul_f32 v40, v19, v40
    v_mfma_f32_16x16x32_bf16 a[32:35], a[128:131], a[192:195], a[32:35]
    ds_read_b64_tr_b16 a[152:153], v13 offset:2048
    ds_read_b64_tr_b16 a[154:155], v13 offset:2304
    v_mfma_f32_16x16x32_bf16 a[32:35], a[132:135], a[196:199], a[32:35]
    v_mul_f32 v41, v19, v41
    v_mul_f32 v42, v19, v42
    v_mfma_f32_16x16x32_bf16 a[32:35], a[136:139], a[200:203], a[32:35]
    ds_read_b64_tr_b16 a[156:157], v13 offset:3072
    ds_read_b64_tr_b16 a[158:159], v13 offset:3328
    v_mfma_f32_16x16x32_bf16 a[32:35], a[140:143], a[204:207], a[32:35]
    buffer_load_dwordx4 v6, s[20:23], s16 offen offset:2048 nt lds
    v_mul_f32 v43, v19, v43
    v_mfma_f32_16x16x32_bf16 a[32:35], a[144:147], a[208:211], a[32:35]
    ds_read_b64_tr_b16 a[160:161], v13 offset:6144
    ds_read_b64_tr_b16 a[162:163], v13 offset:6400
    v_mfma_f32_16x16x32_bf16 a[32:35], a[148:151], a[212:215], a[32:35]
    v_cvt_pk_bf16_f32 v52, v36, v37
    v_cvt_pk_bf16_f32 v53, v38, v39
    v_mfma_f32_16x16x32_bf16 a[40:43], a[148:151], v[84:87], a[40:43]
    ds_read_b64_tr_b16 a[164:165], v13 offset:7168
    ds_read_b64_tr_b16 a[166:167], v13 offset:7424
    v_mfma_f32_16x16x32_bf16 a[40:43], a[144:147], v[80:83], a[40:43]
    v_cvt_pk_bf16_f32 v54, v40, v41
    v_cvt_pk_bf16_f32 v55, v42, v43
    v_mfma_f32_16x16x32_bf16 a[40:43], a[140:143], v[76:79], a[40:43]
    ds_read_b64_tr_b16 v[28:29], v13 offset:10240
    ds_read_b64_tr_b16 v[30:31], v13 offset:10496
    v_mfma_f32_16x16x32_bf16 a[40:43], a[136:139], v[72:75], a[40:43]
    v_accvgpr_write_b32 a72, v52
    v_accvgpr_write_b32 a73, v53
    v_mfma_f32_16x16x32_bf16 a[40:43], a[132:135], v[68:71], a[40:43]
    ds_read_b64_tr_b16 v[32:33], v13 offset:11264
    ds_read_b64_tr_b16 v[34:35], v13 offset:11520
    v_mfma_f32_16x16x32_bf16 a[40:43], a[128:131], v[64:67], a[40:43]
    v_accvgpr_write_b32 a74, v54
    v_accvgpr_write_b32 a75, v55
    v_mfma_f32_16x16x32_bf16 a[48:51], a[128:131], v[136:139], a[48:51]
    v_accvgpr_read_b32 v44, a88
    v_accvgpr_read_b32 v45, a89
    v_mfma_f32_16x16x32_bf16 a[48:51], a[132:135], v[140:143], a[48:51]
    v_accvgpr_read_b32 v46, a90
    v_accvgpr_read_b32 v47, a91
    v_mfma_f32_16x16x32_bf16 a[48:51], a[136:139], v[144:147], a[48:51]
    buffer_load_dwordx4 v7, s[20:23], s16 offen offset:3072 nt lds
    v_accvgpr_read_b32 v48, a92
    v_mfma_f32_16x16x32_bf16 a[48:51], a[140:143], v[148:151], a[48:51]
    v_accvgpr_read_b32 v49, a93
    v_accvgpr_read_b32 v50, a94
    v_mfma_f32_16x16x32_bf16 a[48:51], a[144:147], v[152:155], a[48:51]
    v_accvgpr_read_b32 v51, a95
    v_mul_f32 v44, v19, v44
    v_mfma_f32_16x16x32_bf16 a[48:51], a[148:151], v[156:159], a[48:51]
    v_mul_f32 v45, v19, v45
    v_mul_f32 v46, v19, v46
    v_mfma_f32_16x16x32_bf16 a[56:59], a[148:151], v[228:231], a[56:59]
    v_mul_f32 v47, v19, v47
    v_mul_f32 v48, v19, v48
    v_mfma_f32_16x16x32_bf16 a[56:59], a[144:147], v[224:227], a[56:59]
    v_mul_f32 v49, v19, v49
    v_mul_f32 v50, v19, v50
    v_mfma_f32_16x16x32_bf16 a[56:59], a[140:143], v[220:223], a[56:59]
    v_mul_f32 v51, v19, v51
    v_cvt_pk_bf16_f32 v52, v44, v45
    v_mfma_f32_16x16x32_bf16 a[56:59], a[136:139], v[216:219], a[56:59]
    v_cvt_pk_bf16_f32 v53, v46, v47
    v_cvt_pk_bf16_f32 v54, v48, v49
    v_mfma_f32_16x16x32_bf16 a[56:59], a[132:135], v[212:215], a[56:59]
    v_cvt_pk_bf16_f32 v55, v50, v51
    v_accvgpr_write_b32 a76, v52
    v_mfma_f32_16x16x32_bf16 a[56:59], a[128:131], v[208:211], a[56:59]
    s_waitcnt lgkmcnt(0)
    v_accvgpr_write_b32 a77, v53
    v_accvgpr_write_b32 a78, v54
    v_mfma_f32_16x16x32_bf16 a[36:39], a[152:155], a[192:195], a[36:39]
    v_add_u32 v13, 12288, v13
    v_accvgpr_write_b32 a79, v55
    v_mfma_f32_16x16x32_bf16 a[36:39], a[156:159], a[196:199], a[36:39]
    ds_read_b64_tr_b16 a[128:129], v13 offset:0
    ds_read_b64_tr_b16 a[130:131], v13 offset:256
    v_mfma_f32_16x16x32_bf16 a[36:39], a[160:163], a[200:203], a[36:39]
    v_accvgpr_read_b32 v36, a96
    v_accvgpr_read_b32 v37, a97
    v_mfma_f32_16x16x32_bf16 a[36:39], a[164:167], a[204:207], a[36:39]
    s_add_u32 s16, s16, 16384
    ds_read_b64_tr_b16 a[132:133], v13 offset:1024
    ds_read_b64_tr_b16 a[134:135], v13 offset:1280
    v_mfma_f32_16x16x32_bf16 a[36:39], v[28:31], a[208:211], a[36:39]
    s_and_b32 s16, s16, 0x7ffff
    s_add_u32 m0, s52, 147456
    v_accvgpr_read_b32 v38, a98
    v_mfma_f32_16x16x32_bf16 a[36:39], v[32:35], a[212:215], a[36:39]
    ds_read_b64_tr_b16 a[136:137], v13 offset:4096
    ds_read_b64_tr_b16 a[138:139], v13 offset:4352
    v_mfma_f32_16x16x32_bf16 a[44:47], v[32:35], v[84:87], a[44:47]
    buffer_load_dwordx4 v4, s[20:23], s16 offen offset:0 nt lds
    v_accvgpr_read_b32 v39, a99
    v_mfma_f32_16x16x32_bf16 a[44:47], v[28:31], v[80:83], a[44:47]
    ds_read_b64_tr_b16 a[140:141], v13 offset:5120
    ds_read_b64_tr_b16 a[142:143], v13 offset:5376
    v_mfma_f32_16x16x32_bf16 a[44:47], a[164:167], v[76:79], a[44:47]
    v_accvgpr_read_b32 v40, a100
    v_accvgpr_read_b32 v41, a101
    v_mfma_f32_16x16x32_bf16 a[44:47], a[160:163], v[72:75], a[44:47]
    ds_read_b64_tr_b16 a[144:145], v13 offset:8192
    ds_read_b64_tr_b16 a[146:147], v13 offset:8448
    v_mfma_f32_16x16x32_bf16 a[44:47], a[156:159], v[68:71], a[44:47]
    v_accvgpr_read_b32 v42, a102
    v_accvgpr_read_b32 v43, a103
    v_mfma_f32_16x16x32_bf16 a[44:47], a[152:155], v[64:67], a[44:47]
    ds_read_b64_tr_b16 a[148:149], v13 offset:9216
    ds_read_b64_tr_b16 a[150:151], v13 offset:9472
    v_mfma_f32_16x16x32_bf16 a[52:55], a[152:155], v[136:139], a[52:55]
    v_mul_f32 v36, v20, v36
    v_mul_f32 v37, v20, v37
    v_mfma_f32_16x16x32_bf16 a[52:55], a[156:159], v[140:143], a[52:55]
    v_mul_f32 v38, v20, v38
    v_mul_f32 v39, v20, v39
    v_mfma_f32_16x16x32_bf16 a[52:55], a[160:163], v[144:147], a[52:55]
    v_mul_f32 v40, v20, v40
    v_mul_f32 v41, v20, v41
    v_mfma_f32_16x16x32_bf16 a[52:55], a[164:167], v[148:151], a[52:55]
    buffer_load_dwordx4 v5, s[20:23], s16 offen offset:1024 nt lds
    v_mul_f32 v42, v20, v42
    v_mfma_f32_16x16x32_bf16 a[52:55], v[28:31], v[152:155], a[52:55]
    v_mul_f32 v43, v20, v43
    v_cvt_pk_bf16_f32 v52, v36, v37
    v_mfma_f32_16x16x32_bf16 a[52:55], v[32:35], v[156:159], a[52:55]
    v_cvt_pk_bf16_f32 v53, v38, v39
    v_cvt_pk_bf16_f32 v54, v40, v41
    v_mfma_f32_16x16x32_bf16 a[60:63], v[32:35], v[228:231], a[60:63]
    v_cvt_pk_bf16_f32 v55, v42, v43
    v_accvgpr_write_b32 a80, v52
    v_mfma_f32_16x16x32_bf16 a[60:63], v[28:31], v[224:227], a[60:63]
    v_accvgpr_write_b32 a81, v53
    v_accvgpr_write_b32 a82, v54
    v_mfma_f32_16x16x32_bf16 a[60:63], a[164:167], v[220:223], a[60:63]
    v_accvgpr_write_b32 a83, v55
    v_accvgpr_read_b32 v44, a104
    v_mfma_f32_16x16x32_bf16 a[60:63], a[160:163], v[216:219], a[60:63]
    v_accvgpr_read_b32 v45, a105
    v_accvgpr_read_b32 v46, a106
    v_mfma_f32_16x16x32_bf16 a[60:63], a[156:159], v[212:215], a[60:63]
    v_accvgpr_read_b32 v47, a107
    v_accvgpr_read_b32 v48, a108
    v_mfma_f32_16x16x32_bf16 a[60:63], a[152:155], v[208:211], a[60:63]
    s_waitcnt lgkmcnt(0)
    v_accvgpr_read_b32 v49, a109
    v_accvgpr_read_b32 v50, a110
    v_mfma_f32_16x16x32_bf16 a[32:35], a[128:131], a[216:219], a[32:35]
    ds_read_b64_tr_b16 a[152:153], v13 offset:2048
    ds_read_b64_tr_b16 a[154:155], v13 offset:2304
    v_mfma_f32_16x16x32_bf16 a[32:35], a[132:135], a[220:223], a[32:35]
    v_accvgpr_read_b32 v51, a111
    v_mul_f32 v44, v20, v44
    v_mfma_f32_16x16x32_bf16 a[32:35], a[136:139], a[224:227], a[32:35]
    ds_read_b64_tr_b16 a[156:157], v13 offset:3072
    ds_read_b64_tr_b16 a[158:159], v13 offset:3328
    v_mfma_f32_16x16x32_bf16 a[32:35], a[140:143], a[228:231], a[32:35]
    buffer_load_dwordx4 v6, s[20:23], s16 offen offset:2048 nt lds
    v_mul_f32 v45, v20, v45
    v_mfma_f32_16x16x32_bf16 a[32:35], a[144:147], a[232:235], a[32:35]
    ds_read_b64_tr_b16 a[160:161], v13 offset:6144
    ds_read_b64_tr_b16 a[162:163], v13 offset:6400
    v_mfma_f32_16x16x32_bf16 a[32:35], a[148:151], a[236:239], a[32:35]
    v_mul_f32 v46, v20, v46
    v_mul_f32 v47, v20, v47
    v_mfma_f32_16x16x32_bf16 a[40:43], a[148:151], v[108:111], a[40:43]
    ds_read_b64_tr_b16 a[164:165], v13 offset:7168
    ds_read_b64_tr_b16 a[166:167], v13 offset:7424
    v_mfma_f32_16x16x32_bf16 a[40:43], a[144:147], v[104:107], a[40:43]
    v_mul_f32 v48, v20, v48
    v_mul_f32 v49, v20, v49
    v_mfma_f32_16x16x32_bf16 a[40:43], a[140:143], v[100:103], a[40:43]
    ds_read_b64_tr_b16 v[28:29], v13 offset:10240
    ds_read_b64_tr_b16 v[30:31], v13 offset:10496
    v_mfma_f32_16x16x32_bf16 a[40:43], a[136:139], v[96:99], a[40:43]
    v_mul_f32 v50, v20, v50
    v_mul_f32 v51, v20, v51
    v_mfma_f32_16x16x32_bf16 a[40:43], a[132:135], v[92:95], a[40:43]
    ds_read_b64_tr_b16 v[32:33], v13 offset:11264
    ds_read_b64_tr_b16 v[34:35], v13 offset:11520
    v_mfma_f32_16x16x32_bf16 a[40:43], a[128:131], v[88:91], a[40:43]
    v_cvt_pk_bf16_f32 v52, v44, v45
    v_cvt_pk_bf16_f32 v53, v46, v47
    v_mfma_f32_16x16x32_bf16 a[48:51], a[128:131], v[160:163], a[48:51]
    v_cvt_pk_bf16_f32 v54, v48, v49
    v_cvt_pk_bf16_f32 v55, v50, v51
    v_mfma_f32_16x16x32_bf16 a[48:51], a[132:135], v[164:167], a[48:51]
    v_accvgpr_write_b32 a84, v52
    v_accvgpr_write_b32 a85, v53
    v_mfma_f32_16x16x32_bf16 a[48:51], a[136:139], v[168:171], a[48:51]
    v_accvgpr_write_b32 a86, v54
    v_accvgpr_write_b32 a87, v55
    v_mfma_f32_16x16x32_bf16 a[48:51], a[140:143], v[172:175], a[48:51]
    buffer_load_dwordx4 v7, s[20:23], s16 offen offset:3072 nt lds
    v_accvgpr_read_b32 v36, a112
    v_mfma_f32_16x16x32_bf16 a[48:51], a[144:147], v[176:179], a[48:51]
    v_accvgpr_read_b32 v37, a113
    v_accvgpr_read_b32 v38, a114
    v_mfma_f32_16x16x32_bf16 a[48:51], a[148:151], v[180:183], a[48:51]
    v_accvgpr_read_b32 v39, a115
    v_accvgpr_read_b32 v40, a116
    v_mfma_f32_16x16x32_bf16 a[56:59], a[148:151], v[252:255], a[56:59]
    v_accvgpr_read_b32 v41, a117
    v_accvgpr_read_b32 v42, a118
    v_mfma_f32_16x16x32_bf16 a[56:59], a[144:147], v[248:251], a[56:59]
    v_accvgpr_read_b32 v43, a119
    v_mul_f32 v36, v21, v36
    v_mfma_f32_16x16x32_bf16 a[56:59], a[140:143], v[244:247], a[56:59]
    v_mul_f32 v37, v21, v37
    v_mul_f32 v38, v21, v38
    v_mfma_f32_16x16x32_bf16 a[56:59], a[136:139], v[240:243], a[56:59]
    v_mul_f32 v39, v21, v39
    v_mul_f32 v40, v21, v40
    v_mfma_f32_16x16x32_bf16 a[56:59], a[132:135], v[236:239], a[56:59]
    v_mul_f32 v41, v21, v41
    v_mul_f32 v42, v21, v42
    v_mfma_f32_16x16x32_bf16 a[56:59], a[128:131], v[232:235], a[56:59]
    s_waitcnt lgkmcnt(0)
    v_mul_f32 v43, v21, v43
    v_cvt_pk_bf16_f32 v52, v36, v37
    v_mfma_f32_16x16x32_bf16 a[36:39], a[152:155], a[216:219], a[36:39]
    v_cvt_pk_bf16_f32 v53, v38, v39
    v_cvt_pk_bf16_f32 v54, v40, v41
    v_mfma_f32_16x16x32_bf16 a[36:39], a[156:159], a[220:223], a[36:39]
    v_cvt_pk_bf16_f32 v55, v42, v43
    v_accvgpr_write_b32 a88, v52
    v_mfma_f32_16x16x32_bf16 a[36:39], a[160:163], a[224:227], a[36:39]
    v_accvgpr_write_b32 a89, v53
    v_accvgpr_write_b32 a90, v54
    v_mfma_f32_16x16x32_bf16 a[36:39], a[164:167], a[228:231], a[36:39]
    v_accvgpr_write_b32 a91, v55
    v_accvgpr_read_b32 v44, a120
    v_mfma_f32_16x16x32_bf16 a[36:39], v[28:31], a[232:235], a[36:39]
    v_accvgpr_read_b32 v45, a121
    v_accvgpr_read_b32 v46, a122
    v_mfma_f32_16x16x32_bf16 a[36:39], v[32:35], a[236:239], a[36:39]
    v_accvgpr_read_b32 v47, a123
    v_accvgpr_read_b32 v48, a124
    v_mfma_f32_16x16x32_bf16 a[44:47], v[32:35], v[108:111], a[44:47]
    v_accvgpr_read_b32 v49, a125
    v_accvgpr_read_b32 v50, a126
    v_mfma_f32_16x16x32_bf16 a[44:47], v[28:31], v[104:107], a[44:47]
    v_accvgpr_read_b32 v51, a127
    v_mul_f32 v44, v21, v44
    v_mfma_f32_16x16x32_bf16 a[44:47], a[164:167], v[100:103], a[44:47]
    v_mul_f32 v45, v21, v45
    v_mul_f32 v46, v21, v46
    v_mfma_f32_16x16x32_bf16 a[44:47], a[160:163], v[96:99], a[44:47]
    v_mul_f32 v47, v21, v47
    v_mul_f32 v48, v21, v48
    v_mfma_f32_16x16x32_bf16 a[44:47], a[156:159], v[92:95], a[44:47]
    v_mul_f32 v49, v21, v49
    v_mul_f32 v50, v21, v50
    v_mfma_f32_16x16x32_bf16 a[44:47], a[152:155], v[88:91], a[44:47]
    v_mul_f32 v51, v21, v51
    v_cvt_pk_bf16_f32 v52, v44, v45
    v_mfma_f32_16x16x32_bf16 a[52:55], a[152:155], v[160:163], a[52:55]
    v_cvt_pk_bf16_f32 v53, v46, v47
    v_cvt_pk_bf16_f32 v54, v48, v49
    v_mfma_f32_16x16x32_bf16 a[52:55], a[156:159], v[164:167], a[52:55]
    v_cvt_pk_bf16_f32 v55, v50, v51
    v_accvgpr_write_b32 a92, v52
    v_mfma_f32_16x16x32_bf16 a[52:55], a[160:163], v[168:171], a[52:55]
    v_accvgpr_write_b32 a93, v53
    v_accvgpr_write_b32 a94, v54
    v_mfma_f32_16x16x32_bf16 a[52:55], a[164:167], v[172:175], a[52:55]
    v_accvgpr_write_b32 a95, v55
    v_mfma_f32_16x16x32_bf16 a[52:55], v[28:31], v[176:179], a[52:55]
    v_mfma_f32_16x16x32_bf16 a[52:55], v[32:35], v[180:183], a[52:55]
    v_mfma_f32_16x16x32_bf16 a[60:63], v[32:35], v[252:255], a[60:63]
    v_mfma_f32_16x16x32_bf16 a[60:63], v[28:31], v[248:251], a[60:63]
    v_mfma_f32_16x16x32_bf16 a[60:63], a[164:167], v[244:247], a[60:63]
    v_mfma_f32_16x16x32_bf16 a[60:63], a[160:163], v[240:243], a[60:63]
    v_mfma_f32_16x16x32_bf16 a[60:63], a[156:159], v[236:239], a[60:63]
    v_mfma_f32_16x16x32_bf16 a[60:63], a[152:155], v[232:235], a[60:63]
    v_accvgpr_read_b32 v240, a32
    v_accvgpr_read_b32 v241, a33
    v_accvgpr_read_b32 v242, a34
    v_accvgpr_read_b32 v243, a35
    v_accvgpr_read_b32 v36, a40
    v_accvgpr_read_b32 v37, a41
    v_accvgpr_read_b32 v38, a42
    v_accvgpr_read_b32 v39, a43
    v_accvgpr_read_b32 v44, a48
    v_accvgpr_read_b32 v45, a49
    v_accvgpr_read_b32 v46, a50
    v_accvgpr_read_b32 v47, a51
    v_accvgpr_read_b32 v26, a56
    v_accvgpr_read_b32 v27, a57
    v_accvgpr_read_b32 v28, a58
    v_accvgpr_read_b32 v29, a59
    v_accvgpr_read_b32 v244, a36
    v_accvgpr_read_b32 v245, a37
    v_accvgpr_read_b32 v246, a38
    v_accvgpr_read_b32 v247, a39
    v_accvgpr_read_b32 v40, a44
    v_accvgpr_read_b32 v41, a45
    v_accvgpr_read_b32 v42, a46
    v_accvgpr_read_b32 v43, a47
    v_accvgpr_read_b32 v48, a52
    v_accvgpr_read_b32 v49, a53
    v_accvgpr_read_b32 v50, a54
    v_accvgpr_read_b32 v51, a55
    v_accvgpr_read_b32 v30, a60
    v_accvgpr_read_b32 v31, a61
    v_accvgpr_read_b32 v32, a62
    v_accvgpr_read_b32 v33, a63
    v_and_b32 v128, 15, v1
    v_lshrrev_b32 v129, 4, v1
    v_xor_b32 v130, v129, v128
    v_lshlrev_b32 v130, 4, v130
    v_lshl_add_u32 v130, v128, 8, v130
    v_xor_b32 v131, 0, v130
    v_add_u32 v228, 98304, v131
    v_xor_b32 v131, 64, v130
    v_add_u32 v229, 98304, v131
    v_xor_b32 v131, 128, v130
    v_add_u32 v230, 98304, v131
    v_xor_b32 v131, 192, v130
    v_add_u32 v231, 98304, v131
    v_mov_b32 v56, 0xff800000
    v_mov_b32 v57, 0xff800000
    v_mov_b32 v58, 0xff800000
    v_mov_b32 v59, 0xff800000
    s_waitcnt vmcnt(12)
    s_barrier
L_attn_start:
    ds_read_b128 a[32:35], v228 offset:0
    ds_read_b128 a[36:39], v229 offset:0
    ds_read_b128 a[40:43], v230 offset:0
    ds_read_b128 a[44:47], v231 offset:0
    ds_read_b128 a[48:51], v228 offset:4096
    ds_read_b128 a[52:55], v229 offset:4096
    ds_read_b128 a[56:59], v230 offset:4096
    ds_read_b128 a[60:63], v231 offset:4096
    s_waitcnt lgkmcnt(7)
    v_mfma_f32_16x16x32_bf16 v[64:67], a[32:35], a[0:3], 0
    s_add_u32 s17, s17, 16384
    s_and_b32 s17, s17, 0x7ffff
    s_add_u32 m0, s52, 0
    s_waitcnt lgkmcnt(6)
    v_mfma_f32_16x16x32_bf16 v[64:67], a[36:39], a[4:7], v[64:67]
    buffer_load_dwordx4 v8, s[24:27], s17 offen offset:0 nt lds
    v_lshrrev_b32 v138, 2, v1
    s_waitcnt lgkmcnt(5)
    v_mfma_f32_16x16x32_bf16 v[64:67], a[40:43], a[64:67], v[64:67]
    v_and_b32 v139, 7, v138
    v_lshlrev_b32 v139, 1, v139
    s_waitcnt lgkmcnt(4)
    v_mfma_f32_16x16x32_bf16 v[64:67], a[44:47], a[68:71], v[64:67]
    v_bfe_u32 v136, v1, 1, 1
    v_xor_b32 v139, v139, v136
    v_mfma_f32_16x16x32_bf16 v[72:75], a[44:47], a[76:79], 0
    buffer_load_dwordx4 v9, s[24:27], s17 offen offset:1024 nt lds
    v_lshlrev_b32 v139, 4, v139
    v_mfma_f32_16x16x32_bf16 v[72:75], a[40:43], a[72:75], v[72:75]
    v_lshl_add_u32 v139, v138, 8, v139
    v_and_b32 v136, 1, v1
    v_mfma_f32_16x16x32_bf16 v[72:75], a[36:39], a[12:15], v[72:75]
    v_lshl_add_u32 v139, v136, 3, v139
    v_xor_b32 v232, 0, v139
    v_mfma_f32_16x16x32_bf16 v[72:75], a[32:35], a[8:11], v[72:75]
    v_xor_b32 v233, 32, v139
    v_xor_b32 v234, 64, v139
    v_mfma_f32_16x16x32_bf16 v[80:83], a[32:35], a[16:19], 0
    buffer_load_dwordx4 v8, s[24:27], s17 offen offset:2048 nt lds
    v_xor_b32 v235, 96, v139
    v_mfma_f32_16x16x32_bf16 v[80:83], a[36:39], a[20:23], v[80:83]
    v_xor_b32 v236, 128, v139
    v_xor_b32 v237, 160, v139
    v_mfma_f32_16x16x32_bf16 v[80:83], a[40:43], a[80:83], v[80:83]
    v_xor_b32 v238, 192, v139
    v_xor_b32 v239, 224, v139
    v_mfma_f32_16x16x32_bf16 v[80:83], a[44:47], a[84:87], v[80:83]
    v_mov_b32 v224, 0x3f803f80
    v_mov_b32 v225, 0x3f803f80
    v_mfma_f32_16x16x32_bf16 v[88:91], a[44:47], a[92:95], 0
    buffer_load_dwordx4 v9, s[24:27], s17 offen offset:3072 nt lds
    v_mov_b32 v226, 0x3f803f80
    v_mfma_f32_16x16x32_bf16 v[88:91], a[40:43], a[88:91], v[88:91]
    v_mov_b32 v227, 0x3f803f80
    v_mul_u32_u24 v252, 0xaaaa, v136
    v_mfma_f32_16x16x32_bf16 v[88:91], a[36:39], a[28:31], v[88:91]
    v_add_u32 v252, 0x4444, v252
    v_subrev_u32 v136, 1, v136
    v_mfma_f32_16x16x32_bf16 v[88:91], a[32:35], a[24:27], v[88:91]
    v_and_b32 v248, v136, v224
    v_and_b32 v249, v136, v224
    s_waitcnt lgkmcnt(3)
    v_mfma_f32_16x16x32_bf16 v[68:71], a[48:51], a[0:3], 0
    v_and_b32 v250, v136, v224
    v_and_b32 v251, v136, v224
    s_waitcnt lgkmcnt(2)
    v_mfma_f32_16x16x32_bf16 v[68:71], a[52:55], a[4:7], v[68:71]
    s_waitcnt lgkmcnt(1)
    v_mfma_f32_16x16x32_bf16 v[68:71], a[56:59], a[64:67], v[68:71]
    v_max3_f32 v128, v64, v65, v56
    v_max3_f32 v128, v128, v66, v67
    s_waitcnt lgkmcnt(0)
    v_mfma_f32_16x16x32_bf16 v[68:71], a[60:63], a[68:71], v[68:71]
    v_max3_f32 v129, v72, v73, v57
    v_max3_f32 v129, v129, v74, v75
    v_mfma_f32_16x16x32_bf16 v[76:79], a[60:63], a[76:79], 0
    v_max3_f32 v130, v80, v81, v58
    v_max3_f32 v130, v130, v82, v83
    v_mfma_f32_16x16x32_bf16 v[76:79], a[56:59], a[72:75], v[76:79]
    v_max3_f32 v131, v88, v89, v59
    v_max3_f32 v131, v131, v90, v91
    v_mfma_f32_16x16x32_bf16 v[76:79], a[52:55], a[12:15], v[76:79]
    v_mov_b32 v132, v128
    v_mov_b32 v133, v129
    v_mfma_f32_16x16x32_bf16 v[76:79], a[48:51], a[8:11], v[76:79]
    v_mov_b32 v134, v130
    v_mov_b32 v135, v131
    v_mfma_f32_16x16x32_bf16 v[84:87], a[48:51], a[16:19], 0
    v_permlane32_swap_b32 v128, v132
    v_permlane32_swap_b32 v129, v133
    v_mfma_f32_16x16x32_bf16 v[84:87], a[52:55], a[20:23], v[84:87]
    v_permlane32_swap_b32 v130, v134
    v_permlane32_swap_b32 v131, v135
    v_mfma_f32_16x16x32_bf16 v[84:87], a[56:59], a[80:83], v[84:87]
    v_max_f32 v128, v128, v132
    v_max_f32 v129, v129, v133
    v_mfma_f32_16x16x32_bf16 v[84:87], a[60:63], a[84:87], v[84:87]
    v_max_f32 v130, v130, v134
    v_max_f32 v131, v131, v135
    v_mfma_f32_16x16x32_bf16 v[92:95], a[60:63], a[92:95], 0
    v_mov_b32 v132, v128
    v_mov_b32 v133, v129
    v_mfma_f32_16x16x32_bf16 v[92:95], a[56:59], a[88:91], v[92:95]
    v_mov_b32 v134, v130
    v_mov_b32 v135, v131
    v_mfma_f32_16x16x32_bf16 v[92:95], a[52:55], a[28:31], v[92:95]
    v_permlane16_swap_b32 v128, v132
    v_permlane16_swap_b32 v129, v133
    v_mfma_f32_16x16x32_bf16 v[92:95], a[48:51], a[24:27], v[92:95]
    v_permlane16_swap_b32 v130, v134
    v_permlane16_swap_b32 v131, v135
    ds_read_b128 a[32:35], v228 offset:8192
    ds_read_b128 a[36:39], v229 offset:8192
    ds_read_b128 a[40:43], v230 offset:8192
    ds_read_b128 a[44:47], v231 offset:8192
    ds_read_b128 a[48:51], v228 offset:12288
    ds_read_b128 a[52:55], v229 offset:12288
    ds_read_b128 a[56:59], v230 offset:12288
    ds_read_b128 a[60:63], v231 offset:12288
    v_max_f32 v128, v128, v132
    v_max_f32 v129, v129, v133
    v_max_f32 v130, v130, v134
    v_max_f32 v131, v131, v135
    v_sub_f32 v192, 0, v128
    v_sub_f32 v193, 0, v128
    v_sub_f32 v194, 0, v128
    v_sub_f32 v195, 0, v128
    v_sub_f32 v196, 0, v129
    v_sub_f32 v197, 0, v129
    v_sub_f32 v198, 0, v129
    v_sub_f32 v199, 0, v129
    v_sub_f32 v200, 0, v130
    v_sub_f32 v201, 0, v130
    v_sub_f32 v202, 0, v130
    v_sub_f32 v203, 0, v130
    v_sub_f32 v204, 0, v131
    v_sub_f32 v205, 0, v131
    v_sub_f32 v206, 0, v131
    v_sub_f32 v207, 0, v131
    v_pk_add_f32 v[64:65], v[64:65], v[192:193]
    v_pk_add_f32 v[66:67], v[66:67], v[192:193]
    v_pk_add_f32 v[68:69], v[68:69], v[192:193]
    v_pk_add_f32 v[70:71], v[70:71], v[192:193]
    v_pk_add_f32 v[72:73], v[72:73], v[196:197]
    v_pk_add_f32 v[74:75], v[74:75], v[196:197]
    v_pk_add_f32 v[76:77], v[76:77], v[196:197]
    v_pk_add_f32 v[78:79], v[78:79], v[196:197]
    v_pk_add_f32 v[80:81], v[80:81], v[200:201]
    v_pk_add_f32 v[82:83], v[82:83], v[200:201]
    v_pk_add_f32 v[84:85], v[84:85], v[200:201]
    v_pk_add_f32 v[86:87], v[86:87], v[200:201]
    v_pk_add_f32 v[88:89], v[88:89], v[204:205]
    v_pk_add_f32 v[90:91], v[90:91], v[204:205]
    v_pk_add_f32 v[92:93], v[92:93], v[204:205]
    v_pk_add_f32 v[94:95], v[94:95], v[204:205]
    s_add_u32 s16, s16, 16384
    s_and_b32 s16, s16, 0x7ffff
    s_add_u32 s17, s17, 16384
    s_and_b32 s17, s17, 0x7ffff
    s_waitcnt lgkmcnt(7)
    v_mfma_f32_16x16x32_bf16 v[96:99], a[32:35], a[0:3], v[192:195]
    v_exp_f32 v64, v64
    s_waitcnt lgkmcnt(6)
    v_mfma_f32_16x16x32_bf16 v[96:99], a[36:39], a[4:7], v[96:99]
    v_exp_f32 v65, v65
    s_waitcnt lgkmcnt(5)
    v_mfma_f32_16x16x32_bf16 v[96:99], a[40:43], a[64:67], v[96:99]
    v_exp_f32 v66, v66
    v_cvt_pk_bf16_f32 v132, v64, v65
    s_waitcnt lgkmcnt(4)
    v_mfma_f32_16x16x32_bf16 v[96:99], a[44:47], a[68:71], v[96:99]
    v_exp_f32 v67, v67
    v_mfma_f32_16x16x32_bf16 v[104:107], a[44:47], a[76:79], v[196:199]
    v_exp_f32 v68, v68
    v_cvt_pk_bf16_f32 v133, v66, v67
    v_mfma_f32_16x16x32_bf16 v[104:107], a[40:43], a[72:75], v[104:107]
    v_exp_f32 v69, v69
    v_mfma_f32_16x16x32_bf16 v[104:107], a[36:39], a[12:15], v[104:107]
    v_exp_f32 v70, v70
    v_cvt_pk_bf16_f32 v134, v68, v69
    v_mfma_f32_16x16x32_bf16 v[104:107], a[32:35], a[8:11], v[104:107]
    v_exp_f32 v71, v71
    v_mfma_f32_16x16x32_bf16 v[112:115], a[32:35], a[16:19], v[200:203]
    v_exp_f32 v72, v72
    v_cvt_pk_bf16_f32 v135, v70, v71
    v_mfma_f32_16x16x32_bf16 v[112:115], a[36:39], a[20:23], v[112:115]
    v_exp_f32 v73, v73
    v_mfma_f32_16x16x32_bf16 v[112:115], a[40:43], a[80:83], v[112:115]
    v_exp_f32 v74, v74
    v_cvt_pk_bf16_f32 v140, v72, v73
    v_mfma_f32_16x16x32_bf16 v[112:115], a[44:47], a[84:87], v[112:115]
    v_exp_f32 v75, v75
    v_mfma_f32_16x16x32_bf16 v[120:123], a[44:47], a[92:95], v[204:207]
    v_exp_f32 v76, v76
    v_cvt_pk_bf16_f32 v141, v74, v75
    v_mfma_f32_16x16x32_bf16 v[120:123], a[40:43], a[88:91], v[120:123]
    v_exp_f32 v77, v77
    v_mfma_f32_16x16x32_bf16 v[120:123], a[36:39], a[28:31], v[120:123]
    v_exp_f32 v78, v78
    v_cvt_pk_bf16_f32 v142, v76, v77
    v_mfma_f32_16x16x32_bf16 v[120:123], a[32:35], a[24:27], v[120:123]
    v_exp_f32 v79, v79
    s_waitcnt lgkmcnt(3)
    v_mfma_f32_16x16x32_bf16 v[100:103], a[48:51], a[0:3], v[192:195]
    v_exp_f32 v80, v80
    v_cvt_pk_bf16_f32 v143, v78, v79
    s_waitcnt lgkmcnt(2)
    v_mfma_f32_16x16x32_bf16 v[100:103], a[52:55], a[4:7], v[100:103]
    v_exp_f32 v81, v81
    s_waitcnt lgkmcnt(1)
    v_mfma_f32_16x16x32_bf16 v[100:103], a[56:59], a[64:67], v[100:103]
    v_exp_f32 v82, v82
    v_cvt_pk_bf16_f32 v148, v80, v81
    s_waitcnt lgkmcnt(0)
    v_mfma_f32_16x16x32_bf16 v[100:103], a[60:63], a[68:71], v[100:103]
    v_exp_f32 v83, v83
    v_mfma_f32_16x16x32_bf16 v[108:111], a[60:63], a[76:79], v[196:199]
    v_exp_f32 v84, v84
    v_cvt_pk_bf16_f32 v149, v82, v83
    v_mfma_f32_16x16x32_bf16 v[108:111], a[56:59], a[72:75], v[108:111]
    v_exp_f32 v85, v85
    v_mfma_f32_16x16x32_bf16 v[108:111], a[52:55], a[12:15], v[108:111]
    v_exp_f32 v86, v86
    v_cvt_pk_bf16_f32 v150, v84, v85
    v_mfma_f32_16x16x32_bf16 v[108:111], a[48:51], a[8:11], v[108:111]
    v_exp_f32 v87, v87
    v_mfma_f32_16x16x32_bf16 v[116:119], a[48:51], a[16:19], v[200:203]
    v_exp_f32 v88, v88
    v_cvt_pk_bf16_f32 v151, v86, v87
    v_mfma_f32_16x16x32_bf16 v[116:119], a[52:55], a[20:23], v[116:119]
    v_exp_f32 v89, v89
    v_mfma_f32_16x16x32_bf16 v[116:119], a[56:59], a[80:83], v[116:119]
    v_exp_f32 v90, v90
    v_cvt_pk_bf16_f32 v156, v88, v89
    v_mfma_f32_16x16x32_bf16 v[116:119], a[60:63], a[84:87], v[116:119]
    v_exp_f32 v91, v91
    v_mfma_f32_16x16x32_bf16 v[124:127], a[60:63], a[92:95], v[204:207]
    s_waitcnt lgkmcnt(0)
    v_exp_f32 v92, v92
    v_cvt_pk_bf16_f32 v157, v90, v91
    v_mfma_f32_16x16x32_bf16 v[124:127], a[56:59], a[88:91], v[124:127]
    v_exp_f32 v93, v93
    v_mfma_f32_16x16x32_bf16 v[124:127], a[52:55], a[28:31], v[124:127]
    s_waitcnt vmcnt(12)
    v_exp_f32 v94, v94
    v_cvt_pk_bf16_f32 v158, v92, v93
    v_mfma_f32_16x16x32_bf16 v[124:127], a[48:51], a[24:27], v[124:127]
    s_barrier
    v_exp_f32 v95, v95
    s_nop 0
    v_cvt_pk_bf16_f32 v159, v94, v95
    ds_read_b128 a[32:35], v228 offset:16384
    ds_read_b128 a[36:39], v229 offset:16384
    ds_read_b128 a[40:43], v230 offset:16384
    ds_read_b128 a[44:47], v231 offset:16384
    ds_read_b128 a[48:51], v228 offset:20480
    ds_read_b128 a[52:55], v229 offset:20480
    ds_read_b128 a[56:59], v230 offset:20480
    ds_read_b128 a[60:63], v231 offset:20480
    s_add_u32 m0, s52, 98304
    s_nop 0
    buffer_load_dwordx4 v4, s[20:23], s16 offen offset:0 nt lds
    buffer_load_dwordx4 v5, s[20:23], s16 offen offset:1024 nt lds
    buffer_load_dwordx4 v6, s[20:23], s16 offen offset:2048 nt lds
    buffer_load_dwordx4 v7, s[20:23], s16 offen offset:3072 nt lds
    s_add_u32 s16, s16, 16384
    s_and_b32 s16, s16, 0x7ffff
    s_waitcnt lgkmcnt(0)
    v_mfma_f32_16x16x32_bf16 v[64:67], a[32:35], a[0:3], v[192:195]
    v_exp_f32 v96, v96
    v_mfma_f32_16x16x32_bf16 v[64:67], a[36:39], a[4:7], v[64:67]
    v_exp_f32 v97, v97
    v_mfma_f32_16x16x32_bf16 v[64:67], a[40:43], a[64:67], v[64:67]
    ds_read_b64_tr_b16 a[100:101], v232 offset:40960
    v_cvt_pk_bf16_f32 v160, v96, v97
    v_mfma_f32_16x16x32_bf16 v[64:67], a[44:47], a[68:71], v[64:67]
    v_exp_f32 v98, v98
    v_mfma_f32_16x16x32_bf16 v[72:75], a[44:47], a[76:79], v[196:199]
    v_exp_f32 v99, v99
    v_mfma_f32_16x16x32_bf16 v[72:75], a[40:43], a[72:75], v[72:75]
    ds_read_b64_tr_b16 a[102:103], v232 offset:45056
    v_cvt_pk_bf16_f32 v161, v98, v99
    v_mfma_f32_16x16x32_bf16 v[72:75], a[36:39], a[12:15], v[72:75]
    v_exp_f32 v100, v100
    v_mfma_f32_16x16x32_bf16 v[72:75], a[32:35], a[8:11], v[72:75]
    v_exp_f32 v101, v101
    v_mfma_f32_16x16x32_bf16 v[80:83], a[32:35], a[16:19], v[200:203]
    ds_read_b64_tr_b16 a[108:109], v233 offset:40960
    v_cvt_pk_bf16_f32 v162, v100, v101
    v_mfma_f32_16x16x32_bf16 v[80:83], a[36:39], a[20:23], v[80:83]
    v_exp_f32 v102, v102
    v_mfma_f32_16x16x32_bf16 v[80:83], a[40:43], a[80:83], v[80:83]
    v_exp_f32 v103, v103
    v_mfma_f32_16x16x32_bf16 v[80:83], a[44:47], a[84:87], v[80:83]
    ds_read_b64_tr_b16 a[110:111], v233 offset:45056
    v_cvt_pk_bf16_f32 v163, v102, v103
    v_mfma_f32_16x16x32_bf16 v[88:91], a[44:47], a[92:95], v[204:207]
    v_exp_f32 v104, v104
    v_mfma_f32_16x16x32_bf16 v[88:91], a[40:43], a[88:91], v[88:91]
    ds_read_b64_tr_b16 a[116:117], v234 offset:40960
    ds_read_b64_tr_b16 a[118:119], v234 offset:45056
    v_mfma_f32_16x16x32_bf16 v[88:91], a[36:39], a[28:31], v[88:91]
    v_exp_f32 v105, v105
    v_mfma_f32_16x16x32_bf16 v[88:91], a[32:35], a[24:27], v[88:91]
    v_exp_f32 v106, v106
    v_cvt_pk_bf16_f32 v168, v104, v105
    v_mfma_f32_16x16x32_bf16 v[68:71], a[48:51], a[0:3], v[192:195]
    ds_read_b64_tr_b16 a[124:125], v235 offset:40960
    ds_read_b64_tr_b16 a[126:127], v235 offset:45056
    v_mfma_f32_16x16x32_bf16 v[68:71], a[52:55], a[4:7], v[68:71]
    v_exp_f32 v107, v107
    v_mfma_f32_16x16x32_bf16 v[68:71], a[56:59], a[64:67], v[68:71]
    v_exp_f32 v108, v108
    v_cvt_pk_bf16_f32 v169, v106, v107
    v_mfma_f32_16x16x32_bf16 v[68:71], a[60:63], a[68:71], v[68:71]
    v_mfma_f32_16x16x32_bf16 v[76:79], a[60:63], a[76:79], v[196:199]
    v_exp_f32 v109, v109
    v_mfma_f32_16x16x32_bf16 v[76:79], a[56:59], a[72:75], v[76:79]
    v_exp_f32 v110, v110
    v_cvt_pk_bf16_f32 v170, v108, v109
    v_mfma_f32_16x16x32_bf16 v[76:79], a[52:55], a[12:15], v[76:79]
    v_mfma_f32_16x16x32_bf16 v[76:79], a[48:51], a[8:11], v[76:79]
    v_exp_f32 v111, v111
    v_mfma_f32_16x16x32_bf16 v[84:87], a[48:51], a[16:19], v[200:203]
    v_cvt_pk_bf16_f32 v171, v110, v111
    v_mfma_f32_16x16x32_bf16 v[84:87], a[52:55], a[20:23], v[84:87]
    v_exp_f32 v112, v112
    v_mfma_f32_16x16x32_bf16 v[84:87], a[56:59], a[80:83], v[84:87]
    v_exp_f32 v113, v113
    v_mfma_f32_16x16x32_bf16 v[84:87], a[60:63], a[84:87], v[84:87]
    v_cvt_pk_bf16_f32 v176, v112, v113
    v_mfma_f32_16x16x32_bf16 v[92:95], a[60:63], a[92:95], v[204:207]
    s_waitcnt lgkmcnt(0)
    v_exp_f32 v114, v114
    v_mfma_f32_16x16x32_bf16 v[92:95], a[56:59], a[88:91], v[92:95]
    v_exp_f32 v115, v115
    v_mfma_f32_16x16x32_bf16 v[92:95], a[52:55], a[28:31], v[92:95]
    v_cvt_pk_bf16_f32 v177, v114, v115
    v_mfma_f32_16x16x32_bf16 v[92:95], a[48:51], a[24:27], v[92:95]
    v_exp_f32 v116, v116
    v_mfma_f32_16x16x32_bf16 v[208:211], v[248:251], v[132:135], 0
    v_exp_f32 v117, v117
    v_mfma_f32_16x16x32_bf16 v[212:215], v[248:251], v[140:143], 0
    ds_read_b128 a[32:35], v228 offset:24576
    v_cvt_pk_bf16_f32 v178, v116, v117
    v_mfma_f32_16x16x32_bf16 a[128:131], a[100:103], v[132:135], 0
    v_exp_f32 v118, v118
    v_mfma_f32_16x16x32_bf16 a[160:163], a[100:103], v[140:143], 0
    v_exp_f32 v119, v119
    v_mfma_f32_16x16x32_bf16 a[192:195], a[100:103], v[148:151], 0
    ds_read_b128 a[36:39], v229 offset:24576
    v_cvt_pk_bf16_f32 v179, v118, v119
    v_mfma_f32_16x16x32_bf16 a[224:227], a[100:103], v[156:159], 0
    v_exp_f32 v120, v120
    v_mfma_f32_16x16x32_bf16 a[132:135], a[108:111], v[132:135], 0
    ds_read_b128 a[40:43], v230 offset:24576
    ds_read_b128 a[44:47], v231 offset:24576
    v_mfma_f32_16x16x32_bf16 a[164:167], a[108:111], v[140:143], 0
    v_exp_f32 v121, v121
    v_mfma_f32_16x16x32_bf16 a[196:199], a[108:111], v[148:151], 0
    v_exp_f32 v122, v122
    v_cvt_pk_bf16_f32 v184, v120, v121
    v_mfma_f32_16x16x32_bf16 a[228:231], a[108:111], v[156:159], 0
    ds_read_b128 a[48:51], v228 offset:28672
    ds_read_b128 a[52:55], v229 offset:28672
    v_mfma_f32_16x16x32_bf16 a[136:139], a[116:119], v[132:135], 0
    v_exp_f32 v123, v123
    v_mfma_f32_16x16x32_bf16 a[168:171], a[116:119], v[140:143], 0
    v_exp_f32 v124, v124
    v_cvt_pk_bf16_f32 v185, v122, v123
    v_mfma_f32_16x16x32_bf16 a[200:203], a[116:119], v[148:151], 0
    s_add_u32 m0, s52, 16384
    ds_read_b128 a[56:59], v230 offset:28672
    ds_read_b128 a[60:63], v231 offset:28672
    v_mfma_f32_16x16x32_bf16 a[232:235], a[116:119], v[156:159], 0
    v_exp_f32 v125, v125
    v_mfma_f32_16x16x32_bf16 a[140:143], a[124:127], v[132:135], 0
    v_exp_f32 v126, v126
    v_cvt_pk_bf16_f32 v186, v124, v125
    v_mfma_f32_16x16x32_bf16 a[172:175], a[124:127], v[140:143], 0
    buffer_load_dwordx4 v8, s[24:27], s17 offen offset:0 nt lds
    v_mfma_f32_16x16x32_bf16 a[204:207], a[124:127], v[148:151], 0
    v_exp_f32 v127, v127
    v_mfma_f32_16x16x32_bf16 a[236:239], a[124:127], v[156:159], 0
    buffer_load_dwordx4 v9, s[24:27], s17 offen offset:1024 nt lds
    v_cvt_pk_bf16_f32 v187, v126, v127
    buffer_load_dwordx4 v8, s[24:27], s17 offen offset:2048 nt lds
    buffer_load_dwordx4 v9, s[24:27], s17 offen offset:3072 nt lds
    s_add_u32 s17, s17, 16384
    s_and_b32 s17, s17, 0x7ffff
    s_waitcnt lgkmcnt(0)
    v_mfma_f32_16x16x32_bf16 v[96:99], a[32:35], a[0:3], v[192:195]
    v_exp_f32 v64, v64
    v_mfma_f32_16x16x32_bf16 v[96:99], a[36:39], a[4:7], v[96:99]
    v_exp_f32 v65, v65
    v_mfma_f32_16x16x32_bf16 v[96:99], a[40:43], a[64:67], v[96:99]
    ds_read_b64_tr_b16 a[100:101], v236 offset:40960
    v_cvt_pk_bf16_f32 v164, v64, v65
    v_mfma_f32_16x16x32_bf16 v[96:99], a[44:47], a[68:71], v[96:99]
    v_exp_f32 v66, v66
    v_mfma_f32_16x16x32_bf16 v[104:107], a[44:47], a[76:79], v[196:199]
    v_exp_f32 v67, v67
    v_mfma_f32_16x16x32_bf16 v[104:107], a[40:43], a[72:75], v[104:107]
    ds_read_b64_tr_b16 a[102:103], v236 offset:45056
    v_cvt_pk_bf16_f32 v165, v66, v67
    v_mfma_f32_16x16x32_bf16 v[104:107], a[36:39], a[12:15], v[104:107]
    v_exp_f32 v68, v68
    v_mfma_f32_16x16x32_bf16 v[104:107], a[32:35], a[8:11], v[104:107]
    v_exp_f32 v69, v69
    v_mfma_f32_16x16x32_bf16 v[112:115], a[32:35], a[16:19], v[200:203]
    ds_read_b64_tr_b16 a[108:109], v237 offset:40960
    v_cvt_pk_bf16_f32 v166, v68, v69
    v_mfma_f32_16x16x32_bf16 v[112:115], a[36:39], a[20:23], v[112:115]
    v_exp_f32 v70, v70
    v_mfma_f32_16x16x32_bf16 v[112:115], a[40:43], a[80:83], v[112:115]
    v_exp_f32 v71, v71
    v_mfma_f32_16x16x32_bf16 v[112:115], a[44:47], a[84:87], v[112:115]
    ds_read_b64_tr_b16 a[110:111], v237 offset:45056
    v_cvt_pk_bf16_f32 v167, v70, v71
    v_mfma_f32_16x16x32_bf16 v[120:123], a[44:47], a[92:95], v[204:207]
    v_exp_f32 v72, v72
    v_mfma_f32_16x16x32_bf16 v[120:123], a[40:43], a[88:91], v[120:123]
    ds_read_b64_tr_b16 a[116:117], v238 offset:40960
    ds_read_b64_tr_b16 a[118:119], v238 offset:45056
    v_mfma_f32_16x16x32_bf16 v[120:123], a[36:39], a[28:31], v[120:123]
    v_exp_f32 v73, v73
    v_mfma_f32_16x16x32_bf16 v[120:123], a[32:35], a[24:27], v[120:123]
    v_exp_f32 v74, v74
    v_cvt_pk_bf16_f32 v172, v72, v73
    v_mfma_f32_16x16x32_bf16 v[100:103], a[48:51], a[0:3], v[192:195]
    ds_read_b64_tr_b16 a[124:125], v239 offset:40960
    ds_read_b64_tr_b16 a[126:127], v239 offset:45056
    v_mfma_f32_16x16x32_bf16 v[100:103], a[52:55], a[4:7], v[100:103]
    v_exp_f32 v75, v75
    v_mfma_f32_16x16x32_bf16 v[100:103], a[56:59], a[64:67], v[100:103]
    v_exp_f32 v76, v76
    v_cvt_pk_bf16_f32 v173, v74, v75
    v_mfma_f32_16x16x32_bf16 v[100:103], a[60:63], a[68:71], v[100:103]
    v_mfma_f32_16x16x32_bf16 v[108:111], a[60:63], a[76:79], v[196:199]
    v_exp_f32 v77, v77
    v_mfma_f32_16x16x32_bf16 v[108:111], a[56:59], a[72:75], v[108:111]
    v_exp_f32 v78, v78
    v_cvt_pk_bf16_f32 v174, v76, v77
    v_mfma_f32_16x16x32_bf16 v[108:111], a[52:55], a[12:15], v[108:111]
    v_mfma_f32_16x16x32_bf16 v[108:111], a[48:51], a[8:11], v[108:111]
    v_exp_f32 v79, v79
    v_mfma_f32_16x16x32_bf16 v[116:119], a[48:51], a[16:19], v[200:203]
    v_cvt_pk_bf16_f32 v175, v78, v79
    v_mfma_f32_16x16x32_bf16 v[116:119], a[52:55], a[20:23], v[116:119]
    v_exp_f32 v80, v80
    v_mfma_f32_16x16x32_bf16 v[116:119], a[56:59], a[80:83], v[116:119]
    v_exp_f32 v81, v81
    v_mfma_f32_16x16x32_bf16 v[116:119], a[60:63], a[84:87], v[116:119]
    v_cvt_pk_bf16_f32 v180, v80, v81
    v_mfma_f32_16x16x32_bf16 v[124:127], a[60:63], a[92:95], v[204:207]
    s_waitcnt lgkmcnt(0)
    v_exp_f32 v82, v82
    v_mfma_f32_16x16x32_bf16 v[124:127], a[56:59], a[88:91], v[124:127]
    v_exp_f32 v83, v83
    v_mfma_f32_16x16x32_bf16 v[124:127], a[52:55], a[28:31], v[124:127]
    s_waitcnt vmcnt(16)
    v_cvt_pk_bf16_f32 v181, v82, v83
    v_mfma_f32_16x16x32_bf16 v[124:127], a[48:51], a[24:27], v[124:127]
    s_barrier
    v_exp_f32 v84, v84
    v_mfma_f32_16x16x32_bf16 v[216:219], v[248:251], v[148:151], 0
    v_exp_f32 v85, v85
    v_mfma_f32_16x16x32_bf16 v[220:223], v[248:251], v[156:159], 0
    ds_read_b128 a[32:35], v228 offset:32768
    v_cvt_pk_bf16_f32 v182, v84, v85
    v_mfma_f32_16x16x32_bf16 a[144:147], a[100:103], v[132:135], 0
    v_exp_f32 v86, v86
    v_mfma_f32_16x16x32_bf16 a[176:179], a[100:103], v[140:143], 0
    v_exp_f32 v87, v87
    v_mfma_f32_16x16x32_bf16 a[208:211], a[100:103], v[148:151], 0
    ds_read_b128 a[36:39], v229 offset:32768
    v_cvt_pk_bf16_f32 v183, v86, v87
    v_mfma_f32_16x16x32_bf16 a[240:243], a[100:103], v[156:159], 0
    v_exp_f32 v88, v88
    v_mfma_f32_16x16x32_bf16 a[148:151], a[108:111], v[132:135], 0
    ds_read_b128 a[40:43], v230 offset:32768
    ds_read_b128 a[44:47], v231 offset:32768
    v_mfma_f32_16x16x32_bf16 a[180:183], a[108:111], v[140:143], 0
    v_exp_f32 v89, v89
    v_mfma_f32_16x16x32_bf16 a[212:215], a[108:111], v[148:151], 0
    v_exp_f32 v90, v90
    v_cvt_pk_bf16_f32 v188, v88, v89
    v_mfma_f32_16x16x32_bf16 a[244:247], a[108:111], v[156:159], 0
    ds_read_b128 a[48:51], v228 offset:36864
    ds_read_b128 a[52:55], v229 offset:36864
    v_mfma_f32_16x16x32_bf16 a[152:155], a[116:119], v[132:135], 0
    v_exp_f32 v91, v91
    v_mfma_f32_16x16x32_bf16 a[184:187], a[116:119], v[140:143], 0
    v_exp_f32 v92, v92
    v_cvt_pk_bf16_f32 v189, v90, v91
    v_mfma_f32_16x16x32_bf16 a[216:219], a[116:119], v[148:151], 0
    s_add_u32 m0, s52, 114688
    ds_read_b128 a[56:59], v230 offset:36864
    ds_read_b128 a[60:63], v231 offset:36864
    v_mfma_f32_16x16x32_bf16 a[248:251], a[116:119], v[156:159], 0
    v_exp_f32 v93, v93
    v_mfma_f32_16x16x32_bf16 a[156:159], a[124:127], v[132:135], 0
    v_exp_f32 v94, v94
    v_cvt_pk_bf16_f32 v190, v92, v93
    v_mfma_f32_16x16x32_bf16 a[188:191], a[124:127], v[140:143], 0
    buffer_load_dwordx4 v4, s[20:23], s16 offen offset:0 nt lds
    v_mfma_f32_16x16x32_bf16 a[220:223], a[124:127], v[148:151], 0
    v_exp_f32 v95, v95
    v_mfma_f32_16x16x32_bf16 a[252:255], a[124:127], v[156:159], 0
    buffer_load_dwordx4 v5, s[20:23], s16 offen offset:1024 nt lds
    v_cvt_pk_bf16_f32 v191, v94, v95
    buffer_load_dwordx4 v6, s[20:23], s16 offen offset:2048 nt lds
    buffer_load_dwordx4 v7, s[20:23], s16 offen offset:3072 nt lds
    s_add_u32 s16, s16, 16384
    s_and_b32 s16, s16, 0x7ffff
    s_waitcnt lgkmcnt(0)
    v_mfma_f32_16x16x32_bf16 v[64:67], a[32:35], a[0:3], v[192:195]
    s_and_b32 s76, s2, 3
    v_exp_f32 v96, v96
    v_mfma_f32_16x16x32_bf16 v[64:67], a[36:39], a[4:7], v[64:67]
    s_lshr_b32 s64, s2, 3
    ds_read_b64_tr_b16 a[96:97], v232 offset:49152
    ds_read_b64_tr_b16 a[98:99], v232 offset:53248
    v_mfma_f32_16x16x32_bf16 v[64:67], a[40:43], a[64:67], v[64:67]
    s_and_b32 s77, s64, 3
    v_exp_f32 v97, v97
    v_mfma_f32_16x16x32_bf16 v[64:67], a[44:47], a[68:71], v[64:67]
    s_lshr_b32 s64, s64, 2
    ds_read_b64_tr_b16 a[100:101], v232 offset:57344
    v_cvt_pk_bf16_f32 v128, v96, v97
    v_mfma_f32_16x16x32_bf16 v[72:75], a[44:47], a[76:79], v[196:199]
    s_and_b32 s65, s2, 4
    v_exp_f32 v98, v98
    v_mfma_f32_16x16x32_bf16 v[72:75], a[40:43], a[72:75], v[72:75]
    s_lshl_b32 s65, s65, 1
    ds_read_b64_tr_b16 a[102:103], v232 offset:61440
    ds_read_b64_tr_b16 a[104:105], v233 offset:49152
    v_mfma_f32_16x16x32_bf16 v[72:75], a[36:39], a[12:15], v[72:75]
    s_add_u32 s78, s64, s65
    v_exp_f32 v99, v99
    v_mfma_f32_16x16x32_bf16 v[72:75], a[32:35], a[8:11], v[72:75]
    s_mul_i32 s88, s48, 9216
    ds_read_b64_tr_b16 a[106:107], v233 offset:53248
    v_cvt_pk_bf16_f32 v129, v98, v99
    v_mfma_f32_16x16x32_bf16 v[80:83], a[32:35], a[16:19], v[200:203]
    s_mul_i32 s64, s76, 36
    v_exp_f32 v100, v100
    v_mfma_f32_16x16x32_bf16 v[80:83], a[36:39], a[20:23], v[80:83]
    s_add_u32 s64, s64, s48
    ds_read_b64_tr_b16 a[108:109], v233 offset:57344
    ds_read_b64_tr_b16 a[110:111], v233 offset:61440
    v_mfma_f32_16x16x32_bf16 v[80:83], a[40:43], a[80:83], v[80:83]
    s_lshl_b32 s64, s64, 2
    v_exp_f32 v101, v101
    v_mfma_f32_16x16x32_bf16 v[80:83], a[44:47], a[84:87], v[80:83]
    s_add_u32 s64, s64, s77
    ds_read_b64_tr_b16 a[112:113], v234 offset:49152
    v_cvt_pk_bf16_f32 v130, v100, v101
    v_mfma_f32_16x16x32_bf16 v[88:91], a[44:47], a[92:95], v[204:207]
    s_mul_i32 s64, s64, 9216
    v_exp_f32 v102, v102
    v_mfma_f32_16x16x32_bf16 v[88:91], a[40:43], a[88:91], v[88:91]
    s_add_u32 s64, s64, 41943040
    ds_read_b64_tr_b16 a[114:115], v234 offset:53248
    ds_read_b64_tr_b16 a[116:117], v234 offset:57344
    v_mfma_f32_16x16x32_bf16 v[88:91], a[36:39], a[28:31], v[88:91]
    s_add_u32 s84, s64, 8192
    v_exp_f32 v103, v103
    v_mfma_f32_16x16x32_bf16 v[88:91], a[32:35], a[24:27], v[88:91]
    s_add_u32 s65, s76, 0
    ds_read_b64_tr_b16 a[118:119], v234 offset:61440
    v_cvt_pk_bf16_f32 v131, v102, v103
    v_mfma_f32_16x16x32_bf16 v[68:71], a[48:51], a[0:3], v[192:195]
    s_and_b32 s65, s65, 3
    v_exp_f32 v104, v104
    v_mfma_f32_16x16x32_bf16 v[68:71], a[52:55], a[4:7], v[68:71]
    s_lshl_b32 s65, s65, 11
    ds_read_b64_tr_b16 a[120:121], v235 offset:49152
    ds_read_b64_tr_b16 a[122:123], v235 offset:53248
    v_mfma_f32_16x16x32_bf16 v[68:71], a[56:59], a[64:67], v[68:71]
    s_add_u32 s80, s64, s65
    v_exp_f32 v105, v105
    v_mfma_f32_16x16x32_bf16 v[68:71], a[60:63], a[68:71], v[68:71]
    s_add_u32 s65, s76, 1
    ds_read_b64_tr_b16 a[124:125], v235 offset:57344
    v_cvt_pk_bf16_f32 v136, v104, v105
    v_mfma_f32_16x16x32_bf16 v[76:79], a[60:63], a[76:79], v[196:199]
    s_and_b32 s65, s65, 3
    v_exp_f32 v106, v106
    v_mfma_f32_16x16x32_bf16 v[76:79], a[56:59], a[72:75], v[76:79]
    s_lshl_b32 s65, s65, 11
    ds_read_b64_tr_b16 a[126:127], v235 offset:61440
    v_lshrrev_b32 v253, 2, v1
    v_mfma_f32_16x16x32_bf16 v[76:79], a[52:55], a[12:15], v[76:79]
    s_add_u32 s81, s64, s65
    v_exp_f32 v107, v107
    v_mfma_f32_16x16x32_bf16 v[76:79], a[48:51], a[8:11], v[76:79]
    s_add_u32 s65, s76, 2
    v_cvt_pk_bf16_f32 v137, v106, v107
    v_mul_u32_u24 v253, 1152, v253
    v_mfma_f32_16x16x32_bf16 v[84:87], a[48:51], a[16:19], v[200:203]
    s_and_b32 s65, s65, 3
    v_exp_f32 v108, v108
    v_mfma_f32_16x16x32_bf16 v[84:87], a[52:55], a[20:23], v[84:87]
    s_lshl_b32 s65, s65, 11
    v_and_b32 v255, 3, v1
    v_lshl_add_u32 v253, v255, 4, v253
    v_mfma_f32_16x16x32_bf16 v[84:87], a[56:59], a[80:83], v[84:87]
    s_add_u32 s82, s64, s65
    v_exp_f32 v109, v109
    v_mfma_f32_16x16x32_bf16 v[84:87], a[60:63], a[84:87], v[84:87]
    s_add_u32 s65, s76, 3
    v_cvt_pk_bf16_f32 v138, v108, v109
    v_lshrrev_b32 v254, 1, v1
    v_mfma_f32_16x16x32_bf16 v[92:95], a[60:63], a[92:95], v[204:207]
    s_waitcnt lgkmcnt(0)
    v_exp_f32 v110, v110
    v_mfma_f32_16x16x32_bf16 v[92:95], a[56:59], a[88:91], v[92:95]
    s_and_b32 s65, s65, 3
    v_mul_u32_u24 v254, 1152, v254
    v_and_b32 v255, 1, v1
    v_mfma_f32_16x16x32_bf16 v[92:95], a[52:55], a[28:31], v[92:95]
    s_lshl_b32 s65, s65, 11
    v_exp_f32 v111, v111
    v_mfma_f32_16x16x32_bf16 v[92:95], a[48:51], a[24:27], v[92:95]
    s_add_u32 s83, s64, s65
    v_cvt_pk_bf16_f32 v139, v110, v111
    v_lshl_add_u32 v254, v255, 4, v254
    v_smfmac_f32_16x16x64_bf16 v[208:211], v[224:227], v[160:167], v252
    s_lshl_b32 s64, s76, 2
    v_exp_f32 v112, v112
    v_smfmac_f32_16x16x64_bf16 v[212:215], v[224:227], v[168:175], v252
    s_sub_u32 s64, 108, s64
    ds_read_b128 a[32:35], v228 offset:40960
    ds_read_b128 a[36:39], v229 offset:40960
    v_mfma_f32_16x16x32_bf16 a[128:131], a[96:99], v[160:163], a[128:131]
    s_add_u32 m0, s52, 32768
    v_exp_f32 v113, v113
    v_mfma_f32_16x16x32_bf16 a[128:131], a[100:103], v[164:167], a[128:131]
    s_mul_i32 s56, s64, 36864
    ds_read_b128 a[40:43], v230 offset:40960
    v_cvt_pk_bf16_f32 v144, v112, v113
    v_mfma_f32_16x16x32_bf16 a[160:163], a[100:103], v[172:175], a[160:163]
    s_lshl_b32 s64, s78, 2
    v_exp_f32 v114, v114
    v_mfma_f32_16x16x32_bf16 a[160:163], a[96:99], v[168:171], a[160:163]
    s_add_u32 s64, s64, s48
    ds_read_b128 a[44:47], v231 offset:40960
    ds_read_b128 a[48:51], v228 offset:45056
    v_mfma_f32_16x16x32_bf16 a[192:195], a[96:99], v[176:179], a[192:195]
    s_mul_i32 s65, s64, 8
    v_exp_f32 v115, v115
    v_mfma_f32_16x16x32_bf16 a[192:195], a[100:103], v[180:183], a[192:195]
    s_mul_i32 s66, s76, 4608
    ds_read_b128 a[52:55], v229 offset:45056
    v_cvt_pk_bf16_f32 v145, v114, v115
    v_mfma_f32_16x16x32_bf16 a[224:227], a[100:103], v[188:191], a[224:227]
    s_add_u32 s65, s65, s66
    v_exp_f32 v116, v116
    v_mfma_f32_16x16x32_bf16 a[224:227], a[96:99], v[184:187], a[224:227]
    s_lshl_b32 s65, s65, 10
    ds_read_b128 a[56:59], v230 offset:45056
    ds_read_b128 a[60:63], v231 offset:45056
    v_mfma_f32_16x16x32_bf16 a[132:135], a[104:107], v[160:163], a[132:135]
    s_add_u32 s85, s65, 16777216
    v_exp_f32 v117, v117
    v_mfma_f32_16x16x32_bf16 a[132:135], a[108:111], v[164:167], a[132:135]
    s_lshl_b32 s65, s64, 1
    buffer_load_dwordx4 v8, s[24:27], s17 offen offset:0 nt lds
    v_cvt_pk_bf16_f32 v146, v116, v117
    v_mfma_f32_16x16x32_bf16 a[164:167], a[108:111], v[172:175], a[164:167]
    s_lshl_b32 s66, s76, 10
    v_exp_f32 v118, v118
    v_mfma_f32_16x16x32_bf16 a[164:167], a[104:107], v[168:171], a[164:167]
    s_add_u32 s65, s65, s66
    v_add_u32 v10, 73728, v2
    v_mul_f32 v18, 0xc13504f3, v18
    v_mfma_f32_16x16x32_bf16 a[196:199], a[104:107], v[176:179], a[196:199]
    s_lshl_b32 s65, s65, 12
    v_exp_f32 v119, v119
    v_mfma_f32_16x16x32_bf16 a[196:199], a[108:111], v[180:183], a[196:199]
    s_add_u32 s86, s65, 0
    v_cvt_pk_bf16_f32 v147, v118, v119
    v_lshrrev_b32 v53, 4, v1
    v_mfma_f32_16x16x32_bf16 a[228:231], a[108:111], v[188:191], a[228:231]
    s_mul_i32 s64, s64, 36864
    v_exp_f32 v120, v120
    v_mfma_f32_16x16x32_bf16 a[228:231], a[104:107], v[184:187], a[228:231]
    s_mul_i32 s65, s77, 288
    buffer_load_dwordx4 v9, s[24:27], s17 offen offset:1024 nt lds
    v_lshrrev_b32 v52, 2, v1
    v_mfma_f32_16x16x32_bf16 a[136:139], a[112:115], v[160:163], a[136:139]
    s_add_u32 s64, s64, s65
    v_exp_f32 v121, v121
    v_mfma_f32_16x16x32_bf16 a[136:139], a[116:119], v[164:167], a[136:139]
    s_lshl_b32 s65, s76, 6
    v_cvt_pk_bf16_f32 v152, v120, v121
    v_mul_u32_u24 v54, 1152, v52
    v_mfma_f32_16x16x32_bf16 a[168:171], a[116:119], v[172:175], a[168:171]
    s_add_u32 s53, s64, s65
    v_exp_f32 v122, v122
    v_mfma_f32_16x16x32_bf16 a[168:171], a[112:115], v[168:171], a[168:171]
    s_add_u32 s64, s64, 256
    v_and_b32 v53, 1, v53
    v_mul_f32 v244, v240, v244
    v_mfma_f32_16x16x32_bf16 a[200:203], a[112:115], v[176:179], a[200:203]
    v_exp_f32 v123, v123
    v_mfma_f32_16x16x32_bf16 a[200:203], a[116:119], v[180:183], a[200:203]
    buffer_load_dwordx4 v8, s[24:27], s17 offen offset:2048 nt lds
    v_cvt_pk_bf16_f32 v153, v122, v123
    v_mfma_f32_16x16x32_bf16 a[232:235], a[116:119], v[188:191], a[232:235]
    v_exp_f32 v124, v124
    v_mfma_f32_16x16x32_bf16 a[232:235], a[112:115], v[184:187], a[232:235]
    s_cmp_eq_u32 s48, s76
    s_cselect_b32 s54, s64, 2146435072
    v_lshlrev_b32 v55, 1, v53
    v_mfma_f32_16x16x32_bf16 a[140:143], a[120:123], v[160:163], a[140:143]
    s_lshr_b32 s64, s78, 1
    v_exp_f32 v125, v125
    v_mfma_f32_16x16x32_bf16 a[140:143], a[124:127], v[164:167], a[140:143]
    s_lshl_b32 s64, s64, 2
    v_cvt_pk_bf16_f32 v154, v124, v125
    v_and_b32 v56, 3, v1
    v_mfma_f32_16x16x32_bf16 a[172:175], a[124:127], v[172:175], a[172:175]
    s_add_u32 s64, s64, s76
    v_exp_f32 v126, v126
    v_mfma_f32_16x16x32_bf16 a[172:175], a[120:123], v[168:171], a[172:175]
    s_lshl_b32 s89, s64, 2
    buffer_load_dwordx4 v9, s[24:27], s17 offen offset:3072 nt lds
    v_xor_b32 v55, v55, v56
    v_mfma_f32_16x16x32_bf16 a[204:207], a[120:123], v[176:179], a[204:207]
    s_add_u32 s17, s17, 16384
    v_exp_f32 v127, v127
    v_mfma_f32_16x16x32_bf16 a[204:207], a[124:127], v[180:183], a[204:207]
    s_and_b32 s17, s17, 0x7ffff
    s_add_u32 s89, s89, 64
    v_cvt_pk_bf16_f32 v155, v126, v127
    v_mfma_f32_16x16x32_bf16 a[236:239], a[124:127], v[188:191], a[236:239]
    s_lshl_b32 s64, s64, 7
    v_lshl_add_u32 v14, v55, 4, v54
    v_mul_f32 v245, v241, v245
    v_mfma_f32_16x16x32_bf16 a[236:239], a[120:123], v[184:187], a[236:239]
    s_add_u32 s72, s64, 83886112
    s_waitcnt lgkmcnt(0)
    v_lshlrev_b32 v52, 6, v52
    v_mul_f32 v246, v242, v246
    v_mfma_f32_16x16x32_bf16 v[96:99], a[32:35], a[0:3], v[192:195]
    s_lshl_b32 s64, s2, 2
    v_exp_f32 v64, v64
    v_mfma_f32_16x16x32_bf16 v[96:99], a[36:39], a[4:7], v[96:99]
    s_add_u32 s64, s64, s48
    ds_read_b64_tr_b16 a[96:97], v236 offset:49152
    ds_read_b64_tr_b16 a[98:99], v236 offset:53248
    v_mfma_f32_16x16x32_bf16 v[96:99], a[40:43], a[64:67], v[96:99]
    s_lshl_b32 s64, s64, 7
    v_exp_f32 v65, v65
    v_mfma_f32_16x16x32_bf16 v[96:99], a[44:47], a[68:71], v[96:99]
    s_add_u32 s73, s64, 84934656
    ds_read_b64_tr_b16 a[100:101], v236 offset:57344
    v_cvt_pk_bf16_f32 v132, v64, v65
    v_mfma_f32_16x16x32_bf16 v[104:107], a[44:47], a[76:79], v[196:199]
    s_and_b32 s64, s2, 0xfc
    v_exp_f32 v66, v66
    v_mfma_f32_16x16x32_bf16 v[104:107], a[40:43], a[72:75], v[104:107]
    s_lshl_b32 s64, s64, 2
    ds_read_b64_tr_b16 a[102:103], v236 offset:61440
    ds_read_b64_tr_b16 a[104:105], v237 offset:49152
    v_mfma_f32_16x16x32_bf16 v[104:107], a[36:39], a[12:15], v[104:107]
    s_add_u32 s64, s64, s48
    v_exp_f32 v67, v67
    v_mfma_f32_16x16x32_bf16 v[104:107], a[32:35], a[8:11], v[104:107]
    s_lshl_b32 s64, s64, 7
    ds_read_b64_tr_b16 a[106:107], v237 offset:53248
    v_cvt_pk_bf16_f32 v133, v66, v67
    v_mfma_f32_16x16x32_bf16 v[112:115], a[32:35], a[16:19], v[200:203]
    s_add_u32 s74, s64, 84934656
    v_exp_f32 v68, v68
    v_mfma_f32_16x16x32_bf16 v[112:115], a[36:39], a[20:23], v[112:115]
    s_lshl_b32 s64, s2, 2
    ds_read_b64_tr_b16 a[108:109], v237 offset:57344
    ds_read_b64_tr_b16 a[110:111], v237 offset:61440
    v_mfma_f32_16x16x32_bf16 v[112:115], a[40:43], a[80:83], v[112:115]
    s_add_u32 s64, s64, s48
    v_exp_f32 v69, v69
    v_mfma_f32_16x16x32_bf16 v[112:115], a[44:47], a[84:87], v[112:115]
    s_mul_i32 s64, s64, 18432
    ds_read_b64_tr_b16 a[112:113], v238 offset:49152
    v_cvt_pk_bf16_f32 v134, v68, v69
    v_mfma_f32_16x16x32_bf16 v[120:123], a[44:47], a[92:95], v[204:207]
    s_add_u32 s90, s64, 58720256
    v_exp_f32 v70, v70
    v_mfma_f32_16x16x32_bf16 v[120:123], a[40:43], a[88:91], v[120:123]
    s_add_u32 s64, s90, 2048
    ds_read_b64_tr_b16 a[114:115], v238 offset:53248
    ds_read_b64_tr_b16 a[116:117], v238 offset:57344
    v_mfma_f32_16x16x32_bf16 v[120:123], a[36:39], a[28:31], v[120:123]
    v_exp_f32 v71, v71
    v_mfma_f32_16x16x32_bf16 v[120:123], a[32:35], a[24:27], v[120:123]
    ds_read_b64_tr_b16 a[118:119], v238 offset:61440
    v_cvt_pk_bf16_f32 v135, v70, v71
    v_mfma_f32_16x16x32_bf16 v[100:103], a[48:51], a[0:3], v[192:195]
    v_exp_f32 v72, v72
    v_mfma_f32_16x16x32_bf16 v[100:103], a[52:55], a[4:7], v[100:103]
    ds_read_b64_tr_b16 a[120:121], v239 offset:49152
    ds_read_b64_tr_b16 a[122:123], v239 offset:53248
    v_mfma_f32_16x16x32_bf16 v[100:103], a[56:59], a[64:67], v[100:103]
    v_exp_f32 v73, v73
    v_mfma_f32_16x16x32_bf16 v[100:103], a[60:63], a[68:71], v[100:103]
    ds_read_b64_tr_b16 a[124:125], v239 offset:57344
    v_cvt_pk_bf16_f32 v140, v72, v73
    v_mfma_f32_16x16x32_bf16 v[108:111], a[60:63], a[76:79], v[196:199]
    v_exp_f32 v74, v74
    v_mfma_f32_16x16x32_bf16 v[108:111], a[56:59], a[72:75], v[108:111]
    s_cmp_eq_u32 s48, s76
    s_cselect_b32 s91, s64, 2146435072
    ds_read_b64_tr_b16 a[126:127], v239 offset:61440
    v_mfma_f32_16x16x32_bf16 v[108:111], a[52:55], a[12:15], v[108:111]
    s_and_b32 s66, s2, 0xfc
    v_exp_f32 v75, v75
    v_mfma_f32_16x16x32_bf16 v[108:111], a[48:51], a[8:11], v[108:111]
    s_add_u32 s64, s76, 1
    v_cvt_pk_bf16_f32 v141, v74, v75
    v_lshl_add_u32 v52, v53, 5, v52
    v_mfma_f32_16x16x32_bf16 v[116:119], a[48:51], a[16:19], v[200:203]
    s_and_b32 s64, s64, 3
    v_exp_f32 v76, v76
    v_mfma_f32_16x16x32_bf16 v[116:119], a[52:55], a[20:23], v[116:119]
    s_mov_b32 s65, 0
    v_lshl_add_u32 v52, v56, 3, v52
    v_mul_f32 v247, v243, v247
    v_mfma_f32_16x16x32_bf16 v[116:119], a[56:59], a[80:83], v[116:119]
    s_add_u32 s64, s64, s66
    v_exp_f32 v77, v77
    v_mfma_f32_16x16x32_bf16 v[116:119], a[60:63], a[84:87], v[116:119]
    s_lshl_b32 s64, s64, 2
    v_cvt_pk_bf16_f32 v142, v76, v77
    v_add_u32 v52, 65536, v52
    v_mfma_f32_16x16x32_bf16 v[124:127], a[60:63], a[92:95], v[204:207]
    s_waitcnt lgkmcnt(0)
    v_exp_f32 v78, v78
    v_mfma_f32_16x16x32_bf16 v[124:127], a[56:59], a[88:91], v[124:127]
    s_add_u32 s64, s64, s48
    v_lshlrev_b32 v17, 7, v1
    v_mul_f32 v240, v18, v240
    v_mfma_f32_16x16x32_bf16 v[124:127], a[52:55], a[28:31], v[124:127]
    s_waitcnt vmcnt(16)
    v_exp_f32 v79, v79
    v_mfma_f32_16x16x32_bf16 v[124:127], a[48:51], a[24:27], v[124:127]
    s_barrier
    s_mul_i32 s64, s64, 18432
    v_cvt_pk_bf16_f32 v143, v78, v79
    v_smfmac_f32_16x16x64_bf16 v[216:219], v[224:227], v[176:183], v252
    s_add_u32 s64, s64, s65
    v_exp_f32 v80, v80
    v_smfmac_f32_16x16x64_bf16 v[220:223], v[224:227], v[184:191], v252
    s_add_u32 s92, s64, 58720256
    ds_read_b128 a[32:35], v228 offset:49152
    ds_read_b128 a[36:39], v229 offset:49152
    v_mfma_f32_16x16x32_bf16 a[144:147], a[96:99], v[160:163], a[144:147]
    s_add_u32 m0, s52, 131072
    v_exp_f32 v81, v81
    v_mfma_f32_16x16x32_bf16 a[144:147], a[100:103], v[164:167], a[144:147]
    s_add_u32 s64, s76, 2
    ds_read_b128 a[40:43], v230 offset:49152
    v_cvt_pk_bf16_f32 v148, v80, v81
    v_mfma_f32_16x16x32_bf16 a[176:179], a[100:103], v[172:175], a[176:179]
    s_and_b32 s64, s64, 3
    v_exp_f32 v82, v82
    v_mfma_f32_16x16x32_bf16 a[176:179], a[96:99], v[168:171], a[176:179]
    s_mov_b32 s65, 6144
    ds_read_b128 a[44:47], v231 offset:49152
    ds_read_b128 a[48:51], v228 offset:53248
    v_mfma_f32_16x16x32_bf16 a[208:211], a[96:99], v[176:179], a[208:211]
    s_add_u32 s64, s64, s66
    v_exp_f32 v83, v83
    v_mfma_f32_16x16x32_bf16 a[208:211], a[100:103], v[180:183], a[208:211]
    s_lshl_b32 s64, s64, 2
    ds_read_b128 a[52:55], v229 offset:53248
    v_cvt_pk_bf16_f32 v149, v82, v83
    v_mfma_f32_16x16x32_bf16 a[240:243], a[100:103], v[188:191], a[240:243]
    s_add_u32 s64, s64, s48
    v_exp_f32 v84, v84
    v_mfma_f32_16x16x32_bf16 a[240:243], a[96:99], v[184:187], a[240:243]
    s_mul_i32 s64, s64, 18432
    ds_read_b128 a[56:59], v230 offset:53248
    ds_read_b128 a[60:63], v231 offset:53248
    v_mfma_f32_16x16x32_bf16 a[148:151], a[104:107], v[160:163], a[148:151]
    s_add_u32 s64, s64, s65
    v_exp_f32 v85, v85
    v_mfma_f32_16x16x32_bf16 a[148:151], a[108:111], v[164:167], a[148:151]
    s_add_u32 s93, s64, 58720256
    buffer_load_dwordx4 v4, s[20:23], s16 offen offset:0 nt lds
    v_cvt_pk_bf16_f32 v150, v84, v85
    v_mfma_f32_16x16x32_bf16 a[180:183], a[108:111], v[172:175], a[180:183]
    s_add_u32 s64, s76, 3
    v_exp_f32 v86, v86
    v_mfma_f32_16x16x32_bf16 a[180:183], a[104:107], v[168:171], a[180:183]
    s_and_b32 s64, s64, 3
    v_add_u32 v15, s52, v52
    v_mul_f32 v241, v18, v241
    v_mfma_f32_16x16x32_bf16 a[212:215], a[104:107], v[176:179], a[212:215]
    s_mov_b32 s65, 12288
    v_exp_f32 v87, v87
    v_mfma_f32_16x16x32_bf16 a[212:215], a[108:111], v[180:183], a[212:215]
    s_add_u32 s64, s64, s66
    v_cvt_pk_bf16_f32 v151, v86, v87
    v_xor_b32 v16, 32, v15
    v_mfma_f32_16x16x32_bf16 a[244:247], a[108:111], v[188:191], a[244:247]
    s_lshl_b32 s64, s64, 2
    v_exp_f32 v88, v88
    v_mfma_f32_16x16x32_bf16 a[244:247], a[104:107], v[184:187], a[244:247]
    s_add_u32 s64, s64, s48
    buffer_load_dwordx4 v5, s[20:23], s16 offen offset:1024 nt lds
    v_mul_f32 v242, v18, v242
    v_mfma_f32_16x16x32_bf16 a[152:155], a[112:115], v[160:163], a[152:155]
    s_mul_i32 s64, s64, 18432
    v_exp_f32 v89, v89
    v_mfma_f32_16x16x32_bf16 a[152:155], a[116:119], v[164:167], a[152:155]
    s_add_u32 s64, s64, s65
    v_cvt_pk_bf16_f32 v156, v88, v89
    v_mul_f32 v243, v18, v243
    v_mfma_f32_16x16x32_bf16 a[184:187], a[116:119], v[172:175], a[184:187]
    s_add_u32 s94, s64, 58720256
    v_exp_f32 v90, v90
    v_mfma_f32_16x16x32_bf16 a[184:187], a[112:115], v[168:171], a[184:187]
    s_mov_b32 s64, s48
    v_exp_f32 v240, v240
    v_mfma_f32_16x16x32_bf16 a[216:219], a[112:115], v[176:179], a[216:219]
    s_sub_u32 s65, s48, s76
    v_exp_f32 v91, v91
    v_mfma_f32_16x16x32_bf16 a[216:219], a[116:119], v[180:183], a[216:219]
    s_sub_u32 s65, s65, 1
    buffer_load_dwordx4 v6, s[20:23], s16 offen offset:2048 nt lds
    v_cvt_pk_bf16_f32 v157, v90, v91
    v_mfma_f32_16x16x32_bf16 a[248:251], a[116:119], v[188:191], a[248:251]
    s_and_b32 s65, s65, 3
    v_exp_f32 v92, v92
    v_mfma_f32_16x16x32_bf16 a[248:251], a[112:115], v[184:187], a[248:251]
    s_mul_i32 s65, s65, 6144
    v_exp_f32 v241, v241
    v_mfma_f32_16x16x32_bf16 a[156:159], a[120:123], v[160:163], a[156:159]
    s_add_u32 s65, s65, 2048
    v_exp_f32 v93, v93
    v_mfma_f32_16x16x32_bf16 a[156:159], a[124:127], v[164:167], a[156:159]
    s_add_u32 s64, s64, s66
    v_cvt_pk_bf16_f32 v158, v92, v93
    v_mul_f32 v19, 0xc13504f3, v19
    v_mfma_f32_16x16x32_bf16 a[188:191], a[124:127], v[172:175], a[188:191]
    s_lshl_b32 s64, s64, 2
    v_exp_f32 v94, v94
    v_mfma_f32_16x16x32_bf16 a[188:191], a[120:123], v[168:171], a[188:191]
    s_add_u32 s64, s64, s48
    buffer_load_dwordx4 v7, s[20:23], s16 offen offset:3072 nt lds
    v_mul_f32 v40, v36, v40
    v_mfma_f32_16x16x32_bf16 a[220:223], a[120:123], v[176:179], a[220:223]
    s_add_u32 s16, s16, 16384
    v_exp_f32 v95, v95
    v_mfma_f32_16x16x32_bf16 a[220:223], a[124:127], v[180:183], a[220:223]
    s_and_b32 s16, s16, 0x7ffff
    s_mul_i32 s64, s64, 18432
    v_cvt_pk_bf16_f32 v159, v94, v95
    v_mfma_f32_16x16x32_bf16 a[252:255], a[124:127], v[188:191], a[252:255]
    s_add_u32 s64, s64, s65
    v_exp_f32 v242, v242
    v_mfma_f32_16x16x32_bf16 a[252:255], a[120:123], v[184:187], a[252:255]
    s_add_u32 s95, s64, 58720256
    s_waitcnt lgkmcnt(0)
    v_exp_f32 v243, v243
    v_mfma_f32_16x16x32_bf16 v[64:67], a[32:35], a[0:3], v[192:195]
    v_exp_f32 v96, v96
    v_mfma_f32_16x16x32_bf16 v[64:67], a[36:39], a[4:7], v[64:67]
    ds_read_b64_tr_b16 a[96:97], v232 offset:0
    ds_read_b64_tr_b16 a[98:99], v232 offset:4096
    v_mfma_f32_16x16x32_bf16 v[64:67], a[40:43], a[64:67], v[64:67]
    v_exp_f32 v97, v97
    v_mfma_f32_16x16x32_bf16 v[64:67], a[44:47], a[68:71], v[64:67]
    ds_read_b64_tr_b16 a[100:101], v232 offset:8192
    v_cvt_pk_bf16_f32 v160, v96, v97
    v_mfma_f32_16x16x32_bf16 v[72:75], a[44:47], a[76:79], v[196:199]
    v_exp_f32 v98, v98
    v_mfma_f32_16x16x32_bf16 v[72:75], a[40:43], a[72:75], v[72:75]
    ds_read_b64_tr_b16 a[102:103], v232 offset:12288
    ds_read_b64_tr_b16 a[104:105], v233 offset:0
    v_mfma_f32_16x16x32_bf16 v[72:75], a[36:39], a[12:15], v[72:75]
    v_exp_f32 v99, v99
    v_mfma_f32_16x16x32_bf16 v[72:75], a[32:35], a[8:11], v[72:75]
    ds_read_b64_tr_b16 a[106:107], v233 offset:4096
    v_cvt_pk_bf16_f32 v161, v98, v99
    v_mfma_f32_16x16x32_bf16 v[80:83], a[32:35], a[16:19], v[200:203]
    v_exp_f32 v100, v100
    v_mfma_f32_16x16x32_bf16 v[80:83], a[36:39], a[20:23], v[80:83]
    ds_read_b64_tr_b16 a[108:109], v233 offset:8192
    ds_read_b64_tr_b16 a[110:111], v233 offset:12288
    v_mfma_f32_16x16x32_bf16 v[80:83], a[40:43], a[80:83], v[80:83]
    v_exp_f32 v101, v101
    v_mfma_f32_16x16x32_bf16 v[80:83], a[44:47], a[84:87], v[80:83]
    ds_read_b64_tr_b16 a[112:113], v234 offset:0
    v_cvt_pk_bf16_f32 v162, v100, v101
    v_mfma_f32_16x16x32_bf16 v[88:91], a[44:47], a[92:95], v[204:207]
    v_exp_f32 v102, v102
    v_mfma_f32_16x16x32_bf16 v[88:91], a[40:43], a[88:91], v[88:91]
    ds_read_b64_tr_b16 a[114:115], v234 offset:4096
    ds_read_b64_tr_b16 a[116:117], v234 offset:8192
    v_mfma_f32_16x16x32_bf16 v[88:91], a[36:39], a[28:31], v[88:91]
    v_exp_f32 v103, v103
    v_mfma_f32_16x16x32_bf16 v[88:91], a[32:35], a[24:27], v[88:91]
    ds_read_b64_tr_b16 a[118:119], v234 offset:12288
    v_cvt_pk_bf16_f32 v163, v102, v103
    v_mfma_f32_16x16x32_bf16 v[68:71], a[48:51], a[0:3], v[192:195]
    v_exp_f32 v104, v104
    v_mfma_f32_16x16x32_bf16 v[68:71], a[52:55], a[4:7], v[68:71]
    ds_read_b64_tr_b16 a[120:121], v235 offset:0
    ds_read_b64_tr_b16 a[122:123], v235 offset:4096
    v_mfma_f32_16x16x32_bf16 v[68:71], a[56:59], a[64:67], v[68:71]
    v_exp_f32 v105, v105
    v_mfma_f32_16x16x32_bf16 v[68:71], a[60:63], a[68:71], v[68:71]
    ds_read_b64_tr_b16 a[124:125], v235 offset:8192
    v_cvt_pk_bf16_f32 v168, v104, v105
    v_mfma_f32_16x16x32_bf16 v[76:79], a[60:63], a[76:79], v[196:199]
    v_exp_f32 v106, v106
    v_mfma_f32_16x16x32_bf16 v[76:79], a[56:59], a[72:75], v[76:79]
    s_cmp_eq_u32 s48, s76
    s_cselect_b32 s95, 2146435072, s95
    ds_read_b64_tr_b16 a[126:127], v235 offset:12288
    v_mfma_f32_16x16x32_bf16 v[76:79], a[52:55], a[12:15], v[76:79]
    s_lshl_b32 s64, s50, 2
    v_exp_f32 v107, v107
    v_mfma_f32_16x16x32_bf16 v[76:79], a[48:51], a[8:11], v[76:79]
    s_add_u32 s64, s64, s48
    v_cvt_pk_bf16_f32 v169, v106, v107
    v_fma_f32 v240, v240, v22, v22
    v_mfma_f32_16x16x32_bf16 v[84:87], a[48:51], a[16:19], v[200:203]
    s_lshl_b32 s64, s64, 2
    v_exp_f32 v108, v108
    v_mfma_f32_16x16x32_bf16 v[84:87], a[52:55], a[20:23], v[84:87]
    s_lshl_b32 s65, s49, 7
    v_fma_f32 v241, v241, v22, v22
    v_mul_f32 v41, v37, v41
    v_mfma_f32_16x16x32_bf16 v[84:87], a[56:59], a[80:83], v[84:87]
    s_add_u32 s64, s64, s65
    v_exp_f32 v109, v109
    v_mfma_f32_16x16x32_bf16 v[84:87], a[60:63], a[84:87], v[84:87]
    s_lshl_b32 s100, s64, 12
    v_cvt_pk_bf16_f32 v170, v108, v109
    v_fma_f32 v242, v242, v22, v22
    v_mfma_f32_16x16x32_bf16 v[92:95], a[60:63], a[92:95], v[204:207]
    s_waitcnt lgkmcnt(0)
    v_exp_f32 v110, v110
    v_mfma_f32_16x16x32_bf16 v[92:95], a[56:59], a[88:91], v[92:95]
    s_mul_i32 s64, s76, 1327104
    v_fma_f32 v243, v243, v22, v22
    v_mul_f32 v42, v38, v42
    v_mfma_f32_16x16x32_bf16 v[92:95], a[52:55], a[28:31], v[92:95]
    s_lshr_b32 s65, s2, 3
    v_exp_f32 v111, v111
    v_mfma_f32_16x16x32_bf16 v[92:95], a[48:51], a[24:27], v[92:95]
    s_lshl_b32 s65, s65, 2
    v_cvt_pk_bf16_f32 v171, v110, v111
    v_mul_f32 v43, v39, v43
    v_smfmac_f32_16x16x64_bf16 v[208:211], v[224:227], v[128:135], v252
    s_add_u32 s65, s65, s48
    v_exp_f32 v112, v112
    v_smfmac_f32_16x16x64_bf16 v[212:215], v[224:227], v[136:143], v252
    s_mul_i32 s65, s65, 10368
    ds_read_b128 a[32:35], v228 offset:57344
    ds_read_b128 a[36:39], v229 offset:57344
    v_mfma_f32_16x16x32_bf16 a[128:131], a[96:99], v[128:131], a[128:131]
    s_add_u32 m0, s52, 49152
    v_exp_f32 v113, v113
    v_mfma_f32_16x16x32_bf16 a[128:131], a[100:103], v[132:135], a[128:131]
    s_add_u32 s64, s64, s65
    ds_read_b128 a[40:43], v230 offset:57344
    v_cvt_pk_bf16_f32 v176, v112, v113
    v_mfma_f32_16x16x32_bf16 a[160:163], a[100:103], v[140:143], a[160:163]
    s_add_u32 s63, s64, 41943040
    v_exp_f32 v114, v114
    v_mfma_f32_16x16x32_bf16 a[160:163], a[96:99], v[136:139], a[160:163]
    ds_read_b128 a[44:47], v231 offset:57344
    ds_read_b128 a[48:51], v228 offset:61440
    v_mfma_f32_16x16x32_bf16 a[192:195], a[96:99], v[144:147], a[192:195]
    v_exp_f32 v115, v115
    v_mfma_f32_16x16x32_bf16 a[192:195], a[100:103], v[148:151], a[192:195]
    ds_read_b128 a[52:55], v229 offset:61440
    v_cvt_pk_bf16_f32 v177, v114, v115
    v_mfma_f32_16x16x32_bf16 a[224:227], a[100:103], v[156:159], a[224:227]
    v_exp_f32 v116, v116
    v_mfma_f32_16x16x32_bf16 a[224:227], a[96:99], v[152:155], a[224:227]
    ds_read_b128 a[56:59], v230 offset:61440
    ds_read_b128 a[60:63], v231 offset:61440
    v_mfma_f32_16x16x32_bf16 a[132:135], a[104:107], v[128:131], a[132:135]
    v_exp_f32 v117, v117
    v_mfma_f32_16x16x32_bf16 a[132:135], a[108:111], v[132:135], a[132:135]
    buffer_load_dwordx4 v8, s[24:27], s17 offen offset:0 nt lds
    v_cvt_pk_bf16_f32 v178, v116, v117
    v_mfma_f32_16x16x32_bf16 a[164:167], a[108:111], v[140:143], a[164:167]
    v_exp_f32 v118, v118
    v_mfma_f32_16x16x32_bf16 a[164:167], a[104:107], v[136:139], a[164:167]
    v_rcp_f32 v240, v240
    v_mfma_f32_16x16x32_bf16 a[196:199], a[104:107], v[144:147], a[196:199]
    v_exp_f32 v119, v119
    v_mfma_f32_16x16x32_bf16 a[196:199], a[108:111], v[148:151], a[196:199]
    buffer_load_dwordx4 v9, s[24:27], s17 offen offset:1024 nt lds
    v_cvt_pk_bf16_f32 v179, v118, v119
    v_mfma_f32_16x16x32_bf16 a[228:231], a[108:111], v[156:159], a[228:231]
    v_exp_f32 v120, v120
    v_mfma_f32_16x16x32_bf16 a[228:231], a[104:107], v[152:155], a[228:231]
    v_rcp_f32 v241, v241
    v_mfma_f32_16x16x32_bf16 a[136:139], a[112:115], v[128:131], a[136:139]
    v_exp_f32 v121, v121
    v_mfma_f32_16x16x32_bf16 a[136:139], a[116:119], v[132:135], a[136:139]
    buffer_load_dwordx4 v8, s[24:27], s17 offen offset:2048 nt lds
    v_cvt_pk_bf16_f32 v184, v120, v121
    v_mfma_f32_16x16x32_bf16 a[168:171], a[116:119], v[140:143], a[168:171]
    v_exp_f32 v122, v122
    v_mfma_f32_16x16x32_bf16 a[168:171], a[112:115], v[136:139], a[168:171]
    v_rcp_f32 v242, v242
    v_mfma_f32_16x16x32_bf16 a[200:203], a[112:115], v[144:147], a[200:203]
    v_exp_f32 v123, v123
    v_mfma_f32_16x16x32_bf16 a[200:203], a[116:119], v[148:151], a[200:203]
    buffer_load_dwordx4 v9, s[24:27], s17 offen offset:3072 nt lds
    v_cvt_pk_bf16_f32 v185, v122, v123
    v_mfma_f32_16x16x32_bf16 a[232:235], a[116:119], v[156:159], a[232:235]
    s_add_u32 s17, s17, 16384
    v_exp_f32 v124, v124
    v_mfma_f32_16x16x32_bf16 a[232:235], a[112:115], v[152:155], a[232:235]
    s_and_b32 s17, s17, 0x7ffff
    s_add_u32 s69, s53, 0
    v_mul_f32 v36, v19, v36
    v_mfma_f32_16x16x32_bf16 a[140:143], a[120:123], v[128:131], a[140:143]
    v_exp_f32 v125, v125
    v_mfma_f32_16x16x32_bf16 a[140:143], a[124:127], v[132:135], a[140:143]
    buffer_store_dwordx4 v[224:227], v253, s[40:43], s69 offen sc1
    v_cvt_pk_bf16_f32 v186, v124, v125
    v_mfma_f32_16x16x32_bf16 a[172:175], a[124:127], v[140:143], a[172:175]
    v_exp_f32 v126, v126
    v_mfma_f32_16x16x32_bf16 a[172:175], a[120:123], v[136:139], a[172:175]
    v_rcp_f32 v243, v243
    v_mfma_f32_16x16x32_bf16 a[204:207], a[120:123], v[144:147], a[204:207]
    v_exp_f32 v127, v127
    v_mfma_f32_16x16x32_bf16 a[204:207], a[124:127], v[148:151], a[204:207]
    v_cvt_pk_bf16_f32 v187, v126, v127
    v_mul_f32 v244, v244, v240
    v_mfma_f32_16x16x32_bf16 a[236:239], a[124:127], v[156:159], a[236:239]
    v_mul_f32 v245, v245, v241
    v_mul_f32 v37, v19, v37
    v_mfma_f32_16x16x32_bf16 a[236:239], a[120:123], v[152:155], a[236:239]
    s_waitcnt lgkmcnt(0)
    v_mul_f32 v246, v246, v242
    v_mul_f32 v38, v19, v38
    v_mfma_f32_16x16x32_bf16 v[96:99], a[32:35], a[0:3], v[192:195]
    v_exp_f32 v64, v64
    v_mfma_f32_16x16x32_bf16 v[96:99], a[36:39], a[4:7], v[96:99]
    ds_read_b64_tr_b16 a[96:97], v236 offset:0
    ds_read_b64_tr_b16 a[98:99], v236 offset:4096
    v_mfma_f32_16x16x32_bf16 v[96:99], a[40:43], a[64:67], v[96:99]
    v_exp_f32 v65, v65
    v_mfma_f32_16x16x32_bf16 v[96:99], a[44:47], a[68:71], v[96:99]
    ds_read_b64_tr_b16 a[100:101], v236 offset:8192
    v_cvt_pk_bf16_f32 v164, v64, v65
    v_mfma_f32_16x16x32_bf16 v[104:107], a[44:47], a[76:79], v[196:199]
    v_exp_f32 v66, v66
    v_mfma_f32_16x16x32_bf16 v[104:107], a[40:43], a[72:75], v[104:107]
    ds_read_b64_tr_b16 a[102:103], v236 offset:12288
    ds_read_b64_tr_b16 a[104:105], v237 offset:0
    v_mfma_f32_16x16x32_bf16 v[104:107], a[36:39], a[12:15], v[104:107]
    v_exp_f32 v67, v67
    v_mfma_f32_16x16x32_bf16 v[104:107], a[32:35], a[8:11], v[104:107]
    ds_read_b64_tr_b16 a[106:107], v237 offset:4096
    v_cvt_pk_bf16_f32 v165, v66, v67
    v_mfma_f32_16x16x32_bf16 v[112:115], a[32:35], a[16:19], v[200:203]
    v_exp_f32 v68, v68
    v_mfma_f32_16x16x32_bf16 v[112:115], a[36:39], a[20:23], v[112:115]
    ds_read_b64_tr_b16 a[108:109], v237 offset:8192
    ds_read_b64_tr_b16 a[110:111], v237 offset:12288
    v_mfma_f32_16x16x32_bf16 v[112:115], a[40:43], a[80:83], v[112:115]
    v_exp_f32 v69, v69
    v_mfma_f32_16x16x32_bf16 v[112:115], a[44:47], a[84:87], v[112:115]
    ds_read_b64_tr_b16 a[112:113], v238 offset:0
    v_cvt_pk_bf16_f32 v166, v68, v69
    v_mfma_f32_16x16x32_bf16 v[120:123], a[44:47], a[92:95], v[204:207]
    v_exp_f32 v70, v70
    v_mfma_f32_16x16x32_bf16 v[120:123], a[40:43], a[88:91], v[120:123]
    ds_read_b64_tr_b16 a[114:115], v238 offset:4096
    ds_read_b64_tr_b16 a[116:117], v238 offset:8192
    v_mfma_f32_16x16x32_bf16 v[120:123], a[36:39], a[28:31], v[120:123]
    v_exp_f32 v71, v71
    v_mfma_f32_16x16x32_bf16 v[120:123], a[32:35], a[24:27], v[120:123]
    ds_read_b64_tr_b16 a[118:119], v238 offset:12288
    v_cvt_pk_bf16_f32 v167, v70, v71
    v_mfma_f32_16x16x32_bf16 v[100:103], a[48:51], a[0:3], v[192:195]
    v_exp_f32 v72, v72
    v_mfma_f32_16x16x32_bf16 v[100:103], a[52:55], a[4:7], v[100:103]
    ds_read_b64_tr_b16 a[120:121], v239 offset:0
    ds_read_b64_tr_b16 a[122:123], v239 offset:4096
    v_mfma_f32_16x16x32_bf16 v[100:103], a[56:59], a[64:67], v[100:103]
    v_exp_f32 v73, v73
    v_mfma_f32_16x16x32_bf16 v[100:103], a[60:63], a[68:71], v[100:103]
    ds_read_b64_tr_b16 a[124:125], v239 offset:8192
    v_cvt_pk_bf16_f32 v172, v72, v73
    v_mfma_f32_16x16x32_bf16 v[108:111], a[60:63], a[76:79], v[196:199]
    v_exp_f32 v74, v74
    v_mfma_f32_16x16x32_bf16 v[108:111], a[56:59], a[72:75], v[108:111]
    ds_read_b64_tr_b16 a[126:127], v239 offset:12288
    v_mul_f32 v247, v247, v243
    v_mfma_f32_16x16x32_bf16 v[108:111], a[52:55], a[12:15], v[108:111]
    v_exp_f32 v75, v75
    v_mfma_f32_16x16x32_bf16 v[108:111], a[48:51], a[8:11], v[108:111]
    v_cvt_pk_bf16_f32 v173, v74, v75
    v_cvt_pk_bf16_f32 v240, v244, v245
    v_mfma_f32_16x16x32_bf16 v[116:119], a[48:51], a[16:19], v[200:203]
    v_exp_f32 v76, v76
    v_mfma_f32_16x16x32_bf16 v[116:119], a[52:55], a[20:23], v[116:119]
    s_add_u32 s71, s3, 0
    v_cvt_pk_bf16_f32 v241, v246, v247
    v_mul_f32 v39, v19, v39
    v_mfma_f32_16x16x32_bf16 v[116:119], a[56:59], a[80:83], v[116:119]
    s_and_b32 s71, s71, 3
    v_exp_f32 v77, v77
    v_mfma_f32_16x16x32_bf16 v[116:119], a[60:63], a[84:87], v[116:119]
    s_mul_i32 s71, s71, 4096
    v_cvt_pk_bf16_f32 v174, v76, v77
    v_mul_f32 v20, 0xc13504f3, v20
    v_mfma_f32_16x16x32_bf16 v[124:127], a[60:63], a[92:95], v[204:207]
    s_waitcnt lgkmcnt(0)
    v_exp_f32 v78, v78
    v_mfma_f32_16x16x32_bf16 v[124:127], a[56:59], a[88:91], v[124:127]
    s_add_u32 s71, s71, s60
    v_exp_f32 v36, v36
    v_mfma_f32_16x16x32_bf16 v[124:127], a[52:55], a[28:31], v[124:127]
    s_waitcnt vmcnt(17)
    v_exp_f32 v79, v79
    v_mfma_f32_16x16x32_bf16 v[124:127], a[48:51], a[24:27], v[124:127]
    s_barrier
    buffer_store_dwordx2 v[240:241], v2, s[28:31], s71 offen sc1
    v_cvt_pk_bf16_f32 v175, v78, v79
    v_smfmac_f32_16x16x64_bf16 v[216:219], v[224:227], v[144:151], v252
    v_exp_f32 v80, v80
    v_smfmac_f32_16x16x64_bf16 v[220:223], v[224:227], v[152:159], v252
    ds_read_b128 a[32:35], v228 offset:0
    ds_read_b128 a[36:39], v229 offset:0
    v_mfma_f32_16x16x32_bf16 a[144:147], a[96:99], v[128:131], a[144:147]
    s_add_u32 m0, s52, 147456
    v_exp_f32 v81, v81
    v_mfma_f32_16x16x32_bf16 a[144:147], a[100:103], v[132:135], a[144:147]
    ds_read_b128 a[40:43], v230 offset:0
    v_cvt_pk_bf16_f32 v180, v80, v81
    v_mfma_f32_16x16x32_bf16 a[176:179], a[100:103], v[140:143], a[176:179]
    v_exp_f32 v82, v82
    v_mfma_f32_16x16x32_bf16 a[176:179], a[96:99], v[136:139], a[176:179]
    ds_read_b128 a[44:47], v231 offset:0
    ds_read_b128 a[48:51], v228 offset:4096
    v_mfma_f32_16x16x32_bf16 a[208:211], a[96:99], v[144:147], a[208:211]
    v_exp_f32 v83, v83
    v_mfma_f32_16x16x32_bf16 a[208:211], a[100:103], v[148:151], a[208:211]
    ds_read_b128 a[52:55], v229 offset:4096
    v_cvt_pk_bf16_f32 v181, v82, v83
    v_mfma_f32_16x16x32_bf16 a[240:243], a[100:103], v[156:159], a[240:243]
    v_exp_f32 v84, v84
    v_mfma_f32_16x16x32_bf16 a[240:243], a[96:99], v[152:155], a[240:243]
    ds_read_b128 a[56:59], v230 offset:4096
    ds_read_b128 a[60:63], v231 offset:4096
    v_mfma_f32_16x16x32_bf16 a[148:151], a[104:107], v[128:131], a[148:151]
    v_exp_f32 v85, v85
    v_mfma_f32_16x16x32_bf16 a[148:151], a[108:111], v[132:135], a[148:151]
    buffer_load_dwordx4 v4, s[20:23], s16 offen offset:0 nt lds
    v_cvt_pk_bf16_f32 v182, v84, v85
    v_mfma_f32_16x16x32_bf16 a[180:183], a[108:111], v[140:143], a[180:183]
    v_exp_f32 v86, v86
    v_mfma_f32_16x16x32_bf16 a[180:183], a[104:107], v[136:139], a[180:183]
    v_exp_f32 v37, v37
    v_mfma_f32_16x16x32_bf16 a[212:215], a[104:107], v[144:147], a[212:215]
    v_exp_f32 v87, v87
    v_mfma_f32_16x16x32_bf16 a[212:215], a[108:111], v[148:151], a[212:215]
    buffer_load_dwordx4 v5, s[20:23], s16 offen offset:1024 nt lds
    v_cvt_pk_bf16_f32 v183, v86, v87
    v_mfma_f32_16x16x32_bf16 a[244:247], a[108:111], v[156:159], a[244:247]
    v_exp_f32 v88, v88
    v_mfma_f32_16x16x32_bf16 a[244:247], a[104:107], v[152:155], a[244:247]
    v_exp_f32 v38, v38
    v_mfma_f32_16x16x32_bf16 a[152:155], a[112:115], v[128:131], a[152:155]
    v_exp_f32 v89, v89
    v_mfma_f32_16x16x32_bf16 a[152:155], a[116:119], v[132:135], a[152:155]
    buffer_load_dwordx4 v6, s[20:23], s16 offen offset:2048 nt lds
    v_cvt_pk_bf16_f32 v188, v88, v89
    v_mfma_f32_16x16x32_bf16 a[184:187], a[116:119], v[140:143], a[184:187]
    v_exp_f32 v90, v90
    v_mfma_f32_16x16x32_bf16 a[184:187], a[112:115], v[136:139], a[184:187]
    v_exp_f32 v39, v39
    v_mfma_f32_16x16x32_bf16 a[216:219], a[112:115], v[144:147], a[216:219]
    v_exp_f32 v91, v91
    v_mfma_f32_16x16x32_bf16 a[216:219], a[116:119], v[148:151], a[216:219]
    buffer_load_dwordx4 v7, s[20:23], s16 offen offset:3072 nt lds
    v_cvt_pk_bf16_f32 v189, v90, v91
    v_mfma_f32_16x16x32_bf16 a[248:251], a[116:119], v[156:159], a[248:251]
    s_add_u32 s16, s16, 16384
    v_exp_f32 v92, v92
    v_mfma_f32_16x16x32_bf16 a[248:251], a[112:115], v[152:155], a[248:251]
    s_and_b32 s16, s16, 0x7ffff
    s_add_u32 s69, s53, 18432
    v_fma_f32 v36, v36, v23, v23
    v_mfma_f32_16x16x32_bf16 a[156:159], a[120:123], v[128:131], a[156:159]
    v_exp_f32 v93, v93
    v_mfma_f32_16x16x32_bf16 a[156:159], a[124:127], v[132:135], a[156:159]
    buffer_store_dwordx4 v[224:227], v253, s[40:43], s69 offen sc1
    v_cvt_pk_bf16_f32 v190, v92, v93
    v_mfma_f32_16x16x32_bf16 a[188:191], a[124:127], v[140:143], a[188:191]
    v_exp_f32 v94, v94
    v_mfma_f32_16x16x32_bf16 a[188:191], a[120:123], v[136:139], a[188:191]
    v_fma_f32 v37, v37, v23, v23
    v_mul_f32 v48, v44, v48
    v_mfma_f32_16x16x32_bf16 a[220:223], a[120:123], v[144:147], a[220:223]
    v_exp_f32 v95, v95
    v_mfma_f32_16x16x32_bf16 a[220:223], a[124:127], v[148:151], a[220:223]
    v_cvt_pk_bf16_f32 v191, v94, v95
    v_fma_f32 v38, v38, v23, v23
    v_mfma_f32_16x16x32_bf16 a[252:255], a[124:127], v[156:159], a[252:255]
    v_fma_f32 v39, v39, v23, v23
    v_mul_f32 v49, v45, v49
    v_mfma_f32_16x16x32_bf16 a[252:255], a[120:123], v[152:155], a[252:255]
    s_waitcnt lgkmcnt(0)
    v_rcp_f32 v36, v36
    v_mfma_f32_16x16x32_bf16 v[64:67], a[32:35], a[0:3], v[192:195]
    v_exp_f32 v96, v96
    v_mfma_f32_16x16x32_bf16 v[64:67], a[36:39], a[4:7], v[64:67]
    ds_read_b64_tr_b16 a[96:97], v232 offset:16384
    ds_read_b64_tr_b16 a[98:99], v232 offset:20480
    v_mfma_f32_16x16x32_bf16 v[64:67], a[40:43], a[64:67], v[64:67]
    v_exp_f32 v97, v97
    v_mfma_f32_16x16x32_bf16 v[64:67], a[44:47], a[68:71], v[64:67]
    ds_read_b64_tr_b16 a[100:101], v232 offset:24576
    v_cvt_pk_bf16_f32 v128, v96, v97
    v_mfma_f32_16x16x32_bf16 v[72:75], a[44:47], a[76:79], v[196:199]
    v_exp_f32 v98, v98
    v_mfma_f32_16x16x32_bf16 v[72:75], a[40:43], a[72:75], v[72:75]
    ds_read_b64_tr_b16 a[102:103], v232 offset:28672
    ds_read_b64_tr_b16 a[104:105], v233 offset:16384
    v_mfma_f32_16x16x32_bf16 v[72:75], a[36:39], a[12:15], v[72:75]
    v_exp_f32 v99, v99
    v_mfma_f32_16x16x32_bf16 v[72:75], a[32:35], a[8:11], v[72:75]
    ds_read_b64_tr_b16 a[106:107], v233 offset:20480
    v_cvt_pk_bf16_f32 v129, v98, v99
    v_mfma_f32_16x16x32_bf16 v[80:83], a[32:35], a[16:19], v[200:203]
    v_exp_f32 v100, v100
    v_mfma_f32_16x16x32_bf16 v[80:83], a[36:39], a[20:23], v[80:83]
    ds_read_b64_tr_b16 a[108:109], v233 offset:24576
    ds_read_b64_tr_b16 a[110:111], v233 offset:28672
    v_mfma_f32_16x16x32_bf16 v[80:83], a[40:43], a[80:83], v[80:83]
    v_exp_f32 v101, v101
    v_mfma_f32_16x16x32_bf16 v[80:83], a[44:47], a[84:87], v[80:83]
    ds_read_b64_tr_b16 a[112:113], v234 offset:16384
    v_cvt_pk_bf16_f32 v130, v100, v101
    v_mfma_f32_16x16x32_bf16 v[88:91], a[44:47], a[92:95], v[204:207]
    v_exp_f32 v102, v102
    v_mfma_f32_16x16x32_bf16 v[88:91], a[40:43], a[88:91], v[88:91]
    ds_read_b64_tr_b16 a[114:115], v234 offset:20480
    ds_read_b64_tr_b16 a[116:117], v234 offset:24576
    v_mfma_f32_16x16x32_bf16 v[88:91], a[36:39], a[28:31], v[88:91]
    v_exp_f32 v103, v103
    v_mfma_f32_16x16x32_bf16 v[88:91], a[32:35], a[24:27], v[88:91]
    ds_read_b64_tr_b16 a[118:119], v234 offset:28672
    v_cvt_pk_bf16_f32 v131, v102, v103
    v_mfma_f32_16x16x32_bf16 v[68:71], a[48:51], a[0:3], v[192:195]
    v_exp_f32 v104, v104
    v_mfma_f32_16x16x32_bf16 v[68:71], a[52:55], a[4:7], v[68:71]
    ds_read_b64_tr_b16 a[120:121], v235 offset:16384
    ds_read_b64_tr_b16 a[122:123], v235 offset:20480
    v_mfma_f32_16x16x32_bf16 v[68:71], a[56:59], a[64:67], v[68:71]
    v_exp_f32 v105, v105
    v_mfma_f32_16x16x32_bf16 v[68:71], a[60:63], a[68:71], v[68:71]
    ds_read_b64_tr_b16 a[124:125], v235 offset:24576
    v_cvt_pk_bf16_f32 v136, v104, v105
    v_mfma_f32_16x16x32_bf16 v[76:79], a[60:63], a[76:79], v[196:199]
    v_exp_f32 v106, v106
    v_mfma_f32_16x16x32_bf16 v[76:79], a[56:59], a[72:75], v[76:79]
    ds_read_b64_tr_b16 a[126:127], v235 offset:28672
    v_mul_f32 v50, v46, v50
    v_mfma_f32_16x16x32_bf16 v[76:79], a[52:55], a[12:15], v[76:79]
    v_exp_f32 v107, v107
    v_mfma_f32_16x16x32_bf16 v[76:79], a[48:51], a[8:11], v[76:79]
    v_cvt_pk_bf16_f32 v137, v106, v107
    v_mul_f32 v51, v47, v51
    v_mfma_f32_16x16x32_bf16 v[84:87], a[48:51], a[16:19], v[200:203]
    v_exp_f32 v108, v108
    v_mfma_f32_16x16x32_bf16 v[84:87], a[52:55], a[20:23], v[84:87]
    v_rcp_f32 v37, v37
    v_mfma_f32_16x16x32_bf16 v[84:87], a[56:59], a[80:83], v[84:87]
    v_exp_f32 v109, v109
    v_mfma_f32_16x16x32_bf16 v[84:87], a[60:63], a[84:87], v[84:87]
    v_cvt_pk_bf16_f32 v138, v108, v109
    v_mul_f32 v44, v20, v44
    v_mfma_f32_16x16x32_bf16 v[92:95], a[60:63], a[92:95], v[204:207]
    s_waitcnt lgkmcnt(0)
    v_exp_f32 v110, v110
    v_mfma_f32_16x16x32_bf16 v[92:95], a[56:59], a[88:91], v[92:95]
    v_rcp_f32 v38, v38
    v_mfma_f32_16x16x32_bf16 v[92:95], a[52:55], a[28:31], v[92:95]
    v_exp_f32 v111, v111
    v_mfma_f32_16x16x32_bf16 v[92:95], a[48:51], a[24:27], v[92:95]
    v_cvt_pk_bf16_f32 v139, v110, v111
    v_mul_f32 v45, v20, v45
    v_smfmac_f32_16x16x64_bf16 v[208:211], v[224:227], v[160:167], v252
    v_exp_f32 v112, v112
    v_smfmac_f32_16x16x64_bf16 v[212:215], v[224:227], v[168:175], v252
    ds_read_b128 a[32:35], v228 offset:8192
    ds_read_b128 a[36:39], v229 offset:8192
    v_mfma_f32_16x16x32_bf16 a[128:131], a[96:99], v[160:163], a[128:131]
    s_add_u32 m0, s52, 0
    v_exp_f32 v113, v113
    v_mfma_f32_16x16x32_bf16 a[128:131], a[100:103], v[164:167], a[128:131]
    ds_read_b128 a[40:43], v230 offset:8192
    v_cvt_pk_bf16_f32 v144, v112, v113
    v_mfma_f32_16x16x32_bf16 a[160:163], a[100:103], v[172:175], a[160:163]
    v_exp_f32 v114, v114
    v_mfma_f32_16x16x32_bf16 a[160:163], a[96:99], v[168:171], a[160:163]
    ds_read_b128 a[44:47], v231 offset:8192
    ds_read_b128 a[48:51], v228 offset:12288
    v_mfma_f32_16x16x32_bf16 a[192:195], a[96:99], v[176:179], a[192:195]
    v_exp_f32 v115, v115
    v_mfma_f32_16x16x32_bf16 a[192:195], a[100:103], v[180:183], a[192:195]
    ds_read_b128 a[52:55], v229 offset:12288
    v_cvt_pk_bf16_f32 v145, v114, v115
    v_mfma_f32_16x16x32_bf16 a[224:227], a[100:103], v[188:191], a[224:227]
    v_exp_f32 v116, v116
    v_mfma_f32_16x16x32_bf16 a[224:227], a[96:99], v[184:187], a[224:227]
    ds_read_b128 a[56:59], v230 offset:12288
    ds_read_b128 a[60:63], v231 offset:12288
    v_mfma_f32_16x16x32_bf16 a[132:135], a[104:107], v[160:163], a[132:135]
    v_exp_f32 v117, v117
    v_mfma_f32_16x16x32_bf16 a[132:135], a[108:111], v[164:167], a[132:135]
    buffer_load_dwordx4 v8, s[24:27], s17 offen offset:0 nt lds
    v_cvt_pk_bf16_f32 v146, v116, v117
    v_mfma_f32_16x16x32_bf16 a[164:167], a[108:111], v[172:175], a[164:167]
    v_exp_f32 v118, v118
    v_mfma_f32_16x16x32_bf16 a[164:167], a[104:107], v[168:171], a[164:167]
    v_rcp_f32 v39, v39
    v_mfma_f32_16x16x32_bf16 a[196:199], a[104:107], v[176:179], a[196:199]
    v_exp_f32 v119, v119
    v_mfma_f32_16x16x32_bf16 a[196:199], a[108:111], v[180:183], a[196:199]
    buffer_load_dwordx4 v9, s[24:27], s17 offen offset:1024 nt lds
    v_cvt_pk_bf16_f32 v147, v118, v119
    v_mfma_f32_16x16x32_bf16 a[228:231], a[108:111], v[188:191], a[228:231]
    v_exp_f32 v120, v120
    v_mfma_f32_16x16x32_bf16 a[228:231], a[104:107], v[184:187], a[228:231]
    v_mul_f32 v40, v40, v36
    v_mul_f32 v46, v20, v46
    v_mfma_f32_16x16x32_bf16 a[136:139], a[112:115], v[160:163], a[136:139]
    v_exp_f32 v121, v121
    v_mfma_f32_16x16x32_bf16 a[136:139], a[116:119], v[164:167], a[136:139]
    buffer_load_dwordx4 v8, s[24:27], s17 offen offset:2048 nt lds
    v_cvt_pk_bf16_f32 v152, v120, v121
    v_mfma_f32_16x16x32_bf16 a[168:171], a[116:119], v[172:175], a[168:171]
    v_exp_f32 v122, v122
    v_mfma_f32_16x16x32_bf16 a[168:171], a[112:115], v[168:171], a[168:171]
    v_mul_f32 v41, v41, v37
    v_mul_f32 v47, v20, v47
    v_mfma_f32_16x16x32_bf16 a[200:203], a[112:115], v[176:179], a[200:203]
    v_exp_f32 v123, v123
    v_mfma_f32_16x16x32_bf16 a[200:203], a[116:119], v[180:183], a[200:203]
    buffer_load_dwordx4 v9, s[24:27], s17 offen offset:3072 nt lds
    v_cvt_pk_bf16_f32 v153, v122, v123
    v_mfma_f32_16x16x32_bf16 a[232:235], a[116:119], v[188:191], a[232:235]
    s_add_u32 s17, s17, 16384
    v_exp_f32 v124, v124
    v_mfma_f32_16x16x32_bf16 a[232:235], a[112:115], v[184:187], a[232:235]
    s_and_b32 s17, s17, 0x7ffff
    s_add_u32 s69, s54, 0
    v_mul_f32 v42, v42, v38
    v_mfma_f32_16x16x32_bf16 a[140:143], a[120:123], v[160:163], a[140:143]
    v_exp_f32 v125, v125
    v_mfma_f32_16x16x32_bf16 a[140:143], a[124:127], v[164:167], a[140:143]
    buffer_store_dwordx4 v[224:227], v254, s[40:43], s69 offen sc1
    v_cvt_pk_bf16_f32 v154, v124, v125
    v_mfma_f32_16x16x32_bf16 a[172:175], a[124:127], v[172:175], a[172:175]
    v_exp_f32 v126, v126
    v_mfma_f32_16x16x32_bf16 a[172:175], a[120:123], v[168:171], a[172:175]
    v_mul_f32 v43, v43, v39
    v_mul_f32 v21, 0xc13504f3, v21
    v_mfma_f32_16x16x32_bf16 a[204:207], a[120:123], v[176:179], a[204:207]
    v_exp_f32 v127, v127
    v_mfma_f32_16x16x32_bf16 a[204:207], a[124:127], v[180:183], a[204:207]
    v_cvt_pk_bf16_f32 v155, v126, v127
    v_cvt_pk_bf16_f32 v36, v40, v41
    v_mfma_f32_16x16x32_bf16 a[236:239], a[124:127], v[188:191], a[236:239]
    s_add_u32 s70, s3, 1
    v_cvt_pk_bf16_f32 v37, v42, v43
    v_mul_f32 v30, v26, v30
    v_mfma_f32_16x16x32_bf16 a[236:239], a[120:123], v[184:187], a[236:239]
    s_and_b32 s70, s70, 3
    s_waitcnt lgkmcnt(0)
    v_exp_f32 v44, v44
    s_mul_i32 s70, s70, 4096
    s_add_u32 s70, s70, s60
    buffer_store_dwordx2 v[36:37], v2, s[28:31], s70 offen sc1
    v_exp_f32 v45, v45
    v_exp_f32 v46, v46
    v_exp_f32 v47, v47
    v_fma_f32 v44, v44, v24, v24
    v_fma_f32 v45, v45, v24, v24
    v_fma_f32 v46, v46, v24, v24
    v_fma_f32 v47, v47, v24, v24
    v_rcp_f32 v44, v44
    v_rcp_f32 v45, v45
    v_rcp_f32 v46, v46
    v_rcp_f32 v47, v47
    v_mul_f32 v48, v48, v44
    v_mul_f32 v49, v49, v45
    v_mul_f32 v50, v50, v46
    v_mul_f32 v51, v51, v47
    v_cvt_pk_bf16_f32 v44, v48, v49
    v_cvt_pk_bf16_f32 v45, v50, v51
    s_add_u32 s57, s3, 2
    s_and_b32 s57, s57, 3
    s_mul_i32 s57, s57, 4096
    s_add_u32 s57, s57, s60
    buffer_store_dwordx2 v[44:45], v2, s[28:31], s57 offen sc1
    v_mul_f32 v31, v27, v31
    v_mul_f32 v32, v28, v32
    v_mul_f32 v33, v29, v33
    v_mul_f32 v26, v21, v26
    v_mul_f32 v27, v21, v27
    v_mul_f32 v28, v21, v28
    v_mul_f32 v29, v21, v29
    v_exp_f32 v26, v26
    v_exp_f32 v27, v27
    v_exp_f32 v28, v28
    v_exp_f32 v29, v29
    v_fma_f32 v26, v26, v25, v25
    v_fma_f32 v27, v27, v25, v25
    v_fma_f32 v28, v28, v25, v25
    v_fma_f32 v29, v29, v25, v25
    v_rcp_f32 v26, v26
    v_rcp_f32 v27, v27
    v_rcp_f32 v28, v28
    v_rcp_f32 v29, v29
    v_mul_f32 v30, v30, v26
    v_mul_f32 v31, v31, v27
    v_mul_f32 v32, v32, v28
    v_mul_f32 v33, v33, v29
    v_cvt_pk_bf16_f32 v26, v30, v31
    v_cvt_pk_bf16_f32 v27, v32, v33
    s_add_u32 s58, s3, 3
    s_and_b32 s58, s58, 3
    s_mul_i32 s58, s58, 4096
    s_add_u32 s58, s58, s60
    buffer_store_dwordx2 v[26:27], v2, s[28:31], s58 offen sc1
    s_lshl_b32 s58, s2, 2
    s_add_u32 s58, s58, s48
    s_add_u32 s58, s58, s0
    s_cmp_eq_u32 s0, 0
    s_cselect_b32 s13, s90, 2146435072
    s_cselect_b32 s14, s91, 2146435072
    s_add_u32 s13, s13, 3072
    s_add_u32 s14, s14, 3072
    s_mov_b32 s15, 2146435072
    v_mov_b32 v52, -1
    v_mov_b32 v53, -1
    v_mov_b32 v54, -1
    v_mov_b32 v55, -1
    s_mov_b32 s62, 6
.p2align 6
L_attn:
    v_mfma_f32_16x16x32_bf16 v[96:99], a[32:35], a[0:3], v[192:195]
    s_mul_hi_u32 s65, s58, 0xe38e38f
    v_exp_f32 v64, v64
    v_mfma_f32_16x16x32_bf16 v[96:99], a[36:39], a[4:7], v[96:99]
    s_mul_i32 s66, s65, 18
    ds_read_b64_tr_b16 a[96:97], v236 offset:16384
    ds_read_b64_tr_b16 a[98:99], v236 offset:20480
    v_mfma_f32_16x16x32_bf16 v[96:99], a[40:43], a[64:67], v[96:99]
    s_sub_u32 s66, s58, s66
    v_exp_f32 v65, v65
    v_mfma_f32_16x16x32_bf16 v[96:99], a[44:47], a[68:71], v[96:99]
    s_mul_i32 s67, s65, 36864
    ds_read_b64_tr_b16 a[100:101], v236 offset:24576
    v_cvt_pk_bf16_f32 v132, v64, v65
    v_mfma_f32_16x16x32_bf16 v[104:107], a[44:47], a[76:79], v[196:199]
    s_lshl_b32 s12, s66, 11
    v_exp_f32 v66, v66
    v_mfma_f32_16x16x32_bf16 v[104:107], a[40:43], a[72:75], v[104:107]
    s_add_u32 s12, s12, s67
    ds_read_b64_tr_b16 a[102:103], v236 offset:28672
    ds_read_b64_tr_b16 a[104:105], v237 offset:16384
    v_mfma_f32_16x16x32_bf16 v[104:107], a[36:39], a[12:15], v[104:107]
    s_add_u32 s12, s12, 41943040
    v_exp_f32 v67, v67
    v_mfma_f32_16x16x32_bf16 v[104:107], a[32:35], a[8:11], v[104:107]
    s_lshl_b32 s66, s66, 6
    ds_read_b64_tr_b16 a[106:107], v237 offset:20480
    v_cvt_pk_bf16_f32 v133, v66, v67
    v_mfma_f32_16x16x32_bf16 v[112:115], a[32:35], a[16:19], v[200:203]
    s_add_u32 s67, s67, s66
    v_exp_f32 v68, v68
    v_mfma_f32_16x16x32_bf16 v[112:115], a[36:39], a[20:23], v[112:115]
    s_sub_u32 s66, s67, 5308416
    ds_read_b64_tr_b16 a[108:109], v237 offset:24576
    ds_read_b64_tr_b16 a[110:111], v237 offset:28672
    v_mfma_f32_16x16x32_bf16 v[112:115], a[40:43], a[80:83], v[112:115]
    v_exp_f32 v69, v69
    v_mfma_f32_16x16x32_bf16 v[112:115], a[44:47], a[84:87], v[112:115]
    ds_read_b64_tr_b16 a[112:113], v238 offset:16384
    v_cvt_pk_bf16_f32 v134, v68, v69
    v_mfma_f32_16x16x32_bf16 v[120:123], a[44:47], a[92:95], v[204:207]
    v_exp_f32 v70, v70
    v_mfma_f32_16x16x32_bf16 v[120:123], a[40:43], a[88:91], v[120:123]
    ds_read_b64_tr_b16 a[114:115], v238 offset:20480
    ds_read_b64_tr_b16 a[116:117], v238 offset:24576
    v_mfma_f32_16x16x32_bf16 v[120:123], a[36:39], a[28:31], v[120:123]
    v_exp_f32 v71, v71
    v_mfma_f32_16x16x32_bf16 v[120:123], a[32:35], a[24:27], v[120:123]
    ds_read_b64_tr_b16 a[118:119], v238 offset:28672
    v_cvt_pk_bf16_f32 v135, v70, v71
    v_mfma_f32_16x16x32_bf16 v[100:103], a[48:51], a[0:3], v[192:195]
    v_exp_f32 v72, v72
    v_mfma_f32_16x16x32_bf16 v[100:103], a[52:55], a[4:7], v[100:103]
    ds_read_b64_tr_b16 a[120:121], v239 offset:16384
    ds_read_b64_tr_b16 a[122:123], v239 offset:20480
    v_mfma_f32_16x16x32_bf16 v[100:103], a[56:59], a[64:67], v[100:103]
    v_exp_f32 v73, v73
    v_mfma_f32_16x16x32_bf16 v[100:103], a[60:63], a[68:71], v[100:103]
    ds_read_b64_tr_b16 a[124:125], v239 offset:24576
    v_cvt_pk_bf16_f32 v140, v72, v73
    v_mfma_f32_16x16x32_bf16 v[108:111], a[60:63], a[76:79], v[196:199]
    v_exp_f32 v74, v74
    v_mfma_f32_16x16x32_bf16 v[108:111], a[56:59], a[72:75], v[108:111]
    s_cmp_lt_u32 s65, 144
    s_cselect_b32 s57, s67, s66
    s_cselect_b32 s8, s36, s32
    ds_read_b64_tr_b16 a[126:127], v239 offset:28672
    v_mfma_f32_16x16x32_bf16 v[108:111], a[52:55], a[12:15], v[108:111]
    v_exp_f32 v75, v75
    v_mfma_f32_16x16x32_bf16 v[108:111], a[48:51], a[8:11], v[108:111]
    s_cmp_lt_u32 s65, 144
    s_cselect_b32 s9, s37, s33
    s_cselect_b32 s10, s38, s34
    v_cvt_pk_bf16_f32 v141, v74, v75
    v_mfma_f32_16x16x32_bf16 v[116:119], a[48:51], a[16:19], v[200:203]
    v_exp_f32 v76, v76
    v_mfma_f32_16x16x32_bf16 v[116:119], a[52:55], a[20:23], v[116:119]
    s_cmp_lt_u32 s58, 4896
    s_cselect_b32 s57, s57, 2146435072
    s_cselect_b32 s12, s12, 2146435072
    v_mfma_f32_16x16x32_bf16 v[116:119], a[56:59], a[80:83], v[116:119]
    s_add_u32 s58, s58, 1024
    v_exp_f32 v77, v77
    v_mfma_f32_16x16x32_bf16 v[116:119], a[60:63], a[84:87], v[116:119]
    v_cvt_pk_bf16_f32 v142, v76, v77
    v_mfma_f32_16x16x32_bf16 v[124:127], a[60:63], a[92:95], v[204:207]
    s_waitcnt lgkmcnt(0)
    v_exp_f32 v78, v78
    v_mfma_f32_16x16x32_bf16 v[124:127], a[56:59], a[88:91], v[124:127]
    v_mfma_f32_16x16x32_bf16 v[124:127], a[52:55], a[28:31], v[124:127]
    s_waitcnt vmcnt(18)
    v_exp_f32 v79, v79
    v_mfma_f32_16x16x32_bf16 v[124:127], a[48:51], a[24:27], v[124:127]
    s_barrier
    v_cvt_pk_bf16_f32 v143, v78, v79
    v_smfmac_f32_16x16x64_bf16 v[216:219], v[224:227], v[176:183], v252
    v_exp_f32 v80, v80
    v_smfmac_f32_16x16x64_bf16 v[220:223], v[224:227], v[184:191], v252
    ds_read_b128 a[32:35], v228 offset:16384
    ds_read_b128 a[36:39], v229 offset:16384
    v_mfma_f32_16x16x32_bf16 a[144:147], a[96:99], v[160:163], a[144:147]
    s_add_u32 m0, s52, 98304
    v_exp_f32 v81, v81
    v_mfma_f32_16x16x32_bf16 a[144:147], a[100:103], v[164:167], a[144:147]
    ds_read_b128 a[40:43], v230 offset:16384
    v_cvt_pk_bf16_f32 v148, v80, v81
    v_mfma_f32_16x16x32_bf16 a[176:179], a[100:103], v[172:175], a[176:179]
    v_exp_f32 v82, v82
    v_mfma_f32_16x16x32_bf16 a[176:179], a[96:99], v[168:171], a[176:179]
    ds_read_b128 a[44:47], v231 offset:16384
    ds_read_b128 a[48:51], v228 offset:20480
    v_mfma_f32_16x16x32_bf16 a[208:211], a[96:99], v[176:179], a[208:211]
    v_exp_f32 v83, v83
    v_mfma_f32_16x16x32_bf16 a[208:211], a[100:103], v[180:183], a[208:211]
    ds_read_b128 a[52:55], v229 offset:20480
    v_cvt_pk_bf16_f32 v149, v82, v83
    v_mfma_f32_16x16x32_bf16 a[240:243], a[100:103], v[188:191], a[240:243]
    v_exp_f32 v84, v84
    v_mfma_f32_16x16x32_bf16 a[240:243], a[96:99], v[184:187], a[240:243]
    ds_read_b128 a[56:59], v230 offset:20480
    ds_read_b128 a[60:63], v231 offset:20480
    v_mfma_f32_16x16x32_bf16 a[148:151], a[104:107], v[160:163], a[148:151]
    v_exp_f32 v85, v85
    v_mfma_f32_16x16x32_bf16 a[148:151], a[108:111], v[164:167], a[148:151]
    buffer_load_dwordx4 v4, s[20:23], s16 offen offset:0 nt lds
    v_cvt_pk_bf16_f32 v150, v84, v85
    v_mfma_f32_16x16x32_bf16 a[180:183], a[108:111], v[172:175], a[180:183]
    v_exp_f32 v86, v86
    v_mfma_f32_16x16x32_bf16 a[180:183], a[104:107], v[168:171], a[180:183]
    v_mfma_f32_16x16x32_bf16 a[212:215], a[104:107], v[176:179], a[212:215]
    v_exp_f32 v87, v87
    v_mfma_f32_16x16x32_bf16 a[212:215], a[108:111], v[180:183], a[212:215]
    buffer_load_dwordx4 v5, s[20:23], s16 offen offset:1024 nt lds
    v_cvt_pk_bf16_f32 v151, v86, v87
    v_mfma_f32_16x16x32_bf16 a[244:247], a[108:111], v[188:191], a[244:247]
    v_exp_f32 v88, v88
    v_mfma_f32_16x16x32_bf16 a[244:247], a[104:107], v[184:187], a[244:247]
    v_mfma_f32_16x16x32_bf16 a[152:155], a[112:115], v[160:163], a[152:155]
    v_exp_f32 v89, v89
    v_mfma_f32_16x16x32_bf16 a[152:155], a[116:119], v[164:167], a[152:155]
    buffer_load_dwordx4 v6, s[20:23], s16 offen offset:2048 nt lds
    v_cvt_pk_bf16_f32 v156, v88, v89
    v_mfma_f32_16x16x32_bf16 a[184:187], a[116:119], v[172:175], a[184:187]
    v_exp_f32 v90, v90
    v_mfma_f32_16x16x32_bf16 a[184:187], a[112:115], v[168:171], a[184:187]
    v_mfma_f32_16x16x32_bf16 a[216:219], a[112:115], v[176:179], a[216:219]
    v_exp_f32 v91, v91
    v_mfma_f32_16x16x32_bf16 a[216:219], a[116:119], v[180:183], a[216:219]
    buffer_load_dwordx4 v7, s[20:23], s16 offen offset:3072 nt lds
    v_cvt_pk_bf16_f32 v157, v90, v91
    v_mfma_f32_16x16x32_bf16 a[248:251], a[116:119], v[188:191], a[248:251]
    s_add_u32 s16, s16, 16384
    v_exp_f32 v92, v92
    v_mfma_f32_16x16x32_bf16 a[248:251], a[112:115], v[184:187], a[248:251]
    s_and_b32 s16, s16, 0x7ffff
    s_add_u32 m0, s52, 65536
    v_mfma_f32_16x16x32_bf16 a[156:159], a[120:123], v[160:163], a[156:159]
    v_exp_f32 v93, v93
    v_mfma_f32_16x16x32_bf16 a[156:159], a[124:127], v[164:167], a[156:159]
    buffer_load_dwordx4 v14, s[8:11], s57 offen nt lds
    v_cvt_pk_bf16_f32 v158, v92, v93
    v_mfma_f32_16x16x32_bf16 a[188:191], a[124:127], v[172:175], a[188:191]
    v_exp_f32 v94, v94
    v_mfma_f32_16x16x32_bf16 a[188:191], a[120:123], v[168:171], a[188:191]
    v_mfma_f32_16x16x32_bf16 a[220:223], a[120:123], v[176:179], a[220:223]
    v_exp_f32 v95, v95
    v_mfma_f32_16x16x32_bf16 a[220:223], a[124:127], v[180:183], a[220:223]
    v_cvt_pk_bf16_f32 v159, v94, v95
    v_mfma_f32_16x16x32_bf16 a[252:255], a[124:127], v[188:191], a[252:255]
    v_mfma_f32_16x16x32_bf16 a[252:255], a[120:123], v[184:187], a[252:255]
    s_waitcnt lgkmcnt(0)
    v_mfma_f32_16x16x32_bf16 v[64:67], a[32:35], a[0:3], v[192:195]
    s_add_u32 s57, s57, 17408
    v_exp_f32 v96, v96
    v_mfma_f32_16x16x32_bf16 v[64:67], a[36:39], a[4:7], v[64:67]
    ds_read_b64_tr_b16 a[96:97], v232 offset:32768
    ds_read_b64_tr_b16 a[98:99], v232 offset:36864
    v_mfma_f32_16x16x32_bf16 v[64:67], a[40:43], a[64:67], v[64:67]
    v_exp_f32 v97, v97
    v_mfma_f32_16x16x32_bf16 v[64:67], a[44:47], a[68:71], v[64:67]
    ds_read_b64_tr_b16 a[100:101], v232 offset:40960
    v_cvt_pk_bf16_f32 v160, v96, v97
    v_mfma_f32_16x16x32_bf16 v[72:75], a[44:47], a[76:79], v[196:199]
    v_exp_f32 v98, v98
    v_mfma_f32_16x16x32_bf16 v[72:75], a[40:43], a[72:75], v[72:75]
    ds_read_b64_tr_b16 a[102:103], v232 offset:45056
    ds_read_b64_tr_b16 a[104:105], v233 offset:32768
    v_mfma_f32_16x16x32_bf16 v[72:75], a[36:39], a[12:15], v[72:75]
    v_exp_f32 v99, v99
    v_mfma_f32_16x16x32_bf16 v[72:75], a[32:35], a[8:11], v[72:75]
    ds_read_b64_tr_b16 a[106:107], v233 offset:36864
    v_cvt_pk_bf16_f32 v161, v98, v99
    v_mfma_f32_16x16x32_bf16 v[80:83], a[32:35], a[16:19], v[200:203]
    v_exp_f32 v100, v100
    v_mfma_f32_16x16x32_bf16 v[80:83], a[36:39], a[20:23], v[80:83]
    ds_read_b64_tr_b16 a[108:109], v233 offset:40960
    ds_read_b64_tr_b16 a[110:111], v233 offset:45056
    v_mfma_f32_16x16x32_bf16 v[80:83], a[40:43], a[80:83], v[80:83]
    v_exp_f32 v101, v101
    v_mfma_f32_16x16x32_bf16 v[80:83], a[44:47], a[84:87], v[80:83]
    ds_read_b64_tr_b16 a[112:113], v234 offset:32768
    v_cvt_pk_bf16_f32 v162, v100, v101
    v_mfma_f32_16x16x32_bf16 v[88:91], a[44:47], a[92:95], v[204:207]
    v_exp_f32 v102, v102
    v_mfma_f32_16x16x32_bf16 v[88:91], a[40:43], a[88:91], v[88:91]
    ds_read_b64_tr_b16 a[114:115], v234 offset:36864
    ds_read_b64_tr_b16 a[116:117], v234 offset:40960
    v_mfma_f32_16x16x32_bf16 v[88:91], a[36:39], a[28:31], v[88:91]
    v_exp_f32 v103, v103
    v_mfma_f32_16x16x32_bf16 v[88:91], a[32:35], a[24:27], v[88:91]
    ds_read_b64_tr_b16 a[118:119], v234 offset:45056
    v_cvt_pk_bf16_f32 v163, v102, v103
    v_mfma_f32_16x16x32_bf16 v[68:71], a[48:51], a[0:3], v[192:195]
    v_exp_f32 v104, v104
    v_mfma_f32_16x16x32_bf16 v[68:71], a[52:55], a[4:7], v[68:71]
    ds_read_b64_tr_b16 a[120:121], v235 offset:32768
    ds_read_b64_tr_b16 a[122:123], v235 offset:36864
    v_mfma_f32_16x16x32_bf16 v[68:71], a[56:59], a[64:67], v[68:71]
    v_exp_f32 v105, v105
    v_mfma_f32_16x16x32_bf16 v[68:71], a[60:63], a[68:71], v[68:71]
    ds_read_b64_tr_b16 a[124:125], v235 offset:40960
    v_cvt_pk_bf16_f32 v168, v104, v105
    v_mfma_f32_16x16x32_bf16 v[76:79], a[60:63], a[76:79], v[196:199]
    v_exp_f32 v106, v106
    v_mfma_f32_16x16x32_bf16 v[76:79], a[56:59], a[72:75], v[76:79]
    ds_read_b64_tr_b16 a[126:127], v235 offset:45056
    v_mfma_f32_16x16x32_bf16 v[76:79], a[52:55], a[12:15], v[76:79]
    v_exp_f32 v107, v107
    v_mfma_f32_16x16x32_bf16 v[76:79], a[48:51], a[8:11], v[76:79]
    buffer_load_dwordx4 v14, s[8:11], s57 offen offset:1024 nt lds
    v_cvt_pk_bf16_f32 v169, v106, v107
    v_mfma_f32_16x16x32_bf16 v[84:87], a[48:51], a[16:19], v[200:203]
    v_exp_f32 v108, v108
    v_mfma_f32_16x16x32_bf16 v[84:87], a[52:55], a[20:23], v[84:87]
    v_mfma_f32_16x16x32_bf16 v[84:87], a[56:59], a[80:83], v[84:87]
    v_exp_f32 v109, v109
    v_mfma_f32_16x16x32_bf16 v[84:87], a[60:63], a[84:87], v[84:87]
    v_cvt_pk_bf16_f32 v170, v108, v109
    v_mfma_f32_16x16x32_bf16 v[92:95], a[60:63], a[92:95], v[204:207]
    s_waitcnt lgkmcnt(0)
    v_exp_f32 v110, v110
    v_mfma_f32_16x16x32_bf16 v[92:95], a[56:59], a[88:91], v[92:95]
    v_mfma_f32_16x16x32_bf16 v[92:95], a[52:55], a[28:31], v[92:95]
    v_exp_f32 v111, v111
    v_mfma_f32_16x16x32_bf16 v[92:95], a[48:51], a[24:27], v[92:95]
    v_cvt_pk_bf16_f32 v171, v110, v111
    v_smfmac_f32_16x16x64_bf16 v[208:211], v[224:227], v[128:135], v252
    v_exp_f32 v112, v112
    v_smfmac_f32_16x16x64_bf16 v[212:215], v[224:227], v[136:143], v252
    ds_read_b128 a[32:35], v228 offset:24576
    ds_read_b128 a[36:39], v229 offset:24576
    v_mfma_f32_16x16x32_bf16 a[128:131], a[96:99], v[128:131], a[128:131]
    s_add_u32 m0, s52, 16384
    v_exp_f32 v113, v113
    v_mfma_f32_16x16x32_bf16 a[128:131], a[100:103], v[132:135], a[128:131]
    ds_read_b128 a[40:43], v230 offset:24576
    v_cvt_pk_bf16_f32 v176, v112, v113
    v_mfma_f32_16x16x32_bf16 a[160:163], a[100:103], v[140:143], a[160:163]
    v_exp_f32 v114, v114
    v_mfma_f32_16x16x32_bf16 a[160:163], a[96:99], v[136:139], a[160:163]
    ds_read_b128 a[44:47], v231 offset:24576
    ds_read_b128 a[48:51], v228 offset:28672
    v_mfma_f32_16x16x32_bf16 a[192:195], a[96:99], v[144:147], a[192:195]
    v_exp_f32 v115, v115
    v_mfma_f32_16x16x32_bf16 a[192:195], a[100:103], v[148:151], a[192:195]
    ds_read_b128 a[52:55], v229 offset:28672
    v_cvt_pk_bf16_f32 v177, v114, v115
    v_mfma_f32_16x16x32_bf16 a[224:227], a[100:103], v[156:159], a[224:227]
    v_exp_f32 v116, v116
    v_mfma_f32_16x16x32_bf16 a[224:227], a[96:99], v[152:155], a[224:227]
    ds_read_b128 a[56:59], v230 offset:28672
    ds_read_b128 a[60:63], v231 offset:28672
    v_mfma_f32_16x16x32_bf16 a[132:135], a[104:107], v[128:131], a[132:135]
    v_exp_f32 v117, v117
    v_mfma_f32_16x16x32_bf16 a[132:135], a[108:111], v[132:135], a[132:135]
    buffer_load_dwordx4 v8, s[24:27], s17 offen offset:0 nt lds
    v_cvt_pk_bf16_f32 v178, v116, v117
    v_mfma_f32_16x16x32_bf16 a[164:167], a[108:111], v[140:143], a[164:167]
    v_exp_f32 v118, v118
    v_mfma_f32_16x16x32_bf16 a[164:167], a[104:107], v[136:139], a[164:167]
    v_mfma_f32_16x16x32_bf16 a[196:199], a[104:107], v[144:147], a[196:199]
    v_exp_f32 v119, v119
    v_mfma_f32_16x16x32_bf16 a[196:199], a[108:111], v[148:151], a[196:199]
    v_cvt_pk_bf16_f32 v179, v118, v119
    v_mfma_f32_16x16x32_bf16 a[228:231], a[108:111], v[156:159], a[228:231]
    v_exp_f32 v120, v120
    v_mfma_f32_16x16x32_bf16 a[228:231], a[104:107], v[152:155], a[228:231]
    buffer_load_dwordx4 v9, s[24:27], s17 offen offset:1024 nt lds
    v_mfma_f32_16x16x32_bf16 a[136:139], a[112:115], v[128:131], a[136:139]
    v_exp_f32 v121, v121
    v_mfma_f32_16x16x32_bf16 a[136:139], a[116:119], v[132:135], a[136:139]
    v_cvt_pk_bf16_f32 v184, v120, v121
    v_mfma_f32_16x16x32_bf16 a[168:171], a[116:119], v[140:143], a[168:171]
    v_exp_f32 v122, v122
    v_mfma_f32_16x16x32_bf16 a[168:171], a[112:115], v[136:139], a[168:171]
    v_mfma_f32_16x16x32_bf16 a[200:203], a[112:115], v[144:147], a[200:203]
    v_exp_f32 v123, v123
    v_mfma_f32_16x16x32_bf16 a[200:203], a[116:119], v[148:151], a[200:203]
    buffer_load_dwordx4 v8, s[24:27], s17 offen offset:2048 nt lds
    v_cvt_pk_bf16_f32 v185, v122, v123
    v_mfma_f32_16x16x32_bf16 a[232:235], a[116:119], v[156:159], a[232:235]
    v_exp_f32 v124, v124
    v_mfma_f32_16x16x32_bf16 a[232:235], a[112:115], v[152:155], a[232:235]
    v_mfma_f32_16x16x32_bf16 a[140:143], a[120:123], v[128:131], a[140:143]
    v_exp_f32 v125, v125
    v_mfma_f32_16x16x32_bf16 a[140:143], a[124:127], v[132:135], a[140:143]
    v_cvt_pk_bf16_f32 v186, v124, v125
    v_mfma_f32_16x16x32_bf16 a[172:175], a[124:127], v[140:143], a[172:175]
    v_exp_f32 v126, v126
    v_mfma_f32_16x16x32_bf16 a[172:175], a[120:123], v[136:139], a[172:175]
    buffer_load_dwordx4 v9, s[24:27], s17 offen offset:3072 nt lds
    v_mfma_f32_16x16x32_bf16 a[204:207], a[120:123], v[144:147], a[204:207]
    s_add_u32 s17, s17, 16384
    v_exp_f32 v127, v127
    v_mfma_f32_16x16x32_bf16 a[204:207], a[124:127], v[148:151], a[204:207]
    s_and_b32 s17, s17, 0x7ffff
    v_cvt_pk_bf16_f32 v187, v126, v127
    v_mfma_f32_16x16x32_bf16 a[236:239], a[124:127], v[156:159], a[236:239]
    v_mfma_f32_16x16x32_bf16 a[236:239], a[120:123], v[152:155], a[236:239]
    s_waitcnt lgkmcnt(0)
    v_mfma_f32_16x16x32_bf16 v[96:99], a[32:35], a[0:3], v[192:195]
    v_exp_f32 v64, v64
    v_mfma_f32_16x16x32_bf16 v[96:99], a[36:39], a[4:7], v[96:99]
    ds_read_b64_tr_b16 a[96:97], v236 offset:32768
    ds_read_b64_tr_b16 a[98:99], v236 offset:36864
    v_mfma_f32_16x16x32_bf16 v[96:99], a[40:43], a[64:67], v[96:99]
    v_exp_f32 v65, v65
    v_mfma_f32_16x16x32_bf16 v[96:99], a[44:47], a[68:71], v[96:99]
    ds_read_b64_tr_b16 a[100:101], v236 offset:40960
    v_cvt_pk_bf16_f32 v164, v64, v65
    v_mfma_f32_16x16x32_bf16 v[104:107], a[44:47], a[76:79], v[196:199]
    v_exp_f32 v66, v66
    v_mfma_f32_16x16x32_bf16 v[104:107], a[40:43], a[72:75], v[104:107]
    ds_read_b64_tr_b16 a[102:103], v236 offset:45056
    ds_read_b64_tr_b16 a[104:105], v237 offset:32768
    v_mfma_f32_16x16x32_bf16 v[104:107], a[36:39], a[12:15], v[104:107]
    v_exp_f32 v67, v67
    v_mfma_f32_16x16x32_bf16 v[104:107], a[32:35], a[8:11], v[104:107]
    ds_read_b64_tr_b16 a[106:107], v237 offset:36864
    v_cvt_pk_bf16_f32 v165, v66, v67
    v_mfma_f32_16x16x32_bf16 v[112:115], a[32:35], a[16:19], v[200:203]
    v_exp_f32 v68, v68
    v_mfma_f32_16x16x32_bf16 v[112:115], a[36:39], a[20:23], v[112:115]
    ds_read_b64_tr_b16 a[108:109], v237 offset:40960
    ds_read_b64_tr_b16 a[110:111], v237 offset:45056
    v_mfma_f32_16x16x32_bf16 v[112:115], a[40:43], a[80:83], v[112:115]
    v_exp_f32 v69, v69
    v_mfma_f32_16x16x32_bf16 v[112:115], a[44:47], a[84:87], v[112:115]
    ds_read_b64_tr_b16 a[112:113], v238 offset:32768
    v_cvt_pk_bf16_f32 v166, v68, v69
    v_mfma_f32_16x16x32_bf16 v[120:123], a[44:47], a[92:95], v[204:207]
    v_exp_f32 v70, v70
    v_mfma_f32_16x16x32_bf16 v[120:123], a[40:43], a[88:91], v[120:123]
    ds_read_b64_tr_b16 a[114:115], v238 offset:36864
    ds_read_b64_tr_b16 a[116:117], v238 offset:40960
    v_mfma_f32_16x16x32_bf16 v[120:123], a[36:39], a[28:31], v[120:123]
    v_exp_f32 v71, v71
    v_mfma_f32_16x16x32_bf16 v[120:123], a[32:35], a[24:27], v[120:123]
    ds_read_b64_tr_b16 a[118:119], v238 offset:45056
    v_cvt_pk_bf16_f32 v167, v70, v71
    v_mfma_f32_16x16x32_bf16 v[100:103], a[48:51], a[0:3], v[192:195]
    v_exp_f32 v72, v72
    v_mfma_f32_16x16x32_bf16 v[100:103], a[52:55], a[4:7], v[100:103]
    ds_read_b64_tr_b16 a[120:121], v239 offset:32768
    ds_read_b64_tr_b16 a[122:123], v239 offset:36864
    v_mfma_f32_16x16x32_bf16 v[100:103], a[56:59], a[64:67], v[100:103]
    v_exp_f32 v73, v73
    v_mfma_f32_16x16x32_bf16 v[100:103], a[60:63], a[68:71], v[100:103]
    ds_read_b64_tr_b16 a[124:125], v239 offset:40960
    v_cvt_pk_bf16_f32 v172, v72, v73
    v_mfma_f32_16x16x32_bf16 v[108:111], a[60:63], a[76:79], v[196:199]
    v_exp_f32 v74, v74
    v_mfma_f32_16x16x32_bf16 v[108:111], a[56:59], a[72:75], v[108:111]
    ds_read_b64_tr_b16 a[126:127], v239 offset:45056
    v_mfma_f32_16x16x32_bf16 v[108:111], a[52:55], a[12:15], v[108:111]
    v_exp_f32 v75, v75
    v_mfma_f32_16x16x32_bf16 v[108:111], a[48:51], a[8:11], v[108:111]
    v_cvt_pk_bf16_f32 v173, v74, v75
    v_mfma_f32_16x16x32_bf16 v[116:119], a[48:51], a[16:19], v[200:203]
    v_exp_f32 v76, v76
    v_mfma_f32_16x16x32_bf16 v[116:119], a[52:55], a[20:23], v[116:119]
    v_mfma_f32_16x16x32_bf16 v[116:119], a[56:59], a[80:83], v[116:119]
    v_exp_f32 v77, v77
    v_mfma_f32_16x16x32_bf16 v[116:119], a[60:63], a[84:87], v[116:119]
    v_cvt_pk_bf16_f32 v174, v76, v77
    v_mfma_f32_16x16x32_bf16 v[124:127], a[60:63], a[92:95], v[204:207]
    s_waitcnt lgkmcnt(0)
    v_exp_f32 v78, v78
    v_mfma_f32_16x16x32_bf16 v[124:127], a[56:59], a[88:91], v[124:127]
    v_mfma_f32_16x16x32_bf16 v[124:127], a[52:55], a[28:31], v[124:127]
    s_waitcnt vmcnt(20)
    v_exp_f32 v79, v79
    v_mfma_f32_16x16x32_bf16 v[124:127], a[48:51], a[24:27], v[124:127]
    s_barrier
    v_cvt_pk_bf16_f32 v175, v78, v79
    v_smfmac_f32_16x16x64_bf16 v[216:219], v[224:227], v[144:151], v252
    v_exp_f32 v80, v80
    v_smfmac_f32_16x16x64_bf16 v[220:223], v[224:227], v[152:159], v252
    ds_read_b128 a[32:35], v228 offset:32768
    ds_read_b128 a[36:39], v229 offset:32768
    v_mfma_f32_16x16x32_bf16 a[144:147], a[96:99], v[128:131], a[144:147]
    s_add_u32 m0, s52, 114688
    v_exp_f32 v81, v81
    v_mfma_f32_16x16x32_bf16 a[144:147], a[100:103], v[132:135], a[144:147]
    ds_read_b128 a[40:43], v230 offset:32768
    v_cvt_pk_bf16_f32 v180, v80, v81
    v_mfma_f32_16x16x32_bf16 a[176:179], a[100:103], v[140:143], a[176:179]
    v_exp_f32 v82, v82
    v_mfma_f32_16x16x32_bf16 a[176:179], a[96:99], v[136:139], a[176:179]
    ds_read_b128 a[44:47], v231 offset:32768
    ds_read_b128 a[48:51], v228 offset:36864
    v_mfma_f32_16x16x32_bf16 a[208:211], a[96:99], v[144:147], a[208:211]
    v_exp_f32 v83, v83
    v_mfma_f32_16x16x32_bf16 a[208:211], a[100:103], v[148:151], a[208:211]
    ds_read_b128 a[52:55], v229 offset:36864
    v_cvt_pk_bf16_f32 v181, v82, v83
    v_mfma_f32_16x16x32_bf16 a[240:243], a[100:103], v[156:159], a[240:243]
    v_exp_f32 v84, v84
    v_mfma_f32_16x16x32_bf16 a[240:243], a[96:99], v[152:155], a[240:243]
    ds_read_b128 a[56:59], v230 offset:36864
    ds_read_b128 a[60:63], v231 offset:36864
    v_mfma_f32_16x16x32_bf16 a[148:151], a[104:107], v[128:131], a[148:151]
    v_exp_f32 v85, v85
    v_mfma_f32_16x16x32_bf16 a[148:151], a[108:111], v[132:135], a[148:151]
    buffer_load_dwordx4 v4, s[20:23], s16 offen offset:0 nt lds
    v_cvt_pk_bf16_f32 v182, v84, v85
    v_mfma_f32_16x16x32_bf16 a[180:183], a[108:111], v[140:143], a[180:183]
    v_exp_f32 v86, v86
    v_mfma_f32_16x16x32_bf16 a[180:183], a[104:107], v[136:139], a[180:183]
    v_mfma_f32_16x16x32_bf16 a[212:215], a[104:107], v[144:147], a[212:215]
    v_exp_f32 v87, v87
    v_mfma_f32_16x16x32_bf16 a[212:215], a[108:111], v[148:151], a[212:215]
    v_cvt_pk_bf16_f32 v183, v86, v87
    v_mfma_f32_16x16x32_bf16 a[244:247], a[108:111], v[156:159], a[244:247]
    v_exp_f32 v88, v88
    v_mfma_f32_16x16x32_bf16 a[244:247], a[104:107], v[152:155], a[244:247]
    buffer_load_dwordx4 v5, s[20:23], s16 offen offset:1024 nt lds
    v_mfma_f32_16x16x32_bf16 a[152:155], a[112:115], v[128:131], a[152:155]
    v_exp_f32 v89, v89
    v_mfma_f32_16x16x32_bf16 a[152:155], a[116:119], v[132:135], a[152:155]
    v_cvt_pk_bf16_f32 v188, v88, v89
    v_mfma_f32_16x16x32_bf16 a[184:187], a[116:119], v[140:143], a[184:187]
    v_exp_f32 v90, v90
    v_mfma_f32_16x16x32_bf16 a[184:187], a[112:115], v[136:139], a[184:187]
    v_mfma_f32_16x16x32_bf16 a[216:219], a[112:115], v[144:147], a[216:219]
    v_exp_f32 v91, v91
    v_mfma_f32_16x16x32_bf16 a[216:219], a[116:119], v[148:151], a[216:219]
    buffer_load_dwordx4 v6, s[20:23], s16 offen offset:2048 nt lds
    v_cvt_pk_bf16_f32 v189, v90, v91
    v_mfma_f32_16x16x32_bf16 a[248:251], a[116:119], v[156:159], a[248:251]
    v_exp_f32 v92, v92
    v_mfma_f32_16x16x32_bf16 a[248:251], a[112:115], v[152:155], a[248:251]
    v_mfma_f32_16x16x32_bf16 a[156:159], a[120:123], v[128:131], a[156:159]
    v_exp_f32 v93, v93
    v_mfma_f32_16x16x32_bf16 a[156:159], a[124:127], v[132:135], a[156:159]
    v_cvt_pk_bf16_f32 v190, v92, v93
    v_mfma_f32_16x16x32_bf16 a[188:191], a[124:127], v[140:143], a[188:191]
    v_exp_f32 v94, v94
    v_mfma_f32_16x16x32_bf16 a[188:191], a[120:123], v[136:139], a[188:191]
    buffer_load_dwordx4 v7, s[20:23], s16 offen offset:3072 nt lds
    v_mfma_f32_16x16x32_bf16 a[220:223], a[120:123], v[144:147], a[220:223]
    s_add_u32 s16, s16, 16384
    v_exp_f32 v95, v95
    v_mfma_f32_16x16x32_bf16 a[220:223], a[124:127], v[148:151], a[220:223]
    s_and_b32 s16, s16, 0x7ffff
    v_cvt_pk_bf16_f32 v191, v94, v95
    v_mfma_f32_16x16x32_bf16 a[252:255], a[124:127], v[156:159], a[252:255]
    v_mfma_f32_16x16x32_bf16 a[252:255], a[120:123], v[152:155], a[252:255]
    s_waitcnt lgkmcnt(0)
    v_mfma_f32_16x16x32_bf16 v[64:67], a[32:35], a[0:3], v[192:195]
    v_exp_f32 v96, v96
    v_mfma_f32_16x16x32_bf16 v[64:67], a[36:39], a[4:7], v[64:67]
    ds_read_b64_tr_b16 a[96:97], v232 offset:49152
    ds_read_b64_tr_b16 a[98:99], v232 offset:53248
    v_mfma_f32_16x16x32_bf16 v[64:67], a[40:43], a[64:67], v[64:67]
    v_exp_f32 v97, v97
    v_mfma_f32_16x16x32_bf16 v[64:67], a[44:47], a[68:71], v[64:67]
    ds_read_b64_tr_b16 a[100:101], v232 offset:57344
    v_cvt_pk_bf16_f32 v128, v96, v97
    v_mfma_f32_16x16x32_bf16 v[72:75], a[44:47], a[76:79], v[196:199]
    v_exp_f32 v98, v98
    v_mfma_f32_16x16x32_bf16 v[72:75], a[40:43], a[72:75], v[72:75]
    ds_read_b64_tr_b16 a[102:103], v232 offset:61440
    ds_read_b64_tr_b16 a[104:105], v233 offset:49152
    v_mfma_f32_16x16x32_bf16 v[72:75], a[36:39], a[12:15], v[72:75]
    v_exp_f32 v99, v99
    v_mfma_f32_16x16x32_bf16 v[72:75], a[32:35], a[8:11], v[72:75]
    ds_read_b64_tr_b16 a[106:107], v233 offset:53248
    v_cvt_pk_bf16_f32 v129, v98, v99
    v_mfma_f32_16x16x32_bf16 v[80:83], a[32:35], a[16:19], v[200:203]
    v_exp_f32 v100, v100
    v_mfma_f32_16x16x32_bf16 v[80:83], a[36:39], a[20:23], v[80:83]
    ds_read_b64_tr_b16 a[108:109], v233 offset:57344
    ds_read_b64_tr_b16 a[110:111], v233 offset:61440
    v_mfma_f32_16x16x32_bf16 v[80:83], a[40:43], a[80:83], v[80:83]
    v_exp_f32 v101, v101
    v_mfma_f32_16x16x32_bf16 v[80:83], a[44:47], a[84:87], v[80:83]
    ds_read_b64_tr_b16 a[112:113], v234 offset:49152
    v_cvt_pk_bf16_f32 v130, v100, v101
    v_mfma_f32_16x16x32_bf16 v[88:91], a[44:47], a[92:95], v[204:207]
    v_exp_f32 v102, v102
    v_mfma_f32_16x16x32_bf16 v[88:91], a[40:43], a[88:91], v[88:91]
    ds_read_b64_tr_b16 a[114:115], v234 offset:53248
    ds_read_b64_tr_b16 a[116:117], v234 offset:57344
    v_mfma_f32_16x16x32_bf16 v[88:91], a[36:39], a[28:31], v[88:91]
    v_exp_f32 v103, v103
    v_mfma_f32_16x16x32_bf16 v[88:91], a[32:35], a[24:27], v[88:91]
    ds_read_b64_tr_b16 a[118:119], v234 offset:61440
    v_cvt_pk_bf16_f32 v131, v102, v103
    v_mfma_f32_16x16x32_bf16 v[68:71], a[48:51], a[0:3], v[192:195]
    v_exp_f32 v104, v104
    v_mfma_f32_16x16x32_bf16 v[68:71], a[52:55], a[4:7], v[68:71]
    ds_read_b64_tr_b16 a[120:121], v235 offset:49152
    ds_read_b64_tr_b16 a[122:123], v235 offset:53248
    v_mfma_f32_16x16x32_bf16 v[68:71], a[56:59], a[64:67], v[68:71]
    v_exp_f32 v105, v105
    v_mfma_f32_16x16x32_bf16 v[68:71], a[60:63], a[68:71], v[68:71]
    ds_read_b64_tr_b16 a[124:125], v235 offset:57344
    v_cvt_pk_bf16_f32 v136, v104, v105
    v_mfma_f32_16x16x32_bf16 v[76:79], a[60:63], a[76:79], v[196:199]
    v_exp_f32 v106, v106
    v_mfma_f32_16x16x32_bf16 v[76:79], a[56:59], a[72:75], v[76:79]
    ds_read_b64_tr_b16 a[126:127], v235 offset:61440
    v_mfma_f32_16x16x32_bf16 v[76:79], a[52:55], a[12:15], v[76:79]
    v_exp_f32 v107, v107
    v_mfma_f32_16x16x32_bf16 v[76:79], a[48:51], a[8:11], v[76:79]
    buffer_store_dwordx4 v[52:55], v2, s[28:31], s13 offen offset:0 sc1
    v_cvt_pk_bf16_f32 v137, v106, v107
    v_mfma_f32_16x16x32_bf16 v[84:87], a[48:51], a[16:19], v[200:203]
    v_exp_f32 v108, v108
    v_mfma_f32_16x16x32_bf16 v[84:87], a[52:55], a[20:23], v[84:87]
    v_mfma_f32_16x16x32_bf16 v[84:87], a[56:59], a[80:83], v[84:87]
    v_exp_f32 v109, v109
    v_mfma_f32_16x16x32_bf16 v[84:87], a[60:63], a[84:87], v[84:87]
    v_cvt_pk_bf16_f32 v138, v108, v109
    v_mfma_f32_16x16x32_bf16 v[92:95], a[60:63], a[92:95], v[204:207]
    s_waitcnt lgkmcnt(0)
    v_exp_f32 v110, v110
    v_mfma_f32_16x16x32_bf16 v[92:95], a[56:59], a[88:91], v[92:95]
    v_mfma_f32_16x16x32_bf16 v[92:95], a[52:55], a[28:31], v[92:95]
    v_exp_f32 v111, v111
    v_mfma_f32_16x16x32_bf16 v[92:95], a[48:51], a[24:27], v[92:95]
    v_cvt_pk_bf16_f32 v139, v110, v111
    v_smfmac_f32_16x16x64_bf16 v[208:211], v[224:227], v[160:167], v252
    v_exp_f32 v112, v112
    v_smfmac_f32_16x16x64_bf16 v[212:215], v[224:227], v[168:175], v252
    ds_read_b128 a[32:35], v228 offset:40960
    ds_read_b128 a[36:39], v229 offset:40960
    v_mfma_f32_16x16x32_bf16 a[128:131], a[96:99], v[160:163], a[128:131]
    s_add_u32 m0, s52, 32768
    v_exp_f32 v113, v113
    v_mfma_f32_16x16x32_bf16 a[128:131], a[100:103], v[164:167], a[128:131]
    ds_read_b128 a[40:43], v230 offset:40960
    v_cvt_pk_bf16_f32 v144, v112, v113
    v_mfma_f32_16x16x32_bf16 a[160:163], a[100:103], v[172:175], a[160:163]
    v_exp_f32 v114, v114
    v_mfma_f32_16x16x32_bf16 a[160:163], a[96:99], v[168:171], a[160:163]
    ds_read_b128 a[44:47], v231 offset:40960
    ds_read_b128 a[48:51], v228 offset:45056
    v_mfma_f32_16x16x32_bf16 a[192:195], a[96:99], v[176:179], a[192:195]
    v_exp_f32 v115, v115
    v_mfma_f32_16x16x32_bf16 a[192:195], a[100:103], v[180:183], a[192:195]
    ds_read_b128 a[52:55], v229 offset:45056
    v_cvt_pk_bf16_f32 v145, v114, v115
    v_mfma_f32_16x16x32_bf16 a[224:227], a[100:103], v[188:191], a[224:227]
    v_exp_f32 v116, v116
    v_mfma_f32_16x16x32_bf16 a[224:227], a[96:99], v[184:187], a[224:227]
    ds_read_b128 a[56:59], v230 offset:45056
    ds_read_b128 a[60:63], v231 offset:45056
    v_mfma_f32_16x16x32_bf16 a[132:135], a[104:107], v[160:163], a[132:135]
    v_exp_f32 v117, v117
    v_mfma_f32_16x16x32_bf16 a[132:135], a[108:111], v[164:167], a[132:135]
    buffer_load_dwordx4 v8, s[24:27], s17 offen offset:0 nt lds
    v_cvt_pk_bf16_f32 v146, v116, v117
    v_mfma_f32_16x16x32_bf16 a[164:167], a[108:111], v[172:175], a[164:167]
    v_exp_f32 v118, v118
    v_mfma_f32_16x16x32_bf16 a[164:167], a[104:107], v[168:171], a[164:167]
    buffer_store_dwordx4 v[52:55], v2, s[28:31], s13 offen offset:1024 sc1
    v_mfma_f32_16x16x32_bf16 a[196:199], a[104:107], v[176:179], a[196:199]
    v_exp_f32 v119, v119
    v_mfma_f32_16x16x32_bf16 a[196:199], a[108:111], v[180:183], a[196:199]
    v_cvt_pk_bf16_f32 v147, v118, v119
    v_mfma_f32_16x16x32_bf16 a[228:231], a[108:111], v[188:191], a[228:231]
    v_exp_f32 v120, v120
    v_mfma_f32_16x16x32_bf16 a[228:231], a[104:107], v[184:187], a[228:231]
    buffer_load_dwordx4 v9, s[24:27], s17 offen offset:1024 nt lds
    v_mfma_f32_16x16x32_bf16 a[136:139], a[112:115], v[160:163], a[136:139]
    v_exp_f32 v121, v121
    v_mfma_f32_16x16x32_bf16 a[136:139], a[116:119], v[164:167], a[136:139]
    v_cvt_pk_bf16_f32 v152, v120, v121
    v_mfma_f32_16x16x32_bf16 a[168:171], a[116:119], v[172:175], a[168:171]
    v_exp_f32 v122, v122
    v_mfma_f32_16x16x32_bf16 a[168:171], a[112:115], v[168:171], a[168:171]
    v_mfma_f32_16x16x32_bf16 a[200:203], a[112:115], v[176:179], a[200:203]
    v_exp_f32 v123, v123
    v_mfma_f32_16x16x32_bf16 a[200:203], a[116:119], v[180:183], a[200:203]
    buffer_load_dwordx4 v8, s[24:27], s17 offen offset:2048 nt lds
    v_cvt_pk_bf16_f32 v153, v122, v123
    v_mfma_f32_16x16x32_bf16 a[232:235], a[116:119], v[188:191], a[232:235]
    v_exp_f32 v124, v124
    v_mfma_f32_16x16x32_bf16 a[232:235], a[112:115], v[184:187], a[232:235]
    buffer_store_dwordx4 v[52:55], v2, s[28:31], s14 offen sc1
    v_mfma_f32_16x16x32_bf16 a[140:143], a[120:123], v[160:163], a[140:143]
    v_exp_f32 v125, v125
    v_mfma_f32_16x16x32_bf16 a[140:143], a[124:127], v[164:167], a[140:143]
    v_cvt_pk_bf16_f32 v154, v124, v125
    v_mfma_f32_16x16x32_bf16 a[172:175], a[124:127], v[172:175], a[172:175]
    v_exp_f32 v126, v126
    v_mfma_f32_16x16x32_bf16 a[172:175], a[120:123], v[168:171], a[172:175]
    buffer_load_dwordx4 v9, s[24:27], s17 offen offset:3072 nt lds
    v_mfma_f32_16x16x32_bf16 a[204:207], a[120:123], v[176:179], a[204:207]
    s_add_u32 s17, s17, 16384
    v_exp_f32 v127, v127
    v_mfma_f32_16x16x32_bf16 a[204:207], a[124:127], v[180:183], a[204:207]
    s_and_b32 s17, s17, 0x7ffff
    v_cvt_pk_bf16_f32 v155, v126, v127
    v_mfma_f32_16x16x32_bf16 a[236:239], a[124:127], v[188:191], a[236:239]
    v_mfma_f32_16x16x32_bf16 a[236:239], a[120:123], v[184:187], a[236:239]
    s_waitcnt lgkmcnt(0)
    v_mfma_f32_16x16x32_bf16 v[96:99], a[32:35], a[0:3], v[192:195]
    s_add_u32 s13, s13, 6144
    v_exp_f32 v64, v64
    v_mfma_f32_16x16x32_bf16 v[96:99], a[36:39], a[4:7], v[96:99]
    s_add_u32 s14, s14, 6144
    ds_read_b64_tr_b16 a[96:97], v236 offset:49152
    ds_read_b64_tr_b16 a[98:99], v236 offset:53248
    v_mfma_f32_16x16x32_bf16 v[96:99], a[40:43], a[64:67], v[96:99]
    v_exp_f32 v65, v65
    v_mfma_f32_16x16x32_bf16 v[96:99], a[44:47], a[68:71], v[96:99]
    ds_read_b64_tr_b16 a[100:101], v236 offset:57344
    v_cvt_pk_bf16_f32 v132, v64, v65
    v_mfma_f32_16x16x32_bf16 v[104:107], a[44:47], a[76:79], v[196:199]
    v_exp_f32 v66, v66
    v_mfma_f32_16x16x32_bf16 v[104:107], a[40:43], a[72:75], v[104:107]
    ds_read_b64_tr_b16 a[102:103], v236 offset:61440
    ds_read_b64_tr_b16 a[104:105], v237 offset:49152
    v_mfma_f32_16x16x32_bf16 v[104:107], a[36:39], a[12:15], v[104:107]
    v_exp_f32 v67, v67
    v_mfma_f32_16x16x32_bf16 v[104:107], a[32:35], a[8:11], v[104:107]
    ds_read_b64_tr_b16 a[106:107], v237 offset:53248
    v_cvt_pk_bf16_f32 v133, v66, v67
    v_mfma_f32_16x16x32_bf16 v[112:115], a[32:35], a[16:19], v[200:203]
    v_exp_f32 v68, v68
    v_mfma_f32_16x16x32_bf16 v[112:115], a[36:39], a[20:23], v[112:115]
    ds_read_b64_tr_b16 a[108:109], v237 offset:57344
    ds_read_b64_tr_b16 a[110:111], v237 offset:61440
    v_mfma_f32_16x16x32_bf16 v[112:115], a[40:43], a[80:83], v[112:115]
    v_exp_f32 v69, v69
    v_mfma_f32_16x16x32_bf16 v[112:115], a[44:47], a[84:87], v[112:115]
    ds_read_b64_tr_b16 a[112:113], v238 offset:49152
    v_cvt_pk_bf16_f32 v134, v68, v69
    v_mfma_f32_16x16x32_bf16 v[120:123], a[44:47], a[92:95], v[204:207]
    v_exp_f32 v70, v70
    v_mfma_f32_16x16x32_bf16 v[120:123], a[40:43], a[88:91], v[120:123]
    ds_read_b64_tr_b16 a[114:115], v238 offset:53248
    ds_read_b64_tr_b16 a[116:117], v238 offset:57344
    v_mfma_f32_16x16x32_bf16 v[120:123], a[36:39], a[28:31], v[120:123]
    v_exp_f32 v71, v71
    v_mfma_f32_16x16x32_bf16 v[120:123], a[32:35], a[24:27], v[120:123]
    ds_read_b64_tr_b16 a[118:119], v238 offset:61440
    v_cvt_pk_bf16_f32 v135, v70, v71
    v_mfma_f32_16x16x32_bf16 v[100:103], a[48:51], a[0:3], v[192:195]
    v_exp_f32 v72, v72
    v_mfma_f32_16x16x32_bf16 v[100:103], a[52:55], a[4:7], v[100:103]
    ds_read_b64_tr_b16 a[120:121], v239 offset:49152
    ds_read_b64_tr_b16 a[122:123], v239 offset:53248
    v_mfma_f32_16x16x32_bf16 v[100:103], a[56:59], a[64:67], v[100:103]
    v_exp_f32 v73, v73
    v_mfma_f32_16x16x32_bf16 v[100:103], a[60:63], a[68:71], v[100:103]
    ds_read_b64_tr_b16 a[124:125], v239 offset:57344
    v_cvt_pk_bf16_f32 v140, v72, v73
    v_mfma_f32_16x16x32_bf16 v[108:111], a[60:63], a[76:79], v[196:199]
    v_exp_f32 v74, v74
    v_mfma_f32_16x16x32_bf16 v[108:111], a[56:59], a[72:75], v[108:111]
    s_cmp_gt_u32 s62, 4
    s_cselect_b32 s13, s13, 2146435072
    s_cselect_b32 s14, s14, 2146435072
    ds_read_b64_tr_b16 a[126:127], v239 offset:61440
    v_mfma_f32_16x16x32_bf16 v[108:111], a[52:55], a[12:15], v[108:111]
    v_exp_f32 v75, v75
    v_mfma_f32_16x16x32_bf16 v[108:111], a[48:51], a[8:11], v[108:111]
    v_cvt_pk_bf16_f32 v141, v74, v75
    v_mfma_f32_16x16x32_bf16 v[116:119], a[48:51], a[16:19], v[200:203]
    v_exp_f32 v76, v76
    v_mfma_f32_16x16x32_bf16 v[116:119], a[52:55], a[20:23], v[116:119]
    v_mfma_f32_16x16x32_bf16 v[116:119], a[56:59], a[80:83], v[116:119]
    v_exp_f32 v77, v77
    v_mfma_f32_16x16x32_bf16 v[116:119], a[60:63], a[84:87], v[116:119]
    v_cvt_pk_bf16_f32 v142, v76, v77
    v_mfma_f32_16x16x32_bf16 v[124:127], a[60:63], a[92:95], v[204:207]
    s_waitcnt lgkmcnt(0)
    v_exp_f32 v78, v78
    v_mfma_f32_16x16x32_bf16 v[124:127], a[56:59], a[88:91], v[124:127]
    v_mfma_f32_16x16x32_bf16 v[124:127], a[52:55], a[28:31], v[124:127]
    s_waitcnt vmcnt(21)
    v_exp_f32 v79, v79
    v_mfma_f32_16x16x32_bf16 v[124:127], a[48:51], a[24:27], v[124:127]
    s_barrier
    v_cvt_pk_bf16_f32 v143, v78, v79
    v_smfmac_f32_16x16x64_bf16 v[216:219], v[224:227], v[176:183], v252
    v_exp_f32 v80, v80
    v_smfmac_f32_16x16x64_bf16 v[220:223], v[224:227], v[184:191], v252
    ds_read_b128 a[32:35], v228 offset:49152
    ds_read_b128 a[36:39], v229 offset:49152
    v_mfma_f32_16x16x32_bf16 a[144:147], a[96:99], v[160:163], a[144:147]
    s_add_u32 m0, s52, 131072
    v_exp_f32 v81, v81
    v_mfma_f32_16x16x32_bf16 a[144:147], a[100:103], v[164:167], a[144:147]
    ds_read_b128 a[40:43], v230 offset:49152
    v_cvt_pk_bf16_f32 v148, v80, v81
    v_mfma_f32_16x16x32_bf16 a[176:179], a[100:103], v[172:175], a[176:179]
    v_exp_f32 v82, v82
    v_mfma_f32_16x16x32_bf16 a[176:179], a[96:99], v[168:171], a[176:179]
    ds_read_b128 a[44:47], v231 offset:49152
    ds_read_b128 a[48:51], v228 offset:53248
    v_mfma_f32_16x16x32_bf16 a[208:211], a[96:99], v[176:179], a[208:211]
    v_exp_f32 v83, v83
    v_mfma_f32_16x16x32_bf16 a[208:211], a[100:103], v[180:183], a[208:211]
    ds_read_b128 a[52:55], v229 offset:53248
    v_cvt_pk_bf16_f32 v149, v82, v83
    v_mfma_f32_16x16x32_bf16 a[240:243], a[100:103], v[188:191], a[240:243]
    s_cmp_lg_u32 s62, s101
    s_cbranch_scc1 L_sig_all
    s_cmp_lg_u32 s48, 0
    s_cbranch_scc1 L_sig_all
    s_mov_b64 exec, 1
    v_mov_b32 v60, 1
    buffer_atomic_add v60, off, s[44:47], 0 offset:192
    s_mov_b64 exec, -1
L_sig_all:
    v_exp_f32 v84, v84
    v_mfma_f32_16x16x32_bf16 a[240:243], a[96:99], v[184:187], a[240:243]
    ds_read_b128 a[56:59], v230 offset:53248
    ds_read_b128 a[60:63], v231 offset:53248
    v_mfma_f32_16x16x32_bf16 a[148:151], a[104:107], v[160:163], a[148:151]
    v_exp_f32 v85, v85
    v_mfma_f32_16x16x32_bf16 a[148:151], a[108:111], v[164:167], a[148:151]
    buffer_load_dwordx4 v4, s[20:23], s16 offen offset:0 nt lds
    v_cvt_pk_bf16_f32 v150, v84, v85
    v_mfma_f32_16x16x32_bf16 a[180:183], a[108:111], v[172:175], a[180:183]
    v_exp_f32 v86, v86
    v_mfma_f32_16x16x32_bf16 a[180:183], a[104:107], v[168:171], a[180:183]
    v_mfma_f32_16x16x32_bf16 a[212:215], a[104:107], v[176:179], a[212:215]
    v_exp_f32 v87, v87
    v_mfma_f32_16x16x32_bf16 a[212:215], a[108:111], v[180:183], a[212:215]
    v_cvt_pk_bf16_f32 v151, v86, v87
    v_mfma_f32_16x16x32_bf16 a[244:247], a[108:111], v[188:191], a[244:247]
    v_exp_f32 v88, v88
    v_mfma_f32_16x16x32_bf16 a[244:247], a[104:107], v[184:187], a[244:247]
    buffer_load_dwordx4 v5, s[20:23], s16 offen offset:1024 nt lds
    v_mfma_f32_16x16x32_bf16 a[152:155], a[112:115], v[160:163], a[152:155]
    v_exp_f32 v89, v89
    v_mfma_f32_16x16x32_bf16 a[152:155], a[116:119], v[164:167], a[152:155]
    v_cvt_pk_bf16_f32 v156, v88, v89
    v_mfma_f32_16x16x32_bf16 a[184:187], a[116:119], v[172:175], a[184:187]
    v_exp_f32 v90, v90
    v_mfma_f32_16x16x32_bf16 a[184:187], a[112:115], v[168:171], a[184:187]
    v_mfma_f32_16x16x32_bf16 a[216:219], a[112:115], v[176:179], a[216:219]
    v_exp_f32 v91, v91
    v_mfma_f32_16x16x32_bf16 a[216:219], a[116:119], v[180:183], a[216:219]
    buffer_load_dwordx4 v6, s[20:23], s16 offen offset:2048 nt lds
    v_cvt_pk_bf16_f32 v157, v90, v91
    v_mfma_f32_16x16x32_bf16 a[248:251], a[116:119], v[188:191], a[248:251]
    v_exp_f32 v92, v92
    v_mfma_f32_16x16x32_bf16 a[248:251], a[112:115], v[184:187], a[248:251]
    v_mfma_f32_16x16x32_bf16 a[156:159], a[120:123], v[160:163], a[156:159]
    v_exp_f32 v93, v93
    v_mfma_f32_16x16x32_bf16 a[156:159], a[124:127], v[164:167], a[156:159]
    v_cvt_pk_bf16_f32 v158, v92, v93
    v_mfma_f32_16x16x32_bf16 a[188:191], a[124:127], v[172:175], a[188:191]
    v_exp_f32 v94, v94
    v_mfma_f32_16x16x32_bf16 a[188:191], a[120:123], v[168:171], a[188:191]
    buffer_load_dwordx4 v7, s[20:23], s16 offen offset:3072 nt lds
    v_mfma_f32_16x16x32_bf16 a[220:223], a[120:123], v[176:179], a[220:223]
    s_add_u32 s16, s16, 16384
    v_exp_f32 v95, v95
    v_mfma_f32_16x16x32_bf16 a[220:223], a[124:127], v[180:183], a[220:223]
    s_and_b32 s16, s16, 0x7ffff
    v_cvt_pk_bf16_f32 v159, v94, v95
    v_mfma_f32_16x16x32_bf16 a[252:255], a[124:127], v[188:191], a[252:255]
    v_mfma_f32_16x16x32_bf16 a[252:255], a[120:123], v[184:187], a[252:255]
    s_waitcnt lgkmcnt(0)
    v_mfma_f32_16x16x32_bf16 v[64:67], a[32:35], a[0:3], v[192:195]
    v_exp_f32 v96, v96
    v_mfma_f32_16x16x32_bf16 v[64:67], a[36:39], a[4:7], v[64:67]
    ds_read_b64_tr_b16 a[96:97], v232 offset:0
    ds_read_b64_tr_b16 a[98:99], v232 offset:4096
    v_mfma_f32_16x16x32_bf16 v[64:67], a[40:43], a[64:67], v[64:67]
    v_exp_f32 v97, v97
    v_mfma_f32_16x16x32_bf16 v[64:67], a[44:47], a[68:71], v[64:67]
    ds_read_b64_tr_b16 a[100:101], v232 offset:8192
    v_cvt_pk_bf16_f32 v160, v96, v97
    v_mfma_f32_16x16x32_bf16 v[72:75], a[44:47], a[76:79], v[196:199]
    v_exp_f32 v98, v98
    v_mfma_f32_16x16x32_bf16 v[72:75], a[40:43], a[72:75], v[72:75]
    ds_read_b64_tr_b16 a[102:103], v232 offset:12288
    ds_read_b64_tr_b16 a[104:105], v233 offset:0
    v_mfma_f32_16x16x32_bf16 v[72:75], a[36:39], a[12:15], v[72:75]
    v_exp_f32 v99, v99
    v_mfma_f32_16x16x32_bf16 v[72:75], a[32:35], a[8:11], v[72:75]
    ds_read_b64_tr_b16 a[106:107], v233 offset:4096
    v_cvt_pk_bf16_f32 v161, v98, v99
    v_mfma_f32_16x16x32_bf16 v[80:83], a[32:35], a[16:19], v[200:203]
    v_exp_f32 v100, v100
    v_mfma_f32_16x16x32_bf16 v[80:83], a[36:39], a[20:23], v[80:83]
    ds_read_b64_tr_b16 a[108:109], v233 offset:8192
    ds_read_b64_tr_b16 a[110:111], v233 offset:12288
    v_mfma_f32_16x16x32_bf16 v[80:83], a[40:43], a[80:83], v[80:83]
    v_exp_f32 v101, v101
    v_mfma_f32_16x16x32_bf16 v[80:83], a[44:47], a[84:87], v[80:83]
    ds_read_b64_tr_b16 a[112:113], v234 offset:0
    v_cvt_pk_bf16_f32 v162, v100, v101
    v_mfma_f32_16x16x32_bf16 v[88:91], a[44:47], a[92:95], v[204:207]
    v_exp_f32 v102, v102
    v_mfma_f32_16x16x32_bf16 v[88:91], a[40:43], a[88:91], v[88:91]
    ds_read_b64_tr_b16 a[114:115], v234 offset:4096
    ds_read_b64_tr_b16 a[116:117], v234 offset:8192
    v_mfma_f32_16x16x32_bf16 v[88:91], a[36:39], a[28:31], v[88:91]
    v_exp_f32 v103, v103
    v_mfma_f32_16x16x32_bf16 v[88:91], a[32:35], a[24:27], v[88:91]
    ds_read_b64_tr_b16 a[118:119], v234 offset:12288
    v_cvt_pk_bf16_f32 v163, v102, v103
    v_mfma_f32_16x16x32_bf16 v[68:71], a[48:51], a[0:3], v[192:195]
    v_exp_f32 v104, v104
    v_mfma_f32_16x16x32_bf16 v[68:71], a[52:55], a[4:7], v[68:71]
    ds_read_b64_tr_b16 a[120:121], v235 offset:0
    ds_read_b64_tr_b16 a[122:123], v235 offset:4096
    v_mfma_f32_16x16x32_bf16 v[68:71], a[56:59], a[64:67], v[68:71]
    v_exp_f32 v105, v105
    v_mfma_f32_16x16x32_bf16 v[68:71], a[60:63], a[68:71], v[68:71]
    ds_read_b64_tr_b16 a[124:125], v235 offset:8192
    v_cvt_pk_bf16_f32 v168, v104, v105
    v_mfma_f32_16x16x32_bf16 v[76:79], a[60:63], a[76:79], v[196:199]
    v_exp_f32 v106, v106
    v_mfma_f32_16x16x32_bf16 v[76:79], a[56:59], a[72:75], v[76:79]
    ds_read_b64_tr_b16 a[126:127], v235 offset:12288
    v_mfma_f32_16x16x32_bf16 v[76:79], a[52:55], a[12:15], v[76:79]
    v_exp_f32 v107, v107
    v_mfma_f32_16x16x32_bf16 v[76:79], a[48:51], a[8:11], v[76:79]
    v_cvt_pk_bf16_f32 v169, v106, v107
    v_mfma_f32_16x16x32_bf16 v[84:87], a[48:51], a[16:19], v[200:203]
    v_exp_f32 v108, v108
    v_mfma_f32_16x16x32_bf16 v[84:87], a[52:55], a[20:23], v[84:87]
    v_mfma_f32_16x16x32_bf16 v[84:87], a[56:59], a[80:83], v[84:87]
    v_exp_f32 v109, v109
    v_mfma_f32_16x16x32_bf16 v[84:87], a[60:63], a[84:87], v[84:87]
    v_cvt_pk_bf16_f32 v170, v108, v109
    v_mfma_f32_16x16x32_bf16 v[92:95], a[60:63], a[92:95], v[204:207]
    s_waitcnt lgkmcnt(0)
    v_exp_f32 v110, v110
    v_mfma_f32_16x16x32_bf16 v[92:95], a[56:59], a[88:91], v[92:95]
    v_mfma_f32_16x16x32_bf16 v[92:95], a[52:55], a[28:31], v[92:95]
    v_exp_f32 v111, v111
    v_mfma_f32_16x16x32_bf16 v[92:95], a[48:51], a[24:27], v[92:95]
    v_cvt_pk_bf16_f32 v171, v110, v111
    v_smfmac_f32_16x16x64_bf16 v[208:211], v[224:227], v[128:135], v252
    v_exp_f32 v112, v112
    v_smfmac_f32_16x16x64_bf16 v[212:215], v[224:227], v[136:143], v252
    s_waitcnt vmcnt(19)
    ds_read_b128 a[32:35], v228 offset:57344
    ds_read_b128 a[36:39], v229 offset:57344
    v_mfma_f32_16x16x32_bf16 a[128:131], a[96:99], v[128:131], a[128:131]
    s_add_u32 m0, s52, 49152
    v_exp_f32 v113, v113
    v_mfma_f32_16x16x32_bf16 a[128:131], a[100:103], v[132:135], a[128:131]
    ds_read_b128 a[40:43], v230 offset:57344
    v_cvt_pk_bf16_f32 v176, v112, v113
    v_mfma_f32_16x16x32_bf16 a[160:163], a[100:103], v[140:143], a[160:163]
    v_exp_f32 v114, v114
    v_mfma_f32_16x16x32_bf16 a[160:163], a[96:99], v[136:139], a[160:163]
    ds_read_b128 a[44:47], v231 offset:57344
    ds_read_b128 a[48:51], v228 offset:61440
    v_mfma_f32_16x16x32_bf16 a[192:195], a[96:99], v[144:147], a[192:195]
    v_exp_f32 v115, v115
    v_mfma_f32_16x16x32_bf16 a[192:195], a[100:103], v[148:151], a[192:195]
    ds_read_b128 a[52:55], v229 offset:61440
    v_cvt_pk_bf16_f32 v177, v114, v115
    v_mfma_f32_16x16x32_bf16 a[224:227], a[100:103], v[156:159], a[224:227]
    v_exp_f32 v116, v116
    v_mfma_f32_16x16x32_bf16 a[224:227], a[96:99], v[152:155], a[224:227]
    ds_read_b128 a[56:59], v230 offset:61440
    ds_read_b128 a[60:63], v231 offset:61440
    v_mfma_f32_16x16x32_bf16 a[132:135], a[104:107], v[128:131], a[132:135]
    v_exp_f32 v117, v117
    v_mfma_f32_16x16x32_bf16 a[132:135], a[108:111], v[132:135], a[132:135]
    buffer_load_dwordx4 v8, s[24:27], s17 offen offset:0 nt lds
    v_cvt_pk_bf16_f32 v178, v116, v117
    v_mfma_f32_16x16x32_bf16 a[164:167], a[108:111], v[140:143], a[164:167]
    v_exp_f32 v118, v118
    v_mfma_f32_16x16x32_bf16 a[164:167], a[104:107], v[136:139], a[164:167]
    ds_read_b64_tr_b16 v[240:241], v15 offset:0
    ds_read_b64_tr_b16 v[242:243], v15 offset:1024
    v_mfma_f32_16x16x32_bf16 a[196:199], a[104:107], v[144:147], a[196:199]
    v_exp_f32 v119, v119
    v_mfma_f32_16x16x32_bf16 a[196:199], a[108:111], v[148:151], a[196:199]
    ds_read_b64_tr_b16 v[244:245], v16 offset:0
    v_cvt_pk_bf16_f32 v179, v118, v119
    v_mfma_f32_16x16x32_bf16 a[228:231], a[108:111], v[156:159], a[228:231]
    v_exp_f32 v120, v120
    v_mfma_f32_16x16x32_bf16 a[228:231], a[104:107], v[152:155], a[228:231]
    buffer_load_dwordx4 v9, s[24:27], s17 offen offset:1024 nt lds
    ds_read_b64_tr_b16 v[246:247], v16 offset:1024
    v_mfma_f32_16x16x32_bf16 a[136:139], a[112:115], v[128:131], a[136:139]
    v_exp_f32 v121, v121
    v_mfma_f32_16x16x32_bf16 a[136:139], a[116:119], v[132:135], a[136:139]
    v_cvt_pk_bf16_f32 v184, v120, v121
    v_mfma_f32_16x16x32_bf16 a[168:171], a[116:119], v[140:143], a[168:171]
    v_exp_f32 v122, v122
    v_mfma_f32_16x16x32_bf16 a[168:171], a[112:115], v[136:139], a[168:171]
    v_mfma_f32_16x16x32_bf16 a[200:203], a[112:115], v[144:147], a[200:203]
    v_exp_f32 v123, v123
    v_mfma_f32_16x16x32_bf16 a[200:203], a[116:119], v[148:151], a[200:203]
    buffer_load_dwordx4 v8, s[24:27], s17 offen offset:2048 nt lds
    v_cvt_pk_bf16_f32 v185, v122, v123
    v_mfma_f32_16x16x32_bf16 a[232:235], a[116:119], v[156:159], a[232:235]
    v_exp_f32 v124, v124
    v_mfma_f32_16x16x32_bf16 a[232:235], a[112:115], v[152:155], a[232:235]
    v_mfma_f32_16x16x32_bf16 a[140:143], a[120:123], v[128:131], a[140:143]
    v_exp_f32 v125, v125
    v_mfma_f32_16x16x32_bf16 a[140:143], a[124:127], v[132:135], a[140:143]
    v_cvt_pk_bf16_f32 v186, v124, v125
    v_mfma_f32_16x16x32_bf16 a[172:175], a[124:127], v[140:143], a[172:175]
    v_exp_f32 v126, v126
    v_mfma_f32_16x16x32_bf16 a[172:175], a[120:123], v[136:139], a[172:175]
    buffer_load_dwordx4 v9, s[24:27], s17 offen offset:3072 nt lds
    v_mfma_f32_16x16x32_bf16 a[204:207], a[120:123], v[144:147], a[204:207]
    s_add_u32 s17, s17, 16384
    v_exp_f32 v127, v127
    v_mfma_f32_16x16x32_bf16 a[204:207], a[124:127], v[148:151], a[204:207]
    s_and_b32 s17, s17, 0x7ffff
    v_cvt_pk_bf16_f32 v187, v126, v127
    v_mfma_f32_16x16x32_bf16 a[236:239], a[124:127], v[156:159], a[236:239]
    v_mfma_f32_16x16x32_bf16 a[236:239], a[120:123], v[152:155], a[236:239]
    s_waitcnt lgkmcnt(0)
    v_mfma_f32_16x16x32_bf16 v[96:99], a[32:35], a[0:3], v[192:195]
    v_exp_f32 v64, v64
    v_mfma_f32_16x16x32_bf16 v[96:99], a[36:39], a[4:7], v[96:99]
    ds_read_b64_tr_b16 a[96:97], v236 offset:0
    ds_read_b64_tr_b16 a[98:99], v236 offset:4096
    v_mfma_f32_16x16x32_bf16 v[96:99], a[40:43], a[64:67], v[96:99]
    v_exp_f32 v65, v65
    v_mfma_f32_16x16x32_bf16 v[96:99], a[44:47], a[68:71], v[96:99]
    ds_read_b64_tr_b16 a[100:101], v236 offset:8192
    v_cvt_pk_bf16_f32 v164, v64, v65
    v_mfma_f32_16x16x32_bf16 v[104:107], a[44:47], a[76:79], v[196:199]
    v_exp_f32 v66, v66
    v_mfma_f32_16x16x32_bf16 v[104:107], a[40:43], a[72:75], v[104:107]
    ds_read_b64_tr_b16 a[102:103], v236 offset:12288
    ds_read_b64_tr_b16 a[104:105], v237 offset:0
    v_mfma_f32_16x16x32_bf16 v[104:107], a[36:39], a[12:15], v[104:107]
    v_exp_f32 v67, v67
    v_mfma_f32_16x16x32_bf16 v[104:107], a[32:35], a[8:11], v[104:107]
    ds_read_b64_tr_b16 a[106:107], v237 offset:4096
    v_cvt_pk_bf16_f32 v165, v66, v67
    v_mfma_f32_16x16x32_bf16 v[112:115], a[32:35], a[16:19], v[200:203]
    v_exp_f32 v68, v68
    v_mfma_f32_16x16x32_bf16 v[112:115], a[36:39], a[20:23], v[112:115]
    ds_read_b64_tr_b16 a[108:109], v237 offset:8192
    ds_read_b64_tr_b16 a[110:111], v237 offset:12288
    v_mfma_f32_16x16x32_bf16 v[112:115], a[40:43], a[80:83], v[112:115]
    v_exp_f32 v69, v69
    v_mfma_f32_16x16x32_bf16 v[112:115], a[44:47], a[84:87], v[112:115]
    ds_read_b64_tr_b16 a[112:113], v238 offset:0
    v_cvt_pk_bf16_f32 v166, v68, v69
    v_mfma_f32_16x16x32_bf16 v[120:123], a[44:47], a[92:95], v[204:207]
    v_exp_f32 v70, v70
    v_mfma_f32_16x16x32_bf16 v[120:123], a[40:43], a[88:91], v[120:123]
    ds_read_b64_tr_b16 a[114:115], v238 offset:4096
    ds_read_b64_tr_b16 a[116:117], v238 offset:8192
    v_mfma_f32_16x16x32_bf16 v[120:123], a[36:39], a[28:31], v[120:123]
    v_exp_f32 v71, v71
    v_mfma_f32_16x16x32_bf16 v[120:123], a[32:35], a[24:27], v[120:123]
    ds_read_b64_tr_b16 a[118:119], v238 offset:12288
    v_cvt_pk_bf16_f32 v167, v70, v71
    v_mfma_f32_16x16x32_bf16 v[100:103], a[48:51], a[0:3], v[192:195]
    v_exp_f32 v72, v72
    v_mfma_f32_16x16x32_bf16 v[100:103], a[52:55], a[4:7], v[100:103]
    ds_read_b64_tr_b16 a[120:121], v239 offset:0
    ds_read_b64_tr_b16 a[122:123], v239 offset:4096
    v_mfma_f32_16x16x32_bf16 v[100:103], a[56:59], a[64:67], v[100:103]
    v_exp_f32 v73, v73
    v_mfma_f32_16x16x32_bf16 v[100:103], a[60:63], a[68:71], v[100:103]
    ds_read_b64_tr_b16 a[124:125], v239 offset:8192
    v_cvt_pk_bf16_f32 v172, v72, v73
    v_mfma_f32_16x16x32_bf16 v[108:111], a[60:63], a[76:79], v[196:199]
    v_exp_f32 v74, v74
    v_mfma_f32_16x16x32_bf16 v[108:111], a[56:59], a[72:75], v[108:111]
    ds_read_b64_tr_b16 a[126:127], v239 offset:12288
    v_mfma_f32_16x16x32_bf16 v[108:111], a[52:55], a[12:15], v[108:111]
    v_exp_f32 v75, v75
    v_mfma_f32_16x16x32_bf16 v[108:111], a[48:51], a[8:11], v[108:111]
    v_cvt_pk_bf16_f32 v173, v74, v75
    v_mfma_f32_16x16x32_bf16 v[116:119], a[48:51], a[16:19], v[200:203]
    v_exp_f32 v76, v76
    v_mfma_f32_16x16x32_bf16 v[116:119], a[52:55], a[20:23], v[116:119]
    v_mfma_f32_16x16x32_bf16 v[116:119], a[56:59], a[80:83], v[116:119]
    v_exp_f32 v77, v77
    v_mfma_f32_16x16x32_bf16 v[116:119], a[60:63], a[84:87], v[116:119]
    v_cvt_pk_bf16_f32 v174, v76, v77
    v_mfma_f32_16x16x32_bf16 v[124:127], a[60:63], a[92:95], v[204:207]
    s_waitcnt lgkmcnt(0)
    v_exp_f32 v78, v78
    v_mfma_f32_16x16x32_bf16 v[124:127], a[56:59], a[88:91], v[124:127]
    v_mfma_f32_16x16x32_bf16 v[124:127], a[52:55], a[28:31], v[124:127]
    s_waitcnt vmcnt(19)
    v_exp_f32 v79, v79
    v_mfma_f32_16x16x32_bf16 v[124:127], a[48:51], a[24:27], v[124:127]
    s_barrier
    v_cvt_pk_bf16_f32 v175, v78, v79
    v_smfmac_f32_16x16x64_bf16 v[216:219], v[224:227], v[144:151], v252
    v_exp_f32 v80, v80
    v_smfmac_f32_16x16x64_bf16 v[220:223], v[224:227], v[152:159], v252
    ds_read_b128 a[32:35], v228 offset:0
    ds_read_b128 a[36:39], v229 offset:0
    v_mfma_f32_16x16x32_bf16 a[144:147], a[96:99], v[128:131], a[144:147]
    s_add_u32 m0, s52, 147456
    v_exp_f32 v81, v81
    v_mfma_f32_16x16x32_bf16 a[144:147], a[100:103], v[132:135], a[144:147]
    ds_read_b128 a[40:43], v230 offset:0
    v_cvt_pk_bf16_f32 v180, v80, v81
    v_mfma_f32_16x16x32_bf16 a[176:179], a[100:103], v[140:143], a[176:179]
    v_exp_f32 v82, v82
    v_mfma_f32_16x16x32_bf16 a[176:179], a[96:99], v[136:139], a[176:179]
    ds_read_b128 a[44:47], v231 offset:0
    ds_read_b128 a[48:51], v228 offset:4096
    v_mfma_f32_16x16x32_bf16 a[208:211], a[96:99], v[144:147], a[208:211]
    v_exp_f32 v83, v83
    v_mfma_f32_16x16x32_bf16 a[208:211], a[100:103], v[148:151], a[208:211]
    ds_read_b128 a[52:55], v229 offset:4096
    v_cvt_pk_bf16_f32 v181, v82, v83
    v_mfma_f32_16x16x32_bf16 a[240:243], a[100:103], v[156:159], a[240:243]
    s_sub_u32 s62, s62, 1
    v_exp_f32 v84, v84
    v_mfma_f32_16x16x32_bf16 a[240:243], a[96:99], v[152:155], a[240:243]
    ds_read_b128 a[56:59], v230 offset:4096
    ds_read_b128 a[60:63], v231 offset:4096
    v_mfma_f32_16x16x32_bf16 a[148:151], a[104:107], v[128:131], a[148:151]
    v_exp_f32 v85, v85
    v_mfma_f32_16x16x32_bf16 a[148:151], a[108:111], v[132:135], a[148:151]
    buffer_load_dwordx4 v4, s[20:23], s16 offen offset:0 nt lds
    v_cvt_pk_bf16_f32 v182, v84, v85
    v_mfma_f32_16x16x32_bf16 a[180:183], a[108:111], v[140:143], a[180:183]
    v_exp_f32 v86, v86
    v_mfma_f32_16x16x32_bf16 a[180:183], a[104:107], v[136:139], a[180:183]
    buffer_store_dwordx4 v[240:243], v2, s[28:31], s12 offen offset:0 sc1
    v_mfma_f32_16x16x32_bf16 a[212:215], a[104:107], v[144:147], a[212:215]
    v_exp_f32 v87, v87
    v_mfma_f32_16x16x32_bf16 a[212:215], a[108:111], v[148:151], a[212:215]
    v_cvt_pk_bf16_f32 v183, v86, v87
    v_mfma_f32_16x16x32_bf16 a[244:247], a[108:111], v[156:159], a[244:247]
    v_exp_f32 v88, v88
    v_mfma_f32_16x16x32_bf16 a[244:247], a[104:107], v[152:155], a[244:247]
    buffer_load_dwordx4 v5, s[20:23], s16 offen offset:1024 nt lds
    v_mfma_f32_16x16x32_bf16 a[152:155], a[112:115], v[128:131], a[152:155]
    v_exp_f32 v89, v89
    v_mfma_f32_16x16x32_bf16 a[152:155], a[116:119], v[132:135], a[152:155]
    v_cvt_pk_bf16_f32 v188, v88, v89
    v_mfma_f32_16x16x32_bf16 a[184:187], a[116:119], v[140:143], a[184:187]
    v_exp_f32 v90, v90
    v_mfma_f32_16x16x32_bf16 a[184:187], a[112:115], v[136:139], a[184:187]
    buffer_store_dwordx4 v[244:247], v2, s[28:31], s12 offen offset:1024 sc1
    v_mfma_f32_16x16x32_bf16 a[216:219], a[112:115], v[144:147], a[216:219]
    v_exp_f32 v91, v91
    v_mfma_f32_16x16x32_bf16 a[216:219], a[116:119], v[148:151], a[216:219]
    buffer_load_dwordx4 v6, s[20:23], s16 offen offset:2048 nt lds
    v_cvt_pk_bf16_f32 v189, v90, v91
    v_mfma_f32_16x16x32_bf16 a[248:251], a[116:119], v[156:159], a[248:251]
    v_exp_f32 v92, v92
    v_mfma_f32_16x16x32_bf16 a[248:251], a[112:115], v[152:155], a[248:251]
    v_mfma_f32_16x16x32_bf16 a[156:159], a[120:123], v[128:131], a[156:159]
    v_exp_f32 v93, v93
    v_mfma_f32_16x16x32_bf16 a[156:159], a[124:127], v[132:135], a[156:159]
    v_cvt_pk_bf16_f32 v190, v92, v93
    v_mfma_f32_16x16x32_bf16 a[188:191], a[124:127], v[140:143], a[188:191]
    v_exp_f32 v94, v94
    v_mfma_f32_16x16x32_bf16 a[188:191], a[120:123], v[136:139], a[188:191]
    buffer_load_dwordx4 v7, s[20:23], s16 offen offset:3072 nt lds
    v_mfma_f32_16x16x32_bf16 a[220:223], a[120:123], v[144:147], a[220:223]
    s_add_u32 s16, s16, 16384
    v_exp_f32 v95, v95
    v_mfma_f32_16x16x32_bf16 a[220:223], a[124:127], v[148:151], a[220:223]
    s_and_b32 s16, s16, 0x7ffff
    v_cvt_pk_bf16_f32 v191, v94, v95
    v_mfma_f32_16x16x32_bf16 a[252:255], a[124:127], v[156:159], a[252:255]
    v_mfma_f32_16x16x32_bf16 a[252:255], a[120:123], v[152:155], a[252:255]
    s_waitcnt lgkmcnt(0)
    v_mfma_f32_16x16x32_bf16 v[64:67], a[32:35], a[0:3], v[192:195]
    v_exp_f32 v96, v96
    v_mfma_f32_16x16x32_bf16 v[64:67], a[36:39], a[4:7], v[64:67]
    ds_read_b64_tr_b16 a[96:97], v232 offset:16384
    ds_read_b64_tr_b16 a[98:99], v232 offset:20480
    v_mfma_f32_16x16x32_bf16 v[64:67], a[40:43], a[64:67], v[64:67]
    v_exp_f32 v97, v97
    v_mfma_f32_16x16x32_bf16 v[64:67], a[44:47], a[68:71], v[64:67]
    ds_read_b64_tr_b16 a[100:101], v232 offset:24576
    v_cvt_pk_bf16_f32 v128, v96, v97
    v_mfma_f32_16x16x32_bf16 v[72:75], a[44:47], a[76:79], v[196:199]
    v_exp_f32 v98, v98
    v_mfma_f32_16x16x32_bf16 v[72:75], a[40:43], a[72:75], v[72:75]
    ds_read_b64_tr_b16 a[102:103], v232 offset:28672
    ds_read_b64_tr_b16 a[104:105], v233 offset:16384
    v_mfma_f32_16x16x32_bf16 v[72:75], a[36:39], a[12:15], v[72:75]
    v_exp_f32 v99, v99
    v_mfma_f32_16x16x32_bf16 v[72:75], a[32:35], a[8:11], v[72:75]
    ds_read_b64_tr_b16 a[106:107], v233 offset:20480
    v_cvt_pk_bf16_f32 v129, v98, v99
    v_mfma_f32_16x16x32_bf16 v[80:83], a[32:35], a[16:19], v[200:203]
    v_exp_f32 v100, v100
    v_mfma_f32_16x16x32_bf16 v[80:83], a[36:39], a[20:23], v[80:83]
    ds_read_b64_tr_b16 a[108:109], v233 offset:24576
    ds_read_b64_tr_b16 a[110:111], v233 offset:28672
    v_mfma_f32_16x16x32_bf16 v[80:83], a[40:43], a[80:83], v[80:83]
    v_exp_f32 v101, v101
    v_mfma_f32_16x16x32_bf16 v[80:83], a[44:47], a[84:87], v[80:83]
    ds_read_b64_tr_b16 a[112:113], v234 offset:16384
    v_cvt_pk_bf16_f32 v130, v100, v101
    v_mfma_f32_16x16x32_bf16 v[88:91], a[44:47], a[92:95], v[204:207]
    v_exp_f32 v102, v102
    v_mfma_f32_16x16x32_bf16 v[88:91], a[40:43], a[88:91], v[88:91]
    ds_read_b64_tr_b16 a[114:115], v234 offset:20480
    ds_read_b64_tr_b16 a[116:117], v234 offset:24576
    v_mfma_f32_16x16x32_bf16 v[88:91], a[36:39], a[28:31], v[88:91]
    v_exp_f32 v103, v103
    v_mfma_f32_16x16x32_bf16 v[88:91], a[32:35], a[24:27], v[88:91]
    ds_read_b64_tr_b16 a[118:119], v234 offset:28672
    v_cvt_pk_bf16_f32 v131, v102, v103
    v_mfma_f32_16x16x32_bf16 v[68:71], a[48:51], a[0:3], v[192:195]
    v_exp_f32 v104, v104
    v_mfma_f32_16x16x32_bf16 v[68:71], a[52:55], a[4:7], v[68:71]
    ds_read_b64_tr_b16 a[120:121], v235 offset:16384
    ds_read_b64_tr_b16 a[122:123], v235 offset:20480
    v_mfma_f32_16x16x32_bf16 v[68:71], a[56:59], a[64:67], v[68:71]
    v_exp_f32 v105, v105
    v_mfma_f32_16x16x32_bf16 v[68:71], a[60:63], a[68:71], v[68:71]
    ds_read_b64_tr_b16 a[124:125], v235 offset:24576
    v_cvt_pk_bf16_f32 v136, v104, v105
    v_mfma_f32_16x16x32_bf16 v[76:79], a[60:63], a[76:79], v[196:199]
    v_exp_f32 v106, v106
    v_mfma_f32_16x16x32_bf16 v[76:79], a[56:59], a[72:75], v[76:79]
    ds_read_b64_tr_b16 a[126:127], v235 offset:28672
    v_mfma_f32_16x16x32_bf16 v[76:79], a[52:55], a[12:15], v[76:79]
    v_exp_f32 v107, v107
    v_mfma_f32_16x16x32_bf16 v[76:79], a[48:51], a[8:11], v[76:79]
    v_cvt_pk_bf16_f32 v137, v106, v107
    v_mfma_f32_16x16x32_bf16 v[84:87], a[48:51], a[16:19], v[200:203]
    v_exp_f32 v108, v108
    v_mfma_f32_16x16x32_bf16 v[84:87], a[52:55], a[20:23], v[84:87]
    v_mfma_f32_16x16x32_bf16 v[84:87], a[56:59], a[80:83], v[84:87]
    v_exp_f32 v109, v109
    v_mfma_f32_16x16x32_bf16 v[84:87], a[60:63], a[84:87], v[84:87]
    v_cvt_pk_bf16_f32 v138, v108, v109
    v_mfma_f32_16x16x32_bf16 v[92:95], a[60:63], a[92:95], v[204:207]
    s_waitcnt lgkmcnt(0)
    v_exp_f32 v110, v110
    v_mfma_f32_16x16x32_bf16 v[92:95], a[56:59], a[88:91], v[92:95]
    v_mfma_f32_16x16x32_bf16 v[92:95], a[52:55], a[28:31], v[92:95]
    v_exp_f32 v111, v111
    v_mfma_f32_16x16x32_bf16 v[92:95], a[48:51], a[24:27], v[92:95]
    v_cvt_pk_bf16_f32 v139, v110, v111
    v_smfmac_f32_16x16x64_bf16 v[208:211], v[224:227], v[160:167], v252
    v_exp_f32 v112, v112
    v_smfmac_f32_16x16x64_bf16 v[212:215], v[224:227], v[168:175], v252
    ds_read_b128 a[32:35], v228 offset:8192
    ds_read_b128 a[36:39], v229 offset:8192
    v_mfma_f32_16x16x32_bf16 a[128:131], a[96:99], v[160:163], a[128:131]
    s_add_u32 m0, s52, 0
    v_exp_f32 v113, v113
    v_mfma_f32_16x16x32_bf16 a[128:131], a[100:103], v[164:167], a[128:131]
    ds_read_b128 a[40:43], v230 offset:8192
    v_cvt_pk_bf16_f32 v144, v112, v113
    v_mfma_f32_16x16x32_bf16 a[160:163], a[100:103], v[172:175], a[160:163]
    v_exp_f32 v114, v114
    v_mfma_f32_16x16x32_bf16 a[160:163], a[96:99], v[168:171], a[160:163]
    ds_read_b128 a[44:47], v231 offset:8192
    ds_read_b128 a[48:51], v228 offset:12288
    v_mfma_f32_16x16x32_bf16 a[192:195], a[96:99], v[176:179], a[192:195]
    v_exp_f32 v115, v115
    v_mfma_f32_16x16x32_bf16 a[192:195], a[100:103], v[180:183], a[192:195]
    ds_read_b128 a[52:55], v229 offset:12288
    v_cvt_pk_bf16_f32 v145, v114, v115
    v_mfma_f32_16x16x32_bf16 a[224:227], a[100:103], v[188:191], a[224:227]
    v_exp_f32 v116, v116
    v_mfma_f32_16x16x32_bf16 a[224:227], a[96:99], v[184:187], a[224:227]
    ds_read_b128 a[56:59], v230 offset:12288
    ds_read_b128 a[60:63], v231 offset:12288
    v_mfma_f32_16x16x32_bf16 a[132:135], a[104:107], v[160:163], a[132:135]
    v_exp_f32 v117, v117
    v_mfma_f32_16x16x32_bf16 a[132:135], a[108:111], v[164:167], a[132:135]
    buffer_load_dwordx4 v8, s[24:27], s17 offen offset:0 nt lds
    v_cvt_pk_bf16_f32 v146, v116, v117
    v_mfma_f32_16x16x32_bf16 a[164:167], a[108:111], v[172:175], a[164:167]
    v_exp_f32 v118, v118
    v_mfma_f32_16x16x32_bf16 a[164:167], a[104:107], v[168:171], a[164:167]
    v_mfma_f32_16x16x32_bf16 a[196:199], a[104:107], v[176:179], a[196:199]
    v_exp_f32 v119, v119
    v_mfma_f32_16x16x32_bf16 a[196:199], a[108:111], v[180:183], a[196:199]
    v_cvt_pk_bf16_f32 v147, v118, v119
    v_mfma_f32_16x16x32_bf16 a[228:231], a[108:111], v[188:191], a[228:231]
    v_exp_f32 v120, v120
    v_mfma_f32_16x16x32_bf16 a[228:231], a[104:107], v[184:187], a[228:231]
    buffer_load_dwordx4 v9, s[24:27], s17 offen offset:1024 nt lds
    v_mfma_f32_16x16x32_bf16 a[136:139], a[112:115], v[160:163], a[136:139]
    v_exp_f32 v121, v121
    v_mfma_f32_16x16x32_bf16 a[136:139], a[116:119], v[164:167], a[136:139]
    v_cvt_pk_bf16_f32 v152, v120, v121
    v_mfma_f32_16x16x32_bf16 a[168:171], a[116:119], v[172:175], a[168:171]
    v_exp_f32 v122, v122
    v_mfma_f32_16x16x32_bf16 a[168:171], a[112:115], v[168:171], a[168:171]
    v_mfma_f32_16x16x32_bf16 a[200:203], a[112:115], v[176:179], a[200:203]
    v_exp_f32 v123, v123
    v_mfma_f32_16x16x32_bf16 a[200:203], a[116:119], v[180:183], a[200:203]
    buffer_load_dwordx4 v8, s[24:27], s17 offen offset:2048 nt lds
    v_cvt_pk_bf16_f32 v153, v122, v123
    v_mfma_f32_16x16x32_bf16 a[232:235], a[116:119], v[188:191], a[232:235]
    v_exp_f32 v124, v124
    v_mfma_f32_16x16x32_bf16 a[232:235], a[112:115], v[184:187], a[232:235]
    v_mfma_f32_16x16x32_bf16 a[140:143], a[120:123], v[160:163], a[140:143]
    v_exp_f32 v125, v125
    v_mfma_f32_16x16x32_bf16 a[140:143], a[124:127], v[164:167], a[140:143]
    v_cvt_pk_bf16_f32 v154, v124, v125
    v_mfma_f32_16x16x32_bf16 a[172:175], a[124:127], v[172:175], a[172:175]
    v_exp_f32 v126, v126
    v_mfma_f32_16x16x32_bf16 a[172:175], a[120:123], v[168:171], a[172:175]
    buffer_load_dwordx4 v9, s[24:27], s17 offen offset:3072 nt lds
    v_mfma_f32_16x16x32_bf16 a[204:207], a[120:123], v[176:179], a[204:207]
    s_add_u32 s17, s17, 16384
    v_exp_f32 v127, v127
    v_mfma_f32_16x16x32_bf16 a[204:207], a[124:127], v[180:183], a[204:207]
    s_and_b32 s17, s17, 0x7ffff
    v_cvt_pk_bf16_f32 v155, v126, v127
    v_mfma_f32_16x16x32_bf16 a[236:239], a[124:127], v[188:191], a[236:239]
    v_mfma_f32_16x16x32_bf16 a[236:239], a[120:123], v[184:187], a[236:239]
    s_waitcnt lgkmcnt(0)
    s_cmp_lg_u32 s62, 0
    s_cbranch_scc1 L_attn
    v_mfma_f32_16x16x32_bf16 v[96:99], a[32:35], a[0:3], v[192:195]
    v_exp_f32 v64, v64
    v_mfma_f32_16x16x32_bf16 v[96:99], a[36:39], a[4:7], v[96:99]
    ds_read_b64_tr_b16 a[96:97], v236 offset:16384
    ds_read_b64_tr_b16 a[98:99], v236 offset:20480
    v_mfma_f32_16x16x32_bf16 v[96:99], a[40:43], a[64:67], v[96:99]
    v_exp_f32 v65, v65
    v_mfma_f32_16x16x32_bf16 v[96:99], a[44:47], a[68:71], v[96:99]
    ds_read_b64_tr_b16 a[100:101], v236 offset:24576
    v_cvt_pk_bf16_f32 v132, v64, v65
    v_mfma_f32_16x16x32_bf16 v[104:107], a[44:47], a[76:79], v[196:199]
    v_exp_f32 v66, v66
    v_mfma_f32_16x16x32_bf16 v[104:107], a[40:43], a[72:75], v[104:107]
    ds_read_b64_tr_b16 a[102:103], v236 offset:28672
    ds_read_b64_tr_b16 a[104:105], v237 offset:16384
    v_mfma_f32_16x16x32_bf16 v[104:107], a[36:39], a[12:15], v[104:107]
    v_exp_f32 v67, v67
    v_mfma_f32_16x16x32_bf16 v[104:107], a[32:35], a[8:11], v[104:107]
    ds_read_b64_tr_b16 a[106:107], v237 offset:20480
    v_cvt_pk_bf16_f32 v133, v66, v67
    v_mfma_f32_16x16x32_bf16 v[112:115], a[32:35], a[16:19], v[200:203]
    v_exp_f32 v68, v68
    v_mfma_f32_16x16x32_bf16 v[112:115], a[36:39], a[20:23], v[112:115]
    ds_read_b64_tr_b16 a[108:109], v237 offset:24576
    ds_read_b64_tr_b16 a[110:111], v237 offset:28672
    v_mfma_f32_16x16x32_bf16 v[112:115], a[40:43], a[80:83], v[112:115]
    v_exp_f32 v69, v69
    v_mfma_f32_16x16x32_bf16 v[112:115], a[44:47], a[84:87], v[112:115]
    ds_read_b64_tr_b16 a[112:113], v238 offset:16384
    v_cvt_pk_bf16_f32 v134, v68, v69
    v_mfma_f32_16x16x32_bf16 v[120:123], a[44:47], a[92:95], v[204:207]
    v_exp_f32 v70, v70
    v_mfma_f32_16x16x32_bf16 v[120:123], a[40:43], a[88:91], v[120:123]
    ds_read_b64_tr_b16 a[114:115], v238 offset:20480
    ds_read_b64_tr_b16 a[116:117], v238 offset:24576
    v_mfma_f32_16x16x32_bf16 v[120:123], a[36:39], a[28:31], v[120:123]
    v_exp_f32 v71, v71
    v_mfma_f32_16x16x32_bf16 v[120:123], a[32:35], a[24:27], v[120:123]
    ds_read_b64_tr_b16 a[118:119], v238 offset:28672
    v_cvt_pk_bf16_f32 v135, v70, v71
    v_mfma_f32_16x16x32_bf16 v[100:103], a[48:51], a[0:3], v[192:195]
    v_exp_f32 v72, v72
    v_mfma_f32_16x16x32_bf16 v[100:103], a[52:55], a[4:7], v[100:103]
    ds_read_b64_tr_b16 a[120:121], v239 offset:16384
    ds_read_b64_tr_b16 a[122:123], v239 offset:20480
    v_mfma_f32_16x16x32_bf16 v[100:103], a[56:59], a[64:67], v[100:103]
    v_exp_f32 v73, v73
    v_mfma_f32_16x16x32_bf16 v[100:103], a[60:63], a[68:71], v[100:103]
    ds_read_b64_tr_b16 a[124:125], v239 offset:24576
    v_cvt_pk_bf16_f32 v140, v72, v73
    v_mfma_f32_16x16x32_bf16 v[108:111], a[60:63], a[76:79], v[196:199]
    v_exp_f32 v74, v74
    v_mfma_f32_16x16x32_bf16 v[108:111], a[56:59], a[72:75], v[108:111]
    ds_read_b64_tr_b16 a[126:127], v239 offset:28672
    v_and_b32 v19, 7, v1
    v_mfma_f32_16x16x32_bf16 v[108:111], a[52:55], a[12:15], v[108:111]
    v_exp_f32 v75, v75
    v_mfma_f32_16x16x32_bf16 v[108:111], a[48:51], a[8:11], v[108:111]
    s_mul_i32 s58, s48, 3072
    v_cvt_pk_bf16_f32 v141, v74, v75
    v_lshlrev_b32 v19, 2, v19
    v_mfma_f32_16x16x32_bf16 v[116:119], a[48:51], a[16:19], v[200:203]
    s_add_u32 s58, s58, 151552
    v_exp_f32 v76, v76
    v_mfma_f32_16x16x32_bf16 v[116:119], a[52:55], a[20:23], v[116:119]
    v_lshrrev_b32 v52, 2, v1
    v_mul_u32_u24 v52, 1152, v52
    v_mfma_f32_16x16x32_bf16 v[116:119], a[56:59], a[80:83], v[116:119]
    v_exp_f32 v77, v77
    v_mfma_f32_16x16x32_bf16 v[116:119], a[60:63], a[84:87], v[116:119]
    v_cvt_pk_bf16_f32 v142, v76, v77
    v_and_b32 v53, 3, v1
    v_mfma_f32_16x16x32_bf16 v[124:127], a[60:63], a[92:95], v[204:207]
    s_waitcnt lgkmcnt(0)
    v_exp_f32 v78, v78
    v_mfma_f32_16x16x32_bf16 v[124:127], a[56:59], a[88:91], v[124:127]
    v_lshl_add_u32 v13, v53, 4, v52
    v_lshrrev_b32 v52, 1, v1
    v_mfma_f32_16x16x32_bf16 v[124:127], a[52:55], a[28:31], v[124:127]
    s_waitcnt vmcnt(18)
    v_exp_f32 v79, v79
    v_mfma_f32_16x16x32_bf16 v[124:127], a[48:51], a[24:27], v[124:127]
    s_barrier
    v_cvt_pk_bf16_f32 v143, v78, v79
    v_mul_u32_u24 v52, 1152, v52
    v_smfmac_f32_16x16x64_bf16 v[216:219], v[224:227], v[176:183], v252
    v_exp_f32 v80, v80
    v_smfmac_f32_16x16x64_bf16 v[220:223], v[224:227], v[184:191], v252
    s_lshr_b32 s70, s2, 3
    s_cmp_ge_u32 s70, 3
    s_cbranch_scc1 L_ct2
    s_cmp_lg_u32 s48, 0
    s_cbranch_scc1 L_ct2
    s_getpc_b64 s[68:69]
L_ct2_pc:
    s_lshl_b32 s70, s70, 13
    s_add_u32 s70, s70, L_fin_code-L_ct2_pc
    s_add_u32 s68, s68, s70
    s_addc_u32 s69, s69, 0
    v_lshlrev_b32 v60, 7, v1
    v_mov_b32 v61, s69
    v_add_co_u32 v60, vcc, s68, v60
    s_nop 1
    v_addc_co_u32 v61, vcc, 0, v61, vcc
    global_load_dword v18, v[60:61], off
L_ct2:
    ds_read_b128 a[32:35], v228 offset:16384
    ds_read_b128 a[36:39], v229 offset:16384
    v_mfma_f32_16x16x32_bf16 a[144:147], a[96:99], v[160:163], a[144:147]
    v_exp_f32 v81, v81
    v_mfma_f32_16x16x32_bf16 a[144:147], a[100:103], v[164:167], a[144:147]
    ds_read_b128 a[40:43], v230 offset:16384
    v_cvt_pk_bf16_f32 v148, v80, v81
    v_mfma_f32_16x16x32_bf16 a[176:179], a[100:103], v[172:175], a[176:179]
    v_exp_f32 v82, v82
    v_mfma_f32_16x16x32_bf16 a[176:179], a[96:99], v[168:171], a[176:179]
    ds_read_b128 a[44:47], v231 offset:16384
    ds_read_b128 a[48:51], v228 offset:20480
    v_mfma_f32_16x16x32_bf16 a[208:211], a[96:99], v[176:179], a[208:211]
    v_exp_f32 v83, v83
    v_mfma_f32_16x16x32_bf16 a[208:211], a[100:103], v[180:183], a[208:211]
    ds_read_b128 a[52:55], v229 offset:20480
    v_cvt_pk_bf16_f32 v149, v82, v83
    v_mfma_f32_16x16x32_bf16 a[240:243], a[100:103], v[188:191], a[240:243]
    v_exp_f32 v84, v84
    v_mfma_f32_16x16x32_bf16 a[240:243], a[96:99], v[184:187], a[240:243]
    ds_read_b128 a[56:59], v230 offset:20480
    ds_read_b128 a[60:63], v231 offset:20480
    v_mfma_f32_16x16x32_bf16 a[148:151], a[104:107], v[160:163], a[148:151]
    v_exp_f32 v85, v85
    v_mfma_f32_16x16x32_bf16 a[148:151], a[108:111], v[164:167], a[148:151]
    v_cvt_pk_bf16_f32 v150, v84, v85
    v_and_b32 v53, 1, v1
    v_mfma_f32_16x16x32_bf16 a[180:183], a[108:111], v[172:175], a[180:183]
    v_exp_f32 v86, v86
    v_mfma_f32_16x16x32_bf16 a[180:183], a[104:107], v[168:171], a[180:183]
    v_lshl_add_u32 v14, v53, 4, v52
    v_and_b32 v52, 15, v1
    v_mfma_f32_16x16x32_bf16 a[212:215], a[104:107], v[176:179], a[212:215]
    v_exp_f32 v87, v87
    v_mfma_f32_16x16x32_bf16 a[212:215], a[108:111], v[180:183], a[212:215]
    v_cvt_pk_bf16_f32 v151, v86, v87
    v_lshrrev_b32 v53, 4, v1
    v_mfma_f32_16x16x32_bf16 a[244:247], a[108:111], v[188:191], a[244:247]
    v_exp_f32 v88, v88
    v_mfma_f32_16x16x32_bf16 a[244:247], a[104:107], v[184:187], a[244:247]
    v_lshlrev_b32 v53, 3, v53
    v_add_u32 v53, s58, v53
    v_mfma_f32_16x16x32_bf16 a[152:155], a[112:115], v[160:163], a[152:155]
    v_exp_f32 v89, v89
    v_mfma_f32_16x16x32_bf16 a[152:155], a[116:119], v[164:167], a[152:155]
    v_cvt_pk_bf16_f32 v156, v88, v89
    v_lshl_add_u32 v15, v52, 6, v53
    v_mfma_f32_16x16x32_bf16 a[184:187], a[116:119], v[172:175], a[184:187]
    v_exp_f32 v90, v90
    v_mfma_f32_16x16x32_bf16 a[184:187], a[112:115], v[168:171], a[184:187]
    v_lshl_add_u32 v16, v52, 5, v53
    v_mfma_f32_16x16x32_bf16 a[216:219], a[112:115], v[176:179], a[216:219]
    v_exp_f32 v91, v91
    v_mfma_f32_16x16x32_bf16 a[216:219], a[116:119], v[180:183], a[216:219]
    v_cvt_pk_bf16_f32 v157, v90, v91
    v_mfma_f32_16x16x32_bf16 a[248:251], a[116:119], v[188:191], a[248:251]
    v_exp_f32 v92, v92
    v_mfma_f32_16x16x32_bf16 a[248:251], a[112:115], v[184:187], a[248:251]
    v_mfma_f32_16x16x32_bf16 a[156:159], a[120:123], v[160:163], a[156:159]
    v_exp_f32 v93, v93
    v_mfma_f32_16x16x32_bf16 a[156:159], a[124:127], v[164:167], a[156:159]
    v_cvt_pk_bf16_f32 v158, v92, v93
    v_mfma_f32_16x16x32_bf16 a[188:191], a[124:127], v[172:175], a[188:191]
    v_exp_f32 v94, v94
    v_mfma_f32_16x16x32_bf16 a[188:191], a[120:123], v[168:171], a[188:191]
    v_mfma_f32_16x16x32_bf16 a[220:223], a[120:123], v[176:179], a[220:223]
    v_exp_f32 v95, v95
    v_mfma_f32_16x16x32_bf16 a[220:223], a[124:127], v[180:183], a[220:223]
    v_cvt_pk_bf16_f32 v159, v94, v95
    v_mfma_f32_16x16x32_bf16 a[252:255], a[124:127], v[188:191], a[252:255]
    v_mfma_f32_16x16x32_bf16 a[252:255], a[120:123], v[184:187], a[252:255]
    s_waitcnt lgkmcnt(0)
    v_mfma_f32_16x16x32_bf16 v[64:67], a[32:35], a[0:3], v[192:195]
    v_exp_f32 v96, v96
    v_mfma_f32_16x16x32_bf16 v[64:67], a[36:39], a[4:7], v[64:67]
    ds_read_b64_tr_b16 a[96:97], v232 offset:32768
    ds_read_b64_tr_b16 a[98:99], v232 offset:36864
    v_mfma_f32_16x16x32_bf16 v[64:67], a[40:43], a[64:67], v[64:67]
    v_exp_f32 v97, v97
    v_mfma_f32_16x16x32_bf16 v[64:67], a[44:47], a[68:71], v[64:67]
    ds_read_b64_tr_b16 a[100:101], v232 offset:40960
    v_cvt_pk_bf16_f32 v160, v96, v97
    v_mfma_f32_16x16x32_bf16 v[72:75], a[44:47], a[76:79], v[196:199]
    v_exp_f32 v98, v98
    v_mfma_f32_16x16x32_bf16 v[72:75], a[40:43], a[72:75], v[72:75]
    ds_read_b64_tr_b16 a[102:103], v232 offset:45056
    ds_read_b64_tr_b16 a[104:105], v233 offset:32768
    v_mfma_f32_16x16x32_bf16 v[72:75], a[36:39], a[12:15], v[72:75]
    v_exp_f32 v99, v99
    v_mfma_f32_16x16x32_bf16 v[72:75], a[32:35], a[8:11], v[72:75]
    ds_read_b64_tr_b16 a[106:107], v233 offset:36864
    v_cvt_pk_bf16_f32 v161, v98, v99
    v_mfma_f32_16x16x32_bf16 v[80:83], a[32:35], a[16:19], v[200:203]
    v_exp_f32 v100, v100
    v_mfma_f32_16x16x32_bf16 v[80:83], a[36:39], a[20:23], v[80:83]
    ds_read_b64_tr_b16 a[108:109], v233 offset:40960
    ds_read_b64_tr_b16 a[110:111], v233 offset:45056
    v_mfma_f32_16x16x32_bf16 v[80:83], a[40:43], a[80:83], v[80:83]
    v_exp_f32 v101, v101
    v_mfma_f32_16x16x32_bf16 v[80:83], a[44:47], a[84:87], v[80:83]
    ds_read_b64_tr_b16 a[112:113], v234 offset:32768
    v_cvt_pk_bf16_f32 v162, v100, v101
    v_mfma_f32_16x16x32_bf16 v[88:91], a[44:47], a[92:95], v[204:207]
    v_exp_f32 v102, v102
    v_mfma_f32_16x16x32_bf16 v[88:91], a[40:43], a[88:91], v[88:91]
    ds_read_b64_tr_b16 a[114:115], v234 offset:36864
    ds_read_b64_tr_b16 a[116:117], v234 offset:40960
    v_mfma_f32_16x16x32_bf16 v[88:91], a[36:39], a[28:31], v[88:91]
    v_exp_f32 v103, v103
    v_mfma_f32_16x16x32_bf16 v[88:91], a[32:35], a[24:27], v[88:91]
    ds_read_b64_tr_b16 a[118:119], v234 offset:45056
    v_cvt_pk_bf16_f32 v163, v102, v103
    v_mfma_f32_16x16x32_bf16 v[68:71], a[48:51], a[0:3], v[192:195]
    v_exp_f32 v104, v104
    v_mfma_f32_16x16x32_bf16 v[68:71], a[52:55], a[4:7], v[68:71]
    ds_read_b64_tr_b16 a[120:121], v235 offset:32768
    ds_read_b64_tr_b16 a[122:123], v235 offset:36864
    v_mfma_f32_16x16x32_bf16 v[68:71], a[56:59], a[64:67], v[68:71]
    v_exp_f32 v105, v105
    v_mfma_f32_16x16x32_bf16 v[68:71], a[60:63], a[68:71], v[68:71]
    ds_read_b64_tr_b16 a[124:125], v235 offset:40960
    v_cvt_pk_bf16_f32 v168, v104, v105
    v_mfma_f32_16x16x32_bf16 v[76:79], a[60:63], a[76:79], v[196:199]
    v_exp_f32 v106, v106
    v_mfma_f32_16x16x32_bf16 v[76:79], a[56:59], a[72:75], v[76:79]
    ds_read_b64_tr_b16 a[126:127], v235 offset:45056
    v_mfma_f32_16x16x32_bf16 v[76:79], a[52:55], a[12:15], v[76:79]
    v_exp_f32 v107, v107
    v_mfma_f32_16x16x32_bf16 v[76:79], a[48:51], a[8:11], v[76:79]
    v_cvt_pk_bf16_f32 v169, v106, v107
    v_mfma_f32_16x16x32_bf16 v[84:87], a[48:51], a[16:19], v[200:203]
    v_exp_f32 v108, v108
    v_mfma_f32_16x16x32_bf16 v[84:87], a[52:55], a[20:23], v[84:87]
    v_mfma_f32_16x16x32_bf16 v[84:87], a[56:59], a[80:83], v[84:87]
    v_exp_f32 v109, v109
    v_mfma_f32_16x16x32_bf16 v[84:87], a[60:63], a[84:87], v[84:87]
    v_cvt_pk_bf16_f32 v170, v108, v109
    v_mfma_f32_16x16x32_bf16 v[92:95], a[60:63], a[92:95], v[204:207]
    s_waitcnt lgkmcnt(0)
    v_exp_f32 v110, v110
    v_mfma_f32_16x16x32_bf16 v[92:95], a[56:59], a[88:91], v[92:95]
    v_mfma_f32_16x16x32_bf16 v[92:95], a[52:55], a[28:31], v[92:95]
    v_exp_f32 v111, v111
    v_mfma_f32_16x16x32_bf16 v[92:95], a[48:51], a[24:27], v[92:95]
    v_cvt_pk_bf16_f32 v171, v110, v111
    v_smfmac_f32_16x16x64_bf16 v[208:211], v[224:227], v[128:135], v252
    v_exp_f32 v112, v112
    v_smfmac_f32_16x16x64_bf16 v[212:215], v[224:227], v[136:143], v252
    ds_read_b128 a[32:35], v228 offset:24576
    ds_read_b128 a[36:39], v229 offset:24576
    v_mfma_f32_16x16x32_bf16 a[128:131], a[96:99], v[128:131], a[128:131]
    s_add_u32 m0, s52, 16384
    v_exp_f32 v113, v113
    v_mfma_f32_16x16x32_bf16 a[128:131], a[100:103], v[132:135], a[128:131]
    ds_read_b128 a[40:43], v230 offset:24576
    v_cvt_pk_bf16_f32 v176, v112, v113
    v_mfma_f32_16x16x32_bf16 a[160:163], a[100:103], v[140:143], a[160:163]
    v_exp_f32 v114, v114
    v_mfma_f32_16x16x32_bf16 a[160:163], a[96:99], v[136:139], a[160:163]
    ds_read_b128 a[44:47], v231 offset:24576
    ds_read_b128 a[48:51], v228 offset:28672
    v_mfma_f32_16x16x32_bf16 a[192:195], a[96:99], v[144:147], a[192:195]
    v_exp_f32 v115, v115
    v_mfma_f32_16x16x32_bf16 a[192:195], a[100:103], v[148:151], a[192:195]
    ds_read_b128 a[52:55], v229 offset:28672
    v_cvt_pk_bf16_f32 v177, v114, v115
    v_mfma_f32_16x16x32_bf16 a[224:227], a[100:103], v[156:159], a[224:227]
    v_exp_f32 v116, v116
    v_mfma_f32_16x16x32_bf16 a[224:227], a[96:99], v[152:155], a[224:227]
    ds_read_b128 a[56:59], v230 offset:28672
    ds_read_b128 a[60:63], v231 offset:28672
    v_mfma_f32_16x16x32_bf16 a[132:135], a[104:107], v[128:131], a[132:135]
    v_exp_f32 v117, v117
    v_mfma_f32_16x16x32_bf16 a[132:135], a[108:111], v[132:135], a[132:135]
    buffer_load_dwordx4 v8, s[24:27], s17 offen offset:0 nt lds
    v_cvt_pk_bf16_f32 v178, v116, v117
    v_mfma_f32_16x16x32_bf16 a[164:167], a[108:111], v[140:143], a[164:167]
    v_exp_f32 v118, v118
    v_mfma_f32_16x16x32_bf16 a[164:167], a[104:107], v[136:139], a[164:167]
    v_mfma_f32_16x16x32_bf16 a[196:199], a[104:107], v[144:147], a[196:199]
    v_exp_f32 v119, v119
    v_mfma_f32_16x16x32_bf16 a[196:199], a[108:111], v[148:151], a[196:199]
    v_cvt_pk_bf16_f32 v179, v118, v119
    v_mfma_f32_16x16x32_bf16 a[228:231], a[108:111], v[156:159], a[228:231]
    v_exp_f32 v120, v120
    v_mfma_f32_16x16x32_bf16 a[228:231], a[104:107], v[152:155], a[228:231]
    buffer_load_dwordx4 v9, s[24:27], s17 offen offset:1024 nt lds
    v_mfma_f32_16x16x32_bf16 a[136:139], a[112:115], v[128:131], a[136:139]
    v_exp_f32 v121, v121
    v_mfma_f32_16x16x32_bf16 a[136:139], a[116:119], v[132:135], a[136:139]
    v_cvt_pk_bf16_f32 v184, v120, v121
    v_mfma_f32_16x16x32_bf16 a[168:171], a[116:119], v[140:143], a[168:171]
    v_exp_f32 v122, v122
    v_mfma_f32_16x16x32_bf16 a[168:171], a[112:115], v[136:139], a[168:171]
    v_mfma_f32_16x16x32_bf16 a[200:203], a[112:115], v[144:147], a[200:203]
    v_exp_f32 v123, v123
    v_mfma_f32_16x16x32_bf16 a[200:203], a[116:119], v[148:151], a[200:203]
    buffer_load_dwordx4 v8, s[24:27], s17 offen offset:2048 nt lds
    v_cvt_pk_bf16_f32 v185, v122, v123
    v_mfma_f32_16x16x32_bf16 a[232:235], a[116:119], v[156:159], a[232:235]
    v_exp_f32 v124, v124
    v_mfma_f32_16x16x32_bf16 a[232:235], a[112:115], v[152:155], a[232:235]
    v_mfma_f32_16x16x32_bf16 a[140:143], a[120:123], v[128:131], a[140:143]
    v_exp_f32 v125, v125
    v_mfma_f32_16x16x32_bf16 a[140:143], a[124:127], v[132:135], a[140:143]
    v_cvt_pk_bf16_f32 v186, v124, v125
    v_mfma_f32_16x16x32_bf16 a[172:175], a[124:127], v[140:143], a[172:175]
    v_exp_f32 v126, v126
    v_mfma_f32_16x16x32_bf16 a[172:175], a[120:123], v[136:139], a[172:175]
    buffer_load_dwordx4 v9, s[24:27], s17 offen offset:3072 nt lds
    v_mfma_f32_16x16x32_bf16 a[204:207], a[120:123], v[144:147], a[204:207]
    s_add_u32 s17, s17, 16384
    v_exp_f32 v127, v127
    v_mfma_f32_16x16x32_bf16 a[204:207], a[124:127], v[148:151], a[204:207]
    s_and_b32 s17, s17, 0x7ffff
    v_cvt_pk_bf16_f32 v187, v126, v127
    v_mfma_f32_16x16x32_bf16 a[236:239], a[124:127], v[156:159], a[236:239]
    v_mfma_f32_16x16x32_bf16 a[236:239], a[120:123], v[152:155], a[236:239]
    s_waitcnt lgkmcnt(0)
    v_mfma_f32_16x16x32_bf16 v[96:99], a[32:35], a[0:3], v[192:195]
    v_exp_f32 v64, v64
    v_mfma_f32_16x16x32_bf16 v[96:99], a[36:39], a[4:7], v[96:99]
    ds_read_b64_tr_b16 a[96:97], v236 offset:32768
    ds_read_b64_tr_b16 a[98:99], v236 offset:36864
    v_mfma_f32_16x16x32_bf16 v[96:99], a[40:43], a[64:67], v[96:99]
    v_exp_f32 v65, v65
    v_mfma_f32_16x16x32_bf16 v[96:99], a[44:47], a[68:71], v[96:99]
    ds_read_b64_tr_b16 a[100:101], v236 offset:40960
    v_cvt_pk_bf16_f32 v164, v64, v65
    v_mfma_f32_16x16x32_bf16 v[104:107], a[44:47], a[76:79], v[196:199]
    v_exp_f32 v66, v66
    v_mfma_f32_16x16x32_bf16 v[104:107], a[40:43], a[72:75], v[104:107]
    ds_read_b64_tr_b16 a[102:103], v236 offset:45056
    ds_read_b64_tr_b16 a[104:105], v237 offset:32768
    v_mfma_f32_16x16x32_bf16 v[104:107], a[36:39], a[12:15], v[104:107]
    v_exp_f32 v67, v67
    v_mfma_f32_16x16x32_bf16 v[104:107], a[32:35], a[8:11], v[104:107]
    ds_read_b64_tr_b16 a[106:107], v237 offset:36864
    v_cvt_pk_bf16_f32 v165, v66, v67
    v_mfma_f32_16x16x32_bf16 v[112:115], a[32:35], a[16:19], v[200:203]
    v_exp_f32 v68, v68
    v_mfma_f32_16x16x32_bf16 v[112:115], a[36:39], a[20:23], v[112:115]
    ds_read_b64_tr_b16 a[108:109], v237 offset:40960
    ds_read_b64_tr_b16 a[110:111], v237 offset:45056
    v_mfma_f32_16x16x32_bf16 v[112:115], a[40:43], a[80:83], v[112:115]
    v_exp_f32 v69, v69
    v_mfma_f32_16x16x32_bf16 v[112:115], a[44:47], a[84:87], v[112:115]
    ds_read_b64_tr_b16 a[112:113], v238 offset:32768
    v_cvt_pk_bf16_f32 v166, v68, v69
    v_mfma_f32_16x16x32_bf16 v[120:123], a[44:47], a[92:95], v[204:207]
    v_exp_f32 v70, v70
    v_mfma_f32_16x16x32_bf16 v[120:123], a[40:43], a[88:91], v[120:123]
    ds_read_b64_tr_b16 a[114:115], v238 offset:36864
    ds_read_b64_tr_b16 a[116:117], v238 offset:40960
    v_mfma_f32_16x16x32_bf16 v[120:123], a[36:39], a[28:31], v[120:123]
    v_exp_f32 v71, v71
    v_mfma_f32_16x16x32_bf16 v[120:123], a[32:35], a[24:27], v[120:123]
    ds_read_b64_tr_b16 a[118:119], v238 offset:45056
    v_cvt_pk_bf16_f32 v167, v70, v71
    v_mfma_f32_16x16x32_bf16 v[100:103], a[48:51], a[0:3], v[192:195]
    v_exp_f32 v72, v72
    v_mfma_f32_16x16x32_bf16 v[100:103], a[52:55], a[4:7], v[100:103]
    ds_read_b64_tr_b16 a[120:121], v239 offset:32768
    ds_read_b64_tr_b16 a[122:123], v239 offset:36864
    v_mfma_f32_16x16x32_bf16 v[100:103], a[56:59], a[64:67], v[100:103]
    v_exp_f32 v73, v73
    v_mfma_f32_16x16x32_bf16 v[100:103], a[60:63], a[68:71], v[100:103]
    ds_read_b64_tr_b16 a[124:125], v239 offset:40960
    v_cvt_pk_bf16_f32 v172, v72, v73
    v_mfma_f32_16x16x32_bf16 v[108:111], a[60:63], a[76:79], v[196:199]
    v_exp_f32 v74, v74
    v_mfma_f32_16x16x32_bf16 v[108:111], a[56:59], a[72:75], v[108:111]
    ds_read_b64_tr_b16 a[126:127], v239 offset:45056
    v_mfma_f32_16x16x32_bf16 v[108:111], a[52:55], a[12:15], v[108:111]
    v_exp_f32 v75, v75
    v_mfma_f32_16x16x32_bf16 v[108:111], a[48:51], a[8:11], v[108:111]
    v_cvt_pk_bf16_f32 v173, v74, v75
    v_mfma_f32_16x16x32_bf16 v[116:119], a[48:51], a[16:19], v[200:203]
    v_exp_f32 v76, v76
    v_mfma_f32_16x16x32_bf16 v[116:119], a[52:55], a[20:23], v[116:119]
    v_mfma_f32_16x16x32_bf16 v[116:119], a[56:59], a[80:83], v[116:119]
    v_exp_f32 v77, v77
    v_mfma_f32_16x16x32_bf16 v[116:119], a[60:63], a[84:87], v[116:119]
    v_cvt_pk_bf16_f32 v174, v76, v77
    v_mfma_f32_16x16x32_bf16 v[124:127], a[60:63], a[92:95], v[204:207]
    s_waitcnt lgkmcnt(0)
    v_exp_f32 v78, v78
    v_mfma_f32_16x16x32_bf16 v[124:127], a[56:59], a[88:91], v[124:127]
    v_mfma_f32_16x16x32_bf16 v[124:127], a[52:55], a[28:31], v[124:127]
    s_waitcnt vmcnt(14)
    v_exp_f32 v79, v79
    v_mfma_f32_16x16x32_bf16 v[124:127], a[48:51], a[24:27], v[124:127]
    s_barrier
    v_cvt_pk_bf16_f32 v175, v78, v79
    v_smfmac_f32_16x16x64_bf16 v[216:219], v[224:227], v[144:151], v252
    v_exp_f32 v80, v80
    v_smfmac_f32_16x16x64_bf16 v[220:223], v[224:227], v[152:159], v252
    ds_read_b128 a[32:35], v228 offset:32768
    ds_read_b128 a[36:39], v229 offset:32768
    v_mfma_f32_16x16x32_bf16 a[144:147], a[96:99], v[128:131], a[144:147]
    v_exp_f32 v81, v81
    v_mfma_f32_16x16x32_bf16 a[144:147], a[100:103], v[132:135], a[144:147]
    ds_read_b128 a[40:43], v230 offset:32768
    v_cvt_pk_bf16_f32 v180, v80, v81
    v_mfma_f32_16x16x32_bf16 a[176:179], a[100:103], v[140:143], a[176:179]
    v_exp_f32 v82, v82
    v_mfma_f32_16x16x32_bf16 a[176:179], a[96:99], v[136:139], a[176:179]
    ds_read_b128 a[44:47], v231 offset:32768
    ds_read_b128 a[48:51], v228 offset:36864
    v_mfma_f32_16x16x32_bf16 a[208:211], a[96:99], v[144:147], a[208:211]
    v_exp_f32 v83, v83
    v_mfma_f32_16x16x32_bf16 a[208:211], a[100:103], v[148:151], a[208:211]
    ds_read_b128 a[52:55], v229 offset:36864
    v_cvt_pk_bf16_f32 v181, v82, v83
    v_mfma_f32_16x16x32_bf16 a[240:243], a[100:103], v[156:159], a[240:243]
    v_exp_f32 v84, v84
    v_mfma_f32_16x16x32_bf16 a[240:243], a[96:99], v[152:155], a[240:243]
    ds_read_b128 a[56:59], v230 offset:36864
    ds_read_b128 a[60:63], v231 offset:36864
    v_mfma_f32_16x16x32_bf16 a[148:151], a[104:107], v[128:131], a[148:151]
    v_exp_f32 v85, v85
    v_mfma_f32_16x16x32_bf16 a[148:151], a[108:111], v[132:135], a[148:151]
    buffer_load_dword v12, off, s[44:47], 0 offset:192 sc1
    v_cvt_pk_bf16_f32 v182, v84, v85
    v_mfma_f32_16x16x32_bf16 a[180:183], a[108:111], v[140:143], a[180:183]
    v_exp_f32 v86, v86
    v_mfma_f32_16x16x32_bf16 a[180:183], a[104:107], v[136:139], a[180:183]
    v_mfma_f32_16x16x32_bf16 a[212:215], a[104:107], v[144:147], a[212:215]
    v_exp_f32 v87, v87
    v_mfma_f32_16x16x32_bf16 a[212:215], a[108:111], v[148:151], a[212:215]
    v_cvt_pk_bf16_f32 v183, v86, v87
    v_mfma_f32_16x16x32_bf16 a[244:247], a[108:111], v[156:159], a[244:247]
    v_exp_f32 v88, v88
    v_mfma_f32_16x16x32_bf16 a[244:247], a[104:107], v[152:155], a[244:247]
    v_mfma_f32_16x16x32_bf16 a[152:155], a[112:115], v[128:131], a[152:155]
    v_exp_f32 v89, v89
    v_mfma_f32_16x16x32_bf16 a[152:155], a[116:119], v[132:135], a[152:155]
    v_cvt_pk_bf16_f32 v188, v88, v89
    v_mfma_f32_16x16x32_bf16 a[184:187], a[116:119], v[140:143], a[184:187]
    v_exp_f32 v90, v90
    v_mfma_f32_16x16x32_bf16 a[184:187], a[112:115], v[136:139], a[184:187]
    v_mfma_f32_16x16x32_bf16 a[216:219], a[112:115], v[144:147], a[216:219]
    v_exp_f32 v91, v91
    v_mfma_f32_16x16x32_bf16 a[216:219], a[116:119], v[148:151], a[216:219]
    v_cvt_pk_bf16_f32 v189, v90, v91
    v_mfma_f32_16x16x32_bf16 a[248:251], a[116:119], v[156:159], a[248:251]
    v_exp_f32 v92, v92
    v_mfma_f32_16x16x32_bf16 a[248:251], a[112:115], v[152:155], a[248:251]
    v_mfma_f32_16x16x32_bf16 a[156:159], a[120:123], v[128:131], a[156:159]
    v_exp_f32 v93, v93
    v_mfma_f32_16x16x32_bf16 a[156:159], a[124:127], v[132:135], a[156:159]
    v_cvt_pk_bf16_f32 v190, v92, v93
    v_mfma_f32_16x16x32_bf16 a[188:191], a[124:127], v[140:143], a[188:191]
    v_exp_f32 v94, v94
    v_mfma_f32_16x16x32_bf16 a[188:191], a[120:123], v[136:139], a[188:191]
    v_mfma_f32_16x16x32_bf16 a[220:223], a[120:123], v[144:147], a[220:223]
    v_exp_f32 v95, v95
    v_mfma_f32_16x16x32_bf16 a[220:223], a[124:127], v[148:151], a[220:223]
    v_cvt_pk_bf16_f32 v191, v94, v95
    v_mfma_f32_16x16x32_bf16 a[252:255], a[124:127], v[156:159], a[252:255]
    v_mfma_f32_16x16x32_bf16 a[252:255], a[120:123], v[152:155], a[252:255]
    s_waitcnt lgkmcnt(0)
    v_mfma_f32_16x16x32_bf16 v[64:67], a[32:35], a[0:3], v[192:195]
    v_exp_f32 v96, v96
    v_mfma_f32_16x16x32_bf16 v[64:67], a[36:39], a[4:7], v[64:67]
    ds_read_b64_tr_b16 a[96:97], v232 offset:49152
    ds_read_b64_tr_b16 a[98:99], v232 offset:53248
    v_mfma_f32_16x16x32_bf16 v[64:67], a[40:43], a[64:67], v[64:67]
    v_exp_f32 v97, v97
    v_mfma_f32_16x16x32_bf16 v[64:67], a[44:47], a[68:71], v[64:67]
    ds_read_b64_tr_b16 a[100:101], v232 offset:57344
    v_cvt_pk_bf16_f32 v128, v96, v97
    v_mfma_f32_16x16x32_bf16 v[72:75], a[44:47], a[76:79], v[196:199]
    v_exp_f32 v98, v98
    v_mfma_f32_16x16x32_bf16 v[72:75], a[40:43], a[72:75], v[72:75]
    ds_read_b64_tr_b16 a[102:103], v232 offset:61440
    ds_read_b64_tr_b16 a[104:105], v233 offset:49152
    v_mfma_f32_16x16x32_bf16 v[72:75], a[36:39], a[12:15], v[72:75]
    v_exp_f32 v99, v99
    v_mfma_f32_16x16x32_bf16 v[72:75], a[32:35], a[8:11], v[72:75]
    ds_read_b64_tr_b16 a[106:107], v233 offset:53248
    v_cvt_pk_bf16_f32 v129, v98, v99
    v_mfma_f32_16x16x32_bf16 v[80:83], a[32:35], a[16:19], v[200:203]
    v_exp_f32 v100, v100
    v_mfma_f32_16x16x32_bf16 v[80:83], a[36:39], a[20:23], v[80:83]
    ds_read_b64_tr_b16 a[108:109], v233 offset:57344
    ds_read_b64_tr_b16 a[110:111], v233 offset:61440
    v_mfma_f32_16x16x32_bf16 v[80:83], a[40:43], a[80:83], v[80:83]
    v_exp_f32 v101, v101
    v_mfma_f32_16x16x32_bf16 v[80:83], a[44:47], a[84:87], v[80:83]
    ds_read_b64_tr_b16 a[112:113], v234 offset:49152
    v_cvt_pk_bf16_f32 v130, v100, v101
    v_mfma_f32_16x16x32_bf16 v[88:91], a[44:47], a[92:95], v[204:207]
    v_exp_f32 v102, v102
    v_mfma_f32_16x16x32_bf16 v[88:91], a[40:43], a[88:91], v[88:91]
    ds_read_b64_tr_b16 a[114:115], v234 offset:53248
    ds_read_b64_tr_b16 a[116:117], v234 offset:57344
    v_mfma_f32_16x16x32_bf16 v[88:91], a[36:39], a[28:31], v[88:91]
    v_exp_f32 v103, v103
    v_mfma_f32_16x16x32_bf16 v[88:91], a[32:35], a[24:27], v[88:91]
    ds_read_b64_tr_b16 a[118:119], v234 offset:61440
    v_cvt_pk_bf16_f32 v131, v102, v103
    v_mfma_f32_16x16x32_bf16 v[68:71], a[48:51], a[0:3], v[192:195]
    v_exp_f32 v104, v104
    v_mfma_f32_16x16x32_bf16 v[68:71], a[52:55], a[4:7], v[68:71]
    ds_read_b64_tr_b16 a[120:121], v235 offset:49152
    ds_read_b64_tr_b16 a[122:123], v235 offset:53248
    v_mfma_f32_16x16x32_bf16 v[68:71], a[56:59], a[64:67], v[68:71]
    v_exp_f32 v105, v105
    v_mfma_f32_16x16x32_bf16 v[68:71], a[60:63], a[68:71], v[68:71]
    ds_read_b64_tr_b16 a[124:125], v235 offset:57344
    v_cvt_pk_bf16_f32 v136, v104, v105
    v_mfma_f32_16x16x32_bf16 v[76:79], a[60:63], a[76:79], v[196:199]
    v_exp_f32 v106, v106
    v_mfma_f32_16x16x32_bf16 v[76:79], a[56:59], a[72:75], v[76:79]
    ds_read_b64_tr_b16 a[126:127], v235 offset:61440
    v_mfma_f32_16x16x32_bf16 v[76:79], a[52:55], a[12:15], v[76:79]
    v_exp_f32 v107, v107
    v_mfma_f32_16x16x32_bf16 v[76:79], a[48:51], a[8:11], v[76:79]
    v_cvt_pk_bf16_f32 v137, v106, v107
    v_mfma_f32_16x16x32_bf16 v[84:87], a[48:51], a[16:19], v[200:203]
    v_exp_f32 v108, v108
    v_mfma_f32_16x16x32_bf16 v[84:87], a[52:55], a[20:23], v[84:87]
    v_mfma_f32_16x16x32_bf16 v[84:87], a[56:59], a[80:83], v[84:87]
    v_exp_f32 v109, v109
    v_mfma_f32_16x16x32_bf16 v[84:87], a[60:63], a[84:87], v[84:87]
    v_cvt_pk_bf16_f32 v138, v108, v109
    v_mfma_f32_16x16x32_bf16 v[92:95], a[60:63], a[92:95], v[204:207]
    s_waitcnt lgkmcnt(0)
    v_exp_f32 v110, v110
    v_mfma_f32_16x16x32_bf16 v[92:95], a[56:59], a[88:91], v[92:95]
    v_mfma_f32_16x16x32_bf16 v[92:95], a[52:55], a[28:31], v[92:95]
    v_exp_f32 v111, v111
    v_mfma_f32_16x16x32_bf16 v[92:95], a[48:51], a[24:27], v[92:95]
    v_cvt_pk_bf16_f32 v139, v110, v111
    v_smfmac_f32_16x16x64_bf16 v[208:211], v[224:227], v[160:167], v252
    v_exp_f32 v112, v112
    v_smfmac_f32_16x16x64_bf16 v[212:215], v[224:227], v[168:175], v252
    ds_read_b128 a[32:35], v228 offset:40960
    ds_read_b128 a[36:39], v229 offset:40960
    v_mfma_f32_16x16x32_bf16 a[128:131], a[96:99], v[160:163], a[128:131]
    s_add_u32 m0, s52, 32768
    v_exp_f32 v113, v113
    v_mfma_f32_16x16x32_bf16 a[128:131], a[100:103], v[164:167], a[128:131]
    ds_read_b128 a[40:43], v230 offset:40960
    v_cvt_pk_bf16_f32 v144, v112, v113
    v_mfma_f32_16x16x32_bf16 a[160:163], a[100:103], v[172:175], a[160:163]
    v_exp_f32 v114, v114
    v_mfma_f32_16x16x32_bf16 a[160:163], a[96:99], v[168:171], a[160:163]
    ds_read_b128 a[44:47], v231 offset:40960
    ds_read_b128 a[48:51], v228 offset:45056
    v_mfma_f32_16x16x32_bf16 a[192:195], a[96:99], v[176:179], a[192:195]
    v_exp_f32 v115, v115
    v_mfma_f32_16x16x32_bf16 a[192:195], a[100:103], v[180:183], a[192:195]
    ds_read_b128 a[52:55], v229 offset:45056
    v_cvt_pk_bf16_f32 v145, v114, v115
    v_mfma_f32_16x16x32_bf16 a[224:227], a[100:103], v[188:191], a[224:227]
    v_exp_f32 v116, v116
    v_mfma_f32_16x16x32_bf16 a[224:227], a[96:99], v[184:187], a[224:227]
    ds_read_b128 a[56:59], v230 offset:45056
    ds_read_b128 a[60:63], v231 offset:45056
    v_mfma_f32_16x16x32_bf16 a[132:135], a[104:107], v[160:163], a[132:135]
    v_exp_f32 v117, v117
    v_mfma_f32_16x16x32_bf16 a[132:135], a[108:111], v[164:167], a[132:135]
    buffer_load_dwordx4 v8, s[24:27], s17 offen offset:0 nt lds
    v_cvt_pk_bf16_f32 v146, v116, v117
    v_mfma_f32_16x16x32_bf16 a[164:167], a[108:111], v[172:175], a[164:167]
    v_exp_f32 v118, v118
    v_mfma_f32_16x16x32_bf16 a[164:167], a[104:107], v[168:171], a[164:167]
    s_waitcnt vmcnt(1)
    v_readfirstlane_b32 s68, v12
    v_mfma_f32_16x16x32_bf16 a[196:199], a[104:107], v[176:179], a[196:199]
    v_exp_f32 v119, v119
    v_mfma_f32_16x16x32_bf16 a[196:199], a[108:111], v[180:183], a[196:199]
    s_lshr_b32 s68, s68, 0
    s_and_b32 s68, s68, 65535
    s_cmp_ge_u32 s68, 256
    s_cbranch_scc1 L_pa_ok
    s_cmp_lg_u32 s48, 0
    s_cbranch_scc1 L_pa_ok
    s_mov_b32 s69, 65536
L_pa_spin:
    s_sleep 64
    buffer_load_dword v12, off, s[44:47], 0 offset:192 sc1
    s_waitcnt vmcnt(0)
    v_readfirstlane_b32 s68, v12
    s_nop 1
    s_lshr_b32 s68, s68, 0
    s_and_b32 s68, s68, 65535
    s_cmp_ge_u32 s68, 256
    s_cbranch_scc1 L_pa_ok
    s_sub_u32 s69, s69, 1
    s_cmp_lg_u32 s69, 0
    s_cbranch_scc1 L_pa_spin
L_pa_ok:
    v_cvt_pk_bf16_f32 v147, v118, v119
    v_mfma_f32_16x16x32_bf16 a[228:231], a[108:111], v[188:191], a[228:231]
    v_exp_f32 v120, v120
    v_mfma_f32_16x16x32_bf16 a[228:231], a[104:107], v[184:187], a[228:231]
    buffer_load_dwordx4 v9, s[24:27], s17 offen offset:1024 nt lds
    v_mfma_f32_16x16x32_bf16 a[136:139], a[112:115], v[160:163], a[136:139]
    v_exp_f32 v121, v121
    v_mfma_f32_16x16x32_bf16 a[136:139], a[116:119], v[164:167], a[136:139]
    v_cvt_pk_bf16_f32 v152, v120, v121
    v_mfma_f32_16x16x32_bf16 a[168:171], a[116:119], v[172:175], a[168:171]
    v_exp_f32 v122, v122
    v_mfma_f32_16x16x32_bf16 a[168:171], a[112:115], v[168:171], a[168:171]
    v_mfma_f32_16x16x32_bf16 a[200:203], a[112:115], v[176:179], a[200:203]
    v_exp_f32 v123, v123
    v_mfma_f32_16x16x32_bf16 a[200:203], a[116:119], v[180:183], a[200:203]
    buffer_load_dwordx4 v8, s[24:27], s17 offen offset:2048 nt lds
    v_cvt_pk_bf16_f32 v153, v122, v123
    v_mfma_f32_16x16x32_bf16 a[232:235], a[116:119], v[188:191], a[232:235]
    v_exp_f32 v124, v124
    v_mfma_f32_16x16x32_bf16 a[232:235], a[112:115], v[184:187], a[232:235]
    v_mfma_f32_16x16x32_bf16 a[140:143], a[120:123], v[160:163], a[140:143]
    v_exp_f32 v125, v125
    v_mfma_f32_16x16x32_bf16 a[140:143], a[124:127], v[164:167], a[140:143]
    v_cvt_pk_bf16_f32 v154, v124, v125
    v_mfma_f32_16x16x32_bf16 a[172:175], a[124:127], v[172:175], a[172:175]
    v_exp_f32 v126, v126
    v_mfma_f32_16x16x32_bf16 a[172:175], a[120:123], v[168:171], a[172:175]
    buffer_load_dwordx4 v9, s[24:27], s17 offen offset:3072 nt lds
    v_mfma_f32_16x16x32_bf16 a[204:207], a[120:123], v[176:179], a[204:207]
    s_add_u32 s17, s17, 16384
    v_exp_f32 v127, v127
    v_mfma_f32_16x16x32_bf16 a[204:207], a[124:127], v[180:183], a[204:207]
    s_and_b32 s17, s17, 0x7ffff
    v_cvt_pk_bf16_f32 v155, v126, v127
    v_mfma_f32_16x16x32_bf16 a[236:239], a[124:127], v[188:191], a[236:239]
    v_mfma_f32_16x16x32_bf16 a[236:239], a[120:123], v[184:187], a[236:239]
    s_waitcnt lgkmcnt(0)
    v_mfma_f32_16x16x32_bf16 v[96:99], a[32:35], a[0:3], v[192:195]
    v_exp_f32 v64, v64
    v_mfma_f32_16x16x32_bf16 v[96:99], a[36:39], a[4:7], v[96:99]
    ds_read_b64_tr_b16 a[96:97], v236 offset:49152
    ds_read_b64_tr_b16 a[98:99], v236 offset:53248
    v_mfma_f32_16x16x32_bf16 v[96:99], a[40:43], a[64:67], v[96:99]
    v_exp_f32 v65, v65
    v_mfma_f32_16x16x32_bf16 v[96:99], a[44:47], a[68:71], v[96:99]
    ds_read_b64_tr_b16 a[100:101], v236 offset:57344
    v_cvt_pk_bf16_f32 v132, v64, v65
    v_mfma_f32_16x16x32_bf16 v[104:107], a[44:47], a[76:79], v[196:199]
    v_exp_f32 v66, v66
    v_mfma_f32_16x16x32_bf16 v[104:107], a[40:43], a[72:75], v[104:107]
    ds_read_b64_tr_b16 a[102:103], v236 offset:61440
    ds_read_b64_tr_b16 a[104:105], v237 offset:49152
    v_mfma_f32_16x16x32_bf16 v[104:107], a[36:39], a[12:15], v[104:107]
    v_exp_f32 v67, v67
    v_mfma_f32_16x16x32_bf16 v[104:107], a[32:35], a[8:11], v[104:107]
    ds_read_b64_tr_b16 a[106:107], v237 offset:53248
    v_cvt_pk_bf16_f32 v133, v66, v67
    v_mfma_f32_16x16x32_bf16 v[112:115], a[32:35], a[16:19], v[200:203]
    v_exp_f32 v68, v68
    v_mfma_f32_16x16x32_bf16 v[112:115], a[36:39], a[20:23], v[112:115]
    ds_read_b64_tr_b16 a[108:109], v237 offset:57344
    ds_read_b64_tr_b16 a[110:111], v237 offset:61440
    v_mfma_f32_16x16x32_bf16 v[112:115], a[40:43], a[80:83], v[112:115]
    v_exp_f32 v69, v69
    v_mfma_f32_16x16x32_bf16 v[112:115], a[44:47], a[84:87], v[112:115]
    ds_read_b64_tr_b16 a[112:113], v238 offset:49152
    v_cvt_pk_bf16_f32 v134, v68, v69
    v_mfma_f32_16x16x32_bf16 v[120:123], a[44:47], a[92:95], v[204:207]
    v_exp_f32 v70, v70
    v_mfma_f32_16x16x32_bf16 v[120:123], a[40:43], a[88:91], v[120:123]
    ds_read_b64_tr_b16 a[114:115], v238 offset:53248
    ds_read_b64_tr_b16 a[116:117], v238 offset:57344
    v_mfma_f32_16x16x32_bf16 v[120:123], a[36:39], a[28:31], v[120:123]
    v_exp_f32 v71, v71
    v_mfma_f32_16x16x32_bf16 v[120:123], a[32:35], a[24:27], v[120:123]
    ds_read_b64_tr_b16 a[118:119], v238 offset:61440
    v_cvt_pk_bf16_f32 v135, v70, v71
    v_mfma_f32_16x16x32_bf16 v[100:103], a[48:51], a[0:3], v[192:195]
    v_exp_f32 v72, v72
    v_mfma_f32_16x16x32_bf16 v[100:103], a[52:55], a[4:7], v[100:103]
    ds_read_b64_tr_b16 a[120:121], v239 offset:49152
    ds_read_b64_tr_b16 a[122:123], v239 offset:53248
    v_mfma_f32_16x16x32_bf16 v[100:103], a[56:59], a[64:67], v[100:103]
    v_exp_f32 v73, v73
    v_mfma_f32_16x16x32_bf16 v[100:103], a[60:63], a[68:71], v[100:103]
    ds_read_b64_tr_b16 a[124:125], v239 offset:57344
    v_cvt_pk_bf16_f32 v140, v72, v73
    v_mfma_f32_16x16x32_bf16 v[108:111], a[60:63], a[76:79], v[196:199]
    v_exp_f32 v74, v74
    v_mfma_f32_16x16x32_bf16 v[108:111], a[56:59], a[72:75], v[108:111]
    ds_read_b64_tr_b16 a[126:127], v239 offset:61440
    v_mfma_f32_16x16x32_bf16 v[108:111], a[52:55], a[12:15], v[108:111]
    v_exp_f32 v75, v75
    v_mfma_f32_16x16x32_bf16 v[108:111], a[48:51], a[8:11], v[108:111]
    v_cvt_pk_bf16_f32 v141, v74, v75
    v_mfma_f32_16x16x32_bf16 v[116:119], a[48:51], a[16:19], v[200:203]
    v_exp_f32 v76, v76
    v_mfma_f32_16x16x32_bf16 v[116:119], a[52:55], a[20:23], v[116:119]
    v_mfma_f32_16x16x32_bf16 v[116:119], a[56:59], a[80:83], v[116:119]
    v_exp_f32 v77, v77
    v_mfma_f32_16x16x32_bf16 v[116:119], a[60:63], a[84:87], v[116:119]
    v_cvt_pk_bf16_f32 v142, v76, v77
    v_mfma_f32_16x16x32_bf16 v[124:127], a[60:63], a[92:95], v[204:207]
    s_waitcnt lgkmcnt(0)
    v_exp_f32 v78, v78
    v_mfma_f32_16x16x32_bf16 v[124:127], a[56:59], a[88:91], v[124:127]
    v_mfma_f32_16x16x32_bf16 v[124:127], a[52:55], a[28:31], v[124:127]
    v_exp_f32 v79, v79
    v_mfma_f32_16x16x32_bf16 v[124:127], a[48:51], a[24:27], v[124:127]
    s_barrier
    v_cvt_pk_bf16_f32 v143, v78, v79
    v_smfmac_f32_16x16x64_bf16 v[216:219], v[224:227], v[176:183], v252
    v_exp_f32 v80, v80
    v_smfmac_f32_16x16x64_bf16 v[220:223], v[224:227], v[184:191], v252
    s_add_u32 s79, s80, 0
    ds_read_b128 a[32:35], v228 offset:49152
    ds_read_b128 a[36:39], v229 offset:49152
    v_mfma_f32_16x16x32_bf16 a[144:147], a[96:99], v[160:163], a[144:147]
    s_add_u32 m0, s88, 73728
    v_exp_f32 v81, v81
    v_mfma_f32_16x16x32_bf16 a[144:147], a[100:103], v[164:167], a[144:147]
    ds_read_b128 a[40:43], v230 offset:49152
    v_cvt_pk_bf16_f32 v148, v80, v81
    v_mfma_f32_16x16x32_bf16 a[176:179], a[100:103], v[172:175], a[176:179]
    v_exp_f32 v82, v82
    v_mfma_f32_16x16x32_bf16 a[176:179], a[96:99], v[168:171], a[176:179]
    ds_read_b128 a[44:47], v231 offset:49152
    ds_read_b128 a[48:51], v228 offset:53248
    v_mfma_f32_16x16x32_bf16 a[208:211], a[96:99], v[176:179], a[208:211]
    v_exp_f32 v83, v83
    v_mfma_f32_16x16x32_bf16 a[208:211], a[100:103], v[180:183], a[208:211]
    ds_read_b128 a[52:55], v229 offset:53248
    v_cvt_pk_bf16_f32 v149, v82, v83
    v_mfma_f32_16x16x32_bf16 a[240:243], a[100:103], v[188:191], a[240:243]
    v_exp_f32 v84, v84
    v_mfma_f32_16x16x32_bf16 a[240:243], a[96:99], v[184:187], a[240:243]
    ds_read_b128 a[56:59], v230 offset:53248
    ds_read_b128 a[60:63], v231 offset:53248
    v_mfma_f32_16x16x32_bf16 a[148:151], a[104:107], v[160:163], a[148:151]
    v_exp_f32 v85, v85
    v_mfma_f32_16x16x32_bf16 a[148:151], a[108:111], v[164:167], a[148:151]
    buffer_load_dwordx4 v2, s[28:31], s79 offen offset:0 sc1 lds
    v_cvt_pk_bf16_f32 v150, v84, v85
    v_mfma_f32_16x16x32_bf16 a[180:183], a[108:111], v[172:175], a[180:183]
    v_exp_f32 v86, v86
    v_mfma_f32_16x16x32_bf16 a[180:183], a[104:107], v[168:171], a[180:183]
    buffer_load_dwordx4 v2, s[28:31], s79 offen offset:1024 sc1 lds
    v_mfma_f32_16x16x32_bf16 a[212:215], a[104:107], v[176:179], a[212:215]
    s_add_u32 s79, s81, 0
    v_exp_f32 v87, v87
    v_mfma_f32_16x16x32_bf16 a[212:215], a[108:111], v[180:183], a[212:215]
    s_add_u32 m0, s88, 75776
    v_cvt_pk_bf16_f32 v151, v86, v87
    v_mfma_f32_16x16x32_bf16 a[244:247], a[108:111], v[188:191], a[244:247]
    v_exp_f32 v88, v88
    v_mfma_f32_16x16x32_bf16 a[244:247], a[104:107], v[184:187], a[244:247]
    buffer_load_dwordx4 v2, s[28:31], s79 offen offset:0 sc1 lds
    v_mfma_f32_16x16x32_bf16 a[152:155], a[112:115], v[160:163], a[152:155]
    v_exp_f32 v89, v89
    v_mfma_f32_16x16x32_bf16 a[152:155], a[116:119], v[164:167], a[152:155]
    buffer_load_dwordx4 v2, s[28:31], s79 offen offset:1024 sc1 lds
    v_cvt_pk_bf16_f32 v156, v88, v89
    v_mfma_f32_16x16x32_bf16 a[184:187], a[116:119], v[172:175], a[184:187]
    s_add_u32 s79, s82, 0
    v_exp_f32 v90, v90
    v_mfma_f32_16x16x32_bf16 a[184:187], a[112:115], v[168:171], a[184:187]
    s_add_u32 m0, s88, 77824
    v_mfma_f32_16x16x32_bf16 a[216:219], a[112:115], v[176:179], a[216:219]
    v_exp_f32 v91, v91
    v_mfma_f32_16x16x32_bf16 a[216:219], a[116:119], v[180:183], a[216:219]
    buffer_load_dwordx4 v2, s[28:31], s79 offen offset:0 sc1 lds
    v_cvt_pk_bf16_f32 v157, v90, v91
    v_mfma_f32_16x16x32_bf16 a[248:251], a[116:119], v[188:191], a[248:251]
    v_exp_f32 v92, v92
    v_mfma_f32_16x16x32_bf16 a[248:251], a[112:115], v[184:187], a[248:251]
    buffer_load_dwordx4 v2, s[28:31], s79 offen offset:1024 sc1 lds
    v_mfma_f32_16x16x32_bf16 a[156:159], a[120:123], v[160:163], a[156:159]
    s_add_u32 s79, s83, 0
    v_exp_f32 v93, v93
    v_mfma_f32_16x16x32_bf16 a[156:159], a[124:127], v[164:167], a[156:159]
    s_add_u32 m0, s88, 79872
    v_cvt_pk_bf16_f32 v158, v92, v93
    v_mfma_f32_16x16x32_bf16 a[188:191], a[124:127], v[172:175], a[188:191]
    v_exp_f32 v94, v94
    v_mfma_f32_16x16x32_bf16 a[188:191], a[120:123], v[168:171], a[188:191]
    buffer_load_dwordx4 v2, s[28:31], s79 offen offset:0 sc1 lds
    v_mfma_f32_16x16x32_bf16 a[220:223], a[120:123], v[176:179], a[220:223]
    v_exp_f32 v95, v95
    v_mfma_f32_16x16x32_bf16 a[220:223], a[124:127], v[180:183], a[220:223]
    buffer_load_dwordx4 v2, s[28:31], s79 offen offset:1024 sc1 lds
    v_cvt_pk_bf16_f32 v159, v94, v95
    v_mfma_f32_16x16x32_bf16 a[252:255], a[124:127], v[188:191], a[252:255]
    v_mfma_f32_16x16x32_bf16 a[252:255], a[120:123], v[184:187], a[252:255]
    s_waitcnt lgkmcnt(0)
    v_mfma_f32_16x16x32_bf16 v[64:67], a[32:35], a[0:3], v[192:195]
    s_add_u32 s79, s84, 0
    v_exp_f32 v96, v96
    v_mfma_f32_16x16x32_bf16 v[64:67], a[36:39], a[4:7], v[64:67]
    s_add_u32 m0, s88, 81920
    ds_read_b64_tr_b16 a[96:97], v232 offset:0
    ds_read_b64_tr_b16 a[98:99], v232 offset:4096
    v_mfma_f32_16x16x32_bf16 v[64:67], a[40:43], a[64:67], v[64:67]
    v_exp_f32 v97, v97
    v_mfma_f32_16x16x32_bf16 v[64:67], a[44:47], a[68:71], v[64:67]
    ds_read_b64_tr_b16 a[100:101], v232 offset:8192
    v_cvt_pk_bf16_f32 v160, v96, v97
    v_mfma_f32_16x16x32_bf16 v[72:75], a[44:47], a[76:79], v[196:199]
    v_exp_f32 v98, v98
    v_mfma_f32_16x16x32_bf16 v[72:75], a[40:43], a[72:75], v[72:75]
    ds_read_b64_tr_b16 a[102:103], v232 offset:12288
    ds_read_b64_tr_b16 a[104:105], v233 offset:0
    v_mfma_f32_16x16x32_bf16 v[72:75], a[36:39], a[12:15], v[72:75]
    v_exp_f32 v99, v99
    v_mfma_f32_16x16x32_bf16 v[72:75], a[32:35], a[8:11], v[72:75]
    ds_read_b64_tr_b16 a[106:107], v233 offset:4096
    v_cvt_pk_bf16_f32 v161, v98, v99
    v_mfma_f32_16x16x32_bf16 v[80:83], a[32:35], a[16:19], v[200:203]
    v_exp_f32 v100, v100
    v_mfma_f32_16x16x32_bf16 v[80:83], a[36:39], a[20:23], v[80:83]
    ds_read_b64_tr_b16 a[108:109], v233 offset:8192
    ds_read_b64_tr_b16 a[110:111], v233 offset:12288
    v_mfma_f32_16x16x32_bf16 v[80:83], a[40:43], a[80:83], v[80:83]
    v_exp_f32 v101, v101
    v_mfma_f32_16x16x32_bf16 v[80:83], a[44:47], a[84:87], v[80:83]
    ds_read_b64_tr_b16 a[112:113], v234 offset:0
    v_cvt_pk_bf16_f32 v162, v100, v101
    v_mfma_f32_16x16x32_bf16 v[88:91], a[44:47], a[92:95], v[204:207]
    v_exp_f32 v102, v102
    v_mfma_f32_16x16x32_bf16 v[88:91], a[40:43], a[88:91], v[88:91]
    ds_read_b64_tr_b16 a[114:115], v234 offset:4096
    ds_read_b64_tr_b16 a[116:117], v234 offset:8192
    v_mfma_f32_16x16x32_bf16 v[88:91], a[36:39], a[28:31], v[88:91]
    v_exp_f32 v103, v103
    v_mfma_f32_16x16x32_bf16 v[88:91], a[32:35], a[24:27], v[88:91]
    ds_read_b64_tr_b16 a[118:119], v234 offset:12288
    v_cvt_pk_bf16_f32 v163, v102, v103
    v_mfma_f32_16x16x32_bf16 v[68:71], a[48:51], a[0:3], v[192:195]
    v_exp_f32 v104, v104
    v_mfma_f32_16x16x32_bf16 v[68:71], a[52:55], a[4:7], v[68:71]
    ds_read_b64_tr_b16 a[120:121], v235 offset:0
    ds_read_b64_tr_b16 a[122:123], v235 offset:4096
    v_mfma_f32_16x16x32_bf16 v[68:71], a[56:59], a[64:67], v[68:71]
    v_exp_f32 v105, v105
    v_mfma_f32_16x16x32_bf16 v[68:71], a[60:63], a[68:71], v[68:71]
    ds_read_b64_tr_b16 a[124:125], v235 offset:8192
    v_cvt_pk_bf16_f32 v168, v104, v105
    v_mfma_f32_16x16x32_bf16 v[76:79], a[60:63], a[76:79], v[196:199]
    v_exp_f32 v106, v106
    v_mfma_f32_16x16x32_bf16 v[76:79], a[56:59], a[72:75], v[76:79]
    ds_read_b64_tr_b16 a[126:127], v235 offset:12288
    v_mfma_f32_16x16x32_bf16 v[76:79], a[52:55], a[12:15], v[76:79]
    v_exp_f32 v107, v107
    v_mfma_f32_16x16x32_bf16 v[76:79], a[48:51], a[8:11], v[76:79]
    buffer_load_dwordx4 v2, s[28:31], s79 offen offset:0 sc1 lds
    v_cvt_pk_bf16_f32 v169, v106, v107
    v_mfma_f32_16x16x32_bf16 v[84:87], a[48:51], a[16:19], v[200:203]
    s_add_u32 s87, s85, 0
    v_exp_f32 v108, v108
    v_mfma_f32_16x16x32_bf16 v[84:87], a[52:55], a[20:23], v[84:87]
    buffer_load_dwordx4 v[20:23], v2, s[28:31], s87 offen offset:0 sc1
    v_mfma_f32_16x16x32_bf16 v[84:87], a[56:59], a[80:83], v[84:87]
    v_exp_f32 v109, v109
    v_mfma_f32_16x16x32_bf16 v[84:87], a[60:63], a[84:87], v[84:87]
    v_cvt_pk_bf16_f32 v170, v108, v109
    v_mfma_f32_16x16x32_bf16 v[92:95], a[60:63], a[92:95], v[204:207]
    s_waitcnt lgkmcnt(0)
    v_exp_f32 v110, v110
    v_mfma_f32_16x16x32_bf16 v[92:95], a[56:59], a[88:91], v[92:95]
    v_mfma_f32_16x16x32_bf16 v[92:95], a[52:55], a[28:31], v[92:95]
    v_exp_f32 v111, v111
    v_mfma_f32_16x16x32_bf16 v[92:95], a[48:51], a[24:27], v[92:95]
    v_cvt_pk_bf16_f32 v171, v110, v111
    v_smfmac_f32_16x16x64_bf16 v[208:211], v[224:227], v[128:135], v252
    v_exp_f32 v112, v112
    v_smfmac_f32_16x16x64_bf16 v[212:215], v[224:227], v[136:143], v252
    ds_read_b128 a[32:35], v228 offset:57344
    ds_read_b128 a[36:39], v229 offset:57344
    v_mfma_f32_16x16x32_bf16 a[128:131], a[96:99], v[128:131], a[128:131]
    v_exp_f32 v113, v113
    v_mfma_f32_16x16x32_bf16 a[128:131], a[100:103], v[132:135], a[128:131]
    ds_read_b128 a[40:43], v230 offset:57344
    v_cvt_pk_bf16_f32 v176, v112, v113
    v_mfma_f32_16x16x32_bf16 a[160:163], a[100:103], v[140:143], a[160:163]
    v_exp_f32 v114, v114
    v_mfma_f32_16x16x32_bf16 a[160:163], a[96:99], v[136:139], a[160:163]
    ds_read_b128 a[44:47], v231 offset:57344
    ds_read_b128 a[48:51], v228 offset:61440
    v_mfma_f32_16x16x32_bf16 a[192:195], a[96:99], v[144:147], a[192:195]
    v_exp_f32 v115, v115
    v_mfma_f32_16x16x32_bf16 a[192:195], a[100:103], v[148:151], a[192:195]
    ds_read_b128 a[52:55], v229 offset:61440
    v_cvt_pk_bf16_f32 v177, v114, v115
    v_mfma_f32_16x16x32_bf16 a[224:227], a[100:103], v[156:159], a[224:227]
    v_exp_f32 v116, v116
    v_mfma_f32_16x16x32_bf16 a[224:227], a[96:99], v[152:155], a[224:227]
    ds_read_b128 a[56:59], v230 offset:61440
    ds_read_b128 a[60:63], v231 offset:61440
    v_mfma_f32_16x16x32_bf16 a[132:135], a[104:107], v[128:131], a[132:135]
    v_exp_f32 v117, v117
    v_mfma_f32_16x16x32_bf16 a[132:135], a[108:111], v[132:135], a[132:135]
    buffer_load_dwordx4 v[24:27], v2, s[28:31], s87 offen offset:1024 sc1
    v_cvt_pk_bf16_f32 v178, v116, v117
    v_mfma_f32_16x16x32_bf16 a[164:167], a[108:111], v[140:143], a[164:167]
    v_exp_f32 v118, v118
    v_mfma_f32_16x16x32_bf16 a[164:167], a[104:107], v[136:139], a[164:167]
    buffer_load_dwordx4 v[28:31], v2, s[28:31], s87 offen offset:2048 sc1
    v_mfma_f32_16x16x32_bf16 a[196:199], a[104:107], v[144:147], a[196:199]
    v_exp_f32 v119, v119
    v_mfma_f32_16x16x32_bf16 a[196:199], a[108:111], v[148:151], a[196:199]
    buffer_load_dwordx4 v[32:35], v2, s[28:31], s87 offen offset:3072 sc1
    v_cvt_pk_bf16_f32 v179, v118, v119
    v_mfma_f32_16x16x32_bf16 a[228:231], a[108:111], v[156:159], a[228:231]
    s_add_u32 s87, s85, 4096
    v_exp_f32 v120, v120
    v_mfma_f32_16x16x32_bf16 a[228:231], a[104:107], v[152:155], a[228:231]
    buffer_load_dwordx4 v[36:39], v2, s[28:31], s87 offen offset:0 sc1
    v_mfma_f32_16x16x32_bf16 a[136:139], a[112:115], v[128:131], a[136:139]
    s_add_u32 s79, s80, 147456
    v_exp_f32 v121, v121
    v_mfma_f32_16x16x32_bf16 a[136:139], a[116:119], v[132:135], a[136:139]
    s_add_u32 m0, s88, 110592
    v_cvt_pk_bf16_f32 v184, v120, v121
    v_mfma_f32_16x16x32_bf16 a[168:171], a[116:119], v[140:143], a[168:171]
    v_exp_f32 v122, v122
    v_mfma_f32_16x16x32_bf16 a[168:171], a[112:115], v[136:139], a[168:171]
    buffer_load_dwordx4 v2, s[28:31], s79 offen offset:0 sc1 lds
    v_mfma_f32_16x16x32_bf16 a[200:203], a[112:115], v[144:147], a[200:203]
    v_exp_f32 v123, v123
    v_mfma_f32_16x16x32_bf16 a[200:203], a[116:119], v[148:151], a[200:203]
    buffer_load_dwordx4 v2, s[28:31], s79 offen offset:1024 sc1 lds
    v_cvt_pk_bf16_f32 v185, v122, v123
    v_mfma_f32_16x16x32_bf16 a[232:235], a[116:119], v[156:159], a[232:235]
    v_exp_f32 v124, v124
    v_mfma_f32_16x16x32_bf16 a[232:235], a[112:115], v[152:155], a[232:235]
    s_add_u32 s79, s81, 147456
    s_add_u32 m0, s88, 112640
    v_mfma_f32_16x16x32_bf16 a[140:143], a[120:123], v[128:131], a[140:143]
    v_exp_f32 v125, v125
    v_mfma_f32_16x16x32_bf16 a[140:143], a[124:127], v[132:135], a[140:143]
    buffer_load_dwordx4 v2, s[28:31], s79 offen offset:0 sc1 lds
    v_cvt_pk_bf16_f32 v186, v124, v125
    v_mfma_f32_16x16x32_bf16 a[172:175], a[124:127], v[140:143], a[172:175]
    v_exp_f32 v126, v126
    v_mfma_f32_16x16x32_bf16 a[172:175], a[120:123], v[136:139], a[172:175]
    buffer_load_dwordx4 v2, s[28:31], s79 offen offset:1024 sc1 lds
    v_mfma_f32_16x16x32_bf16 a[204:207], a[120:123], v[144:147], a[204:207]
    v_exp_f32 v127, v127
    v_mfma_f32_16x16x32_bf16 a[204:207], a[124:127], v[148:151], a[204:207]
    v_cvt_pk_bf16_f32 v187, v126, v127
    v_mfma_f32_16x16x32_bf16 a[236:239], a[124:127], v[156:159], a[236:239]
    v_mfma_f32_16x16x32_bf16 a[236:239], a[120:123], v[152:155], a[236:239]
    s_waitcnt lgkmcnt(0)
    v_mfma_f32_16x16x32_bf16 v[96:99], a[32:35], a[0:3], v[192:195]
    s_add_u32 s79, s82, 147456
    v_exp_f32 v64, v64
    v_mfma_f32_16x16x32_bf16 v[96:99], a[36:39], a[4:7], v[96:99]
    s_add_u32 m0, s88, 114688
    ds_read_b64_tr_b16 a[96:97], v236 offset:0
    ds_read_b64_tr_b16 a[98:99], v236 offset:4096
    v_mfma_f32_16x16x32_bf16 v[96:99], a[40:43], a[64:67], v[96:99]
    v_exp_f32 v65, v65
    v_mfma_f32_16x16x32_bf16 v[96:99], a[44:47], a[68:71], v[96:99]
    ds_read_b64_tr_b16 a[100:101], v236 offset:8192
    v_cvt_pk_bf16_f32 v164, v64, v65
    v_mfma_f32_16x16x32_bf16 v[104:107], a[44:47], a[76:79], v[196:199]
    v_exp_f32 v66, v66
    v_mfma_f32_16x16x32_bf16 v[104:107], a[40:43], a[72:75], v[104:107]
    ds_read_b64_tr_b16 a[102:103], v236 offset:12288
    ds_read_b64_tr_b16 a[104:105], v237 offset:0
    v_mfma_f32_16x16x32_bf16 v[104:107], a[36:39], a[12:15], v[104:107]
    v_exp_f32 v67, v67
    v_mfma_f32_16x16x32_bf16 v[104:107], a[32:35], a[8:11], v[104:107]
    ds_read_b64_tr_b16 a[106:107], v237 offset:4096
    v_cvt_pk_bf16_f32 v165, v66, v67
    v_mfma_f32_16x16x32_bf16 v[112:115], a[32:35], a[16:19], v[200:203]
    v_exp_f32 v68, v68
    v_mfma_f32_16x16x32_bf16 v[112:115], a[36:39], a[20:23], v[112:115]
    ds_read_b64_tr_b16 a[108:109], v237 offset:8192
    ds_read_b64_tr_b16 a[110:111], v237 offset:12288
    v_mfma_f32_16x16x32_bf16 v[112:115], a[40:43], a[80:83], v[112:115]
    v_exp_f32 v69, v69
    v_mfma_f32_16x16x32_bf16 v[112:115], a[44:47], a[84:87], v[112:115]
    ds_read_b64_tr_b16 a[112:113], v238 offset:0
    v_cvt_pk_bf16_f32 v166, v68, v69
    v_mfma_f32_16x16x32_bf16 v[120:123], a[44:47], a[92:95], v[204:207]
    v_exp_f32 v70, v70
    v_mfma_f32_16x16x32_bf16 v[120:123], a[40:43], a[88:91], v[120:123]
    ds_read_b64_tr_b16 a[114:115], v238 offset:4096
    ds_read_b64_tr_b16 a[116:117], v238 offset:8192
    v_mfma_f32_16x16x32_bf16 v[120:123], a[36:39], a[28:31], v[120:123]
    v_exp_f32 v71, v71
    v_mfma_f32_16x16x32_bf16 v[120:123], a[32:35], a[24:27], v[120:123]
    ds_read_b64_tr_b16 a[118:119], v238 offset:12288
    v_cvt_pk_bf16_f32 v167, v70, v71
    v_mfma_f32_16x16x32_bf16 v[100:103], a[48:51], a[0:3], v[192:195]
    v_exp_f32 v72, v72
    v_mfma_f32_16x16x32_bf16 v[100:103], a[52:55], a[4:7], v[100:103]
    ds_read_b64_tr_b16 a[120:121], v239 offset:0
    ds_read_b64_tr_b16 a[122:123], v239 offset:4096
    v_mfma_f32_16x16x32_bf16 v[100:103], a[56:59], a[64:67], v[100:103]
    v_exp_f32 v73, v73
    v_mfma_f32_16x16x32_bf16 v[100:103], a[60:63], a[68:71], v[100:103]
    ds_read_b64_tr_b16 a[124:125], v239 offset:8192
    v_cvt_pk_bf16_f32 v172, v72, v73
    v_mfma_f32_16x16x32_bf16 v[108:111], a[60:63], a[76:79], v[196:199]
    v_exp_f32 v74, v74
    v_mfma_f32_16x16x32_bf16 v[108:111], a[56:59], a[72:75], v[108:111]
    ds_read_b64_tr_b16 a[126:127], v239 offset:12288
    v_mfma_f32_16x16x32_bf16 v[108:111], a[52:55], a[12:15], v[108:111]
    v_exp_f32 v75, v75
    v_mfma_f32_16x16x32_bf16 v[108:111], a[48:51], a[8:11], v[108:111]
    buffer_load_dwordx4 v2, s[28:31], s79 offen offset:0 sc1 lds
    v_cvt_pk_bf16_f32 v173, v74, v75
    v_mfma_f32_16x16x32_bf16 v[116:119], a[48:51], a[16:19], v[200:203]
    v_exp_f32 v76, v76
    v_mfma_f32_16x16x32_bf16 v[116:119], a[52:55], a[20:23], v[116:119]
    buffer_load_dwordx4 v2, s[28:31], s79 offen offset:1024 sc1 lds
    v_mfma_f32_16x16x32_bf16 v[116:119], a[56:59], a[80:83], v[116:119]
    v_exp_f32 v77, v77
    v_mfma_f32_16x16x32_bf16 v[116:119], a[60:63], a[84:87], v[116:119]
    v_cvt_pk_bf16_f32 v174, v76, v77
    v_mfma_f32_16x16x32_bf16 v[124:127], a[60:63], a[92:95], v[204:207]
    s_waitcnt lgkmcnt(0)
    v_exp_f32 v78, v78
    v_mfma_f32_16x16x32_bf16 v[124:127], a[56:59], a[88:91], v[124:127]
    v_mfma_f32_16x16x32_bf16 v[124:127], a[52:55], a[28:31], v[124:127]
    s_waitcnt vmcnt(20)
    v_exp_f32 v79, v79
    v_mfma_f32_16x16x32_bf16 v[124:127], a[48:51], a[24:27], v[124:127]
    s_barrier
    v_cvt_pk_bf16_f32 v175, v78, v79
    v_smfmac_f32_16x16x64_bf16 v[216:219], v[224:227], v[144:151], v252
    v_exp_f32 v80, v80
    v_smfmac_f32_16x16x64_bf16 v[220:223], v[224:227], v[152:159], v252
    s_add_u32 s79, s83, 147456
    v_mov_b32 v60, 0
    v_mov_b32 v61, 147456
    v_mfma_f32_16x16x32_bf16 a[144:147], a[96:99], v[128:131], a[144:147]
    s_add_u32 m0, s88, 116736
    v_exp_f32 v81, v81
    v_mfma_f32_16x16x32_bf16 a[144:147], a[100:103], v[132:135], a[144:147]
    ds_write_b32 v61, v60
    v_cvt_pk_bf16_f32 v180, v80, v81
    v_mfma_f32_16x16x32_bf16 a[176:179], a[100:103], v[140:143], a[176:179]
    v_exp_f32 v82, v82
    v_mfma_f32_16x16x32_bf16 a[176:179], a[96:99], v[136:139], a[176:179]
    buffer_load_dwordx4 v2, s[28:31], s79 offen offset:0 sc1 lds
    v_mfma_f32_16x16x32_bf16 a[208:211], a[96:99], v[144:147], a[208:211]
    v_exp_f32 v83, v83
    v_mfma_f32_16x16x32_bf16 a[208:211], a[100:103], v[148:151], a[208:211]
    buffer_load_dwordx4 v2, s[28:31], s79 offen offset:1024 sc1 lds
    v_cvt_pk_bf16_f32 v181, v82, v83
    v_mfma_f32_16x16x32_bf16 a[240:243], a[100:103], v[156:159], a[240:243]
    v_exp_f32 v84, v84
    v_mfma_f32_16x16x32_bf16 a[240:243], a[96:99], v[152:155], a[240:243]
    ds_read_b64_tr_b16 a[96:97], v232 offset:16384
    ds_read_b64_tr_b16 a[98:99], v232 offset:20480
    v_mfma_f32_16x16x32_bf16 a[148:151], a[104:107], v[128:131], a[148:151]
    s_add_u32 s79, s84, 147456
    v_exp_f32 v85, v85
    v_mfma_f32_16x16x32_bf16 a[148:151], a[108:111], v[132:135], a[148:151]
    s_add_u32 m0, s88, 118784
    ds_read_b64_tr_b16 a[100:101], v232 offset:24576
    v_cvt_pk_bf16_f32 v182, v84, v85
    v_mfma_f32_16x16x32_bf16 a[180:183], a[108:111], v[140:143], a[180:183]
    v_exp_f32 v86, v86
    v_mfma_f32_16x16x32_bf16 a[180:183], a[104:107], v[136:139], a[180:183]
    buffer_load_dwordx4 v2, s[28:31], s79 offen offset:0 sc1 lds
    ds_read_b64_tr_b16 a[102:103], v232 offset:28672
    v_mfma_f32_16x16x32_bf16 a[212:215], a[104:107], v[144:147], a[212:215]
    v_exp_f32 v87, v87
    v_mfma_f32_16x16x32_bf16 a[212:215], a[108:111], v[148:151], a[212:215]
    buffer_load_dwordx4 v[40:43], v2, s[28:31], s87 offen offset:1024 sc1
    v_cvt_pk_bf16_f32 v183, v86, v87
    v_mfma_f32_16x16x32_bf16 a[244:247], a[108:111], v[156:159], a[244:247]
    v_exp_f32 v88, v88
    v_mfma_f32_16x16x32_bf16 a[244:247], a[104:107], v[152:155], a[244:247]
    ds_read_b64_tr_b16 a[104:105], v233 offset:16384
    ds_read_b64_tr_b16 a[106:107], v233 offset:20480
    v_mfma_f32_16x16x32_bf16 a[152:155], a[112:115], v[128:131], a[152:155]
    v_exp_f32 v89, v89
    v_mfma_f32_16x16x32_bf16 a[152:155], a[116:119], v[132:135], a[152:155]
    buffer_load_dwordx4 v[44:47], v2, s[28:31], s87 offen offset:2048 sc1
    v_cvt_pk_bf16_f32 v188, v88, v89
    v_mfma_f32_16x16x32_bf16 a[184:187], a[116:119], v[140:143], a[184:187]
    v_exp_f32 v90, v90
    v_mfma_f32_16x16x32_bf16 a[184:187], a[112:115], v[136:139], a[184:187]
    ds_read_b64_tr_b16 a[108:109], v233 offset:24576
    ds_read_b64_tr_b16 a[110:111], v233 offset:28672
    v_mfma_f32_16x16x32_bf16 a[216:219], a[112:115], v[144:147], a[216:219]
    v_exp_f32 v91, v91
    v_mfma_f32_16x16x32_bf16 a[216:219], a[116:119], v[148:151], a[216:219]
    buffer_load_dwordx4 v[48:51], v2, s[28:31], s87 offen offset:3072 sc1
    v_cvt_pk_bf16_f32 v189, v90, v91
    v_mfma_f32_16x16x32_bf16 a[248:251], a[116:119], v[156:159], a[248:251]
    v_exp_f32 v92, v92
    v_mfma_f32_16x16x32_bf16 a[248:251], a[112:115], v[152:155], a[248:251]
    ds_read_b64_tr_b16 a[112:113], v234 offset:16384
    ds_read_b64_tr_b16 a[114:115], v234 offset:20480
    v_mfma_f32_16x16x32_bf16 a[156:159], a[120:123], v[128:131], a[156:159]
    v_exp_f32 v93, v93
    v_mfma_f32_16x16x32_bf16 a[156:159], a[124:127], v[132:135], a[156:159]
    ds_read_b64_tr_b16 a[116:117], v234 offset:24576
    v_cvt_pk_bf16_f32 v190, v92, v93
    v_mfma_f32_16x16x32_bf16 a[188:191], a[124:127], v[140:143], a[188:191]
    s_add_u32 s65, s53, 0
    v_exp_f32 v94, v94
    v_mfma_f32_16x16x32_bf16 a[188:191], a[120:123], v[136:139], a[188:191]
    s_add_u32 m0, s58, 0
    ds_read_b64_tr_b16 a[118:119], v234 offset:28672
    v_mfma_f32_16x16x32_bf16 a[220:223], a[120:123], v[144:147], a[220:223]
    v_exp_f32 v95, v95
    v_mfma_f32_16x16x32_bf16 a[220:223], a[124:127], v[148:151], a[220:223]
    buffer_load_dwordx4 v13, s[4:7], s65 offen lds
    v_cvt_pk_bf16_f32 v191, v94, v95
    v_mfma_f32_16x16x32_bf16 a[252:255], a[124:127], v[156:159], a[252:255]
    v_mfma_f32_16x16x32_bf16 a[252:255], a[120:123], v[152:155], a[252:255]
    ds_read_b64_tr_b16 a[120:121], v235 offset:16384
    ds_read_b64_tr_b16 a[122:123], v235 offset:20480
    ds_read_b64_tr_b16 a[124:125], v235 offset:24576
    ds_read_b64_tr_b16 a[126:127], v235 offset:28672
    v_smfmac_f32_16x16x64_bf16 v[208:211], v[224:227], v[160:167], v252
    s_add_u32 s65, s53, 18432
    v_exp_f32 v96, v96
    v_smfmac_f32_16x16x64_bf16 v[212:215], v[224:227], v[168:175], v252
    s_add_u32 m0, s58, 1024
    s_waitcnt lgkmcnt(14)
    v_mfma_f32_16x16x32_bf16 a[128:131], a[96:99], v[160:163], a[128:131]
    v_exp_f32 v97, v97
    s_waitcnt lgkmcnt(12)
    v_mfma_f32_16x16x32_bf16 a[128:131], a[100:103], v[164:167], a[128:131]
    buffer_load_dwordx4 v13, s[4:7], s65 offen lds
    v_cvt_pk_bf16_f32 v128, v96, v97
    v_mfma_f32_16x16x32_bf16 a[160:163], a[100:103], v[172:175], a[160:163]
    s_add_u32 s65, s54, 0
    v_exp_f32 v98, v98
    v_mfma_f32_16x16x32_bf16 a[160:163], a[96:99], v[168:171], a[160:163]
    s_add_u32 m0, s58, 2048
    v_mfma_f32_16x16x32_bf16 a[192:195], a[96:99], v[176:179], a[192:195]
    v_exp_f32 v99, v99
    v_mfma_f32_16x16x32_bf16 a[192:195], a[100:103], v[180:183], a[192:195]
    buffer_load_dwordx4 v14, s[4:7], s65 offen lds
    v_cvt_pk_bf16_f32 v129, v98, v99
    v_mfma_f32_16x16x32_bf16 a[224:227], a[100:103], v[188:191], a[224:227]
    s_add_u32 s87, s85, 524288
    v_exp_f32 v100, v100
    v_mfma_f32_16x16x32_bf16 a[224:227], a[96:99], v[184:187], a[224:227]
    ds_read_b64_tr_b16 a[96:97], v236 offset:16384
    ds_read_b64_tr_b16 a[98:99], v236 offset:20480
    s_waitcnt lgkmcnt(12)
    v_mfma_f32_16x16x32_bf16 a[132:135], a[104:107], v[160:163], a[132:135]
    v_exp_f32 v101, v101
    s_waitcnt lgkmcnt(10)
    v_mfma_f32_16x16x32_bf16 a[132:135], a[108:111], v[164:167], a[132:135]
    ds_read_b64_tr_b16 a[100:101], v236 offset:24576
    v_cvt_pk_bf16_f32 v130, v100, v101
    v_mfma_f32_16x16x32_bf16 a[164:167], a[108:111], v[172:175], a[164:167]
    v_exp_f32 v102, v102
    v_mfma_f32_16x16x32_bf16 a[164:167], a[104:107], v[168:171], a[164:167]
    ds_read_b64_tr_b16 a[102:103], v236 offset:28672
    buffer_load_dwordx4 a[32:35], v2, s[28:31], s87 offen offset:0 sc1
    v_mfma_f32_16x16x32_bf16 a[196:199], a[104:107], v[176:179], a[196:199]
    v_exp_f32 v103, v103
    v_mfma_f32_16x16x32_bf16 a[196:199], a[108:111], v[180:183], a[196:199]
    buffer_load_dwordx4 a[36:39], v2, s[28:31], s87 offen offset:1024 sc1
    v_cvt_pk_bf16_f32 v131, v102, v103
    v_mfma_f32_16x16x32_bf16 a[228:231], a[108:111], v[188:191], a[228:231]
    v_exp_f32 v104, v104
    v_mfma_f32_16x16x32_bf16 a[228:231], a[104:107], v[184:187], a[228:231]
    ds_read_b64_tr_b16 a[104:105], v237 offset:16384
    ds_read_b64_tr_b16 a[106:107], v237 offset:20480
    s_waitcnt lgkmcnt(12)
    v_mfma_f32_16x16x32_bf16 a[136:139], a[112:115], v[160:163], a[136:139]
    v_exp_f32 v105, v105
    s_waitcnt lgkmcnt(10)
    v_mfma_f32_16x16x32_bf16 a[136:139], a[116:119], v[164:167], a[136:139]
    ds_read_b64_tr_b16 a[108:109], v237 offset:24576
    v_cvt_pk_bf16_f32 v136, v104, v105
    v_mfma_f32_16x16x32_bf16 a[168:171], a[116:119], v[172:175], a[168:171]
    v_exp_f32 v106, v106
    v_mfma_f32_16x16x32_bf16 a[168:171], a[112:115], v[168:171], a[168:171]
    ds_read_b64_tr_b16 a[110:111], v237 offset:28672
    buffer_load_dwordx4 a[40:43], v2, s[28:31], s87 offen offset:2048 sc1
    v_mfma_f32_16x16x32_bf16 a[200:203], a[112:115], v[176:179], a[200:203]
    v_exp_f32 v107, v107
    v_mfma_f32_16x16x32_bf16 a[200:203], a[116:119], v[180:183], a[200:203]
    buffer_load_dwordx4 a[44:47], v2, s[28:31], s87 offen offset:3072 sc1
    v_cvt_pk_bf16_f32 v137, v106, v107
    v_mfma_f32_16x16x32_bf16 a[232:235], a[116:119], v[188:191], a[232:235]
    v_exp_f32 v108, v108
    v_mfma_f32_16x16x32_bf16 a[232:235], a[112:115], v[184:187], a[232:235]
    s_add_u32 s87, s85, 528384
    ds_read_b64_tr_b16 a[112:113], v238 offset:16384
    ds_read_b64_tr_b16 a[114:115], v238 offset:20480
    s_waitcnt lgkmcnt(12)
    v_mfma_f32_16x16x32_bf16 a[140:143], a[120:123], v[160:163], a[140:143]
    v_exp_f32 v109, v109
    s_waitcnt lgkmcnt(10)
    v_mfma_f32_16x16x32_bf16 a[140:143], a[124:127], v[164:167], a[140:143]
    ds_read_b64_tr_b16 a[116:117], v238 offset:24576
    v_cvt_pk_bf16_f32 v138, v108, v109
    v_mfma_f32_16x16x32_bf16 a[172:175], a[124:127], v[172:175], a[172:175]
    v_exp_f32 v110, v110
    v_mfma_f32_16x16x32_bf16 a[172:175], a[120:123], v[168:171], a[172:175]
    ds_read_b64_tr_b16 a[118:119], v238 offset:28672
    buffer_load_dwordx4 a[48:51], v2, s[28:31], s87 offen offset:0 sc1
    v_mfma_f32_16x16x32_bf16 a[204:207], a[120:123], v[176:179], a[204:207]
    v_exp_f32 v111, v111
    v_mfma_f32_16x16x32_bf16 a[204:207], a[124:127], v[180:183], a[204:207]
    buffer_load_dwordx4 a[52:55], v2, s[28:31], s87 offen offset:1024 sc1
    v_cvt_pk_bf16_f32 v139, v110, v111
    v_mfma_f32_16x16x32_bf16 a[236:239], a[124:127], v[188:191], a[236:239]
    v_exp_f32 v112, v112
    v_mfma_f32_16x16x32_bf16 a[236:239], a[120:123], v[184:187], a[236:239]
    ds_read_b64_tr_b16 a[120:121], v239 offset:16384
    ds_read_b64_tr_b16 a[122:123], v239 offset:20480
    v_smfmac_f32_16x16x64_bf16 v[216:219], v[224:227], v[176:183], v252
    v_exp_f32 v113, v113
    v_smfmac_f32_16x16x64_bf16 v[220:223], v[224:227], v[184:191], v252
    ds_read_b64_tr_b16 a[124:125], v239 offset:24576
    v_cvt_pk_bf16_f32 v144, v112, v113
    s_waitcnt lgkmcnt(13)
    v_mfma_f32_16x16x32_bf16 a[144:147], a[96:99], v[160:163], a[144:147]
    v_exp_f32 v114, v114
    s_waitcnt lgkmcnt(11)
    v_mfma_f32_16x16x32_bf16 a[144:147], a[100:103], v[164:167], a[144:147]
    ds_read_b64_tr_b16 a[126:127], v239 offset:28672
    buffer_load_dwordx4 a[56:59], v2, s[28:31], s87 offen offset:2048 sc1
    v_mfma_f32_16x16x32_bf16 a[176:179], a[100:103], v[172:175], a[176:179]
    v_exp_f32 v115, v115
    v_mfma_f32_16x16x32_bf16 a[176:179], a[96:99], v[168:171], a[176:179]
    buffer_load_dwordx4 a[60:63], v2, s[28:31], s87 offen offset:3072 sc1
    v_cvt_pk_bf16_f32 v145, v114, v115
    v_mfma_f32_16x16x32_bf16 a[208:211], a[96:99], v[176:179], a[208:211]
    v_exp_f32 v116, v116
    v_mfma_f32_16x16x32_bf16 a[208:211], a[100:103], v[180:183], a[208:211]
    v_mfma_f32_16x16x32_bf16 a[240:243], a[100:103], v[188:191], a[240:243]
    v_exp_f32 v117, v117
    v_mfma_f32_16x16x32_bf16 a[240:243], a[96:99], v[184:187], a[240:243]
    ds_read_b64_tr_b16 a[96:97], v232 offset:32768
    v_cvt_pk_bf16_f32 v146, v116, v117
    s_waitcnt lgkmcnt(11)
    v_mfma_f32_16x16x32_bf16 a[148:151], a[104:107], v[160:163], a[148:151]
    s_waitcnt lgkmcnt(0)
    v_exp_f32 v118, v118
    v_mfma_f32_16x16x32_bf16 a[148:151], a[108:111], v[164:167], a[148:151]
    s_waitcnt vmcnt(28)
    ds_read_b64_tr_b16 a[98:99], v232 offset:36864
    ds_read_b64_tr_b16 a[100:101], v233 offset:32768
    v_mfma_f32_16x16x32_bf16 a[180:183], a[108:111], v[172:175], a[180:183]
    s_barrier
    v_exp_f32 v119, v119
    v_mfma_f32_16x16x32_bf16 a[180:183], a[104:107], v[168:171], a[180:183]
    s_add_u32 s79, s80, 294912
    ds_read_b64_tr_b16 a[102:103], v233 offset:36864
    v_cvt_pk_bf16_f32 v147, v118, v119
    v_mfma_f32_16x16x32_bf16 a[212:215], a[104:107], v[176:179], a[212:215]
    s_add_u32 m0, s88, 0
    v_exp_f32 v120, v120
    v_mfma_f32_16x16x32_bf16 a[212:215], a[108:111], v[180:183], a[212:215]
    ds_read_b128 v[64:67], v10 offset:0
    ds_read_b128 v[68:71], v10 offset:9216
    v_mfma_f32_16x16x32_bf16 a[244:247], a[108:111], v[188:191], a[244:247]
    v_exp_f32 v121, v121
    v_mfma_f32_16x16x32_bf16 a[244:247], a[104:107], v[184:187], a[244:247]
    ds_read_b64_tr_b16 a[104:105], v234 offset:32768
    v_cvt_pk_bf16_f32 v152, v120, v121
    v_mfma_f32_16x16x32_bf16 a[152:155], a[112:115], v[160:163], a[152:155]
    v_exp_f32 v122, v122
    v_mfma_f32_16x16x32_bf16 a[152:155], a[116:119], v[164:167], a[152:155]
    ds_read_b64_tr_b16 a[106:107], v234 offset:36864
    ds_read_b64_tr_b16 a[108:109], v235 offset:32768
    v_mfma_f32_16x16x32_bf16 a[184:187], a[116:119], v[172:175], a[184:187]
    v_exp_f32 v123, v123
    v_mfma_f32_16x16x32_bf16 a[184:187], a[112:115], v[168:171], a[184:187]
    ds_read_b64_tr_b16 a[110:111], v235 offset:36864
    v_cvt_pk_bf16_f32 v153, v122, v123
    v_mfma_f32_16x16x32_bf16 a[216:219], a[112:115], v[176:179], a[216:219]
    v_exp_f32 v124, v124
    v_mfma_f32_16x16x32_bf16 a[216:219], a[116:119], v[180:183], a[216:219]
    ds_read_b128 v[72:75], v10 offset:18432
    ds_read_b128 v[76:79], v10 offset:27648
    v_mfma_f32_16x16x32_bf16 a[248:251], a[116:119], v[188:191], a[248:251]
    v_exp_f32 v125, v125
    v_mfma_f32_16x16x32_bf16 a[248:251], a[112:115], v[184:187], a[248:251]
    ds_read_b64_tr_b16 a[112:113], v236 offset:32768
    v_cvt_pk_bf16_f32 v154, v124, v125
    v_mfma_f32_16x16x32_bf16 a[156:159], a[120:123], v[160:163], a[156:159]
    v_exp_f32 v126, v126
    v_mfma_f32_16x16x32_bf16 a[156:159], a[124:127], v[164:167], a[156:159]
    ds_read_b64_tr_b16 a[114:115], v236 offset:36864
    ds_read_b64_tr_b16 a[116:117], v237 offset:32768
    v_mfma_f32_16x16x32_bf16 a[188:191], a[124:127], v[172:175], a[188:191]
    v_exp_f32 v127, v127
    v_mfma_f32_16x16x32_bf16 a[188:191], a[120:123], v[168:171], a[188:191]
    ds_read_b64_tr_b16 a[118:119], v237 offset:36864
    v_cvt_pk_bf16_f32 v155, v126, v127
    v_mfma_f32_16x16x32_bf16 a[220:223], a[120:123], v[176:179], a[220:223]
    ds_read_b128 v[80:83], v10 offset:1024
    ds_read_b128 v[84:87], v10 offset:10240
    v_mfma_f32_16x16x32_bf16 a[220:223], a[124:127], v[180:183], a[220:223]
    ds_read_b128 v[88:91], v10 offset:19456
    ds_read_b128 v[92:95], v10 offset:28672
    v_mfma_f32_16x16x32_bf16 a[252:255], a[124:127], v[188:191], a[252:255]
    buffer_load_dwordx4 v2, s[28:31], s79 offen offset:0 sc1 lds
    v_mfma_f32_16x16x32_bf16 a[252:255], a[120:123], v[184:187], a[252:255]
    ds_read_b64_tr_b16 a[120:121], v238 offset:32768
    ds_read_b64_tr_b16 a[122:123], v238 offset:36864
    s_waitcnt lgkmcnt(15)
    v_mfma_f32_16x16x32_bf16 a[128:131], a[96:99], v[128:131], a[128:131]
    ds_read_b64_tr_b16 a[124:125], v239 offset:32768
    ds_read_b64_tr_b16 a[126:127], v239 offset:36864
    v_mfma_f32_16x16x32_bf16 a[160:163], a[96:99], v[136:139], a[160:163]
    buffer_load_dwordx4 v2, s[28:31], s79 offen offset:1024 sc1 lds
    v_mfma_f32_16x16x32_bf16 a[192:195], a[96:99], v[144:147], a[192:195]
    v_mfma_f32_16x16x32_bf16 a[224:227], a[96:99], v[152:155], a[224:227]
    v_mfma_f32_16x16x32_bf16 a[132:135], a[100:103], v[128:131], a[132:135]
    v_mfma_f32_16x16x32_bf16 a[164:167], a[100:103], v[136:139], a[164:167]
    v_mfma_f32_16x16x32_bf16 a[196:199], a[100:103], v[144:147], a[196:199]
    v_mfma_f32_16x16x32_bf16 a[228:231], a[100:103], v[152:155], a[228:231]
    s_add_u32 s79, s81, 294912
    s_add_u32 m0, s88, 2048
    s_waitcnt lgkmcnt(15)
    v_mfma_f32_16x16x32_bf16 a[136:139], a[104:107], v[128:131], a[136:139]
    buffer_load_dwordx4 v2, s[28:31], s79 offen offset:0 sc1 lds
    v_mfma_f32_16x16x32_bf16 a[168:171], a[104:107], v[136:139], a[168:171]
    v_mfma_f32_16x16x32_bf16 a[200:203], a[104:107], v[144:147], a[200:203]
    v_mfma_f32_16x16x32_bf16 a[232:235], a[104:107], v[152:155], a[232:235]
    s_waitcnt lgkmcnt(14)
    v_mfma_f32_16x16x32_bf16 a[140:143], a[108:111], v[128:131], a[140:143]
    v_mfma_f32_16x16x32_bf16 a[172:175], a[108:111], v[136:139], a[172:175]
    v_mfma_f32_16x16x32_bf16 a[204:207], a[108:111], v[144:147], a[204:207]
    v_mfma_f32_16x16x32_bf16 a[236:239], a[108:111], v[152:155], a[236:239]
    s_waitcnt lgkmcnt(10)
    v_mfma_f32_16x16x32_bf16 a[144:147], a[112:115], v[128:131], a[144:147]
    v_mfma_f32_16x16x32_bf16 a[176:179], a[112:115], v[136:139], a[176:179]
    v_mfma_f32_16x16x32_bf16 a[208:211], a[112:115], v[144:147], a[208:211]
    v_mfma_f32_16x16x32_bf16 a[240:243], a[112:115], v[152:155], a[240:243]
    s_waitcnt lgkmcnt(8)
    v_mfma_f32_16x16x32_bf16 a[148:151], a[116:119], v[128:131], a[148:151]
    v_mfma_f32_16x16x32_bf16 a[180:183], a[116:119], v[136:139], a[180:183]
    buffer_load_dwordx4 v2, s[28:31], s79 offen offset:1024 sc1 lds
    v_mfma_f32_16x16x32_bf16 a[212:215], a[116:119], v[144:147], a[212:215]
    v_mfma_f32_16x16x32_bf16 a[244:247], a[116:119], v[152:155], a[244:247]
    v_mfma_f32_16x16x32_bf16 v[208:211], v[248:251], v[128:131], v[208:211]
    v_mfma_f32_16x16x32_bf16 v[212:215], v[248:251], v[136:139], v[212:215]
    v_mfma_f32_16x16x32_bf16 v[216:219], v[248:251], v[144:147], v[216:219]
    v_mfma_f32_16x16x32_bf16 v[220:223], v[248:251], v[152:155], v[220:223]
    s_waitcnt lgkmcnt(2)
    v_mfma_f32_16x16x32_bf16 a[152:155], a[120:123], v[128:131], a[152:155]
    v_mfma_f32_16x16x32_bf16 a[184:187], a[120:123], v[136:139], a[184:187]
    v_mfma_f32_16x16x32_bf16 a[216:219], a[120:123], v[144:147], a[216:219]
    v_mfma_f32_16x16x32_bf16 a[248:251], a[120:123], v[152:155], a[248:251]
    s_waitcnt lgkmcnt(0)
    v_mfma_f32_16x16x32_bf16 a[156:159], a[124:127], v[128:131], a[156:159]
    v_mfma_f32_16x16x32_bf16 a[188:191], a[124:127], v[136:139], a[188:191]
    v_mfma_f32_16x16x32_bf16 a[220:223], a[124:127], v[144:147], a[220:223]
    v_mfma_f32_16x16x32_bf16 a[252:255], a[124:127], v[152:155], a[252:255]
L_fin_code:
    s_waitcnt vmcnt(31)
    v_mfma_f32_16x16x32_bf16 v[112:115], v[64:67], v[20:23], 0
    s_mov_b32 s70, 0x53800000
    s_mov_b64 s[68:69], 0
    ds_read_b128 v[96:99], v10 offset:2048
    ds_read_b128 v[100:103], v10 offset:11264
    s_waitcnt vmcnt(30)
    v_mfma_f32_16x16x32_bf16 v[112:115], v[68:71], v[24:27], v[112:115]
    s_add_u32 s87, s85, 1048576
    v_add_f32 v208, v208, v209
    v_add_f32 v212, v212, v213
    s_waitcnt vmcnt(29)
    v_mfma_f32_16x16x32_bf16 v[112:115], v[72:75], v[28:31], v[112:115]
    ds_read_b128 v[104:107], v10 offset:20480
    ds_read_b128 v[108:111], v10 offset:29696
    s_waitcnt vmcnt(28)
    v_mfma_f32_16x16x32_bf16 v[112:115], v[76:79], v[32:35], v[112:115]
    v_add_f32 v216, v216, v217
    v_add_f32 v220, v220, v221
    s_waitcnt vmcnt(15)
    v_mfma_f32_16x16x32_bf16 v[116:119], v[76:79], v[48:51], 0
    v_cmp_nlt_f32 s[64:65], v208, s70
    v_cmp_nlt_f32 s[66:67], v212, s70
    v_mfma_f32_16x16x32_bf16 v[116:119], v[72:75], v[44:47], v[116:119]
    s_or_b64 s[68:69], s[68:69], s[64:65]
    s_or_b64 s[68:69], s[68:69], s[66:67]
    buffer_load_dwordx4 v[240:243], v2, s[28:31], s87 offen offset:0 sc1
    v_mfma_f32_16x16x32_bf16 v[116:119], v[68:71], v[40:43], v[116:119]
    v_cmp_nlt_f32 s[64:65], v216, s70
    v_cmp_nlt_f32 s[66:67], v220, s70
    v_mfma_f32_16x16x32_bf16 v[116:119], v[64:67], v[36:39], v[116:119]
    s_waitcnt lgkmcnt(4)
    s_or_b64 s[68:69], s[68:69], s[64:65]
    s_or_b64 s[68:69], s[68:69], s[66:67]
    v_mfma_f32_16x16x32_bf16 v[120:123], v[80:83], v[20:23], 0
    s_cmp_eq_u64 s[68:69], 0
    s_cbranch_scc1 L_range_ok
    s_cmp_lg_u32 s0, 0
    s_cbranch_scc1 L_range_ok
    v_mov_b32 v60, 147456
    v_mov_b32 v61, 1
    ds_write_b32 v60, v61
    s_waitcnt lgkmcnt(0)
L_range_ok:
    ds_read_b128 v[64:67], v10 offset:3072
    ds_read_b128 v[68:71], v10 offset:12288
    v_mfma_f32_16x16x32_bf16 v[120:123], v[84:87], v[24:27], v[120:123]
    s_barrier
    buffer_load_dwordx4 v[244:247], v2, s[28:31], s87 offen offset:1024 sc1
    v_mov_b32 v60, 147456
    v_mfma_f32_16x16x32_bf16 v[120:123], v[88:91], v[28:31], v[120:123]
    ds_read_b128 v[72:75], v10 offset:21504
    ds_read_b128 v[76:79], v10 offset:30720
    v_mfma_f32_16x16x32_bf16 v[120:123], v[92:95], v[32:35], v[120:123]
    ds_read_b32 v61, v60
    v_mfma_f32_16x16x32_bf16 v[124:127], v[92:95], v[48:51], 0
    buffer_load_dwordx4 v[52:55], v2, s[28:31], s87 offen offset:2048 sc1
    v_mfma_f32_16x16x32_bf16 v[124:127], v[88:91], v[44:47], v[124:127]
    s_add_u32 s79, s82, 294912
    v_rcp_f32 v248, v208
    v_mfma_f32_16x16x32_bf16 v[124:127], v[84:87], v[40:43], v[124:127]
    s_add_u32 m0, s88, 4096
    v_mfma_f32_16x16x32_bf16 v[124:127], v[80:83], v[36:39], v[124:127]
    s_waitcnt lgkmcnt(4)
    v_rcp_f32 v249, v212
    v_mfma_f32_16x16x32_bf16 v[128:131], v[96:99], v[20:23], 0
    ds_read_b128 v[80:83], v10 offset:4096
    ds_read_b128 v[84:87], v10 offset:13312
    v_mfma_f32_16x16x32_bf16 v[128:131], v[100:103], v[24:27], v[128:131]
    v_rcp_f32 v250, v216
    v_mfma_f32_16x16x32_bf16 v[128:131], v[104:107], v[28:31], v[128:131]
    ds_read_b128 v[88:91], v10 offset:22528
    ds_read_b128 v[92:95], v10 offset:31744
    v_mfma_f32_16x16x32_bf16 v[128:131], v[108:111], v[32:35], v[128:131]
    s_waitcnt lgkmcnt(4)
    v_readfirstlane_b32 s68, v61
    v_rcp_f32 v251, v220
    v_mfma_f32_16x16x32_bf16 v[132:135], v[108:111], v[48:51], 0
    buffer_load_dwordx4 v2, s[28:31], s79 offen offset:0 sc1 lds
    v_mfma_f32_16x16x32_bf16 v[132:135], v[104:107], v[44:47], v[132:135]
    s_cmp_lg_u32 s68, 0
    s_cbranch_scc1 L_slow
    buffer_load_dwordx4 v[228:231], v2, s[28:31], s87 offen offset:3072 sc1
    v_mfma_f32_16x16x32_bf16 v[132:135], v[100:103], v[40:43], v[132:135]
    s_add_u32 s71, s3, 0
    s_and_b32 s71, s71, 3
    buffer_load_dwordx4 v2, s[28:31], s79 offen offset:1024 sc1 lds
    v_mfma_f32_16x16x32_bf16 v[132:135], v[96:99], v[36:39], v[132:135]
    s_waitcnt lgkmcnt(4)
    s_mul_i32 s71, s71, 4096
    s_add_u32 s71, s71, s100
    v_mfma_f32_16x16x32_bf16 v[136:139], v[64:67], v[20:23], 0
    s_add_u32 s87, s85, 1052672
    ds_read_b128 v[96:99], v10 offset:5120
    ds_read_b128 v[100:103], v10 offset:14336
    v_mfma_f32_16x16x32_bf16 v[136:139], v[68:71], v[24:27], v[136:139]
    buffer_load_dwordx4 v[192:195], v2, s[28:31], s87 offen offset:0 sc1
    v_accvgpr_read_b32 v184, a128
    v_mfma_f32_16x16x32_bf16 v[136:139], v[72:75], v[28:31], v[136:139]
    ds_read_b128 v[104:107], v10 offset:23552
    ds_read_b128 v[108:111], v10 offset:32768
    v_mfma_f32_16x16x32_bf16 v[136:139], v[76:79], v[32:35], v[136:139]
    v_accvgpr_read_b32 v185, a129
    v_accvgpr_read_b32 v186, a130
    v_mfma_f32_16x16x32_bf16 v[140:143], v[76:79], v[48:51], 0
    s_add_u32 s79, s83, 294912
    s_add_u32 m0, s88, 6144
    v_accvgpr_read_b32 v187, a131
    v_mfma_f32_16x16x32_bf16 v[140:143], v[72:75], v[44:47], v[140:143]
    buffer_load_dwordx4 v2, s[28:31], s79 offen offset:0 sc1 lds
    v_accvgpr_read_b32 v188, a132
    v_mfma_f32_16x16x32_bf16 v[140:143], v[68:71], v[40:43], v[140:143]
    v_accvgpr_read_b32 v189, a133
    v_accvgpr_read_b32 v190, a134
    v_mfma_f32_16x16x32_bf16 v[140:143], v[64:67], v[36:39], v[140:143]
    s_waitcnt lgkmcnt(4)
    v_accvgpr_read_b32 v191, a135
    v_mul_f32 v184, v248, v184
    v_mfma_f32_16x16x32_bf16 v[144:147], v[80:83], v[20:23], 0
    ds_read_b128 v[64:67], v10 offset:6144
    ds_read_b128 v[68:71], v10 offset:15360
    v_mfma_f32_16x16x32_bf16 v[144:147], v[84:87], v[24:27], v[144:147]
    buffer_load_dwordx4 v[196:199], v2, s[28:31], s87 offen offset:1024 sc1
    v_mul_f32 v185, v248, v185
    v_mfma_f32_16x16x32_bf16 v[144:147], v[88:91], v[28:31], v[144:147]
    ds_read_b128 v[72:75], v10 offset:24576
    ds_read_b128 v[76:79], v10 offset:33792
    v_mfma_f32_16x16x32_bf16 v[144:147], v[92:95], v[32:35], v[144:147]
    v_mul_f32 v186, v248, v186
    v_mul_f32 v187, v248, v187
    v_mfma_f32_16x16x32_bf16 v[148:151], v[92:95], v[48:51], 0
    buffer_load_dwordx4 v2, s[28:31], s79 offen offset:1024 sc1 lds
    v_mul_f32 v188, v248, v188
    v_mfma_f32_16x16x32_bf16 v[148:151], v[88:91], v[44:47], v[148:151]
    v_mul_f32 v189, v248, v189
    v_mul_f32 v190, v248, v190
    v_mfma_f32_16x16x32_bf16 v[148:151], v[84:87], v[40:43], v[148:151]
    v_mul_f32 v191, v248, v191
    v_cvt_pk_bf16_f32 v224, v184, v185
    v_mfma_f32_16x16x32_bf16 v[148:151], v[80:83], v[36:39], v[148:151]
    s_waitcnt lgkmcnt(4)
    v_cvt_pk_bf16_f32 v225, v186, v187
    v_cvt_pk_bf16_f32 v226, v188, v189
    v_mfma_f32_16x16x32_bf16 v[152:155], v[96:99], v[20:23], 0
    ds_read_b128 v[80:83], v10 offset:7168
    ds_read_b128 v[84:87], v10 offset:16384
    v_mfma_f32_16x16x32_bf16 v[152:155], v[100:103], v[24:27], v[152:155]
    buffer_load_dwordx4 v[200:203], v2, s[28:31], s87 offen offset:2048 sc1
    v_cvt_pk_bf16_f32 v227, v190, v191
    v_mfma_f32_16x16x32_bf16 v[152:155], v[104:107], v[28:31], v[152:155]
    ds_read_b128 v[88:91], v10 offset:25600
    ds_read_b128 v[92:95], v10 offset:34816
    v_mfma_f32_16x16x32_bf16 v[152:155], v[108:111], v[32:35], v[152:155]
    buffer_store_dwordx4 v[224:227], v2, s[28:31], s71 offen offset:0 sc1
    v_accvgpr_read_b32 v232, a136
    v_mfma_f32_16x16x32_bf16 v[156:159], v[108:111], v[48:51], 0
    s_add_u32 s79, s84, 294912
    s_add_u32 m0, s88, 8192
    v_accvgpr_read_b32 v233, a137
    v_mfma_f32_16x16x32_bf16 v[156:159], v[104:107], v[44:47], v[156:159]
    buffer_load_dwordx4 v2, s[28:31], s79 offen offset:0 sc1 lds
    v_accvgpr_read_b32 v234, a138
    v_mfma_f32_16x16x32_bf16 v[156:159], v[100:103], v[40:43], v[156:159]
    v_accvgpr_read_b32 v235, a139
    v_accvgpr_read_b32 v236, a140
    v_mfma_f32_16x16x32_bf16 v[156:159], v[96:99], v[36:39], v[156:159]
    s_waitcnt lgkmcnt(4)
    v_accvgpr_read_b32 v237, a141
    v_accvgpr_read_b32 v238, a142
    v_mfma_f32_16x16x32_bf16 v[160:163], v[64:67], v[20:23], 0
    ds_read_b128 v[96:99], v10 offset:8192
    ds_read_b128 v[100:103], v10 offset:17408
    v_mfma_f32_16x16x32_bf16 v[160:163], v[68:71], v[24:27], v[160:163]
    buffer_load_dwordx4 v[204:207], v2, s[28:31], s87 offen offset:3072 sc1
    v_accvgpr_read_b32 v239, a143
    v_mfma_f32_16x16x32_bf16 v[160:163], v[72:75], v[28:31], v[160:163]
    ds_read_b128 v[104:107], v10 offset:26624
    ds_read_b128 v[108:111], v10 offset:35840
    v_mfma_f32_16x16x32_bf16 v[160:163], v[76:79], v[32:35], v[160:163]
    v_mul_f32 v232, v248, v232
    v_mul_f32 v233, v248, v233
    v_mfma_f32_16x16x32_bf16 v[164:167], v[76:79], v[48:51], 0
    v_mul_f32 v234, v248, v234
    v_mul_f32 v235, v248, v235
    v_mfma_f32_16x16x32_bf16 v[164:167], v[72:75], v[44:47], v[164:167]
    v_mul_f32 v236, v248, v236
    v_mul_f32 v237, v248, v237
    v_mfma_f32_16x16x32_bf16 v[164:167], v[68:71], v[40:43], v[164:167]
    v_mul_f32 v238, v248, v238
    v_mul_f32 v239, v248, v239
    v_mfma_f32_16x16x32_bf16 v[164:167], v[64:67], v[36:39], v[164:167]
    s_waitcnt lgkmcnt(4)
    v_cvt_pk_bf16_f32 v56, v232, v233
    v_cvt_pk_bf16_f32 v57, v234, v235
    v_mfma_f32_16x16x32_bf16 v[168:171], v[80:83], v[20:23], 0
    v_add_u32 v10, 36864, v10
    v_cvt_pk_bf16_f32 v58, v236, v237
    v_mfma_f32_16x16x32_bf16 v[168:171], v[84:87], v[24:27], v[168:171]
    s_barrier
    v_cvt_pk_bf16_f32 v59, v238, v239
    v_mfma_f32_16x16x32_bf16 v[168:171], v[88:91], v[28:31], v[168:171]
    s_add_u32 s79, s80, 442368
    ds_read_b128 v[64:67], v10 offset:0
    ds_read_b128 v[68:71], v10 offset:9216
    v_mfma_f32_16x16x32_bf16 v[168:171], v[92:95], v[32:35], v[168:171]
    s_add_u32 m0, s88, 36864
    buffer_store_dwordx4 v[56:59], v2, s[28:31], s71 offen offset:1024 sc1
    v_accvgpr_read_b32 v184, a144
    v_mfma_f32_16x16x32_bf16 v[172:175], v[92:95], v[48:51], 0
    ds_read_b128 v[72:75], v10 offset:18432
    ds_read_b128 v[76:79], v10 offset:27648
    v_mfma_f32_16x16x32_bf16 v[172:175], v[88:91], v[44:47], v[172:175]
    buffer_load_dwordx4 v2, s[28:31], s79 offen offset:0 sc1 lds
    v_accvgpr_read_b32 v185, a145
    v_mfma_f32_16x16x32_bf16 v[172:175], v[84:87], v[40:43], v[172:175]
    s_add_u32 s87, s85, 1572864
    v_accvgpr_read_b32 v186, a146
    v_accvgpr_read_b32 v187, a147
    v_mfma_f32_16x16x32_bf16 v[172:175], v[80:83], v[36:39], v[172:175]
    s_waitcnt lgkmcnt(4)
    buffer_load_dwordx4 a[0:3], v2, s[28:31], s87 offen offset:0 sc1
    v_accvgpr_read_b32 v188, a148
    v_mfma_f32_16x16x32_bf16 v[176:179], v[96:99], v[20:23], 0
    ds_read_b128 v[80:83], v10 offset:1024
    ds_read_b128 v[84:87], v10 offset:10240
    v_mfma_f32_16x16x32_bf16 v[176:179], v[100:103], v[24:27], v[176:179]
    v_accvgpr_read_b32 v189, a149
    v_accvgpr_read_b32 v190, a150
    v_mfma_f32_16x16x32_bf16 v[176:179], v[104:107], v[28:31], v[176:179]
    ds_read_b128 v[88:91], v10 offset:19456
    ds_read_b128 v[92:95], v10 offset:28672
    v_mfma_f32_16x16x32_bf16 v[176:179], v[108:111], v[32:35], v[176:179]
    buffer_load_dwordx4 v2, s[28:31], s79 offen offset:1024 sc1 lds
    v_accvgpr_read_b32 v191, a151
    v_mfma_f32_16x16x32_bf16 v[180:183], v[108:111], v[48:51], 0
    v_mul_f32 v184, v248, v184
    v_mul_f32 v185, v248, v185
    v_mfma_f32_16x16x32_bf16 v[180:183], v[104:107], v[44:47], v[180:183]
    v_mul_f32 v186, v248, v186
    v_mul_f32 v187, v248, v187
    v_mfma_f32_16x16x32_bf16 v[180:183], v[100:103], v[40:43], v[180:183]
    buffer_load_dwordx4 a[4:7], v2, s[28:31], s87 offen offset:1024 sc1
    v_mul_f32 v188, v248, v188
    v_mfma_f32_16x16x32_bf16 v[180:183], v[96:99], v[36:39], v[180:183]
    s_waitcnt lgkmcnt(4)
    v_mul_f32 v189, v248, v189
    v_mul_f32 v190, v248, v190
    s_waitcnt vmcnt(30)
    v_mfma_f32_16x16x32_bf16 v[112:115], v[64:67], a[32:35], v[112:115]
    ds_read_b128 v[96:99], v10 offset:2048
    ds_read_b128 v[100:103], v10 offset:11264
    s_waitcnt vmcnt(29)
    v_mfma_f32_16x16x32_bf16 v[112:115], v[68:71], a[36:39], v[112:115]
    v_mul_f32 v191, v248, v191
    v_cvt_pk_bf16_f32 v224, v184, v185
    s_waitcnt vmcnt(28)
    v_mfma_f32_16x16x32_bf16 v[112:115], v[72:75], a[40:43], v[112:115]
    s_add_u32 s79, s81, 442368
    ds_read_b128 v[104:107], v10 offset:20480
    ds_read_b128 v[108:111], v10 offset:29696
    s_waitcnt vmcnt(27)
    v_mfma_f32_16x16x32_bf16 v[112:115], v[76:79], a[44:47], v[112:115]
    s_add_u32 m0, s88, 38912
    v_cvt_pk_bf16_f32 v225, v186, v187
    v_cvt_pk_bf16_f32 v226, v188, v189
    s_waitcnt vmcnt(23)
    v_mfma_f32_16x16x32_bf16 v[116:119], v[76:79], a[60:63], v[116:119]
    buffer_load_dwordx4 v2, s[28:31], s79 offen offset:0 sc1 lds
    v_cvt_pk_bf16_f32 v227, v190, v191
    v_mfma_f32_16x16x32_bf16 v[116:119], v[72:75], a[56:59], v[116:119]
    buffer_store_dwordx4 v[224:227], v2, s[28:31], s71 offen offset:2048 sc1
    v_accvgpr_read_b32 v232, a152
    v_mfma_f32_16x16x32_bf16 v[116:119], v[68:71], a[52:55], v[116:119]
    buffer_load_dwordx4 a[8:11], v2, s[28:31], s87 offen offset:2048 sc1
    v_accvgpr_read_b32 v233, a153
    v_mfma_f32_16x16x32_bf16 v[116:119], v[64:67], a[48:51], v[116:119]
    s_waitcnt lgkmcnt(4)
    v_accvgpr_read_b32 v234, a154
    v_accvgpr_read_b32 v235, a155
    v_mfma_f32_16x16x32_bf16 v[120:123], v[80:83], a[32:35], v[120:123]
    ds_read_b128 v[64:67], v10 offset:3072
    ds_read_b128 v[68:71], v10 offset:12288
    v_mfma_f32_16x16x32_bf16 v[120:123], v[84:87], a[36:39], v[120:123]
    v_accvgpr_read_b32 v236, a156
    v_accvgpr_read_b32 v237, a157
    v_mfma_f32_16x16x32_bf16 v[120:123], v[88:91], a[40:43], v[120:123]
    ds_read_b128 v[72:75], v10 offset:21504
    ds_read_b128 v[76:79], v10 offset:30720
    v_mfma_f32_16x16x32_bf16 v[120:123], v[92:95], a[44:47], v[120:123]
    buffer_load_dwordx4 v2, s[28:31], s79 offen offset:1024 sc1 lds
    v_accvgpr_read_b32 v238, a158
    v_mfma_f32_16x16x32_bf16 v[124:127], v[92:95], a[60:63], v[124:127]
    v_accvgpr_read_b32 v239, a159
    v_mul_f32 v232, v248, v232
    v_mfma_f32_16x16x32_bf16 v[124:127], v[88:91], a[56:59], v[124:127]
    v_mul_f32 v233, v248, v233
    v_mul_f32 v234, v248, v234
    v_mfma_f32_16x16x32_bf16 v[124:127], v[84:87], a[52:55], v[124:127]
    buffer_load_dwordx4 a[12:15], v2, s[28:31], s87 offen offset:3072 sc1
    v_mul_f32 v235, v248, v235
    v_mfma_f32_16x16x32_bf16 v[124:127], v[80:83], a[48:51], v[124:127]
    s_waitcnt lgkmcnt(4)
    v_mul_f32 v236, v248, v236
    v_mul_f32 v237, v248, v237
    v_mfma_f32_16x16x32_bf16 v[128:131], v[96:99], a[32:35], v[128:131]
    ds_read_b128 v[80:83], v10 offset:4096
    ds_read_b128 v[84:87], v10 offset:13312
    v_mfma_f32_16x16x32_bf16 v[128:131], v[100:103], a[36:39], v[128:131]
    v_mul_f32 v238, v248, v238
    v_mul_f32 v239, v248, v239
    v_mfma_f32_16x16x32_bf16 v[128:131], v[104:107], a[40:43], v[128:131]
    s_add_u32 s79, s82, 442368
    ds_read_b128 v[88:91], v10 offset:22528
    ds_read_b128 v[92:95], v10 offset:31744
    v_mfma_f32_16x16x32_bf16 v[128:131], v[108:111], a[44:47], v[128:131]
    s_add_u32 m0, s88, 40960
    v_cvt_pk_bf16_f32 v56, v232, v233
    v_cvt_pk_bf16_f32 v57, v234, v235
    v_mfma_f32_16x16x32_bf16 v[132:135], v[108:111], a[60:63], v[132:135]
    buffer_load_dwordx4 v2, s[28:31], s79 offen offset:0 sc1 lds
    v_cvt_pk_bf16_f32 v58, v236, v237
    v_mfma_f32_16x16x32_bf16 v[132:135], v[104:107], a[56:59], v[132:135]
    v_cvt_pk_bf16_f32 v59, v238, v239
    v_mfma_f32_16x16x32_bf16 v[132:135], v[100:103], a[52:55], v[132:135]
    s_add_u32 s87, s85, 1576960
    buffer_store_dwordx4 v[56:59], v2, s[28:31], s71 offen offset:3072 sc1
    v_mfma_f32_16x16x32_bf16 v[132:135], v[96:99], a[48:51], v[132:135]
    s_waitcnt lgkmcnt(4)
    s_add_u32 s71, s3, 1
    buffer_load_dwordx4 a[16:19], v2, s[28:31], s87 offen offset:0 sc1
    v_mfma_f32_16x16x32_bf16 v[136:139], v[64:67], a[32:35], v[136:139]
    s_and_b32 s71, s71, 3
    ds_read_b128 v[96:99], v10 offset:5120
    ds_read_b128 v[100:103], v10 offset:14336
    v_mfma_f32_16x16x32_bf16 v[136:139], v[68:71], a[36:39], v[136:139]
    s_mul_i32 s71, s71, 4096
    s_add_u32 s71, s71, s100
    v_accvgpr_read_b32 v184, a160
    v_mfma_f32_16x16x32_bf16 v[136:139], v[72:75], a[40:43], v[136:139]
    ds_read_b128 v[104:107], v10 offset:23552
    ds_read_b128 v[108:111], v10 offset:32768
    v_mfma_f32_16x16x32_bf16 v[136:139], v[76:79], a[44:47], v[136:139]
    buffer_load_dwordx4 v2, s[28:31], s79 offen offset:1024 sc1 lds
    v_accvgpr_read_b32 v185, a161
    v_mfma_f32_16x16x32_bf16 v[140:143], v[76:79], a[60:63], v[140:143]
    v_accvgpr_read_b32 v186, a162
    v_accvgpr_read_b32 v187, a163
    v_mfma_f32_16x16x32_bf16 v[140:143], v[72:75], a[56:59], v[140:143]
    v_accvgpr_read_b32 v188, a164
    v_accvgpr_read_b32 v189, a165
    v_mfma_f32_16x16x32_bf16 v[140:143], v[68:71], a[52:55], v[140:143]
    buffer_load_dwordx4 a[20:23], v2, s[28:31], s87 offen offset:1024 sc1
    v_accvgpr_read_b32 v190, a166
    v_mfma_f32_16x16x32_bf16 v[140:143], v[64:67], a[48:51], v[140:143]
    s_waitcnt lgkmcnt(4)
    v_accvgpr_read_b32 v191, a167
    v_mul_f32 v184, v249, v184
    v_mfma_f32_16x16x32_bf16 v[144:147], v[80:83], a[32:35], v[144:147]
    ds_read_b128 v[64:67], v10 offset:6144
    ds_read_b128 v[68:71], v10 offset:15360
    v_mfma_f32_16x16x32_bf16 v[144:147], v[84:87], a[36:39], v[144:147]
    v_mul_f32 v185, v249, v185
    v_mul_f32 v186, v249, v186
    v_mfma_f32_16x16x32_bf16 v[144:147], v[88:91], a[40:43], v[144:147]
    s_add_u32 s79, s83, 442368
    ds_read_b128 v[72:75], v10 offset:24576
    ds_read_b128 v[76:79], v10 offset:33792
    v_mfma_f32_16x16x32_bf16 v[144:147], v[92:95], a[44:47], v[144:147]
    s_add_u32 m0, s88, 43008
    v_mul_f32 v187, v249, v187
    v_mul_f32 v188, v249, v188
    v_mfma_f32_16x16x32_bf16 v[148:151], v[92:95], a[60:63], v[148:151]
    buffer_load_dwordx4 v2, s[28:31], s79 offen offset:0 sc1 lds
    v_mul_f32 v189, v249, v189
    v_mfma_f32_16x16x32_bf16 v[148:151], v[88:91], a[56:59], v[148:151]
    v_mul_f32 v190, v249, v190
    v_mul_f32 v191, v249, v191
    v_mfma_f32_16x16x32_bf16 v[148:151], v[84:87], a[52:55], v[148:151]
    buffer_load_dwordx4 a[24:27], v2, s[28:31], s87 offen offset:2048 sc1
    v_cvt_pk_bf16_f32 v224, v184, v185
    v_mfma_f32_16x16x32_bf16 v[148:151], v[80:83], a[48:51], v[148:151]
    s_waitcnt lgkmcnt(4)
    v_cvt_pk_bf16_f32 v225, v186, v187
    v_cvt_pk_bf16_f32 v226, v188, v189
    v_mfma_f32_16x16x32_bf16 v[152:155], v[96:99], a[32:35], v[152:155]
    ds_read_b128 v[80:83], v10 offset:7168
    ds_read_b128 v[84:87], v10 offset:16384
    v_mfma_f32_16x16x32_bf16 v[152:155], v[100:103], a[36:39], v[152:155]
    v_cvt_pk_bf16_f32 v227, v190, v191
    v_mfma_f32_16x16x32_bf16 v[152:155], v[104:107], a[40:43], v[152:155]
    ds_read_b128 v[88:91], v10 offset:25600
    ds_read_b128 v[92:95], v10 offset:34816
    v_mfma_f32_16x16x32_bf16 v[152:155], v[108:111], a[44:47], v[152:155]
    buffer_load_dwordx4 v2, s[28:31], s79 offen offset:1024 sc1 lds
    buffer_store_dwordx4 v[224:227], v2, s[28:31], s71 offen offset:0 sc1
    v_mfma_f32_16x16x32_bf16 v[156:159], v[108:111], a[60:63], v[156:159]
    v_accvgpr_read_b32 v232, a168
    v_accvgpr_read_b32 v233, a169
    v_mfma_f32_16x16x32_bf16 v[156:159], v[104:107], a[56:59], v[156:159]
    v_accvgpr_read_b32 v234, a170
    v_accvgpr_read_b32 v235, a171
    v_mfma_f32_16x16x32_bf16 v[156:159], v[100:103], a[52:55], v[156:159]
    buffer_load_dwordx4 a[28:31], v2, s[28:31], s87 offen offset:3072 sc1
    v_accvgpr_read_b32 v236, a172
    v_mfma_f32_16x16x32_bf16 v[156:159], v[96:99], a[48:51], v[156:159]
    s_waitcnt lgkmcnt(4)
    v_accvgpr_read_b32 v237, a173
    v_accvgpr_read_b32 v238, a174
    v_mfma_f32_16x16x32_bf16 v[160:163], v[64:67], a[32:35], v[160:163]
    ds_read_b128 v[96:99], v10 offset:8192
    ds_read_b128 v[100:103], v10 offset:17408
    v_mfma_f32_16x16x32_bf16 v[160:163], v[68:71], a[36:39], v[160:163]
    v_accvgpr_read_b32 v239, a175
    v_mul_f32 v232, v249, v232
    v_mfma_f32_16x16x32_bf16 v[160:163], v[72:75], a[40:43], v[160:163]
    s_add_u32 s79, s84, 442368
    ds_read_b128 v[104:107], v10 offset:26624
    ds_read_b128 v[108:111], v10 offset:35840
    v_mfma_f32_16x16x32_bf16 v[160:163], v[76:79], a[44:47], v[160:163]
    s_add_u32 m0, s88, 45056
    v_mul_f32 v233, v249, v233
    v_mul_f32 v234, v249, v234
    v_mfma_f32_16x16x32_bf16 v[164:167], v[76:79], a[60:63], v[164:167]
    buffer_load_dwordx4 v2, s[28:31], s79 offen offset:0 sc1 lds
    v_mul_f32 v235, v249, v235
    v_mfma_f32_16x16x32_bf16 v[164:167], v[72:75], a[56:59], v[164:167]
    v_mul_f32 v236, v249, v236
    v_mul_f32 v237, v249, v237
    v_mfma_f32_16x16x32_bf16 v[164:167], v[68:71], a[52:55], v[164:167]
    v_mul_f32 v238, v249, v238
    v_mul_f32 v239, v249, v239
    v_mfma_f32_16x16x32_bf16 v[164:167], v[64:67], a[48:51], v[164:167]
    s_waitcnt lgkmcnt(4)
    v_cvt_pk_bf16_f32 v56, v232, v233
    v_cvt_pk_bf16_f32 v57, v234, v235
    v_mfma_f32_16x16x32_bf16 v[168:171], v[80:83], a[32:35], v[168:171]
    s_waitcnt vmcnt(22)
    v_subrev_u32 v10, 110592, v10
    v_cvt_pk_bf16_f32 v58, v236, v237
    v_mfma_f32_16x16x32_bf16 v[168:171], v[84:87], a[36:39], v[168:171]
    s_barrier
    v_cvt_pk_bf16_f32 v59, v238, v239
    v_mfma_f32_16x16x32_bf16 v[168:171], v[88:91], a[40:43], v[168:171]
    s_add_u32 s79, s80, 589824
    ds_read_b128 v[64:67], v10 offset:0
    ds_read_b128 v[68:71], v10 offset:9216
    v_mfma_f32_16x16x32_bf16 v[168:171], v[92:95], a[44:47], v[168:171]
    s_add_u32 m0, s88, 73728
    buffer_store_dwordx4 v[56:59], v2, s[28:31], s71 offen offset:1024 sc1
    v_accvgpr_read_b32 v184, a176
    v_mfma_f32_16x16x32_bf16 v[172:175], v[92:95], a[60:63], v[172:175]
    ds_read_b128 v[72:75], v10 offset:18432
    ds_read_b128 v[76:79], v10 offset:27648
    v_mfma_f32_16x16x32_bf16 v[172:175], v[88:91], a[56:59], v[172:175]
    buffer_load_dwordx4 v2, s[28:31], s79 offen offset:0 sc1 lds
    v_accvgpr_read_b32 v185, a177
    v_mfma_f32_16x16x32_bf16 v[172:175], v[84:87], a[52:55], v[172:175]
    s_add_u32 s87, s85, 2097152
    v_accvgpr_read_b32 v186, a178
    v_accvgpr_read_b32 v187, a179
    v_mfma_f32_16x16x32_bf16 v[172:175], v[80:83], a[48:51], v[172:175]
    s_waitcnt lgkmcnt(4)
    buffer_load_dwordx4 a[64:67], v2, s[28:31], s87 offen offset:0 sc1
    v_accvgpr_read_b32 v188, a180
    v_mfma_f32_16x16x32_bf16 v[176:179], v[96:99], a[32:35], v[176:179]
    ds_read_b128 v[80:83], v10 offset:1024
    ds_read_b128 v[84:87], v10 offset:10240
    v_mfma_f32_16x16x32_bf16 v[176:179], v[100:103], a[36:39], v[176:179]
    v_accvgpr_read_b32 v189, a181
    v_accvgpr_read_b32 v190, a182
    v_mfma_f32_16x16x32_bf16 v[176:179], v[104:107], a[40:43], v[176:179]
    ds_read_b128 v[88:91], v10 offset:19456
    ds_read_b128 v[92:95], v10 offset:28672
    v_mfma_f32_16x16x32_bf16 v[176:179], v[108:111], a[44:47], v[176:179]
    buffer_load_dwordx4 v2, s[28:31], s79 offen offset:1024 sc1 lds
    v_accvgpr_read_b32 v191, a183
    v_mfma_f32_16x16x32_bf16 v[180:183], v[108:111], a[60:63], v[180:183]
    v_mul_f32 v184, v249, v184
    v_mul_f32 v185, v249, v185
    v_mfma_f32_16x16x32_bf16 v[180:183], v[104:107], a[56:59], v[180:183]
    v_mul_f32 v186, v249, v186
    v_mul_f32 v187, v249, v187
    v_mfma_f32_16x16x32_bf16 v[180:183], v[100:103], a[52:55], v[180:183]
    buffer_load_dwordx4 a[68:71], v2, s[28:31], s87 offen offset:1024 sc1
    v_mul_f32 v188, v249, v188
    v_mfma_f32_16x16x32_bf16 v[180:183], v[96:99], a[48:51], v[180:183]
    s_waitcnt lgkmcnt(4)
    v_mul_f32 v189, v249, v189
    v_mul_f32 v190, v249, v190
    v_mfma_f32_16x16x32_bf16 v[112:115], v[64:67], v[240:243], v[112:115]
    ds_read_b128 v[96:99], v10 offset:2048
    ds_read_b128 v[100:103], v10 offset:11264
    v_mfma_f32_16x16x32_bf16 v[112:115], v[68:71], v[244:247], v[112:115]
    v_mul_f32 v191, v249, v191
    v_cvt_pk_bf16_f32 v224, v184, v185
    v_mfma_f32_16x16x32_bf16 v[112:115], v[72:75], v[52:55], v[112:115]
    s_add_u32 s79, s81, 589824
    ds_read_b128 v[104:107], v10 offset:20480
    ds_read_b128 v[108:111], v10 offset:29696
    v_mfma_f32_16x16x32_bf16 v[112:115], v[76:79], v[228:231], v[112:115]
    s_add_u32 m0, s88, 75776
    v_cvt_pk_bf16_f32 v225, v186, v187
    v_cvt_pk_bf16_f32 v226, v188, v189
    s_waitcnt vmcnt(26)
    v_mfma_f32_16x16x32_bf16 v[116:119], v[76:79], v[204:207], v[116:119]
    buffer_load_dwordx4 v2, s[28:31], s79 offen offset:0 sc1 lds
    v_cvt_pk_bf16_f32 v227, v190, v191
    v_mfma_f32_16x16x32_bf16 v[116:119], v[72:75], v[200:203], v[116:119]
    buffer_store_dwordx4 v[224:227], v2, s[28:31], s71 offen offset:2048 sc1
    v_accvgpr_read_b32 v232, a184
    v_mfma_f32_16x16x32_bf16 v[116:119], v[68:71], v[196:199], v[116:119]
    buffer_load_dwordx4 a[72:75], v2, s[28:31], s87 offen offset:2048 sc1
    v_accvgpr_read_b32 v233, a185
    v_mfma_f32_16x16x32_bf16 v[116:119], v[64:67], v[192:195], v[116:119]
    s_waitcnt lgkmcnt(4)
    v_accvgpr_read_b32 v234, a186
    v_accvgpr_read_b32 v235, a187
    v_mfma_f32_16x16x32_bf16 v[120:123], v[80:83], v[240:243], v[120:123]
    ds_read_b128 v[64:67], v10 offset:3072
    ds_read_b128 v[68:71], v10 offset:12288
    v_mfma_f32_16x16x32_bf16 v[120:123], v[84:87], v[244:247], v[120:123]
    v_accvgpr_read_b32 v236, a188
    v_accvgpr_read_b32 v237, a189
    v_mfma_f32_16x16x32_bf16 v[120:123], v[88:91], v[52:55], v[120:123]
    ds_read_b128 v[72:75], v10 offset:21504
    ds_read_b128 v[76:79], v10 offset:30720
    v_mfma_f32_16x16x32_bf16 v[120:123], v[92:95], v[228:231], v[120:123]
    buffer_load_dwordx4 v2, s[28:31], s79 offen offset:1024 sc1 lds
    v_accvgpr_read_b32 v238, a190
    v_mfma_f32_16x16x32_bf16 v[124:127], v[92:95], v[204:207], v[124:127]
    v_accvgpr_read_b32 v239, a191
    v_mul_f32 v232, v249, v232
    v_mfma_f32_16x16x32_bf16 v[124:127], v[88:91], v[200:203], v[124:127]
    v_mul_f32 v233, v249, v233
    v_mul_f32 v234, v249, v234
    v_mfma_f32_16x16x32_bf16 v[124:127], v[84:87], v[196:199], v[124:127]
    buffer_load_dwordx4 a[76:79], v2, s[28:31], s87 offen offset:3072 sc1
    v_mul_f32 v235, v249, v235
    v_mfma_f32_16x16x32_bf16 v[124:127], v[80:83], v[192:195], v[124:127]
    s_waitcnt lgkmcnt(4)
    v_mul_f32 v236, v249, v236
    v_mul_f32 v237, v249, v237
    v_mfma_f32_16x16x32_bf16 v[128:131], v[96:99], v[240:243], v[128:131]
    ds_read_b128 v[80:83], v10 offset:4096
    ds_read_b128 v[84:87], v10 offset:13312
    v_mfma_f32_16x16x32_bf16 v[128:131], v[100:103], v[244:247], v[128:131]
    v_mul_f32 v238, v249, v238
    v_mul_f32 v239, v249, v239
    v_mfma_f32_16x16x32_bf16 v[128:131], v[104:107], v[52:55], v[128:131]
    s_add_u32 s79, s82, 589824
    ds_read_b128 v[88:91], v10 offset:22528
    ds_read_b128 v[92:95], v10 offset:31744
    v_mfma_f32_16x16x32_bf16 v[128:131], v[108:111], v[228:231], v[128:131]
    s_add_u32 m0, s88, 77824
    v_cvt_pk_bf16_f32 v56, v232, v233
    v_cvt_pk_bf16_f32 v57, v234, v235
    v_mfma_f32_16x16x32_bf16 v[132:135], v[108:111], v[204:207], v[132:135]
    buffer_load_dwordx4 v2, s[28:31], s79 offen offset:0 sc1 lds
    v_cvt_pk_bf16_f32 v58, v236, v237
    v_mfma_f32_16x16x32_bf16 v[132:135], v[104:107], v[200:203], v[132:135]
    v_cvt_pk_bf16_f32 v59, v238, v239
    v_mfma_f32_16x16x32_bf16 v[132:135], v[100:103], v[196:199], v[132:135]
    s_add_u32 s87, s85, 2101248
    buffer_store_dwordx4 v[56:59], v2, s[28:31], s71 offen offset:3072 sc1
    v_mfma_f32_16x16x32_bf16 v[132:135], v[96:99], v[192:195], v[132:135]
    s_waitcnt lgkmcnt(4)
    s_add_u32 s71, s3, 2
    buffer_load_dwordx4 a[80:83], v2, s[28:31], s87 offen offset:0 sc1
    v_mfma_f32_16x16x32_bf16 v[136:139], v[64:67], v[240:243], v[136:139]
    s_and_b32 s71, s71, 3
    ds_read_b128 v[96:99], v10 offset:5120
    ds_read_b128 v[100:103], v10 offset:14336
    v_mfma_f32_16x16x32_bf16 v[136:139], v[68:71], v[244:247], v[136:139]
    s_mul_i32 s71, s71, 4096
    s_add_u32 s71, s71, s100
    v_accvgpr_read_b32 v184, a192
    v_mfma_f32_16x16x32_bf16 v[136:139], v[72:75], v[52:55], v[136:139]
    ds_read_b128 v[104:107], v10 offset:23552
    ds_read_b128 v[108:111], v10 offset:32768
    v_mfma_f32_16x16x32_bf16 v[136:139], v[76:79], v[228:231], v[136:139]
    buffer_load_dwordx4 v2, s[28:31], s79 offen offset:1024 sc1 lds
    v_accvgpr_read_b32 v185, a193
    v_mfma_f32_16x16x32_bf16 v[140:143], v[76:79], v[204:207], v[140:143]
    v_accvgpr_read_b32 v186, a194
    v_accvgpr_read_b32 v187, a195
    v_mfma_f32_16x16x32_bf16 v[140:143], v[72:75], v[200:203], v[140:143]
    v_accvgpr_read_b32 v188, a196
    v_accvgpr_read_b32 v189, a197
    v_mfma_f32_16x16x32_bf16 v[140:143], v[68:71], v[196:199], v[140:143]
    buffer_load_dwordx4 a[84:87], v2, s[28:31], s87 offen offset:1024 sc1
    v_accvgpr_read_b32 v190, a198
    v_mfma_f32_16x16x32_bf16 v[140:143], v[64:67], v[192:195], v[140:143]
    s_waitcnt lgkmcnt(4)
    v_accvgpr_read_b32 v191, a199
    v_mul_f32 v184, v250, v184
    v_mfma_f32_16x16x32_bf16 v[144:147], v[80:83], v[240:243], v[144:147]
    ds_read_b128 v[64:67], v10 offset:6144
    ds_read_b128 v[68:71], v10 offset:15360
    v_mfma_f32_16x16x32_bf16 v[144:147], v[84:87], v[244:247], v[144:147]
    v_mul_f32 v185, v250, v185
    v_mul_f32 v186, v250, v186
    v_mfma_f32_16x16x32_bf16 v[144:147], v[88:91], v[52:55], v[144:147]
    s_add_u32 s79, s83, 589824
    ds_read_b128 v[72:75], v10 offset:24576
    ds_read_b128 v[76:79], v10 offset:33792
    v_mfma_f32_16x16x32_bf16 v[144:147], v[92:95], v[228:231], v[144:147]
    s_add_u32 m0, s88, 79872
    v_mul_f32 v187, v250, v187
    v_mul_f32 v188, v250, v188
    v_mfma_f32_16x16x32_bf16 v[148:151], v[92:95], v[204:207], v[148:151]
    buffer_load_dwordx4 v2, s[28:31], s79 offen offset:0 sc1 lds
    v_mul_f32 v189, v250, v189
    v_mfma_f32_16x16x32_bf16 v[148:151], v[88:91], v[200:203], v[148:151]
    v_mul_f32 v190, v250, v190
    v_mul_f32 v191, v250, v191
    v_mfma_f32_16x16x32_bf16 v[148:151], v[84:87], v[196:199], v[148:151]
    buffer_load_dwordx4 a[88:91], v2, s[28:31], s87 offen offset:2048 sc1
    v_cvt_pk_bf16_f32 v224, v184, v185
    v_mfma_f32_16x16x32_bf16 v[148:151], v[80:83], v[192:195], v[148:151]
    s_waitcnt lgkmcnt(4)
    v_cvt_pk_bf16_f32 v225, v186, v187
    v_cvt_pk_bf16_f32 v226, v188, v189
    v_mfma_f32_16x16x32_bf16 v[152:155], v[96:99], v[240:243], v[152:155]
    ds_read_b128 v[80:83], v10 offset:7168
    ds_read_b128 v[84:87], v10 offset:16384
    v_mfma_f32_16x16x32_bf16 v[152:155], v[100:103], v[244:247], v[152:155]
    v_cvt_pk_bf16_f32 v227, v190, v191
    v_mfma_f32_16x16x32_bf16 v[152:155], v[104:107], v[52:55], v[152:155]
    ds_read_b128 v[88:91], v10 offset:25600
    ds_read_b128 v[92:95], v10 offset:34816
    v_mfma_f32_16x16x32_bf16 v[152:155], v[108:111], v[228:231], v[152:155]
    buffer_load_dwordx4 v2, s[28:31], s79 offen offset:1024 sc1 lds
    buffer_store_dwordx4 v[224:227], v2, s[28:31], s71 offen offset:0 sc1
    v_mfma_f32_16x16x32_bf16 v[156:159], v[108:111], v[204:207], v[156:159]
    v_accvgpr_read_b32 v232, a200
    v_accvgpr_read_b32 v233, a201
    v_mfma_f32_16x16x32_bf16 v[156:159], v[104:107], v[200:203], v[156:159]
    v_accvgpr_read_b32 v234, a202
    v_accvgpr_read_b32 v235, a203
    v_mfma_f32_16x16x32_bf16 v[156:159], v[100:103], v[196:199], v[156:159]
    buffer_load_dwordx4 a[92:95], v2, s[28:31], s87 offen offset:3072 sc1
    v_accvgpr_read_b32 v236, a204
    v_mfma_f32_16x16x32_bf16 v[156:159], v[96:99], v[192:195], v[156:159]
    s_waitcnt lgkmcnt(4)
    v_accvgpr_read_b32 v237, a205
    v_accvgpr_read_b32 v238, a206
    v_mfma_f32_16x16x32_bf16 v[160:163], v[64:67], v[240:243], v[160:163]
    ds_read_b128 v[96:99], v10 offset:8192
    ds_read_b128 v[100:103], v10 offset:17408
    v_mfma_f32_16x16x32_bf16 v[160:163], v[68:71], v[244:247], v[160:163]
    v_accvgpr_read_b32 v239, a207
    v_mul_f32 v232, v250, v232
    v_mfma_f32_16x16x32_bf16 v[160:163], v[72:75], v[52:55], v[160:163]
    s_add_u32 s79, s84, 589824
    ds_read_b128 v[104:107], v10 offset:26624
    ds_read_b128 v[108:111], v10 offset:35840
    v_mfma_f32_16x16x32_bf16 v[160:163], v[76:79], v[228:231], v[160:163]
    s_add_u32 m0, s88, 81920
    v_mul_f32 v233, v250, v233
    v_mul_f32 v234, v250, v234
    v_mfma_f32_16x16x32_bf16 v[164:167], v[76:79], v[204:207], v[164:167]
    buffer_load_dwordx4 v2, s[28:31], s79 offen offset:0 sc1 lds
    v_mul_f32 v235, v250, v235
    v_mfma_f32_16x16x32_bf16 v[164:167], v[72:75], v[200:203], v[164:167]
    v_mul_f32 v236, v250, v236
    v_mul_f32 v237, v250, v237
    v_mfma_f32_16x16x32_bf16 v[164:167], v[68:71], v[196:199], v[164:167]
    v_mul_f32 v238, v250, v238
    v_mul_f32 v239, v250, v239
    v_mfma_f32_16x16x32_bf16 v[164:167], v[64:67], v[192:195], v[164:167]
    s_waitcnt lgkmcnt(4)
    v_cvt_pk_bf16_f32 v56, v232, v233
    v_cvt_pk_bf16_f32 v57, v234, v235
    v_mfma_f32_16x16x32_bf16 v[168:171], v[80:83], v[240:243], v[168:171]
    s_waitcnt vmcnt(21)
    v_add_u32 v10, 36864, v10
    v_cvt_pk_bf16_f32 v58, v236, v237
    v_mfma_f32_16x16x32_bf16 v[168:171], v[84:87], v[244:247], v[168:171]
    s_barrier
    v_cvt_pk_bf16_f32 v59, v238, v239
    v_mfma_f32_16x16x32_bf16 v[168:171], v[88:91], v[52:55], v[168:171]
    s_add_u32 s79, s80, 737280
    ds_read_b128 v[64:67], v10 offset:0
    ds_read_b128 v[68:71], v10 offset:9216
    v_mfma_f32_16x16x32_bf16 v[168:171], v[92:95], v[228:231], v[168:171]
    s_add_u32 m0, s88, 110592
    buffer_store_dwordx4 v[56:59], v2, s[28:31], s71 offen offset:1024 sc1
    v_accvgpr_read_b32 v184, a208
    v_mfma_f32_16x16x32_bf16 v[172:175], v[92:95], v[204:207], v[172:175]
    ds_read_b128 v[72:75], v10 offset:18432
    ds_read_b128 v[76:79], v10 offset:27648
    v_mfma_f32_16x16x32_bf16 v[172:175], v[88:91], v[200:203], v[172:175]
    buffer_load_dwordx4 v2, s[28:31], s79 offen offset:0 sc1 lds
    v_accvgpr_read_b32 v185, a209
    v_mfma_f32_16x16x32_bf16 v[172:175], v[84:87], v[196:199], v[172:175]
    s_add_u32 s87, s85, 2621440
    v_accvgpr_read_b32 v186, a210
    v_accvgpr_read_b32 v187, a211
    v_mfma_f32_16x16x32_bf16 v[172:175], v[80:83], v[192:195], v[172:175]
    s_waitcnt lgkmcnt(4)
    buffer_load_dwordx4 a[32:35], v2, s[28:31], s87 offen offset:0 sc1
    v_accvgpr_read_b32 v188, a212
    v_mfma_f32_16x16x32_bf16 v[176:179], v[96:99], v[240:243], v[176:179]
    ds_read_b128 v[80:83], v10 offset:1024
    ds_read_b128 v[84:87], v10 offset:10240
    v_mfma_f32_16x16x32_bf16 v[176:179], v[100:103], v[244:247], v[176:179]
    v_accvgpr_read_b32 v189, a213
    v_accvgpr_read_b32 v190, a214
    v_mfma_f32_16x16x32_bf16 v[176:179], v[104:107], v[52:55], v[176:179]
    ds_read_b128 v[88:91], v10 offset:19456
    ds_read_b128 v[92:95], v10 offset:28672
    v_mfma_f32_16x16x32_bf16 v[176:179], v[108:111], v[228:231], v[176:179]
    buffer_load_dwordx4 v2, s[28:31], s79 offen offset:1024 sc1 lds
    v_accvgpr_read_b32 v191, a215
    v_mfma_f32_16x16x32_bf16 v[180:183], v[108:111], v[204:207], v[180:183]
    v_mul_f32 v184, v250, v184
    v_mul_f32 v185, v250, v185
    v_mfma_f32_16x16x32_bf16 v[180:183], v[104:107], v[200:203], v[180:183]
    v_mul_f32 v186, v250, v186
    v_mul_f32 v187, v250, v187
    v_mfma_f32_16x16x32_bf16 v[180:183], v[100:103], v[196:199], v[180:183]
    buffer_load_dwordx4 a[36:39], v2, s[28:31], s87 offen offset:1024 sc1
    v_mul_f32 v188, v250, v188
    v_mfma_f32_16x16x32_bf16 v[180:183], v[96:99], v[192:195], v[180:183]
    s_waitcnt lgkmcnt(4)
    v_mul_f32 v189, v250, v189
    v_mul_f32 v190, v250, v190
    v_mfma_f32_16x16x32_bf16 v[112:115], v[64:67], a[0:3], v[112:115]
    ds_read_b128 v[96:99], v10 offset:2048
    ds_read_b128 v[100:103], v10 offset:11264
    v_mfma_f32_16x16x32_bf16 v[112:115], v[68:71], a[4:7], v[112:115]
    v_mul_f32 v191, v250, v191
    v_cvt_pk_bf16_f32 v224, v184, v185
    v_mfma_f32_16x16x32_bf16 v[112:115], v[72:75], a[8:11], v[112:115]
    s_add_u32 s79, s81, 737280
    ds_read_b128 v[104:107], v10 offset:20480
    ds_read_b128 v[108:111], v10 offset:29696
    v_mfma_f32_16x16x32_bf16 v[112:115], v[76:79], a[12:15], v[112:115]
    s_add_u32 m0, s88, 112640
    v_cvt_pk_bf16_f32 v225, v186, v187
    v_cvt_pk_bf16_f32 v226, v188, v189
    v_mfma_f32_16x16x32_bf16 v[116:119], v[76:79], a[28:31], v[116:119]
    buffer_load_dwordx4 v2, s[28:31], s79 offen offset:0 sc1 lds
    v_cvt_pk_bf16_f32 v227, v190, v191
    v_mfma_f32_16x16x32_bf16 v[116:119], v[72:75], a[24:27], v[116:119]
    buffer_store_dwordx4 v[224:227], v2, s[28:31], s71 offen offset:2048 sc1
    v_accvgpr_read_b32 v232, a216
    v_mfma_f32_16x16x32_bf16 v[116:119], v[68:71], a[20:23], v[116:119]
    buffer_load_dwordx4 a[40:43], v2, s[28:31], s87 offen offset:2048 sc1
    v_accvgpr_read_b32 v233, a217
    v_mfma_f32_16x16x32_bf16 v[116:119], v[64:67], a[16:19], v[116:119]
    s_waitcnt lgkmcnt(4)
    v_accvgpr_read_b32 v234, a218
    v_accvgpr_read_b32 v235, a219
    v_mfma_f32_16x16x32_bf16 v[120:123], v[80:83], a[0:3], v[120:123]
    ds_read_b128 v[64:67], v10 offset:3072
    ds_read_b128 v[68:71], v10 offset:12288
    v_mfma_f32_16x16x32_bf16 v[120:123], v[84:87], a[4:7], v[120:123]
    v_accvgpr_read_b32 v236, a220
    v_accvgpr_read_b32 v237, a221
    v_mfma_f32_16x16x32_bf16 v[120:123], v[88:91], a[8:11], v[120:123]
    ds_read_b128 v[72:75], v10 offset:21504
    ds_read_b128 v[76:79], v10 offset:30720
    v_mfma_f32_16x16x32_bf16 v[120:123], v[92:95], a[12:15], v[120:123]
    buffer_load_dwordx4 v2, s[28:31], s79 offen offset:1024 sc1 lds
    v_accvgpr_read_b32 v238, a222
    v_mfma_f32_16x16x32_bf16 v[124:127], v[92:95], a[28:31], v[124:127]
    v_accvgpr_read_b32 v239, a223
    v_mul_f32 v232, v250, v232
    v_mfma_f32_16x16x32_bf16 v[124:127], v[88:91], a[24:27], v[124:127]
    v_mul_f32 v233, v250, v233
    v_mul_f32 v234, v250, v234
    v_mfma_f32_16x16x32_bf16 v[124:127], v[84:87], a[20:23], v[124:127]
    buffer_load_dwordx4 a[44:47], v2, s[28:31], s87 offen offset:3072 sc1
    v_mul_f32 v235, v250, v235
    v_mfma_f32_16x16x32_bf16 v[124:127], v[80:83], a[16:19], v[124:127]
    s_waitcnt lgkmcnt(4)
    v_mul_f32 v236, v250, v236
    v_mul_f32 v237, v250, v237
    v_mfma_f32_16x16x32_bf16 v[128:131], v[96:99], a[0:3], v[128:131]
    ds_read_b128 v[80:83], v10 offset:4096
    ds_read_b128 v[84:87], v10 offset:13312
    v_mfma_f32_16x16x32_bf16 v[128:131], v[100:103], a[4:7], v[128:131]
    v_mul_f32 v238, v250, v238
    v_mul_f32 v239, v250, v239
    v_mfma_f32_16x16x32_bf16 v[128:131], v[104:107], a[8:11], v[128:131]
    s_add_u32 s79, s82, 737280
    ds_read_b128 v[88:91], v10 offset:22528
    ds_read_b128 v[92:95], v10 offset:31744
    v_mfma_f32_16x16x32_bf16 v[128:131], v[108:111], a[12:15], v[128:131]
    s_add_u32 m0, s88, 114688
    v_cvt_pk_bf16_f32 v56, v232, v233
    v_cvt_pk_bf16_f32 v57, v234, v235
    v_mfma_f32_16x16x32_bf16 v[132:135], v[108:111], a[28:31], v[132:135]
    buffer_load_dwordx4 v2, s[28:31], s79 offen offset:0 sc1 lds
    v_cvt_pk_bf16_f32 v58, v236, v237
    v_mfma_f32_16x16x32_bf16 v[132:135], v[104:107], a[24:27], v[132:135]
    v_cvt_pk_bf16_f32 v59, v238, v239
    v_mfma_f32_16x16x32_bf16 v[132:135], v[100:103], a[20:23], v[132:135]
    s_add_u32 s87, s85, 2625536
    buffer_store_dwordx4 v[56:59], v2, s[28:31], s71 offen offset:3072 sc1
    v_mfma_f32_16x16x32_bf16 v[132:135], v[96:99], a[16:19], v[132:135]
    s_waitcnt lgkmcnt(4)
    s_add_u32 s71, s3, 3
    buffer_load_dwordx4 a[48:51], v2, s[28:31], s87 offen offset:0 sc1
    v_mfma_f32_16x16x32_bf16 v[136:139], v[64:67], a[0:3], v[136:139]
    s_and_b32 s71, s71, 3
    ds_read_b128 v[96:99], v10 offset:5120
    ds_read_b128 v[100:103], v10 offset:14336
    v_mfma_f32_16x16x32_bf16 v[136:139], v[68:71], a[4:7], v[136:139]
    s_mul_i32 s71, s71, 4096
    s_add_u32 s71, s71, s100
    v_accvgpr_read_b32 v184, a224
    v_mfma_f32_16x16x32_bf16 v[136:139], v[72:75], a[8:11], v[136:139]
    ds_read_b128 v[104:107], v10 offset:23552
    ds_read_b128 v[108:111], v10 offset:32768
    v_mfma_f32_16x16x32_bf16 v[136:139], v[76:79], a[12:15], v[136:139]
    buffer_load_dwordx4 v2, s[28:31], s79 offen offset:1024 sc1 lds
    v_accvgpr_read_b32 v185, a225
    v_mfma_f32_16x16x32_bf16 v[140:143], v[76:79], a[28:31], v[140:143]
    v_accvgpr_read_b32 v186, a226
    v_accvgpr_read_b32 v187, a227
    v_mfma_f32_16x16x32_bf16 v[140:143], v[72:75], a[24:27], v[140:143]
    v_accvgpr_read_b32 v188, a228
    v_accvgpr_read_b32 v189, a229
    v_mfma_f32_16x16x32_bf16 v[140:143], v[68:71], a[20:23], v[140:143]
    buffer_load_dwordx4 a[52:55], v2, s[28:31], s87 offen offset:1024 sc1
    v_accvgpr_read_b32 v190, a230
    v_mfma_f32_16x16x32_bf16 v[140:143], v[64:67], a[16:19], v[140:143]
    s_waitcnt lgkmcnt(4)
    v_accvgpr_read_b32 v191, a231
    v_mul_f32 v184, v251, v184
    v_mfma_f32_16x16x32_bf16 v[144:147], v[80:83], a[0:3], v[144:147]
    ds_read_b128 v[64:67], v10 offset:6144
    ds_read_b128 v[68:71], v10 offset:15360
    v_mfma_f32_16x16x32_bf16 v[144:147], v[84:87], a[4:7], v[144:147]
    v_mul_f32 v185, v251, v185
    v_mul_f32 v186, v251, v186
    v_mfma_f32_16x16x32_bf16 v[144:147], v[88:91], a[8:11], v[144:147]
    s_add_u32 s79, s83, 737280
    ds_read_b128 v[72:75], v10 offset:24576
    ds_read_b128 v[76:79], v10 offset:33792
    v_mfma_f32_16x16x32_bf16 v[144:147], v[92:95], a[12:15], v[144:147]
    s_add_u32 m0, s88, 116736
    v_mul_f32 v187, v251, v187
    v_mul_f32 v188, v251, v188
    v_mfma_f32_16x16x32_bf16 v[148:151], v[92:95], a[28:31], v[148:151]
    buffer_load_dwordx4 v2, s[28:31], s79 offen offset:0 sc1 lds
    v_mul_f32 v189, v251, v189
    v_mfma_f32_16x16x32_bf16 v[148:151], v[88:91], a[24:27], v[148:151]
    v_mul_f32 v190, v251, v190
    v_mul_f32 v191, v251, v191
    v_mfma_f32_16x16x32_bf16 v[148:151], v[84:87], a[20:23], v[148:151]
    buffer_load_dwordx4 a[56:59], v2, s[28:31], s87 offen offset:2048 sc1
    v_cvt_pk_bf16_f32 v224, v184, v185
    v_mfma_f32_16x16x32_bf16 v[148:151], v[80:83], a[16:19], v[148:151]
    s_waitcnt lgkmcnt(4)
    v_cvt_pk_bf16_f32 v225, v186, v187
    v_cvt_pk_bf16_f32 v226, v188, v189
    v_mfma_f32_16x16x32_bf16 v[152:155], v[96:99], a[0:3], v[152:155]
    ds_read_b128 v[80:83], v10 offset:7168
    ds_read_b128 v[84:87], v10 offset:16384
    v_mfma_f32_16x16x32_bf16 v[152:155], v[100:103], a[4:7], v[152:155]
    v_cvt_pk_bf16_f32 v227, v190, v191
    v_mfma_f32_16x16x32_bf16 v[152:155], v[104:107], a[8:11], v[152:155]
    ds_read_b128 v[88:91], v10 offset:25600
    ds_read_b128 v[92:95], v10 offset:34816
    v_mfma_f32_16x16x32_bf16 v[152:155], v[108:111], a[12:15], v[152:155]
    buffer_load_dwordx4 v2, s[28:31], s79 offen offset:1024 sc1 lds
    buffer_store_dwordx4 v[224:227], v2, s[28:31], s71 offen offset:0 sc1
    v_mfma_f32_16x16x32_bf16 v[156:159], v[108:111], a[28:31], v[156:159]
    v_accvgpr_read_b32 v232, a232
    v_accvgpr_read_b32 v233, a233
    v_mfma_f32_16x16x32_bf16 v[156:159], v[104:107], a[24:27], v[156:159]
    v_accvgpr_read_b32 v234, a234
    v_accvgpr_read_b32 v235, a235
    v_mfma_f32_16x16x32_bf16 v[156:159], v[100:103], a[20:23], v[156:159]
    buffer_load_dwordx4 a[60:63], v2, s[28:31], s87 offen offset:3072 sc1
    v_accvgpr_read_b32 v236, a236
    v_mfma_f32_16x16x32_bf16 v[156:159], v[96:99], a[16:19], v[156:159]
    s_waitcnt lgkmcnt(4)
    v_accvgpr_read_b32 v237, a237
    v_accvgpr_read_b32 v238, a238
    v_mfma_f32_16x16x32_bf16 v[160:163], v[64:67], a[0:3], v[160:163]
    ds_read_b128 v[96:99], v10 offset:8192
    ds_read_b128 v[100:103], v10 offset:17408
    v_mfma_f32_16x16x32_bf16 v[160:163], v[68:71], a[4:7], v[160:163]
    v_accvgpr_read_b32 v239, a239
    v_mul_f32 v232, v251, v232
    v_mfma_f32_16x16x32_bf16 v[160:163], v[72:75], a[8:11], v[160:163]
    s_add_u32 s79, s84, 737280
    ds_read_b128 v[104:107], v10 offset:26624
    ds_read_b128 v[108:111], v10 offset:35840
    v_mfma_f32_16x16x32_bf16 v[160:163], v[76:79], a[12:15], v[160:163]
    s_add_u32 m0, s88, 118784
    v_mul_f32 v233, v251, v233
    v_mul_f32 v234, v251, v234
    v_mfma_f32_16x16x32_bf16 v[164:167], v[76:79], a[28:31], v[164:167]
    buffer_load_dwordx4 v2, s[28:31], s79 offen offset:0 sc1 lds
    v_mul_f32 v235, v251, v235
    v_mfma_f32_16x16x32_bf16 v[164:167], v[72:75], a[24:27], v[164:167]
    v_mul_f32 v236, v251, v236
    v_mul_f32 v237, v251, v237
    v_mfma_f32_16x16x32_bf16 v[164:167], v[68:71], a[20:23], v[164:167]
    v_mul_f32 v238, v251, v238
    v_mul_f32 v239, v251, v239
    v_mfma_f32_16x16x32_bf16 v[164:167], v[64:67], a[16:19], v[164:167]
    s_waitcnt lgkmcnt(4)
    v_cvt_pk_bf16_f32 v56, v232, v233
    v_cvt_pk_bf16_f32 v57, v234, v235
    v_mfma_f32_16x16x32_bf16 v[168:171], v[80:83], a[0:3], v[168:171]
    s_waitcnt vmcnt(21)
    v_add_u32 v10, 36864, v10
    v_cvt_pk_bf16_f32 v58, v236, v237
    v_mfma_f32_16x16x32_bf16 v[168:171], v[84:87], a[4:7], v[168:171]
    s_barrier
    v_cvt_pk_bf16_f32 v59, v238, v239
    v_mfma_f32_16x16x32_bf16 v[168:171], v[88:91], a[8:11], v[168:171]
    s_add_u32 s79, s80, 884736
    ds_read_b128 v[64:67], v10 offset:0
    ds_read_b128 v[68:71], v10 offset:9216
    v_mfma_f32_16x16x32_bf16 v[168:171], v[92:95], a[12:15], v[168:171]
    s_add_u32 m0, s88, 0
    buffer_store_dwordx4 v[56:59], v2, s[28:31], s71 offen offset:1024 sc1
    v_accvgpr_read_b32 v184, a240
    v_mfma_f32_16x16x32_bf16 v[172:175], v[92:95], a[28:31], v[172:175]
    ds_read_b128 v[72:75], v10 offset:18432
    ds_read_b128 v[76:79], v10 offset:27648
    v_mfma_f32_16x16x32_bf16 v[172:175], v[88:91], a[24:27], v[172:175]
    buffer_load_dwordx4 v2, s[28:31], s79 offen offset:0 sc1 lds
    v_accvgpr_read_b32 v185, a241
    v_mfma_f32_16x16x32_bf16 v[172:175], v[84:87], a[20:23], v[172:175]
    s_add_u32 s87, s85, 3145728
    v_accvgpr_read_b32 v186, a242
    v_accvgpr_read_b32 v187, a243
    v_mfma_f32_16x16x32_bf16 v[172:175], v[80:83], a[16:19], v[172:175]
    s_waitcnt lgkmcnt(4)
    buffer_load_dwordx4 a[96:99], v2, s[28:31], s87 offen offset:0 sc1
    v_accvgpr_read_b32 v188, a244
    v_mfma_f32_16x16x32_bf16 v[176:179], v[96:99], a[0:3], v[176:179]
    ds_read_b128 v[80:83], v10 offset:1024
    ds_read_b128 v[84:87], v10 offset:10240
    v_mfma_f32_16x16x32_bf16 v[176:179], v[100:103], a[4:7], v[176:179]
    v_accvgpr_read_b32 v189, a245
    v_accvgpr_read_b32 v190, a246
    v_mfma_f32_16x16x32_bf16 v[176:179], v[104:107], a[8:11], v[176:179]
    ds_read_b128 v[88:91], v10 offset:19456
    ds_read_b128 v[92:95], v10 offset:28672
    v_mfma_f32_16x16x32_bf16 v[176:179], v[108:111], a[12:15], v[176:179]
    buffer_load_dwordx4 v2, s[28:31], s79 offen offset:1024 sc1 lds
    v_accvgpr_read_b32 v191, a247
    v_mfma_f32_16x16x32_bf16 v[180:183], v[108:111], a[28:31], v[180:183]
    v_mul_f32 v184, v251, v184
    v_mul_f32 v185, v251, v185
    v_mfma_f32_16x16x32_bf16 v[180:183], v[104:107], a[24:27], v[180:183]
    v_mul_f32 v186, v251, v186
    v_mul_f32 v187, v251, v187
    v_mfma_f32_16x16x32_bf16 v[180:183], v[100:103], a[20:23], v[180:183]
    buffer_load_dwordx4 a[100:103], v2, s[28:31], s87 offen offset:1024 sc1
    v_mul_f32 v188, v251, v188
    v_mfma_f32_16x16x32_bf16 v[180:183], v[96:99], a[16:19], v[180:183]
    s_waitcnt lgkmcnt(4)
    v_mul_f32 v189, v251, v189
    v_mul_f32 v190, v251, v190
    v_mfma_f32_16x16x32_bf16 v[112:115], v[64:67], a[64:67], v[112:115]
    ds_read_b128 v[96:99], v10 offset:2048
    ds_read_b128 v[100:103], v10 offset:11264
    v_mfma_f32_16x16x32_bf16 v[112:115], v[68:71], a[68:71], v[112:115]
    v_mul_f32 v191, v251, v191
    v_cvt_pk_bf16_f32 v224, v184, v185
    v_mfma_f32_16x16x32_bf16 v[112:115], v[72:75], a[72:75], v[112:115]
    s_add_u32 s79, s81, 884736
    ds_read_b128 v[104:107], v10 offset:20480
    ds_read_b128 v[108:111], v10 offset:29696
    v_mfma_f32_16x16x32_bf16 v[112:115], v[76:79], a[76:79], v[112:115]
    s_add_u32 m0, s88, 2048
    v_cvt_pk_bf16_f32 v225, v186, v187
    v_cvt_pk_bf16_f32 v226, v188, v189
    v_mfma_f32_16x16x32_bf16 v[116:119], v[76:79], a[92:95], v[116:119]
    buffer_load_dwordx4 v2, s[28:31], s79 offen offset:0 sc1 lds
    v_cvt_pk_bf16_f32 v227, v190, v191
    v_mfma_f32_16x16x32_bf16 v[116:119], v[72:75], a[88:91], v[116:119]
    buffer_store_dwordx4 v[224:227], v2, s[28:31], s71 offen offset:2048 sc1
    v_accvgpr_read_b32 v232, a248
    v_mfma_f32_16x16x32_bf16 v[116:119], v[68:71], a[84:87], v[116:119]
    buffer_load_dwordx4 a[104:107], v2, s[28:31], s87 offen offset:2048 sc1
    v_accvgpr_read_b32 v233, a249
    v_mfma_f32_16x16x32_bf16 v[116:119], v[64:67], a[80:83], v[116:119]
    s_waitcnt lgkmcnt(4)
    v_accvgpr_read_b32 v234, a250
    v_accvgpr_read_b32 v235, a251
    v_mfma_f32_16x16x32_bf16 v[120:123], v[80:83], a[64:67], v[120:123]
    ds_read_b128 v[64:67], v10 offset:3072
    ds_read_b128 v[68:71], v10 offset:12288
    v_mfma_f32_16x16x32_bf16 v[120:123], v[84:87], a[68:71], v[120:123]
    v_accvgpr_read_b32 v236, a252
    v_accvgpr_read_b32 v237, a253
    v_mfma_f32_16x16x32_bf16 v[120:123], v[88:91], a[72:75], v[120:123]
    ds_read_b128 v[72:75], v10 offset:21504
    ds_read_b128 v[76:79], v10 offset:30720
    v_mfma_f32_16x16x32_bf16 v[120:123], v[92:95], a[76:79], v[120:123]
    buffer_load_dwordx4 v2, s[28:31], s79 offen offset:1024 sc1 lds
    v_accvgpr_read_b32 v238, a254
    v_mfma_f32_16x16x32_bf16 v[124:127], v[92:95], a[92:95], v[124:127]
    v_accvgpr_read_b32 v239, a255
    v_mul_f32 v232, v251, v232
    v_mfma_f32_16x16x32_bf16 v[124:127], v[88:91], a[88:91], v[124:127]
    v_mul_f32 v233, v251, v233
    v_mul_f32 v234, v251, v234
    v_mfma_f32_16x16x32_bf16 v[124:127], v[84:87], a[84:87], v[124:127]
    buffer_load_dwordx4 a[108:111], v2, s[28:31], s87 offen offset:3072 sc1
    v_mul_f32 v235, v251, v235
    v_mfma_f32_16x16x32_bf16 v[124:127], v[80:83], a[80:83], v[124:127]
    s_waitcnt lgkmcnt(4)
    v_mul_f32 v236, v251, v236
    v_mul_f32 v237, v251, v237
    v_mfma_f32_16x16x32_bf16 v[128:131], v[96:99], a[64:67], v[128:131]
    ds_read_b128 v[80:83], v10 offset:4096
    ds_read_b128 v[84:87], v10 offset:13312
    v_mfma_f32_16x16x32_bf16 v[128:131], v[100:103], a[68:71], v[128:131]
    v_mul_f32 v238, v251, v238
    v_mul_f32 v239, v251, v239
    v_mfma_f32_16x16x32_bf16 v[128:131], v[104:107], a[72:75], v[128:131]
    s_add_u32 s79, s82, 884736
    ds_read_b128 v[88:91], v10 offset:22528
    ds_read_b128 v[92:95], v10 offset:31744
    v_mfma_f32_16x16x32_bf16 v[128:131], v[108:111], a[76:79], v[128:131]
    s_add_u32 m0, s88, 4096
    v_cvt_pk_bf16_f32 v56, v232, v233
    v_cvt_pk_bf16_f32 v57, v234, v235
    v_mfma_f32_16x16x32_bf16 v[132:135], v[108:111], a[92:95], v[132:135]
    buffer_load_dwordx4 v2, s[28:31], s79 offen offset:0 sc1 lds
    v_cvt_pk_bf16_f32 v58, v236, v237
    v_mfma_f32_16x16x32_bf16 v[132:135], v[104:107], a[88:91], v[132:135]
    v_cvt_pk_bf16_f32 v59, v238, v239
    v_mfma_f32_16x16x32_bf16 v[132:135], v[100:103], a[84:87], v[132:135]
    s_add_u32 s87, s85, 3149824
    buffer_store_dwordx4 v[56:59], v2, s[28:31], s71 offen offset:3072 sc1
    v_mfma_f32_16x16x32_bf16 v[132:135], v[96:99], a[80:83], v[132:135]
    s_waitcnt lgkmcnt(4)
    buffer_load_dwordx4 a[112:115], v2, s[28:31], s87 offen offset:0 sc1
    v_mfma_f32_16x16x32_bf16 v[136:139], v[64:67], a[64:67], v[136:139]
    ds_read_b128 v[96:99], v10 offset:5120
    ds_read_b128 v[100:103], v10 offset:14336
    v_mfma_f32_16x16x32_bf16 v[136:139], v[68:71], a[68:71], v[136:139]
    v_mfma_f32_16x16x32_bf16 v[136:139], v[72:75], a[72:75], v[136:139]
    ds_read_b128 v[104:107], v10 offset:23552
    ds_read_b128 v[108:111], v10 offset:32768
    v_mfma_f32_16x16x32_bf16 v[136:139], v[76:79], a[76:79], v[136:139]
    buffer_load_dwordx4 v2, s[28:31], s79 offen offset:1024 sc1 lds
    v_mfma_f32_16x16x32_bf16 v[140:143], v[76:79], a[92:95], v[140:143]
    v_mfma_f32_16x16x32_bf16 v[140:143], v[72:75], a[88:91], v[140:143]
    v_mfma_f32_16x16x32_bf16 v[140:143], v[68:71], a[84:87], v[140:143]
    buffer_load_dwordx4 a[116:119], v2, s[28:31], s87 offen offset:1024 sc1
    v_mfma_f32_16x16x32_bf16 v[140:143], v[64:67], a[80:83], v[140:143]
    s_waitcnt lgkmcnt(4)
    v_mfma_f32_16x16x32_bf16 v[144:147], v[80:83], a[64:67], v[144:147]
    ds_read_b128 v[64:67], v10 offset:6144
    ds_read_b128 v[68:71], v10 offset:15360
    v_mfma_f32_16x16x32_bf16 v[144:147], v[84:87], a[68:71], v[144:147]
    v_mfma_f32_16x16x32_bf16 v[144:147], v[88:91], a[72:75], v[144:147]
    s_add_u32 s79, s83, 884736
    ds_read_b128 v[72:75], v10 offset:24576
    ds_read_b128 v[76:79], v10 offset:33792
    v_mfma_f32_16x16x32_bf16 v[144:147], v[92:95], a[76:79], v[144:147]
    s_add_u32 m0, s88, 6144
    v_mfma_f32_16x16x32_bf16 v[148:151], v[92:95], a[92:95], v[148:151]
    buffer_load_dwordx4 v2, s[28:31], s79 offen offset:0 sc1 lds
    v_mfma_f32_16x16x32_bf16 v[148:151], v[88:91], a[88:91], v[148:151]
    v_mfma_f32_16x16x32_bf16 v[148:151], v[84:87], a[84:87], v[148:151]
    buffer_load_dwordx4 a[120:123], v2, s[28:31], s87 offen offset:2048 sc1
    v_mfma_f32_16x16x32_bf16 v[148:151], v[80:83], a[80:83], v[148:151]
    s_waitcnt lgkmcnt(4)
    v_mfma_f32_16x16x32_bf16 v[152:155], v[96:99], a[64:67], v[152:155]
    ds_read_b128 v[80:83], v10 offset:7168
    ds_read_b128 v[84:87], v10 offset:16384
    v_mfma_f32_16x16x32_bf16 v[152:155], v[100:103], a[68:71], v[152:155]
    v_mfma_f32_16x16x32_bf16 v[152:155], v[104:107], a[72:75], v[152:155]
    ds_read_b128 v[88:91], v10 offset:25600
    ds_read_b128 v[92:95], v10 offset:34816
    v_mfma_f32_16x16x32_bf16 v[152:155], v[108:111], a[76:79], v[152:155]
    buffer_load_dwordx4 v2, s[28:31], s79 offen offset:1024 sc1 lds
    v_mfma_f32_16x16x32_bf16 v[156:159], v[108:111], a[92:95], v[156:159]
    v_mfma_f32_16x16x32_bf16 v[156:159], v[104:107], a[88:91], v[156:159]
    v_mfma_f32_16x16x32_bf16 v[156:159], v[100:103], a[84:87], v[156:159]
    buffer_load_dwordx4 a[124:127], v2, s[28:31], s87 offen offset:3072 sc1
    v_mfma_f32_16x16x32_bf16 v[156:159], v[96:99], a[80:83], v[156:159]
    s_waitcnt lgkmcnt(4)
    v_mfma_f32_16x16x32_bf16 v[160:163], v[64:67], a[64:67], v[160:163]
    ds_read_b128 v[96:99], v10 offset:8192
    ds_read_b128 v[100:103], v10 offset:17408
    v_mfma_f32_16x16x32_bf16 v[160:163], v[68:71], a[68:71], v[160:163]
    v_mfma_f32_16x16x32_bf16 v[160:163], v[72:75], a[72:75], v[160:163]
    s_add_u32 s79, s84, 884736
    ds_read_b128 v[104:107], v10 offset:26624
    ds_read_b128 v[108:111], v10 offset:35840
    v_mfma_f32_16x16x32_bf16 v[160:163], v[76:79], a[76:79], v[160:163]
    s_add_u32 m0, s88, 8192
    v_mfma_f32_16x16x32_bf16 v[164:167], v[76:79], a[92:95], v[164:167]
    buffer_load_dwordx4 v2, s[28:31], s79 offen offset:0 sc1 lds
    v_mfma_f32_16x16x32_bf16 v[164:167], v[72:75], a[88:91], v[164:167]
    v_mfma_f32_16x16x32_bf16 v[164:167], v[68:71], a[84:87], v[164:167]
    v_mfma_f32_16x16x32_bf16 v[164:167], v[64:67], a[80:83], v[164:167]
    s_waitcnt lgkmcnt(4)
    v_mfma_f32_16x16x32_bf16 v[168:171], v[80:83], a[64:67], v[168:171]
    s_waitcnt vmcnt(20)
    v_add_u32 v10, 36864, v10
    v_mfma_f32_16x16x32_bf16 v[168:171], v[84:87], a[68:71], v[168:171]
    s_barrier
    v_mfma_f32_16x16x32_bf16 v[168:171], v[88:91], a[72:75], v[168:171]
    s_add_u32 s79, s80, 1032192
    ds_read_b128 v[64:67], v10 offset:0
    ds_read_b128 v[68:71], v10 offset:9216
    v_mfma_f32_16x16x32_bf16 v[168:171], v[92:95], a[76:79], v[168:171]
    s_add_u32 m0, s88, 36864
    v_mfma_f32_16x16x32_bf16 v[172:175], v[92:95], a[92:95], v[172:175]
    ds_read_b128 v[72:75], v10 offset:18432
    ds_read_b128 v[76:79], v10 offset:27648
    v_mfma_f32_16x16x32_bf16 v[172:175], v[88:91], a[88:91], v[172:175]
    buffer_load_dwordx4 v2, s[28:31], s79 offen offset:0 sc1 lds
    v_mfma_f32_16x16x32_bf16 v[172:175], v[84:87], a[84:87], v[172:175]
    s_add_u32 s87, s85, 3670016
    v_mfma_f32_16x16x32_bf16 v[172:175], v[80:83], a[80:83], v[172:175]
    s_waitcnt lgkmcnt(4)
    buffer_load_dwordx4 a[0:3], v2, s[28:31], s87 offen offset:0 sc1
    v_mfma_f32_16x16x32_bf16 v[176:179], v[96:99], a[64:67], v[176:179]
    ds_read_b128 v[80:83], v10 offset:1024
    ds_read_b128 v[84:87], v10 offset:10240
    v_mfma_f32_16x16x32_bf16 v[176:179], v[100:103], a[68:71], v[176:179]
    v_mfma_f32_16x16x32_bf16 v[176:179], v[104:107], a[72:75], v[176:179]
    ds_read_b128 v[88:91], v10 offset:19456
    ds_read_b128 v[92:95], v10 offset:28672
    v_mfma_f32_16x16x32_bf16 v[176:179], v[108:111], a[76:79], v[176:179]
    buffer_load_dwordx4 v2, s[28:31], s79 offen offset:1024 sc1 lds
    v_mfma_f32_16x16x32_bf16 v[180:183], v[108:111], a[92:95], v[180:183]
    v_mfma_f32_16x16x32_bf16 v[180:183], v[104:107], a[88:91], v[180:183]
    v_mfma_f32_16x16x32_bf16 v[180:183], v[100:103], a[84:87], v[180:183]
    buffer_load_dwordx4 a[4:7], v2, s[28:31], s87 offen offset:1024 sc1
    v_mfma_f32_16x16x32_bf16 v[180:183], v[96:99], a[80:83], v[180:183]
    s_waitcnt lgkmcnt(4)
    v_mfma_f32_16x16x32_bf16 v[112:115], v[64:67], a[32:35], v[112:115]
    ds_read_b128 v[96:99], v10 offset:2048
    ds_read_b128 v[100:103], v10 offset:11264
    v_mfma_f32_16x16x32_bf16 v[112:115], v[68:71], a[36:39], v[112:115]
    v_mfma_f32_16x16x32_bf16 v[112:115], v[72:75], a[40:43], v[112:115]
    s_add_u32 s79, s81, 1032192
    ds_read_b128 v[104:107], v10 offset:20480
    ds_read_b128 v[108:111], v10 offset:29696
    v_mfma_f32_16x16x32_bf16 v[112:115], v[76:79], a[44:47], v[112:115]
    s_add_u32 m0, s88, 38912
    v_mfma_f32_16x16x32_bf16 v[116:119], v[76:79], a[60:63], v[116:119]
    buffer_load_dwordx4 v2, s[28:31], s79 offen offset:0 sc1 lds
    v_mfma_f32_16x16x32_bf16 v[116:119], v[72:75], a[56:59], v[116:119]
    v_mfma_f32_16x16x32_bf16 v[116:119], v[68:71], a[52:55], v[116:119]
    buffer_load_dwordx4 a[8:11], v2, s[28:31], s87 offen offset:2048 sc1
    v_mfma_f32_16x16x32_bf16 v[116:119], v[64:67], a[48:51], v[116:119]
    s_waitcnt lgkmcnt(4)
    v_mfma_f32_16x16x32_bf16 v[120:123], v[80:83], a[32:35], v[120:123]
    ds_read_b128 v[64:67], v10 offset:3072
    ds_read_b128 v[68:71], v10 offset:12288
    v_mfma_f32_16x16x32_bf16 v[120:123], v[84:87], a[36:39], v[120:123]
    v_mfma_f32_16x16x32_bf16 v[120:123], v[88:91], a[40:43], v[120:123]
    ds_read_b128 v[72:75], v10 offset:21504
    ds_read_b128 v[76:79], v10 offset:30720
    v_mfma_f32_16x16x32_bf16 v[120:123], v[92:95], a[44:47], v[120:123]
    buffer_load_dwordx4 v2, s[28:31], s79 offen offset:1024 sc1 lds
    v_mfma_f32_16x16x32_bf16 v[124:127], v[92:95], a[60:63], v[124:127]
    v_mfma_f32_16x16x32_bf16 v[124:127], v[88:91], a[56:59], v[124:127]
    v_mfma_f32_16x16x32_bf16 v[124:127], v[84:87], a[52:55], v[124:127]
    buffer_load_dwordx4 a[12:15], v2, s[28:31], s87 offen offset:3072 sc1
    v_mfma_f32_16x16x32_bf16 v[124:127], v[80:83], a[48:51], v[124:127]
    s_waitcnt lgkmcnt(4)
    v_mfma_f32_16x16x32_bf16 v[128:131], v[96:99], a[32:35], v[128:131]
    ds_read_b128 v[80:83], v10 offset:4096
    ds_read_b128 v[84:87], v10 offset:13312
    v_mfma_f32_16x16x32_bf16 v[128:131], v[100:103], a[36:39], v[128:131]
    v_mfma_f32_16x16x32_bf16 v[128:131], v[104:107], a[40:43], v[128:131]
    s_add_u32 s79, s82, 1032192
    ds_read_b128 v[88:91], v10 offset:22528
    ds_read_b128 v[92:95], v10 offset:31744
    v_mfma_f32_16x16x32_bf16 v[128:131], v[108:111], a[44:47], v[128:131]
    s_add_u32 m0, s88, 40960
    v_mfma_f32_16x16x32_bf16 v[132:135], v[108:111], a[60:63], v[132:135]
    buffer_load_dwordx4 v2, s[28:31], s79 offen offset:0 sc1 lds
    v_mfma_f32_16x16x32_bf16 v[132:135], v[104:107], a[56:59], v[132:135]
    v_mfma_f32_16x16x32_bf16 v[132:135], v[100:103], a[52:55], v[132:135]
    s_add_u32 s87, s85, 3674112
    v_mfma_f32_16x16x32_bf16 v[132:135], v[96:99], a[48:51], v[132:135]
    s_waitcnt lgkmcnt(4)
    buffer_load_dwordx4 a[16:19], v2, s[28:31], s87 offen offset:0 sc1
    v_mfma_f32_16x16x32_bf16 v[136:139], v[64:67], a[32:35], v[136:139]
    ds_read_b128 v[96:99], v10 offset:5120
    ds_read_b128 v[100:103], v10 offset:14336
    v_mfma_f32_16x16x32_bf16 v[136:139], v[68:71], a[36:39], v[136:139]
    v_mfma_f32_16x16x32_bf16 v[136:139], v[72:75], a[40:43], v[136:139]
    ds_read_b128 v[104:107], v10 offset:23552
    ds_read_b128 v[108:111], v10 offset:32768
    v_mfma_f32_16x16x32_bf16 v[136:139], v[76:79], a[44:47], v[136:139]
    buffer_load_dwordx4 v2, s[28:31], s79 offen offset:1024 sc1 lds
    v_mfma_f32_16x16x32_bf16 v[140:143], v[76:79], a[60:63], v[140:143]
    v_mfma_f32_16x16x32_bf16 v[140:143], v[72:75], a[56:59], v[140:143]
    v_mfma_f32_16x16x32_bf16 v[140:143], v[68:71], a[52:55], v[140:143]
    buffer_load_dwordx4 a[20:23], v2, s[28:31], s87 offen offset:1024 sc1
    v_mfma_f32_16x16x32_bf16 v[140:143], v[64:67], a[48:51], v[140:143]
    s_waitcnt lgkmcnt(4)
    v_mfma_f32_16x16x32_bf16 v[144:147], v[80:83], a[32:35], v[144:147]
    ds_read_b128 v[64:67], v10 offset:6144
    ds_read_b128 v[68:71], v10 offset:15360
    v_mfma_f32_16x16x32_bf16 v[144:147], v[84:87], a[36:39], v[144:147]
    v_mfma_f32_16x16x32_bf16 v[144:147], v[88:91], a[40:43], v[144:147]
    s_add_u32 s79, s83, 1032192
    ds_read_b128 v[72:75], v10 offset:24576
    ds_read_b128 v[76:79], v10 offset:33792
    v_mfma_f32_16x16x32_bf16 v[144:147], v[92:95], a[44:47], v[144:147]
    s_add_u32 m0, s88, 43008
    v_mfma_f32_16x16x32_bf16 v[148:151], v[92:95], a[60:63], v[148:151]
    buffer_load_dwordx4 v2, s[28:31], s79 offen offset:0 sc1 lds
    v_mfma_f32_16x16x32_bf16 v[148:151], v[88:91], a[56:59], v[148:151]
    v_mfma_f32_16x16x32_bf16 v[148:151], v[84:87], a[52:55], v[148:151]
    buffer_load_dwordx4 a[24:27], v2, s[28:31], s87 offen offset:2048 sc1
    v_mfma_f32_16x16x32_bf16 v[148:151], v[80:83], a[48:51], v[148:151]
    s_waitcnt lgkmcnt(4)
    v_mfma_f32_16x16x32_bf16 v[152:155], v[96:99], a[32:35], v[152:155]
    ds_read_b128 v[80:83], v10 offset:7168
    ds_read_b128 v[84:87], v10 offset:16384
    v_mfma_f32_16x16x32_bf16 v[152:155], v[100:103], a[36:39], v[152:155]
    v_mfma_f32_16x16x32_bf16 v[152:155], v[104:107], a[40:43], v[152:155]
    ds_read_b128 v[88:91], v10 offset:25600
    ds_read_b128 v[92:95], v10 offset:34816
    v_mfma_f32_16x16x32_bf16 v[152:155], v[108:111], a[44:47], v[152:155]
    buffer_load_dwordx4 v2, s[28:31], s79 offen offset:1024 sc1 lds
    v_mfma_f32_16x16x32_bf16 v[156:159], v[108:111], a[60:63], v[156:159]
    v_mfma_f32_16x16x32_bf16 v[156:159], v[104:107], a[56:59], v[156:159]
    v_mfma_f32_16x16x32_bf16 v[156:159], v[100:103], a[52:55], v[156:159]
    buffer_load_dwordx4 a[28:31], v2, s[28:31], s87 offen offset:3072 sc1
    v_mfma_f32_16x16x32_bf16 v[156:159], v[96:99], a[48:51], v[156:159]
    s_waitcnt lgkmcnt(4)
    v_mfma_f32_16x16x32_bf16 v[160:163], v[64:67], a[32:35], v[160:163]
    ds_read_b128 v[96:99], v10 offset:8192
    ds_read_b128 v[100:103], v10 offset:17408
    v_mfma_f32_16x16x32_bf16 v[160:163], v[68:71], a[36:39], v[160:163]
    v_mfma_f32_16x16x32_bf16 v[160:163], v[72:75], a[40:43], v[160:163]
    s_add_u32 s79, s84, 1032192
    ds_read_b128 v[104:107], v10 offset:26624
    ds_read_b128 v[108:111], v10 offset:35840
    v_mfma_f32_16x16x32_bf16 v[160:163], v[76:79], a[44:47], v[160:163]
    s_add_u32 m0, s88, 45056
    v_mfma_f32_16x16x32_bf16 v[164:167], v[76:79], a[60:63], v[164:167]
    buffer_load_dwordx4 v2, s[28:31], s79 offen offset:0 sc1 lds
    v_mfma_f32_16x16x32_bf16 v[164:167], v[72:75], a[56:59], v[164:167]
    v_mfma_f32_16x16x32_bf16 v[164:167], v[68:71], a[52:55], v[164:167]
    v_mfma_f32_16x16x32_bf16 v[164:167], v[64:67], a[48:51], v[164:167]
    s_waitcnt lgkmcnt(4)
    v_mfma_f32_16x16x32_bf16 v[168:171], v[80:83], a[32:35], v[168:171]
    s_waitcnt vmcnt(17)
    v_subrev_u32 v10, 110592, v10
    v_mfma_f32_16x16x32_bf16 v[168:171], v[84:87], a[36:39], v[168:171]
    s_barrier
    v_mfma_f32_16x16x32_bf16 v[168:171], v[88:91], a[40:43], v[168:171]
    s_add_u32 s79, s80, 1179648
    ds_read_b128 v[64:67], v10 offset:0
    ds_read_b128 v[68:71], v10 offset:9216
    v_mfma_f32_16x16x32_bf16 v[168:171], v[92:95], a[44:47], v[168:171]
    s_cmp_lg_u32 s48, 0
    s_cbranch_scc1 L_sig_o
    s_mov_b64 exec, 1
    v_mov_b32 v11, 1
    buffer_store_dword v11, off, s[28:31], s75 sc1
    s_mov_b64 exec, -1
L_sig_o:
    s_add_u32 m0, s88, 73728
    v_mfma_f32_16x16x32_bf16 v[172:175], v[92:95], a[60:63], v[172:175]
    ds_read_b128 v[72:75], v10 offset:18432
    ds_read_b128 v[76:79], v10 offset:27648
    v_mfma_f32_16x16x32_bf16 v[172:175], v[88:91], a[56:59], v[172:175]
    buffer_load_dwordx4 v2, s[28:31], s79 offen offset:0 sc1 lds
    v_mfma_f32_16x16x32_bf16 v[172:175], v[84:87], a[52:55], v[172:175]
    s_add_u32 s87, s85, 4194304
    v_mfma_f32_16x16x32_bf16 v[172:175], v[80:83], a[48:51], v[172:175]
    s_waitcnt lgkmcnt(4)
    buffer_load_dwordx4 a[64:67], v2, s[28:31], s87 offen offset:0 sc1
    v_mfma_f32_16x16x32_bf16 v[176:179], v[96:99], a[32:35], v[176:179]
    ds_read_b128 v[80:83], v10 offset:1024
    ds_read_b128 v[84:87], v10 offset:10240
    v_mfma_f32_16x16x32_bf16 v[176:179], v[100:103], a[36:39], v[176:179]
    v_mfma_f32_16x16x32_bf16 v[176:179], v[104:107], a[40:43], v[176:179]
    ds_read_b128 v[88:91], v10 offset:19456
    ds_read_b128 v[92:95], v10 offset:28672
    v_mfma_f32_16x16x32_bf16 v[176:179], v[108:111], a[44:47], v[176:179]
    buffer_load_dwordx4 v2, s[28:31], s79 offen offset:1024 sc1 lds
    v_mfma_f32_16x16x32_bf16 v[180:183], v[108:111], a[60:63], v[180:183]
    v_mfma_f32_16x16x32_bf16 v[180:183], v[104:107], a[56:59], v[180:183]
    v_mfma_f32_16x16x32_bf16 v[180:183], v[100:103], a[52:55], v[180:183]
    buffer_load_dwordx4 a[68:71], v2, s[28:31], s87 offen offset:1024 sc1
    v_mfma_f32_16x16x32_bf16 v[180:183], v[96:99], a[48:51], v[180:183]
    s_waitcnt lgkmcnt(4)
    v_mfma_f32_16x16x32_bf16 v[112:115], v[64:67], a[96:99], v[112:115]
    ds_read_b128 v[96:99], v10 offset:2048
    ds_read_b128 v[100:103], v10 offset:11264
    v_mfma_f32_16x16x32_bf16 v[112:115], v[68:71], a[100:103], v[112:115]
    v_mfma_f32_16x16x32_bf16 v[112:115], v[72:75], a[104:107], v[112:115]
    s_add_u32 s79, s81, 1179648
    ds_read_b128 v[104:107], v10 offset:20480
    ds_read_b128 v[108:111], v10 offset:29696
    v_mfma_f32_16x16x32_bf16 v[112:115], v[76:79], a[108:111], v[112:115]
    s_add_u32 m0, s88, 75776
    v_mfma_f32_16x16x32_bf16 v[116:119], v[76:79], a[124:127], v[116:119]
    buffer_load_dwordx4 v2, s[28:31], s79 offen offset:0 sc1 lds
    v_mfma_f32_16x16x32_bf16 v[116:119], v[72:75], a[120:123], v[116:119]
    v_mfma_f32_16x16x32_bf16 v[116:119], v[68:71], a[116:119], v[116:119]
    buffer_load_dwordx4 a[72:75], v2, s[28:31], s87 offen offset:2048 sc1
    v_mfma_f32_16x16x32_bf16 v[116:119], v[64:67], a[112:115], v[116:119]
    s_waitcnt lgkmcnt(4)
    v_mfma_f32_16x16x32_bf16 v[120:123], v[80:83], a[96:99], v[120:123]
    ds_read_b128 v[64:67], v10 offset:3072
    ds_read_b128 v[68:71], v10 offset:12288
    v_mfma_f32_16x16x32_bf16 v[120:123], v[84:87], a[100:103], v[120:123]
    v_mfma_f32_16x16x32_bf16 v[120:123], v[88:91], a[104:107], v[120:123]
    ds_read_b128 v[72:75], v10 offset:21504
    ds_read_b128 v[76:79], v10 offset:30720
    v_mfma_f32_16x16x32_bf16 v[120:123], v[92:95], a[108:111], v[120:123]
    buffer_load_dwordx4 v2, s[28:31], s79 offen offset:1024 sc1 lds
    v_mfma_f32_16x16x32_bf16 v[124:127], v[92:95], a[124:127], v[124:127]
    v_mfma_f32_16x16x32_bf16 v[124:127], v[88:91], a[120:123], v[124:127]
    v_mfma_f32_16x16x32_bf16 v[124:127], v[84:87], a[116:119], v[124:127]
    buffer_load_dwordx4 a[76:79], v2, s[28:31], s87 offen offset:3072 sc1
    v_mfma_f32_16x16x32_bf16 v[124:127], v[80:83], a[112:115], v[124:127]
    s_waitcnt lgkmcnt(4)
    v_mfma_f32_16x16x32_bf16 v[128:131], v[96:99], a[96:99], v[128:131]
    ds_read_b128 v[80:83], v10 offset:4096
    ds_read_b128 v[84:87], v10 offset:13312
    v_mfma_f32_16x16x32_bf16 v[128:131], v[100:103], a[100:103], v[128:131]
    v_mfma_f32_16x16x32_bf16 v[128:131], v[104:107], a[104:107], v[128:131]
    s_add_u32 s79, s82, 1179648
    ds_read_b128 v[88:91], v10 offset:22528
    ds_read_b128 v[92:95], v10 offset:31744
    v_mfma_f32_16x16x32_bf16 v[128:131], v[108:111], a[108:111], v[128:131]
    s_add_u32 m0, s88, 77824
    v_mfma_f32_16x16x32_bf16 v[132:135], v[108:111], a[124:127], v[132:135]
    buffer_load_dwordx4 v2, s[28:31], s79 offen offset:0 sc1 lds
    v_mfma_f32_16x16x32_bf16 v[132:135], v[104:107], a[120:123], v[132:135]
    v_mfma_f32_16x16x32_bf16 v[132:135], v[100:103], a[116:119], v[132:135]
    s_add_u32 s87, s85, 4198400
    v_mfma_f32_16x16x32_bf16 v[132:135], v[96:99], a[112:115], v[132:135]
    s_waitcnt lgkmcnt(4)
    buffer_load_dwordx4 a[80:83], v2, s[28:31], s87 offen offset:0 sc1
    v_mfma_f32_16x16x32_bf16 v[136:139], v[64:67], a[96:99], v[136:139]
    ds_read_b128 v[96:99], v10 offset:5120
    ds_read_b128 v[100:103], v10 offset:14336
    v_mfma_f32_16x16x32_bf16 v[136:139], v[68:71], a[100:103], v[136:139]
    v_mfma_f32_16x16x32_bf16 v[136:139], v[72:75], a[104:107], v[136:139]
    ds_read_b128 v[104:107], v10 offset:23552
    ds_read_b128 v[108:111], v10 offset:32768
    v_mfma_f32_16x16x32_bf16 v[136:139], v[76:79], a[108:111], v[136:139]
    buffer_load_dwordx4 v2, s[28:31], s79 offen offset:1024 sc1 lds
    v_mfma_f32_16x16x32_bf16 v[140:143], v[76:79], a[124:127], v[140:143]
    v_mfma_f32_16x16x32_bf16 v[140:143], v[72:75], a[120:123], v[140:143]
    v_mfma_f32_16x16x32_bf16 v[140:143], v[68:71], a[116:119], v[140:143]
    buffer_load_dwordx4 a[84:87], v2, s[28:31], s87 offen offset:1024 sc1
    v_mfma_f32_16x16x32_bf16 v[140:143], v[64:67], a[112:115], v[140:143]
    s_waitcnt lgkmcnt(4)
    v_mfma_f32_16x16x32_bf16 v[144:147], v[80:83], a[96:99], v[144:147]
    ds_read_b128 v[64:67], v10 offset:6144
    ds_read_b128 v[68:71], v10 offset:15360
    v_mfma_f32_16x16x32_bf16 v[144:147], v[84:87], a[100:103], v[144:147]
    v_mfma_f32_16x16x32_bf16 v[144:147], v[88:91], a[104:107], v[144:147]
    s_add_u32 s79, s83, 1179648
    ds_read_b128 v[72:75], v10 offset:24576
    ds_read_b128 v[76:79], v10 offset:33792
    v_mfma_f32_16x16x32_bf16 v[144:147], v[92:95], a[108:111], v[144:147]
    s_add_u32 m0, s88, 79872
    v_mfma_f32_16x16x32_bf16 v[148:151], v[92:95], a[124:127], v[148:151]
    buffer_load_dwordx4 v2, s[28:31], s79 offen offset:0 sc1 lds
    v_mfma_f32_16x16x32_bf16 v[148:151], v[88:91], a[120:123], v[148:151]
    v_mfma_f32_16x16x32_bf16 v[148:151], v[84:87], a[116:119], v[148:151]
    buffer_load_dwordx4 a[88:91], v2, s[28:31], s87 offen offset:2048 sc1
    v_mfma_f32_16x16x32_bf16 v[148:151], v[80:83], a[112:115], v[148:151]
    s_waitcnt lgkmcnt(4)
    v_mfma_f32_16x16x32_bf16 v[152:155], v[96:99], a[96:99], v[152:155]
    ds_read_b128 v[80:83], v10 offset:7168
    ds_read_b128 v[84:87], v10 offset:16384
    v_mfma_f32_16x16x32_bf16 v[152:155], v[100:103], a[100:103], v[152:155]
    v_mfma_f32_16x16x32_bf16 v[152:155], v[104:107], a[104:107], v[152:155]
    ds_read_b128 v[88:91], v10 offset:25600
    ds_read_b128 v[92:95], v10 offset:34816
    v_mfma_f32_16x16x32_bf16 v[152:155], v[108:111], a[108:111], v[152:155]
    buffer_load_dwordx4 v2, s[28:31], s79 offen offset:1024 sc1 lds
    v_mfma_f32_16x16x32_bf16 v[156:159], v[108:111], a[124:127], v[156:159]
    v_mfma_f32_16x16x32_bf16 v[156:159], v[104:107], a[120:123], v[156:159]
    v_mfma_f32_16x16x32_bf16 v[156:159], v[100:103], a[116:119], v[156:159]
    buffer_load_dwordx4 a[92:95], v2, s[28:31], s87 offen offset:3072 sc1
    v_mfma_f32_16x16x32_bf16 v[156:159], v[96:99], a[112:115], v[156:159]
    s_waitcnt lgkmcnt(4)
    v_mfma_f32_16x16x32_bf16 v[160:163], v[64:67], a[96:99], v[160:163]
    ds_read_b128 v[96:99], v10 offset:8192
    ds_read_b128 v[100:103], v10 offset:17408
    v_mfma_f32_16x16x32_bf16 v[160:163], v[68:71], a[100:103], v[160:163]
    v_mfma_f32_16x16x32_bf16 v[160:163], v[72:75], a[104:107], v[160:163]
    s_add_u32 s79, s84, 1179648
    ds_read_b128 v[104:107], v10 offset:26624
    ds_read_b128 v[108:111], v10 offset:35840
    v_mfma_f32_16x16x32_bf16 v[160:163], v[76:79], a[108:111], v[160:163]
    s_add_u32 m0, s88, 81920
    v_mfma_f32_16x16x32_bf16 v[164:167], v[76:79], a[124:127], v[164:167]
    buffer_load_dwordx4 v2, s[28:31], s79 offen offset:0 sc1 lds
    v_mfma_f32_16x16x32_bf16 v[164:167], v[72:75], a[120:123], v[164:167]
    v_mfma_f32_16x16x32_bf16 v[164:167], v[68:71], a[116:119], v[164:167]
    v_mfma_f32_16x16x32_bf16 v[164:167], v[64:67], a[112:115], v[164:167]
    s_waitcnt lgkmcnt(4)
    v_mfma_f32_16x16x32_bf16 v[168:171], v[80:83], a[96:99], v[168:171]
    s_waitcnt vmcnt(17)
    s_waitcnt lgkmcnt(0)
    v_add_u32 v10, 36864, v10
    v_mfma_f32_16x16x32_bf16 v[168:171], v[84:87], a[100:103], v[168:171]
    s_barrier
    v_mfma_f32_16x16x32_bf16 v[168:171], v[88:91], a[104:107], v[168:171]
    s_add_u32 s80, s80, s56
    ds_read_b128 v[64:67], v10 offset:0
    ds_read_b128 v[68:71], v10 offset:9216
    v_mfma_f32_16x16x32_bf16 v[168:171], v[92:95], a[108:111], v[168:171]
    s_add_u32 s79, s80, 1327104
    s_add_u32 m0, s88, 110592
    v_mfma_f32_16x16x32_bf16 v[172:175], v[92:95], a[124:127], v[172:175]
    ds_read_b128 v[72:75], v10 offset:18432
    ds_read_b128 v[76:79], v10 offset:27648
    v_mfma_f32_16x16x32_bf16 v[172:175], v[88:91], a[120:123], v[172:175]
    buffer_load_dwordx4 v2, s[28:31], s79 offen offset:0 sc1 lds
    v_mfma_f32_16x16x32_bf16 v[172:175], v[84:87], a[116:119], v[172:175]
    buffer_load_dwordx4 v2, s[28:31], s79 offen offset:1024 sc1 lds
    v_mfma_f32_16x16x32_bf16 v[172:175], v[80:83], a[112:115], v[172:175]
    s_waitcnt lgkmcnt(4)
    v_mfma_f32_16x16x32_bf16 v[176:179], v[96:99], a[96:99], v[176:179]
    ds_read_b128 v[80:83], v10 offset:1024
    ds_read_b128 v[84:87], v10 offset:10240
    v_mfma_f32_16x16x32_bf16 v[176:179], v[100:103], a[100:103], v[176:179]
    s_add_u32 s81, s81, s56
    s_add_u32 s79, s81, 1327104
    s_add_u32 m0, s88, 112640
    v_mfma_f32_16x16x32_bf16 v[176:179], v[104:107], a[104:107], v[176:179]
    ds_read_b128 v[88:91], v10 offset:19456
    ds_read_b128 v[92:95], v10 offset:28672
    v_mfma_f32_16x16x32_bf16 v[176:179], v[108:111], a[108:111], v[176:179]
    buffer_load_dwordx4 v2, s[28:31], s79 offen offset:0 sc1 lds
    v_mfma_f32_16x16x32_bf16 v[180:183], v[108:111], a[124:127], v[180:183]
    v_mfma_f32_16x16x32_bf16 v[180:183], v[104:107], a[120:123], v[180:183]
    buffer_load_dwordx4 v2, s[28:31], s79 offen offset:1024 sc1 lds
    v_mfma_f32_16x16x32_bf16 v[180:183], v[100:103], a[116:119], v[180:183]
    v_mfma_f32_16x16x32_bf16 v[180:183], v[96:99], a[112:115], v[180:183]
    s_waitcnt lgkmcnt(4)
    v_mfma_f32_16x16x32_bf16 v[112:115], v[64:67], a[0:3], v[112:115]
    ds_read_b128 v[96:99], v10 offset:2048
    ds_read_b128 v[100:103], v10 offset:11264
    v_mfma_f32_16x16x32_bf16 v[112:115], v[68:71], a[4:7], v[112:115]
    s_add_u32 s82, s82, s56
    s_add_u32 s79, s82, 1327104
    s_add_u32 m0, s88, 114688
    v_mfma_f32_16x16x32_bf16 v[112:115], v[72:75], a[8:11], v[112:115]
    ds_read_b128 v[104:107], v10 offset:20480
    ds_read_b128 v[108:111], v10 offset:29696
    v_mfma_f32_16x16x32_bf16 v[112:115], v[76:79], a[12:15], v[112:115]
    buffer_load_dwordx4 v2, s[28:31], s79 offen offset:0 sc1 lds
    v_mfma_f32_16x16x32_bf16 v[116:119], v[76:79], a[28:31], v[116:119]
    v_mfma_f32_16x16x32_bf16 v[116:119], v[72:75], a[24:27], v[116:119]
    buffer_load_dwordx4 v2, s[28:31], s79 offen offset:1024 sc1 lds
    v_mfma_f32_16x16x32_bf16 v[116:119], v[68:71], a[20:23], v[116:119]
    v_mfma_f32_16x16x32_bf16 v[116:119], v[64:67], a[16:19], v[116:119]
    s_waitcnt lgkmcnt(4)
    buffer_load_dword v12, v19, s[28:31], s72 offen sc1
    v_mfma_f32_16x16x32_bf16 v[120:123], v[80:83], a[0:3], v[120:123]
    ds_read_b128 v[64:67], v10 offset:3072
    ds_read_b128 v[68:71], v10 offset:12288
    v_mfma_f32_16x16x32_bf16 v[120:123], v[84:87], a[4:7], v[120:123]
    s_add_u32 s83, s83, s56
    s_add_u32 s79, s83, 1327104
    s_add_u32 m0, s88, 116736
    v_mfma_f32_16x16x32_bf16 v[120:123], v[88:91], a[8:11], v[120:123]
    ds_read_b128 v[72:75], v10 offset:21504
    ds_read_b128 v[76:79], v10 offset:30720
    v_mfma_f32_16x16x32_bf16 v[120:123], v[92:95], a[12:15], v[120:123]
    buffer_load_dwordx4 v2, s[28:31], s79 offen offset:0 sc1 lds
    v_mfma_f32_16x16x32_bf16 v[124:127], v[92:95], a[28:31], v[124:127]
    buffer_load_dwordx4 v2, s[28:31], s79 offen offset:1024 sc1 lds
    v_mfma_f32_16x16x32_bf16 v[124:127], v[88:91], a[24:27], v[124:127]
    v_mfma_f32_16x16x32_bf16 v[124:127], v[84:87], a[20:23], v[124:127]
    v_mfma_f32_16x16x32_bf16 v[124:127], v[80:83], a[16:19], v[124:127]
    s_waitcnt lgkmcnt(4)
    v_mfma_f32_16x16x32_bf16 v[128:131], v[96:99], a[0:3], v[128:131]
    s_add_u32 s84, s84, s56
    ds_read_b128 v[80:83], v10 offset:4096
    ds_read_b128 v[84:87], v10 offset:13312
    v_mfma_f32_16x16x32_bf16 v[128:131], v[100:103], a[4:7], v[128:131]
    s_add_u32 s79, s84, 1327104
    s_add_u32 m0, s88, 118784
    v_mfma_f32_16x16x32_bf16 v[128:131], v[104:107], a[8:11], v[128:131]
    ds_read_b128 v[88:91], v10 offset:22528
    ds_read_b128 v[92:95], v10 offset:31744
    v_mfma_f32_16x16x32_bf16 v[128:131], v[108:111], a[12:15], v[128:131]
    buffer_load_dwordx4 v2, s[28:31], s79 offen offset:0 sc1 lds
    v_mfma_f32_16x16x32_bf16 v[132:135], v[108:111], a[28:31], v[132:135]
    s_add_u32 s79, s80, 1474560
    s_add_u32 m0, s88, 0
    v_mfma_f32_16x16x32_bf16 v[132:135], v[104:107], a[24:27], v[132:135]
    buffer_load_dwordx4 v2, s[28:31], s79 offen offset:0 sc1 lds
    v_mfma_f32_16x16x32_bf16 v[132:135], v[100:103], a[20:23], v[132:135]
    v_mfma_f32_16x16x32_bf16 v[132:135], v[96:99], a[16:19], v[132:135]
    s_waitcnt lgkmcnt(4)
    v_mfma_f32_16x16x32_bf16 v[136:139], v[64:67], a[0:3], v[136:139]
    ds_read_b128 v[96:99], v10 offset:5120
    ds_read_b128 v[100:103], v10 offset:14336
    v_mfma_f32_16x16x32_bf16 v[136:139], v[68:71], a[4:7], v[136:139]
    buffer_load_dwordx4 v2, s[28:31], s79 offen offset:1024 sc1 lds
    v_mfma_f32_16x16x32_bf16 v[136:139], v[72:75], a[8:11], v[136:139]
    ds_read_b128 v[104:107], v10 offset:23552
    ds_read_b128 v[108:111], v10 offset:32768
    v_mfma_f32_16x16x32_bf16 v[136:139], v[76:79], a[12:15], v[136:139]
    v_mfma_f32_16x16x32_bf16 v[140:143], v[76:79], a[28:31], v[140:143]
    s_add_u32 s79, s81, 1474560
    s_add_u32 m0, s88, 2048
    v_mfma_f32_16x16x32_bf16 v[140:143], v[72:75], a[24:27], v[140:143]
    buffer_load_dwordx4 v2, s[28:31], s79 offen offset:0 sc1 lds
    v_mfma_f32_16x16x32_bf16 v[140:143], v[68:71], a[20:23], v[140:143]
    v_mfma_f32_16x16x32_bf16 v[140:143], v[64:67], a[16:19], v[140:143]
    s_waitcnt lgkmcnt(4)
    v_mfma_f32_16x16x32_bf16 v[144:147], v[80:83], a[0:3], v[144:147]
    ds_read_b128 v[64:67], v10 offset:6144
    ds_read_b128 v[68:71], v10 offset:15360
    v_mfma_f32_16x16x32_bf16 v[144:147], v[84:87], a[4:7], v[144:147]
    buffer_load_dwordx4 v2, s[28:31], s79 offen offset:1024 sc1 lds
    v_mfma_f32_16x16x32_bf16 v[144:147], v[88:91], a[8:11], v[144:147]
    ds_read_b128 v[72:75], v10 offset:24576
    ds_read_b128 v[76:79], v10 offset:33792
    v_mfma_f32_16x16x32_bf16 v[144:147], v[92:95], a[12:15], v[144:147]
    s_add_u32 s79, s82, 1474560
    s_add_u32 m0, s88, 4096
    v_mfma_f32_16x16x32_bf16 v[148:151], v[92:95], a[28:31], v[148:151]
    buffer_load_dwordx4 v2, s[28:31], s79 offen offset:0 sc1 lds
    v_mfma_f32_16x16x32_bf16 v[148:151], v[88:91], a[24:27], v[148:151]
    v_mfma_f32_16x16x32_bf16 v[148:151], v[84:87], a[20:23], v[148:151]
    v_mfma_f32_16x16x32_bf16 v[148:151], v[80:83], a[16:19], v[148:151]
    s_waitcnt lgkmcnt(4)
    buffer_load_dwordx4 v2, s[28:31], s79 offen offset:1024 sc1 lds
    v_mfma_f32_16x16x32_bf16 v[152:155], v[96:99], a[0:3], v[152:155]
    ds_read_b128 v[80:83], v10 offset:7168
    ds_read_b128 v[84:87], v10 offset:16384
    v_mfma_f32_16x16x32_bf16 v[152:155], v[100:103], a[4:7], v[152:155]
    v_mfma_f32_16x16x32_bf16 v[152:155], v[104:107], a[8:11], v[152:155]
    ds_read_b128 v[88:91], v10 offset:25600
    ds_read_b128 v[92:95], v10 offset:34816
    v_mfma_f32_16x16x32_bf16 v[152:155], v[108:111], a[12:15], v[152:155]
    s_add_u32 s79, s83, 1474560
    s_add_u32 m0, s88, 6144
    v_mfma_f32_16x16x32_bf16 v[156:159], v[108:111], a[28:31], v[156:159]
    buffer_load_dwordx4 v2, s[28:31], s79 offen offset:0 sc1 lds
    v_mfma_f32_16x16x32_bf16 v[156:159], v[104:107], a[24:27], v[156:159]
    v_mfma_f32_16x16x32_bf16 v[156:159], v[100:103], a[20:23], v[156:159]
    v_mfma_f32_16x16x32_bf16 v[156:159], v[96:99], a[16:19], v[156:159]
    s_waitcnt lgkmcnt(4)
    buffer_load_dwordx4 v2, s[28:31], s79 offen offset:1024 sc1 lds
    v_mfma_f32_16x16x32_bf16 v[160:163], v[64:67], a[0:3], v[160:163]
    ds_read_b128 v[96:99], v10 offset:8192
    ds_read_b128 v[100:103], v10 offset:17408
    v_mfma_f32_16x16x32_bf16 v[160:163], v[68:71], a[4:7], v[160:163]
    v_mfma_f32_16x16x32_bf16 v[160:163], v[72:75], a[8:11], v[160:163]
    ds_read_b128 v[104:107], v10 offset:26624
    ds_read_b128 v[108:111], v10 offset:35840
    v_mfma_f32_16x16x32_bf16 v[160:163], v[76:79], a[12:15], v[160:163]
    s_add_u32 s79, s84, 1474560
    s_add_u32 m0, s88, 8192
    s_waitcnt vmcnt(11)
    v_cmp_eq_u32 vcc, 1, v12
    v_mfma_f32_16x16x32_bf16 v[164:167], v[76:79], a[28:31], v[164:167]
    buffer_load_dwordx4 v2, s[28:31], s79 offen offset:0 sc1 lds
    v_mfma_f32_16x16x32_bf16 v[164:167], v[72:75], a[24:27], v[164:167]
    s_and_b32 s68, vcc_lo, 255
    s_cmp_eq_u32 s68, 255
    s_cbranch_scc1 L_po_ok
    s_cmp_lg_u32 s48, 0
    s_cbranch_scc1 L_po_ok
    s_mov_b32 s69, 65536
L_po_spin:
    s_sleep 4
    buffer_load_dword v12, v19, s[28:31], s72 offen sc1
    s_waitcnt vmcnt(0)
    v_cmp_eq_u32 vcc, 1, v12
    s_nop 1
    s_and_b32 s68, vcc_lo, 255
    s_cmp_eq_u32 s68, 255
    s_cbranch_scc1 L_po_ok
    s_sub_u32 s69, s69, 1
    s_cmp_lg_u32 s69, 0
    s_cbranch_scc1 L_po_spin
L_po_ok:
    v_mfma_f32_16x16x32_bf16 v[164:167], v[68:71], a[20:23], v[164:167]
    v_mfma_f32_16x16x32_bf16 v[164:167], v[64:67], a[16:19], v[164:167]
    s_waitcnt lgkmcnt(4)
    v_mfma_f32_16x16x32_bf16 v[168:171], v[80:83], a[0:3], v[168:171]
    v_add_u32 v10, 36864, v10
    v_mfma_f32_16x16x32_bf16 v[168:171], v[84:87], a[4:7], v[168:171]
    s_barrier
    v_mfma_f32_16x16x32_bf16 v[168:171], v[88:91], a[8:11], v[168:171]
    s_add_u32 s87, s86, 0
    ds_read_b128 v[64:67], v10 offset:0
    ds_read_b128 v[68:71], v10 offset:9216
    v_mfma_f32_16x16x32_bf16 v[168:171], v[92:95], a[12:15], v[168:171]
    buffer_load_dwordx4 a[32:35], v2, s[28:31], s87 offen offset:0 sc1
    v_mfma_f32_16x16x32_bf16 v[172:175], v[92:95], a[28:31], v[172:175]
    ds_read_b128 v[72:75], v10 offset:18432
    ds_read_b128 v[76:79], v10 offset:27648
    v_mfma_f32_16x16x32_bf16 v[172:175], v[88:91], a[24:27], v[172:175]
    buffer_load_dwordx4 a[36:39], v2, s[28:31], s87 offen offset:1024 sc1
    v_mfma_f32_16x16x32_bf16 v[172:175], v[84:87], a[20:23], v[172:175]
    buffer_load_dwordx4 a[40:43], v2, s[28:31], s87 offen offset:2048 sc1
    v_mfma_f32_16x16x32_bf16 v[172:175], v[80:83], a[16:19], v[172:175]
    s_waitcnt lgkmcnt(4)
    v_mfma_f32_16x16x32_bf16 v[176:179], v[96:99], a[0:3], v[176:179]
    ds_read_b128 v[80:83], v10 offset:1024
    ds_read_b128 v[84:87], v10 offset:10240
    v_mfma_f32_16x16x32_bf16 v[176:179], v[100:103], a[4:7], v[176:179]
    buffer_load_dwordx4 a[44:47], v2, s[28:31], s87 offen offset:3072 sc1
    v_mfma_f32_16x16x32_bf16 v[176:179], v[104:107], a[8:11], v[176:179]
    ds_read_b128 v[88:91], v10 offset:19456
    ds_read_b128 v[92:95], v10 offset:28672
    v_mfma_f32_16x16x32_bf16 v[176:179], v[108:111], a[12:15], v[176:179]
    s_add_u32 s87, s86, 4096
    v_mfma_f32_16x16x32_bf16 v[180:183], v[108:111], a[28:31], v[180:183]
    buffer_load_dwordx4 a[48:51], v2, s[28:31], s87 offen offset:0 sc1
    v_mfma_f32_16x16x32_bf16 v[180:183], v[104:107], a[24:27], v[180:183]
    buffer_load_dwordx4 a[52:55], v2, s[28:31], s87 offen offset:1024 sc1
    v_mfma_f32_16x16x32_bf16 v[180:183], v[100:103], a[20:23], v[180:183]
    v_mfma_f32_16x16x32_bf16 v[180:183], v[96:99], a[16:19], v[180:183]
    s_waitcnt lgkmcnt(4)
    v_mfma_f32_16x16x32_bf16 v[112:115], v[64:67], a[64:67], v[112:115]
    ds_read_b128 v[96:99], v10 offset:2048
    ds_read_b128 v[100:103], v10 offset:11264
    v_mfma_f32_16x16x32_bf16 v[112:115], v[68:71], a[68:71], v[112:115]
    buffer_load_dwordx4 a[56:59], v2, s[28:31], s87 offen offset:2048 sc1
    v_mfma_f32_16x16x32_bf16 v[112:115], v[72:75], a[72:75], v[112:115]
    ds_read_b128 v[104:107], v10 offset:20480
    ds_read_b128 v[108:111], v10 offset:29696
    v_mfma_f32_16x16x32_bf16 v[112:115], v[76:79], a[76:79], v[112:115]
    buffer_load_dwordx4 a[60:63], v2, s[28:31], s87 offen offset:3072 sc1
    v_mfma_f32_16x16x32_bf16 v[116:119], v[76:79], a[92:95], v[116:119]
    s_add_u32 s87, s86, 524288
    v_mfma_f32_16x16x32_bf16 v[116:119], v[72:75], a[88:91], v[116:119]
    buffer_load_dwordx4 a[96:99], v2, s[28:31], s87 offen offset:0 sc1
    v_mfma_f32_16x16x32_bf16 v[116:119], v[68:71], a[84:87], v[116:119]
    buffer_load_dwordx4 a[100:103], v2, s[28:31], s87 offen offset:1024 sc1
    v_mfma_f32_16x16x32_bf16 v[116:119], v[64:67], a[80:83], v[116:119]
    s_waitcnt lgkmcnt(4)
    buffer_load_dwordx4 a[104:107], v2, s[28:31], s87 offen offset:2048 sc1
    v_mfma_f32_16x16x32_bf16 v[120:123], v[80:83], a[64:67], v[120:123]
    ds_read_b128 v[64:67], v10 offset:3072
    ds_read_b128 v[68:71], v10 offset:12288
    v_mfma_f32_16x16x32_bf16 v[120:123], v[84:87], a[68:71], v[120:123]
    v_mfma_f32_16x16x32_bf16 v[120:123], v[88:91], a[72:75], v[120:123]
    ds_read_b128 v[72:75], v10 offset:21504
    ds_read_b128 v[76:79], v10 offset:30720
    v_mfma_f32_16x16x32_bf16 v[120:123], v[92:95], a[76:79], v[120:123]
    buffer_load_dwordx4 a[108:111], v2, s[28:31], s87 offen offset:3072 sc1
    v_mfma_f32_16x16x32_bf16 v[124:127], v[92:95], a[92:95], v[124:127]
    v_mfma_f32_16x16x32_bf16 v[124:127], v[88:91], a[88:91], v[124:127]
    v_mfma_f32_16x16x32_bf16 v[124:127], v[84:87], a[84:87], v[124:127]
    v_mfma_f32_16x16x32_bf16 v[124:127], v[80:83], a[80:83], v[124:127]
    s_waitcnt lgkmcnt(4)
    v_mfma_f32_16x16x32_bf16 v[128:131], v[96:99], a[64:67], v[128:131]
    ds_read_b128 v[80:83], v10 offset:4096
    ds_read_b128 v[84:87], v10 offset:13312
    v_mfma_f32_16x16x32_bf16 v[128:131], v[100:103], a[68:71], v[128:131]
    v_mfma_f32_16x16x32_bf16 v[128:131], v[104:107], a[72:75], v[128:131]
    ds_read_b128 v[88:91], v10 offset:22528
    ds_read_b128 v[92:95], v10 offset:31744
    v_mfma_f32_16x16x32_bf16 v[128:131], v[108:111], a[76:79], v[128:131]
    v_mfma_f32_16x16x32_bf16 v[132:135], v[108:111], a[92:95], v[132:135]
    s_add_u32 s87, s86, 528384
    v_mfma_f32_16x16x32_bf16 v[132:135], v[104:107], a[88:91], v[132:135]
    buffer_load_dwordx4 a[112:115], v2, s[28:31], s87 offen offset:0 sc1
    v_mfma_f32_16x16x32_bf16 v[132:135], v[100:103], a[84:87], v[132:135]
    v_mfma_f32_16x16x32_bf16 v[132:135], v[96:99], a[80:83], v[132:135]
    s_waitcnt lgkmcnt(4)
    v_mfma_f32_16x16x32_bf16 v[136:139], v[64:67], a[64:67], v[136:139]
    ds_read_b128 v[96:99], v10 offset:5120
    ds_read_b128 v[100:103], v10 offset:14336
    v_mfma_f32_16x16x32_bf16 v[136:139], v[68:71], a[68:71], v[136:139]
    v_mfma_f32_16x16x32_bf16 v[136:139], v[72:75], a[72:75], v[136:139]
    ds_read_b128 v[104:107], v10 offset:23552
    ds_read_b128 v[108:111], v10 offset:32768
    v_mfma_f32_16x16x32_bf16 v[136:139], v[76:79], a[76:79], v[136:139]
    v_mfma_f32_16x16x32_bf16 v[140:143], v[76:79], a[92:95], v[140:143]
    v_mfma_f32_16x16x32_bf16 v[140:143], v[72:75], a[88:91], v[140:143]
    buffer_load_dwordx4 a[116:119], v2, s[28:31], s87 offen offset:1024 sc1
    v_mfma_f32_16x16x32_bf16 v[140:143], v[68:71], a[84:87], v[140:143]
    v_mfma_f32_16x16x32_bf16 v[140:143], v[64:67], a[80:83], v[140:143]
    s_waitcnt lgkmcnt(4)
    v_mfma_f32_16x16x32_bf16 v[144:147], v[80:83], a[64:67], v[144:147]
    ds_read_b128 v[64:67], v10 offset:6144
    ds_read_b128 v[68:71], v10 offset:15360
    v_mfma_f32_16x16x32_bf16 v[144:147], v[84:87], a[68:71], v[144:147]
    v_mfma_f32_16x16x32_bf16 v[144:147], v[88:91], a[72:75], v[144:147]
    ds_read_b128 v[72:75], v10 offset:24576
    ds_read_b128 v[76:79], v10 offset:33792
    v_mfma_f32_16x16x32_bf16 v[144:147], v[92:95], a[76:79], v[144:147]
    v_mfma_f32_16x16x32_bf16 v[148:151], v[92:95], a[92:95], v[148:151]
    v_mfma_f32_16x16x32_bf16 v[148:151], v[88:91], a[88:91], v[148:151]
    buffer_load_dwordx4 a[120:123], v2, s[28:31], s87 offen offset:2048 sc1
    v_mfma_f32_16x16x32_bf16 v[148:151], v[84:87], a[84:87], v[148:151]
    v_mfma_f32_16x16x32_bf16 v[148:151], v[80:83], a[80:83], v[148:151]
    s_waitcnt lgkmcnt(4)
    v_mfma_f32_16x16x32_bf16 v[152:155], v[96:99], a[64:67], v[152:155]
    ds_read_b128 v[80:83], v10 offset:7168
    ds_read_b128 v[84:87], v10 offset:16384
    v_mfma_f32_16x16x32_bf16 v[152:155], v[100:103], a[68:71], v[152:155]
    v_mfma_f32_16x16x32_bf16 v[152:155], v[104:107], a[72:75], v[152:155]
    ds_read_b128 v[88:91], v10 offset:25600
    ds_read_b128 v[92:95], v10 offset:34816
    v_mfma_f32_16x16x32_bf16 v[152:155], v[108:111], a[76:79], v[152:155]
    v_mfma_f32_16x16x32_bf16 v[156:159], v[108:111], a[92:95], v[156:159]
    v_mfma_f32_16x16x32_bf16 v[156:159], v[104:107], a[88:91], v[156:159]
    v_mfma_f32_16x16x32_bf16 v[156:159], v[100:103], a[84:87], v[156:159]
    buffer_load_dwordx4 a[124:127], v2, s[28:31], s87 offen offset:3072 sc1
    v_mfma_f32_16x16x32_bf16 v[156:159], v[96:99], a[80:83], v[156:159]
    s_waitcnt lgkmcnt(4)
    v_mfma_f32_16x16x32_bf16 v[160:163], v[64:67], a[64:67], v[160:163]
    ds_read_b128 v[96:99], v10 offset:8192
    ds_read_b128 v[100:103], v10 offset:17408
    v_mfma_f32_16x16x32_bf16 v[160:163], v[68:71], a[68:71], v[160:163]
    v_mfma_f32_16x16x32_bf16 v[160:163], v[72:75], a[72:75], v[160:163]
    ds_read_b128 v[104:107], v10 offset:26624
    ds_read_b128 v[108:111], v10 offset:35840
    v_mfma_f32_16x16x32_bf16 v[160:163], v[76:79], a[76:79], v[160:163]
    v_mfma_f32_16x16x32_bf16 v[164:167], v[76:79], a[92:95], v[164:167]
    v_mfma_f32_16x16x32_bf16 v[164:167], v[72:75], a[88:91], v[164:167]
    v_mfma_f32_16x16x32_bf16 v[164:167], v[68:71], a[84:87], v[164:167]
    v_mfma_f32_16x16x32_bf16 v[164:167], v[64:67], a[80:83], v[164:167]
    s_waitcnt lgkmcnt(4)
    v_mfma_f32_16x16x32_bf16 v[168:171], v[80:83], a[64:67], v[168:171]
    s_waitcnt vmcnt(25)
    v_add_u32 v10, 36864, v10
    v_mfma_f32_16x16x32_bf16 v[168:171], v[84:87], a[68:71], v[168:171]
    s_barrier
    v_mfma_f32_16x16x32_bf16 v[168:171], v[88:91], a[72:75], v[168:171]
    s_add_u32 s79, s80, 1622016
    ds_read_b128 v[64:67], v10 offset:0
    ds_read_b128 v[68:71], v10 offset:9216
    v_mfma_f32_16x16x32_bf16 v[168:171], v[92:95], a[76:79], v[168:171]
    s_add_u32 m0, s88, 36864
    v_mfma_f32_16x16x32_bf16 v[172:175], v[92:95], a[92:95], v[172:175]
    ds_read_b128 v[72:75], v10 offset:18432
    ds_read_b128 v[76:79], v10 offset:27648
    v_mfma_f32_16x16x32_bf16 v[172:175], v[88:91], a[88:91], v[172:175]
    buffer_load_dwordx4 v2, s[28:31], s79 offen offset:0 sc1 lds
    v_mfma_f32_16x16x32_bf16 v[172:175], v[84:87], a[84:87], v[172:175]
    s_add_u32 s87, s86, 1048576
    v_mfma_f32_16x16x32_bf16 v[172:175], v[80:83], a[80:83], v[172:175]
    s_waitcnt lgkmcnt(4)
    buffer_load_dwordx4 a[0:3], v2, s[28:31], s87 offen offset:0 sc1
    v_mfma_f32_16x16x32_bf16 v[176:179], v[96:99], a[64:67], v[176:179]
    ds_read_b128 v[80:83], v10 offset:1024
    ds_read_b128 v[84:87], v10 offset:10240
    v_mfma_f32_16x16x32_bf16 v[176:179], v[100:103], a[68:71], v[176:179]
    v_mfma_f32_16x16x32_bf16 v[176:179], v[104:107], a[72:75], v[176:179]
    ds_read_b128 v[88:91], v10 offset:19456
    ds_read_b128 v[92:95], v10 offset:28672
    v_mfma_f32_16x16x32_bf16 v[176:179], v[108:111], a[76:79], v[176:179]
    buffer_load_dwordx4 v2, s[28:31], s79 offen offset:1024 sc1 lds
    v_mfma_f32_16x16x32_bf16 v[180:183], v[108:111], a[92:95], v[180:183]
    v_mfma_f32_16x16x32_bf16 v[180:183], v[104:107], a[88:91], v[180:183]
    v_mfma_f32_16x16x32_bf16 v[180:183], v[100:103], a[84:87], v[180:183]
    buffer_load_dwordx4 a[4:7], v2, s[28:31], s87 offen offset:1024 sc1
    v_mfma_f32_16x16x32_bf16 v[180:183], v[96:99], a[80:83], v[180:183]
    s_waitcnt lgkmcnt(4)
    s_waitcnt vmcnt(19)
    v_mfma_f32_16x16x32_bf16 v[184:187], v[64:67], a[32:35], 0
    ds_read_b128 v[96:99], v10 offset:2048
    ds_read_b128 v[100:103], v10 offset:11264
    s_waitcnt vmcnt(18)
    v_mfma_f32_16x16x32_bf16 v[184:187], v[68:71], a[36:39], v[184:187]
    s_waitcnt vmcnt(17)
    v_mfma_f32_16x16x32_bf16 v[184:187], v[72:75], a[40:43], v[184:187]
    s_add_u32 s79, s81, 1622016
    ds_read_b128 v[104:107], v10 offset:20480
    ds_read_b128 v[108:111], v10 offset:29696
    s_waitcnt vmcnt(16)
    v_mfma_f32_16x16x32_bf16 v[184:187], v[76:79], a[44:47], v[184:187]
    s_add_u32 m0, s88, 38912
    s_waitcnt vmcnt(12)
    v_mfma_f32_16x16x32_bf16 v[188:191], v[76:79], a[60:63], 0
    buffer_load_dwordx4 v2, s[28:31], s79 offen offset:0 sc1 lds
    v_mfma_f32_16x16x32_bf16 v[188:191], v[72:75], a[56:59], v[188:191]
    v_mfma_f32_16x16x32_bf16 v[188:191], v[68:71], a[52:55], v[188:191]
    buffer_load_dwordx4 a[8:11], v2, s[28:31], s87 offen offset:2048 sc1
    v_mfma_f32_16x16x32_bf16 v[188:191], v[64:67], a[48:51], v[188:191]
    s_waitcnt lgkmcnt(4)
    v_mfma_f32_16x16x32_bf16 v[192:195], v[80:83], a[32:35], 0
    ds_read_b128 v[64:67], v10 offset:3072
    ds_read_b128 v[68:71], v10 offset:12288
    v_mfma_f32_16x16x32_bf16 v[192:195], v[84:87], a[36:39], v[192:195]
    v_mfma_f32_16x16x32_bf16 v[192:195], v[88:91], a[40:43], v[192:195]
    ds_read_b128 v[72:75], v10 offset:21504
    ds_read_b128 v[76:79], v10 offset:30720
    v_mfma_f32_16x16x32_bf16 v[192:195], v[92:95], a[44:47], v[192:195]
    buffer_load_dwordx4 v2, s[28:31], s79 offen offset:1024 sc1 lds
    v_mfma_f32_16x16x32_bf16 v[196:199], v[92:95], a[60:63], 0
    v_mfma_f32_16x16x32_bf16 v[196:199], v[88:91], a[56:59], v[196:199]
    v_mfma_f32_16x16x32_bf16 v[196:199], v[84:87], a[52:55], v[196:199]
    buffer_load_dwordx4 a[12:15], v2, s[28:31], s87 offen offset:3072 sc1
    v_mfma_f32_16x16x32_bf16 v[196:199], v[80:83], a[48:51], v[196:199]
    s_waitcnt lgkmcnt(4)
    v_mfma_f32_16x16x32_bf16 v[200:203], v[96:99], a[32:35], 0
    ds_read_b128 v[80:83], v10 offset:4096
    ds_read_b128 v[84:87], v10 offset:13312
    v_mfma_f32_16x16x32_bf16 v[200:203], v[100:103], a[36:39], v[200:203]
    v_mfma_f32_16x16x32_bf16 v[200:203], v[104:107], a[40:43], v[200:203]
    s_add_u32 s79, s82, 1622016
    ds_read_b128 v[88:91], v10 offset:22528
    ds_read_b128 v[92:95], v10 offset:31744
    v_mfma_f32_16x16x32_bf16 v[200:203], v[108:111], a[44:47], v[200:203]
    s_add_u32 m0, s88, 40960
    v_mfma_f32_16x16x32_bf16 v[204:207], v[108:111], a[60:63], 0
    buffer_load_dwordx4 v2, s[28:31], s79 offen offset:0 sc1 lds
    v_mfma_f32_16x16x32_bf16 v[204:207], v[104:107], a[56:59], v[204:207]
    v_mfma_f32_16x16x32_bf16 v[204:207], v[100:103], a[52:55], v[204:207]
    s_add_u32 s87, s86, 1052672
    v_mfma_f32_16x16x32_bf16 v[204:207], v[96:99], a[48:51], v[204:207]
    s_waitcnt lgkmcnt(4)
    buffer_load_dwordx4 a[16:19], v2, s[28:31], s87 offen offset:0 sc1
    v_mfma_f32_16x16x32_bf16 v[208:211], v[64:67], a[32:35], 0
    ds_read_b128 v[96:99], v10 offset:5120
    ds_read_b128 v[100:103], v10 offset:14336
    v_mfma_f32_16x16x32_bf16 v[208:211], v[68:71], a[36:39], v[208:211]
    v_mfma_f32_16x16x32_bf16 v[208:211], v[72:75], a[40:43], v[208:211]
    ds_read_b128 v[104:107], v10 offset:23552
    ds_read_b128 v[108:111], v10 offset:32768
    v_mfma_f32_16x16x32_bf16 v[208:211], v[76:79], a[44:47], v[208:211]
    buffer_load_dwordx4 v2, s[28:31], s79 offen offset:1024 sc1 lds
    v_mfma_f32_16x16x32_bf16 v[212:215], v[76:79], a[60:63], 0
    v_mfma_f32_16x16x32_bf16 v[212:215], v[72:75], a[56:59], v[212:215]
    v_mfma_f32_16x16x32_bf16 v[212:215], v[68:71], a[52:55], v[212:215]
    buffer_load_dwordx4 a[20:23], v2, s[28:31], s87 offen offset:1024 sc1
    v_mfma_f32_16x16x32_bf16 v[212:215], v[64:67], a[48:51], v[212:215]
    s_waitcnt lgkmcnt(4)
    v_mfma_f32_16x16x32_bf16 v[216:219], v[80:83], a[32:35], 0
    ds_read_b128 v[64:67], v10 offset:6144
    ds_read_b128 v[68:71], v10 offset:15360
    v_mfma_f32_16x16x32_bf16 v[216:219], v[84:87], a[36:39], v[216:219]
    v_mfma_f32_16x16x32_bf16 v[216:219], v[88:91], a[40:43], v[216:219]
    s_add_u32 s79, s83, 1622016
    ds_read_b128 v[72:75], v10 offset:24576
    ds_read_b128 v[76:79], v10 offset:33792
    v_mfma_f32_16x16x32_bf16 v[216:219], v[92:95], a[44:47], v[216:219]
    s_add_u32 m0, s88, 43008
    v_mfma_f32_16x16x32_bf16 v[220:223], v[92:95], a[60:63], 0
    buffer_load_dwordx4 v2, s[28:31], s79 offen offset:0 sc1 lds
    v_mfma_f32_16x16x32_bf16 v[220:223], v[88:91], a[56:59], v[220:223]
    v_mfma_f32_16x16x32_bf16 v[220:223], v[84:87], a[52:55], v[220:223]
    buffer_load_dwordx4 a[24:27], v2, s[28:31], s87 offen offset:2048 sc1
    v_mfma_f32_16x16x32_bf16 v[220:223], v[80:83], a[48:51], v[220:223]
    s_waitcnt lgkmcnt(4)
    v_mfma_f32_16x16x32_bf16 v[224:227], v[96:99], a[32:35], 0
    ds_read_b128 v[80:83], v10 offset:7168
    ds_read_b128 v[84:87], v10 offset:16384
    v_mfma_f32_16x16x32_bf16 v[224:227], v[100:103], a[36:39], v[224:227]
    v_mfma_f32_16x16x32_bf16 v[224:227], v[104:107], a[40:43], v[224:227]
    ds_read_b128 v[88:91], v10 offset:25600
    ds_read_b128 v[92:95], v10 offset:34816
    v_mfma_f32_16x16x32_bf16 v[224:227], v[108:111], a[44:47], v[224:227]
    buffer_load_dwordx4 v2, s[28:31], s79 offen offset:1024 sc1 lds
    v_mfma_f32_16x16x32_bf16 v[228:231], v[108:111], a[60:63], 0
    v_mfma_f32_16x16x32_bf16 v[228:231], v[104:107], a[56:59], v[228:231]
    v_mfma_f32_16x16x32_bf16 v[228:231], v[100:103], a[52:55], v[228:231]
    buffer_load_dwordx4 a[28:31], v2, s[28:31], s87 offen offset:3072 sc1
    v_mfma_f32_16x16x32_bf16 v[228:231], v[96:99], a[48:51], v[228:231]
    s_waitcnt lgkmcnt(4)
    v_mfma_f32_16x16x32_bf16 v[232:235], v[64:67], a[32:35], 0
    ds_read_b128 v[96:99], v10 offset:8192
    ds_read_b128 v[100:103], v10 offset:17408
    v_mfma_f32_16x16x32_bf16 v[232:235], v[68:71], a[36:39], v[232:235]
    v_mfma_f32_16x16x32_bf16 v[232:235], v[72:75], a[40:43], v[232:235]
    s_add_u32 s79, s84, 1622016
    ds_read_b128 v[104:107], v10 offset:26624
    ds_read_b128 v[108:111], v10 offset:35840
    v_mfma_f32_16x16x32_bf16 v[232:235], v[76:79], a[44:47], v[232:235]
    s_add_u32 m0, s88, 45056
    v_mfma_f32_16x16x32_bf16 v[236:239], v[76:79], a[60:63], 0
    buffer_load_dwordx4 v2, s[28:31], s79 offen offset:0 sc1 lds
    v_mfma_f32_16x16x32_bf16 v[236:239], v[72:75], a[56:59], v[236:239]
    v_mfma_f32_16x16x32_bf16 v[236:239], v[68:71], a[52:55], v[236:239]
    v_mfma_f32_16x16x32_bf16 v[236:239], v[64:67], a[48:51], v[236:239]
    s_waitcnt lgkmcnt(4)
    v_mfma_f32_16x16x32_bf16 v[240:243], v[80:83], a[32:35], 0
    v_subrev_u32 v10, 110592, v10
    v_mfma_f32_16x16x32_bf16 v[240:243], v[84:87], a[36:39], v[240:243]
    s_barrier
    v_mfma_f32_16x16x32_bf16 v[240:243], v[88:91], a[40:43], v[240:243]
    s_add_u32 s79, s80, 1769472
    ds_read_b128 v[64:67], v10 offset:0
    ds_read_b128 v[68:71], v10 offset:9216
    v_mfma_f32_16x16x32_bf16 v[240:243], v[92:95], a[44:47], v[240:243]
    s_add_u32 m0, s88, 73728
    v_mfma_f32_16x16x32_bf16 v[244:247], v[92:95], a[60:63], 0
    ds_read_b128 v[72:75], v10 offset:18432
    ds_read_b128 v[76:79], v10 offset:27648
    v_mfma_f32_16x16x32_bf16 v[244:247], v[88:91], a[56:59], v[244:247]
    buffer_load_dwordx4 v2, s[28:31], s79 offen offset:0 sc1 lds
    v_mfma_f32_16x16x32_bf16 v[244:247], v[84:87], a[52:55], v[244:247]
    s_add_u32 s87, s86, 1572864
    v_mfma_f32_16x16x32_bf16 v[244:247], v[80:83], a[48:51], v[244:247]
    s_waitcnt lgkmcnt(4)
    buffer_load_dwordx4 a[64:67], v2, s[28:31], s87 offen offset:0 sc1
    v_mfma_f32_16x16x32_bf16 v[248:251], v[96:99], a[32:35], 0
    ds_read_b128 v[80:83], v10 offset:1024
    ds_read_b128 v[84:87], v10 offset:10240
    v_mfma_f32_16x16x32_bf16 v[248:251], v[100:103], a[36:39], v[248:251]
    v_mfma_f32_16x16x32_bf16 v[248:251], v[104:107], a[40:43], v[248:251]
    ds_read_b128 v[88:91], v10 offset:19456
    ds_read_b128 v[92:95], v10 offset:28672
    v_mfma_f32_16x16x32_bf16 v[248:251], v[108:111], a[44:47], v[248:251]
    buffer_load_dwordx4 v2, s[28:31], s79 offen offset:1024 sc1 lds
    v_mfma_f32_16x16x32_bf16 v[252:255], v[108:111], a[60:63], 0
    v_mfma_f32_16x16x32_bf16 v[252:255], v[104:107], a[56:59], v[252:255]
    v_mfma_f32_16x16x32_bf16 v[252:255], v[100:103], a[52:55], v[252:255]
    buffer_load_dwordx4 a[68:71], v2, s[28:31], s87 offen offset:1024 sc1
    v_mfma_f32_16x16x32_bf16 v[252:255], v[96:99], a[48:51], v[252:255]
    s_waitcnt lgkmcnt(4)
    s_waitcnt vmcnt(28)
    v_mfma_f32_16x16x32_bf16 v[184:187], v[64:67], a[96:99], v[184:187]
    ds_read_b128 v[96:99], v10 offset:2048
    ds_read_b128 v[100:103], v10 offset:11264
    s_waitcnt vmcnt(27)
    v_mfma_f32_16x16x32_bf16 v[184:187], v[68:71], a[100:103], v[184:187]
    s_waitcnt vmcnt(26)
    v_mfma_f32_16x16x32_bf16 v[184:187], v[72:75], a[104:107], v[184:187]
    s_add_u32 s79, s81, 1769472
    ds_read_b128 v[104:107], v10 offset:20480
    ds_read_b128 v[108:111], v10 offset:29696
    s_waitcnt vmcnt(25)
    v_mfma_f32_16x16x32_bf16 v[184:187], v[76:79], a[108:111], v[184:187]
    s_add_u32 m0, s88, 75776
    s_waitcnt vmcnt(21)
    v_mfma_f32_16x16x32_bf16 v[188:191], v[76:79], a[124:127], v[188:191]
    buffer_load_dwordx4 v2, s[28:31], s79 offen offset:0 sc1 lds
    v_mfma_f32_16x16x32_bf16 v[188:191], v[72:75], a[120:123], v[188:191]
    v_mfma_f32_16x16x32_bf16 v[188:191], v[68:71], a[116:119], v[188:191]
    buffer_load_dwordx4 a[72:75], v2, s[28:31], s87 offen offset:2048 sc1
    v_mfma_f32_16x16x32_bf16 v[188:191], v[64:67], a[112:115], v[188:191]
    s_waitcnt lgkmcnt(4)
    v_mfma_f32_16x16x32_bf16 v[192:195], v[80:83], a[96:99], v[192:195]
    ds_read_b128 v[64:67], v10 offset:3072
    ds_read_b128 v[68:71], v10 offset:12288
    v_mfma_f32_16x16x32_bf16 v[192:195], v[84:87], a[100:103], v[192:195]
    v_mfma_f32_16x16x32_bf16 v[192:195], v[88:91], a[104:107], v[192:195]
    ds_read_b128 v[72:75], v10 offset:21504
    ds_read_b128 v[76:79], v10 offset:30720
    v_mfma_f32_16x16x32_bf16 v[192:195], v[92:95], a[108:111], v[192:195]
    buffer_load_dwordx4 v2, s[28:31], s79 offen offset:1024 sc1 lds
    v_mfma_f32_16x16x32_bf16 v[196:199], v[92:95], a[124:127], v[196:199]
    v_mfma_f32_16x16x32_bf16 v[196:199], v[88:91], a[120:123], v[196:199]
    v_mfma_f32_16x16x32_bf16 v[196:199], v[84:87], a[116:119], v[196:199]
    buffer_load_dwordx4 a[76:79], v2, s[28:31], s87 offen offset:3072 sc1
    v_mfma_f32_16x16x32_bf16 v[196:199], v[80:83], a[112:115], v[196:199]
    s_waitcnt lgkmcnt(4)
    v_mfma_f32_16x16x32_bf16 v[200:203], v[96:99], a[96:99], v[200:203]
    ds_read_b128 v[80:83], v10 offset:4096
    ds_read_b128 v[84:87], v10 offset:13312
    v_mfma_f32_16x16x32_bf16 v[200:203], v[100:103], a[100:103], v[200:203]
    v_mfma_f32_16x16x32_bf16 v[200:203], v[104:107], a[104:107], v[200:203]
    s_add_u32 s79, s82, 1769472
    ds_read_b128 v[88:91], v10 offset:22528
    ds_read_b128 v[92:95], v10 offset:31744
    v_mfma_f32_16x16x32_bf16 v[200:203], v[108:111], a[108:111], v[200:203]
    s_add_u32 m0, s88, 77824
    v_mfma_f32_16x16x32_bf16 v[204:207], v[108:111], a[124:127], v[204:207]
    buffer_load_dwordx4 v2, s[28:31], s79 offen offset:0 sc1 lds
    v_mfma_f32_16x16x32_bf16 v[204:207], v[104:107], a[120:123], v[204:207]
    v_mfma_f32_16x16x32_bf16 v[204:207], v[100:103], a[116:119], v[204:207]
    s_add_u32 s87, s86, 1576960
    v_mfma_f32_16x16x32_bf16 v[204:207], v[96:99], a[112:115], v[204:207]
    s_waitcnt lgkmcnt(4)
    buffer_load_dwordx4 a[80:83], v2, s[28:31], s87 offen offset:0 sc1
    v_mfma_f32_16x16x32_bf16 v[208:211], v[64:67], a[96:99], v[208:211]
    ds_read_b128 v[96:99], v10 offset:5120
    ds_read_b128 v[100:103], v10 offset:14336
    v_mfma_f32_16x16x32_bf16 v[208:211], v[68:71], a[100:103], v[208:211]
    v_mfma_f32_16x16x32_bf16 v[208:211], v[72:75], a[104:107], v[208:211]
    ds_read_b128 v[104:107], v10 offset:23552
    ds_read_b128 v[108:111], v10 offset:32768
    v_mfma_f32_16x16x32_bf16 v[208:211], v[76:79], a[108:111], v[208:211]
    buffer_load_dwordx4 v2, s[28:31], s79 offen offset:1024 sc1 lds
    v_mfma_f32_16x16x32_bf16 v[212:215], v[76:79], a[124:127], v[212:215]
    v_mfma_f32_16x16x32_bf16 v[212:215], v[72:75], a[120:123], v[212:215]
    v_mfma_f32_16x16x32_bf16 v[212:215], v[68:71], a[116:119], v[212:215]
    buffer_load_dwordx4 a[84:87], v2, s[28:31], s87 offen offset:1024 sc1
    v_mfma_f32_16x16x32_bf16 v[212:215], v[64:67], a[112:115], v[212:215]
    s_waitcnt lgkmcnt(4)
    v_mfma_f32_16x16x32_bf16 v[216:219], v[80:83], a[96:99], v[216:219]
    ds_read_b128 v[64:67], v10 offset:6144
    ds_read_b128 v[68:71], v10 offset:15360
    v_mfma_f32_16x16x32_bf16 v[216:219], v[84:87], a[100:103], v[216:219]
    v_mfma_f32_16x16x32_bf16 v[216:219], v[88:91], a[104:107], v[216:219]
    s_add_u32 s79, s83, 1769472
    ds_read_b128 v[72:75], v10 offset:24576
    ds_read_b128 v[76:79], v10 offset:33792
    v_mfma_f32_16x16x32_bf16 v[216:219], v[92:95], a[108:111], v[216:219]
    s_add_u32 m0, s88, 79872
    v_mfma_f32_16x16x32_bf16 v[220:223], v[92:95], a[124:127], v[220:223]
    buffer_load_dwordx4 v2, s[28:31], s79 offen offset:0 sc1 lds
    v_mfma_f32_16x16x32_bf16 v[220:223], v[88:91], a[120:123], v[220:223]
    v_mfma_f32_16x16x32_bf16 v[220:223], v[84:87], a[116:119], v[220:223]
    buffer_load_dwordx4 a[88:91], v2, s[28:31], s87 offen offset:2048 sc1
    v_mfma_f32_16x16x32_bf16 v[220:223], v[80:83], a[112:115], v[220:223]
    s_waitcnt lgkmcnt(4)
    v_mfma_f32_16x16x32_bf16 v[224:227], v[96:99], a[96:99], v[224:227]
    ds_read_b128 v[80:83], v10 offset:7168
    ds_read_b128 v[84:87], v10 offset:16384
    v_mfma_f32_16x16x32_bf16 v[224:227], v[100:103], a[100:103], v[224:227]
    v_mfma_f32_16x16x32_bf16 v[224:227], v[104:107], a[104:107], v[224:227]
    ds_read_b128 v[88:91], v10 offset:25600
    ds_read_b128 v[92:95], v10 offset:34816
    v_mfma_f32_16x16x32_bf16 v[224:227], v[108:111], a[108:111], v[224:227]
    buffer_load_dwordx4 v2, s[28:31], s79 offen offset:1024 sc1 lds
    v_mfma_f32_16x16x32_bf16 v[228:231], v[108:111], a[124:127], v[228:231]
    v_mfma_f32_16x16x32_bf16 v[228:231], v[104:107], a[120:123], v[228:231]
    v_mfma_f32_16x16x32_bf16 v[228:231], v[100:103], a[116:119], v[228:231]
    buffer_load_dwordx4 a[92:95], v2, s[28:31], s87 offen offset:3072 sc1
    v_mfma_f32_16x16x32_bf16 v[228:231], v[96:99], a[112:115], v[228:231]
    s_waitcnt lgkmcnt(4)
    v_mfma_f32_16x16x32_bf16 v[232:235], v[64:67], a[96:99], v[232:235]
    ds_read_b128 v[96:99], v10 offset:8192
    ds_read_b128 v[100:103], v10 offset:17408
    v_mfma_f32_16x16x32_bf16 v[232:235], v[68:71], a[100:103], v[232:235]
    v_mfma_f32_16x16x32_bf16 v[232:235], v[72:75], a[104:107], v[232:235]
    s_add_u32 s79, s84, 1769472
    ds_read_b128 v[104:107], v10 offset:26624
    ds_read_b128 v[108:111], v10 offset:35840
    v_mfma_f32_16x16x32_bf16 v[232:235], v[76:79], a[108:111], v[232:235]
    s_add_u32 m0, s88, 81920
    v_mfma_f32_16x16x32_bf16 v[236:239], v[76:79], a[124:127], v[236:239]
    buffer_load_dwordx4 v2, s[28:31], s79 offen offset:0 sc1 lds
    v_mfma_f32_16x16x32_bf16 v[236:239], v[72:75], a[120:123], v[236:239]
    v_mfma_f32_16x16x32_bf16 v[236:239], v[68:71], a[116:119], v[236:239]
    v_mfma_f32_16x16x32_bf16 v[236:239], v[64:67], a[112:115], v[236:239]
    s_waitcnt lgkmcnt(4)
    v_mfma_f32_16x16x32_bf16 v[240:243], v[80:83], a[96:99], v[240:243]
    s_waitcnt vmcnt(17)
    v_add_u32 v10, 36864, v10
    v_mfma_f32_16x16x32_bf16 v[240:243], v[84:87], a[100:103], v[240:243]
    s_barrier
    v_mfma_f32_16x16x32_bf16 v[240:243], v[88:91], a[104:107], v[240:243]
    s_add_u32 s79, s80, 1916928
    ds_read_b128 v[64:67], v10 offset:0
    ds_read_b128 v[68:71], v10 offset:9216
    v_mfma_f32_16x16x32_bf16 v[240:243], v[92:95], a[108:111], v[240:243]
    s_add_u32 m0, s88, 110592
    v_mfma_f32_16x16x32_bf16 v[244:247], v[92:95], a[124:127], v[244:247]
    ds_read_b128 v[72:75], v10 offset:18432
    ds_read_b128 v[76:79], v10 offset:27648
    v_mfma_f32_16x16x32_bf16 v[244:247], v[88:91], a[120:123], v[244:247]
    buffer_load_dwordx4 v2, s[28:31], s79 offen offset:0 sc1 lds
    v_mfma_f32_16x16x32_bf16 v[244:247], v[84:87], a[116:119], v[244:247]
    s_add_u32 s87, s86, 2097152
    v_mfma_f32_16x16x32_bf16 v[244:247], v[80:83], a[112:115], v[244:247]
    s_waitcnt lgkmcnt(4)
    buffer_load_dwordx4 a[32:35], v2, s[28:31], s87 offen offset:0 sc1
    v_mfma_f32_16x16x32_bf16 v[248:251], v[96:99], a[96:99], v[248:251]
    ds_read_b128 v[80:83], v10 offset:1024
    ds_read_b128 v[84:87], v10 offset:10240
    v_mfma_f32_16x16x32_bf16 v[248:251], v[100:103], a[100:103], v[248:251]
    v_mfma_f32_16x16x32_bf16 v[248:251], v[104:107], a[104:107], v[248:251]
    ds_read_b128 v[88:91], v10 offset:19456
    ds_read_b128 v[92:95], v10 offset:28672
    v_mfma_f32_16x16x32_bf16 v[248:251], v[108:111], a[108:111], v[248:251]
    buffer_load_dwordx4 v2, s[28:31], s79 offen offset:1024 sc1 lds
    v_mfma_f32_16x16x32_bf16 v[252:255], v[108:111], a[124:127], v[252:255]
    v_mfma_f32_16x16x32_bf16 v[252:255], v[104:107], a[120:123], v[252:255]
    v_mfma_f32_16x16x32_bf16 v[252:255], v[100:103], a[116:119], v[252:255]
    buffer_load_dwordx4 a[36:39], v2, s[28:31], s87 offen offset:1024 sc1
    v_mfma_f32_16x16x32_bf16 v[252:255], v[96:99], a[112:115], v[252:255]
    s_waitcnt lgkmcnt(4)
    v_mfma_f32_16x16x32_bf16 v[184:187], v[64:67], a[0:3], v[184:187]
    ds_read_b128 v[96:99], v10 offset:2048
    ds_read_b128 v[100:103], v10 offset:11264
    v_mfma_f32_16x16x32_bf16 v[184:187], v[68:71], a[4:7], v[184:187]
    ds_read_b64 v[24:25], v15 offset:0
    ds_read_b64 v[26:27], v15 offset:1024
    v_mfma_f32_16x16x32_bf16 v[184:187], v[72:75], a[8:11], v[184:187]
    s_add_u32 s79, s81, 1916928
    ds_read_b128 v[104:107], v10 offset:20480
    ds_read_b128 v[108:111], v10 offset:29696
    v_mfma_f32_16x16x32_bf16 v[184:187], v[76:79], a[12:15], v[184:187]
    s_add_u32 m0, s88, 112640
    ds_read_b64 v[28:29], v15 offset:32
    ds_read_b64 v[30:31], v15 offset:1056
    v_mfma_f32_16x16x32_bf16 v[188:191], v[76:79], a[28:31], v[188:191]
    buffer_load_dwordx4 v2, s[28:31], s79 offen offset:0 sc1 lds
    ds_read_b64 v[32:33], v16 offset:2048
    v_mfma_f32_16x16x32_bf16 v[188:191], v[72:75], a[24:27], v[188:191]
    ds_read_b64 v[34:35], v16 offset:2560
    v_bfe_u32 v48, v1, 2, 2
    v_mfma_f32_16x16x32_bf16 v[188:191], v[68:71], a[20:23], v[188:191]
    buffer_load_dwordx4 a[40:43], v2, s[28:31], s87 offen offset:2048 sc1
    v_lshrrev_b32 v49, 4, v1
    v_mfma_f32_16x16x32_bf16 v[188:191], v[64:67], a[16:19], v[188:191]
    s_waitcnt lgkmcnt(4)
    v_cmp_eq_u32 vcc, v49, v48
    v_and_b32 v50, 1, v1
    v_mfma_f32_16x16x32_bf16 v[192:195], v[80:83], a[0:3], v[192:195]
    ds_read_b128 v[64:67], v10 offset:3072
    ds_read_b128 v[68:71], v10 offset:12288
    v_mfma_f32_16x16x32_bf16 v[192:195], v[84:87], a[4:7], v[192:195]
    v_lshlrev_b32 v50, 4, v50
    v_mov_b32 v51, 0x3f80
    v_mfma_f32_16x16x32_bf16 v[192:195], v[88:91], a[8:11], v[192:195]
    ds_read_b128 v[72:75], v10 offset:21504
    ds_read_b128 v[76:79], v10 offset:30720
    v_mfma_f32_16x16x32_bf16 v[192:195], v[92:95], a[12:15], v[192:195]
    buffer_load_dwordx4 v2, s[28:31], s79 offen offset:1024 sc1 lds
    v_lshlrev_b32 v51, v50, v51
    v_mfma_f32_16x16x32_bf16 v[196:199], v[92:95], a[28:31], v[196:199]
    v_cndmask_b32 v51, 0, v51, vcc
    v_bfe_u32 v50, v1, 1, 1
    v_mfma_f32_16x16x32_bf16 v[196:199], v[88:91], a[24:27], v[196:199]
    v_mul_lo_u32 v53, v50, v51
    v_sub_u32 v52, v51, v53
    v_mfma_f32_16x16x32_bf16 v[196:199], v[84:87], a[20:23], v[196:199]
    buffer_load_dwordx4 a[44:47], v2, s[28:31], s87 offen offset:3072 sc1
    v_accvgpr_write_b32 a128, v52
    v_mfma_f32_16x16x32_bf16 v[196:199], v[80:83], a[16:19], v[196:199]
    s_waitcnt lgkmcnt(4)
    v_accvgpr_write_b32 a129, v53
    v_accvgpr_write_b32 a130, 0
    v_mfma_f32_16x16x32_bf16 v[200:203], v[96:99], a[0:3], v[200:203]
    ds_read_b128 v[80:83], v10 offset:4096
    ds_read_b128 v[84:87], v10 offset:13312
    v_mfma_f32_16x16x32_bf16 v[200:203], v[100:103], a[4:7], v[200:203]
    v_accvgpr_write_b32 a131, 0
    v_accvgpr_write_b32 a132, 0
    v_mfma_f32_16x16x32_bf16 v[200:203], v[104:107], a[8:11], v[200:203]
    s_add_u32 s79, s82, 1916928
    ds_read_b128 v[88:91], v10 offset:22528
    ds_read_b128 v[92:95], v10 offset:31744
    v_mfma_f32_16x16x32_bf16 v[200:203], v[108:111], a[12:15], v[200:203]
    s_add_u32 m0, s88, 114688
    v_accvgpr_write_b32 a133, 0
    v_accvgpr_write_b32 a134, v52
    v_mfma_f32_16x16x32_bf16 v[204:207], v[108:111], a[28:31], v[204:207]
    buffer_load_dwordx4 v2, s[28:31], s79 offen offset:0 sc1 lds
    v_accvgpr_write_b32 a135, v53
    v_mfma_f32_16x16x32_bf16 v[204:207], v[104:107], a[24:27], v[204:207]
    v_and_b32 v62, 3, v1
    v_min_u32 v62, 2, v62
    v_mfma_f32_16x16x32_bf16 v[204:207], v[100:103], a[20:23], v[204:207]
    s_add_u32 s87, s86, 2101248
    v_lshlrev_b32 v19, 2, v62
    v_add_u32 v11, s76, v62
    v_mfma_f32_16x16x32_bf16 v[204:207], v[96:99], a[16:19], v[204:207]
    s_waitcnt lgkmcnt(4)
    buffer_load_dwordx4 a[48:51], v2, s[28:31], s87 offen offset:0 sc1
    v_add_u32 v11, 1, v11
    v_mfma_f32_16x16x32_bf16 v[208:211], v[64:67], a[0:3], v[208:211]
    ds_read_b128 v[96:99], v10 offset:5120
    ds_read_b128 v[100:103], v10 offset:14336
    v_mfma_f32_16x16x32_bf16 v[208:211], v[68:71], a[4:7], v[208:211]
    v_and_b32 v11, 3, v11
    v_lshl_add_u32 v11, v11, 9, v19
    v_mfma_f32_16x16x32_bf16 v[208:211], v[72:75], a[8:11], v[208:211]
    ds_read_b128 v[104:107], v10 offset:23552
    ds_read_b128 v[108:111], v10 offset:32768
    v_mfma_f32_16x16x32_bf16 v[208:211], v[76:79], a[12:15], v[208:211]
    buffer_load_dwordx4 v2, s[28:31], s79 offen offset:1024 sc1 lds
    v_mov_b32 v12, 1
    v_mfma_f32_16x16x32_bf16 v[212:215], v[76:79], a[28:31], v[212:215]
    v_mul_u32_u24 v62, 6144, v62
    v_mfma_f32_16x16x32_bf16 v[212:215], v[72:75], a[24:27], v[212:215]
    v_mfma_f32_16x16x32_bf16 v[212:215], v[68:71], a[20:23], v[212:215]
    buffer_load_dwordx4 a[52:55], v2, s[28:31], s87 offen offset:1024 sc1
    v_mfma_f32_16x16x32_bf16 v[212:215], v[64:67], a[16:19], v[212:215]
    s_waitcnt lgkmcnt(4)
    v_mfma_f32_16x16x32_bf16 v[216:219], v[80:83], a[0:3], v[216:219]
    ds_read_b128 v[64:67], v10 offset:6144
    ds_read_b128 v[68:71], v10 offset:15360
    v_mfma_f32_16x16x32_bf16 v[216:219], v[84:87], a[4:7], v[216:219]
    v_mfma_f32_16x16x32_bf16 v[216:219], v[88:91], a[8:11], v[216:219]
    s_add_u32 s79, s83, 1916928
    ds_read_b128 v[72:75], v10 offset:24576
    ds_read_b128 v[76:79], v10 offset:33792
    v_mfma_f32_16x16x32_bf16 v[216:219], v[92:95], a[12:15], v[216:219]
    s_add_u32 m0, s88, 116736
    v_mfma_f32_16x16x32_bf16 v[220:223], v[92:95], a[28:31], v[220:223]
    buffer_load_dwordx4 v2, s[28:31], s79 offen offset:0 sc1 lds
    v_mfma_f32_16x16x32_bf16 v[220:223], v[88:91], a[24:27], v[220:223]
    v_mfma_f32_16x16x32_bf16 v[220:223], v[84:87], a[20:23], v[220:223]
    buffer_load_dwordx4 a[56:59], v2, s[28:31], s87 offen offset:2048 sc1
    v_mfma_f32_16x16x32_bf16 v[220:223], v[80:83], a[16:19], v[220:223]
    s_waitcnt lgkmcnt(4)
    v_mfma_f32_16x16x32_bf16 v[224:227], v[96:99], a[0:3], v[224:227]
    ds_read_b128 v[80:83], v10 offset:7168
    ds_read_b128 v[84:87], v10 offset:16384
    v_mfma_f32_16x16x32_bf16 v[224:227], v[100:103], a[4:7], v[224:227]
    v_mfma_f32_16x16x32_bf16 v[224:227], v[104:107], a[8:11], v[224:227]
    ds_read_b128 v[88:91], v10 offset:25600
    ds_read_b128 v[92:95], v10 offset:34816
    v_mfma_f32_16x16x32_bf16 v[224:227], v[108:111], a[12:15], v[224:227]
    buffer_load_dwordx4 v2, s[28:31], s79 offen offset:1024 sc1 lds
    v_mfma_f32_16x16x32_bf16 v[228:231], v[108:111], a[28:31], v[228:231]
    v_mfma_f32_16x16x32_bf16 v[228:231], v[104:107], a[24:27], v[228:231]
    v_mfma_f32_16x16x32_bf16 v[228:231], v[100:103], a[20:23], v[228:231]
    buffer_load_dwordx4 a[60:63], v2, s[28:31], s87 offen offset:3072 sc1
    v_mfma_f32_16x16x32_bf16 v[228:231], v[96:99], a[16:19], v[228:231]
    s_waitcnt lgkmcnt(4)
    v_mfma_f32_16x16x32_bf16 v[232:235], v[64:67], a[0:3], v[232:235]
    ds_read_b128 v[96:99], v10 offset:8192
    ds_read_b128 v[100:103], v10 offset:17408
    v_mfma_f32_16x16x32_bf16 v[232:235], v[68:71], a[4:7], v[232:235]
    v_mfma_f32_16x16x32_bf16 v[232:235], v[72:75], a[8:11], v[232:235]
    s_add_u32 s79, s84, 1916928
    ds_read_b128 v[104:107], v10 offset:26624
    ds_read_b128 v[108:111], v10 offset:35840
    v_mfma_f32_16x16x32_bf16 v[232:235], v[76:79], a[12:15], v[232:235]
    s_add_u32 m0, s88, 118784
    v_mfma_f32_16x16x32_bf16 v[236:239], v[76:79], a[28:31], v[236:239]
    buffer_load_dwordx4 v2, s[28:31], s79 offen offset:0 sc1 lds
    v_mfma_f32_16x16x32_bf16 v[236:239], v[72:75], a[24:27], v[236:239]
    v_mfma_f32_16x16x32_bf16 v[236:239], v[68:71], a[20:23], v[236:239]
    v_mfma_f32_16x16x32_bf16 v[236:239], v[64:67], a[16:19], v[236:239]
    s_waitcnt lgkmcnt(4)
    v_mfma_f32_16x16x32_bf16 v[240:243], v[80:83], a[0:3], v[240:243]
    s_waitcnt vmcnt(17)
    v_add_u32 v10, 36864, v10
    v_mfma_f32_16x16x32_bf16 v[240:243], v[84:87], a[4:7], v[240:243]
    s_barrier
    v_mfma_f32_16x16x32_bf16 v[240:243], v[88:91], a[8:11], v[240:243]
    s_add_u32 s79, s80, 2064384
    ds_read_b128 v[64:67], v10 offset:0
    ds_read_b128 v[68:71], v10 offset:9216
    v_mfma_f32_16x16x32_bf16 v[240:243], v[92:95], a[12:15], v[240:243]
    s_add_u32 m0, s88, 0
    v_mfma_f32_16x16x32_bf16 v[244:247], v[92:95], a[28:31], v[244:247]
    ds_read_b128 v[72:75], v10 offset:18432
    ds_read_b128 v[76:79], v10 offset:27648
    v_mfma_f32_16x16x32_bf16 v[244:247], v[88:91], a[24:27], v[244:247]
    buffer_load_dwordx4 v2, s[28:31], s79 offen offset:0 sc1 lds
    v_mfma_f32_16x16x32_bf16 v[244:247], v[84:87], a[20:23], v[244:247]
    s_add_u32 s87, s86, 2621440
    v_mfma_f32_16x16x32_bf16 v[244:247], v[80:83], a[16:19], v[244:247]
    s_waitcnt lgkmcnt(4)
    buffer_load_dwordx4 a[96:99], v2, s[28:31], s87 offen offset:0 sc1
    v_mfma_f32_16x16x32_bf16 v[248:251], v[96:99], a[0:3], v[248:251]
    ds_read_b128 v[80:83], v10 offset:1024
    ds_read_b128 v[84:87], v10 offset:10240
    v_mfma_f32_16x16x32_bf16 v[248:251], v[100:103], a[4:7], v[248:251]
    v_mfma_f32_16x16x32_bf16 v[248:251], v[104:107], a[8:11], v[248:251]
    ds_read_b128 v[88:91], v10 offset:19456
    ds_read_b128 v[92:95], v10 offset:28672
    v_mfma_f32_16x16x32_bf16 v[248:251], v[108:111], a[12:15], v[248:251]
    buffer_load_dwordx4 v2, s[28:31], s79 offen offset:1024 sc1 lds
    v_mfma_f32_16x16x32_bf16 v[252:255], v[108:111], a[28:31], v[252:255]
    v_mfma_f32_16x16x32_bf16 v[252:255], v[104:107], a[24:27], v[252:255]
    v_mfma_f32_16x16x32_bf16 v[252:255], v[100:103], a[20:23], v[252:255]
    buffer_load_dwordx4 a[100:103], v2, s[28:31], s87 offen offset:1024 sc1
    v_mfma_f32_16x16x32_bf16 v[252:255], v[96:99], a[16:19], v[252:255]
    s_waitcnt lgkmcnt(4)
    v_mfma_f32_16x16x32_bf16 v[184:187], v[64:67], a[64:67], v[184:187]
    ds_read_b128 v[96:99], v10 offset:2048
    ds_read_b128 v[100:103], v10 offset:11264
    v_mfma_f32_16x16x32_bf16 v[184:187], v[68:71], a[68:71], v[184:187]
    v_mfma_f32_16x16x32_bf16 v[184:187], v[72:75], a[72:75], v[184:187]
    s_add_u32 s79, s81, 2064384
    ds_read_b128 v[104:107], v10 offset:20480
    ds_read_b128 v[108:111], v10 offset:29696
    v_mfma_f32_16x16x32_bf16 v[184:187], v[76:79], a[76:79], v[184:187]
    s_add_u32 m0, s88, 2048
    v_mfma_f32_16x16x32_bf16 v[188:191], v[76:79], a[92:95], v[188:191]
    buffer_load_dwordx4 v2, s[28:31], s79 offen offset:0 sc1 lds
    v_mfma_f32_16x16x32_bf16 v[188:191], v[72:75], a[88:91], v[188:191]
    v_mfma_f32_16x16x32_bf16 v[188:191], v[68:71], a[84:87], v[188:191]
    buffer_load_dwordx4 a[104:107], v2, s[28:31], s87 offen offset:2048 sc1
    v_mfma_f32_16x16x32_bf16 v[188:191], v[64:67], a[80:83], v[188:191]
    s_waitcnt lgkmcnt(4)
    v_mfma_f32_16x16x32_bf16 v[192:195], v[80:83], a[64:67], v[192:195]
    ds_read_b128 v[64:67], v10 offset:3072
    ds_read_b128 v[68:71], v10 offset:12288
    v_mfma_f32_16x16x32_bf16 v[192:195], v[84:87], a[68:71], v[192:195]
    v_mfma_f32_16x16x32_bf16 v[192:195], v[88:91], a[72:75], v[192:195]
    ds_read_b128 v[72:75], v10 offset:21504
    ds_read_b128 v[76:79], v10 offset:30720
    v_mfma_f32_16x16x32_bf16 v[192:195], v[92:95], a[76:79], v[192:195]
    buffer_load_dwordx4 v2, s[28:31], s79 offen offset:1024 sc1 lds
    v_mfma_f32_16x16x32_bf16 v[196:199], v[92:95], a[92:95], v[196:199]
    v_mfma_f32_16x16x32_bf16 v[196:199], v[88:91], a[88:91], v[196:199]
    v_mfma_f32_16x16x32_bf16 v[196:199], v[84:87], a[84:87], v[196:199]
    buffer_load_dwordx4 a[108:111], v2, s[28:31], s87 offen offset:3072 sc1
    v_mfma_f32_16x16x32_bf16 v[196:199], v[80:83], a[80:83], v[196:199]
    s_waitcnt lgkmcnt(4)
    v_mfma_f32_16x16x32_bf16 v[200:203], v[96:99], a[64:67], v[200:203]
    ds_read_b128 v[80:83], v10 offset:4096
    ds_read_b128 v[84:87], v10 offset:13312
    v_mfma_f32_16x16x32_bf16 v[200:203], v[100:103], a[68:71], v[200:203]
    v_mfma_f32_16x16x32_bf16 v[200:203], v[104:107], a[72:75], v[200:203]
    s_add_u32 s79, s82, 2064384
    ds_read_b128 v[88:91], v10 offset:22528
    ds_read_b128 v[92:95], v10 offset:31744
    v_mfma_f32_16x16x32_bf16 v[200:203], v[108:111], a[76:79], v[200:203]
    s_add_u32 m0, s88, 4096
    v_mfma_f32_16x16x32_bf16 v[204:207], v[108:111], a[92:95], v[204:207]
    buffer_load_dwordx4 v2, s[28:31], s79 offen offset:0 sc1 lds
    v_mfma_f32_16x16x32_bf16 v[204:207], v[104:107], a[88:91], v[204:207]
    v_mfma_f32_16x16x32_bf16 v[204:207], v[100:103], a[84:87], v[204:207]
    s_add_u32 s87, s86, 2625536
    v_mfma_f32_16x16x32_bf16 v[204:207], v[96:99], a[80:83], v[204:207]
    s_waitcnt lgkmcnt(4)
    buffer_load_dwordx4 a[112:115], v2, s[28:31], s87 offen offset:0 sc1
    v_mfma_f32_16x16x32_bf16 v[208:211], v[64:67], a[64:67], v[208:211]
    ds_read_b128 v[96:99], v10 offset:5120
    ds_read_b128 v[100:103], v10 offset:14336
    v_mfma_f32_16x16x32_bf16 v[208:211], v[68:71], a[68:71], v[208:211]
    v_mfma_f32_16x16x32_bf16 v[208:211], v[72:75], a[72:75], v[208:211]
    ds_read_b128 v[104:107], v10 offset:23552
    ds_read_b128 v[108:111], v10 offset:32768
    v_mfma_f32_16x16x32_bf16 v[208:211], v[76:79], a[76:79], v[208:211]
    buffer_load_dwordx4 v2, s[28:31], s79 offen offset:1024 sc1 lds
    v_mfma_f32_16x16x32_bf16 v[212:215], v[76:79], a[92:95], v[212:215]
    v_mfma_f32_16x16x32_bf16 v[212:215], v[72:75], a[88:91], v[212:215]
    v_mfma_f32_16x16x32_bf16 v[212:215], v[68:71], a[84:87], v[212:215]
    buffer_load_dwordx4 a[116:119], v2, s[28:31], s87 offen offset:1024 sc1
    v_mfma_f32_16x16x32_bf16 v[212:215], v[64:67], a[80:83], v[212:215]
    s_waitcnt lgkmcnt(4)
    v_mfma_f32_16x16x32_bf16 v[216:219], v[80:83], a[64:67], v[216:219]
    ds_read_b128 v[64:67], v10 offset:6144
    ds_read_b128 v[68:71], v10 offset:15360
    v_mfma_f32_16x16x32_bf16 v[216:219], v[84:87], a[68:71], v[216:219]
    v_mfma_f32_16x16x32_bf16 v[216:219], v[88:91], a[72:75], v[216:219]
    s_add_u32 s79, s83, 2064384
    ds_read_b128 v[72:75], v10 offset:24576
    ds_read_b128 v[76:79], v10 offset:33792
    v_mfma_f32_16x16x32_bf16 v[216:219], v[92:95], a[76:79], v[216:219]
    s_add_u32 m0, s88, 6144
    v_mfma_f32_16x16x32_bf16 v[220:223], v[92:95], a[92:95], v[220:223]
    buffer_load_dwordx4 v2, s[28:31], s79 offen offset:0 sc1 lds
    v_mfma_f32_16x16x32_bf16 v[220:223], v[88:91], a[88:91], v[220:223]
    v_mfma_f32_16x16x32_bf16 v[220:223], v[84:87], a[84:87], v[220:223]
    buffer_load_dwordx4 a[120:123], v2, s[28:31], s87 offen offset:2048 sc1
    v_mfma_f32_16x16x32_bf16 v[220:223], v[80:83], a[80:83], v[220:223]
    s_waitcnt lgkmcnt(4)
    v_mfma_f32_16x16x32_bf16 v[224:227], v[96:99], a[64:67], v[224:227]
    ds_read_b128 v[80:83], v10 offset:7168
    ds_read_b128 v[84:87], v10 offset:16384
    v_mfma_f32_16x16x32_bf16 v[224:227], v[100:103], a[68:71], v[224:227]
    v_mfma_f32_16x16x32_bf16 v[224:227], v[104:107], a[72:75], v[224:227]
    ds_read_b128 v[88:91], v10 offset:25600
    ds_read_b128 v[92:95], v10 offset:34816
    v_mfma_f32_16x16x32_bf16 v[224:227], v[108:111], a[76:79], v[224:227]
    buffer_load_dwordx4 v2, s[28:31], s79 offen offset:1024 sc1 lds
    v_mfma_f32_16x16x32_bf16 v[228:231], v[108:111], a[92:95], v[228:231]
    v_mfma_f32_16x16x32_bf16 v[228:231], v[104:107], a[88:91], v[228:231]
    v_mfma_f32_16x16x32_bf16 v[228:231], v[100:103], a[84:87], v[228:231]
    buffer_load_dwordx4 a[124:127], v2, s[28:31], s87 offen offset:3072 sc1
    v_mfma_f32_16x16x32_bf16 v[228:231], v[96:99], a[80:83], v[228:231]
    s_waitcnt lgkmcnt(4)
    v_mfma_f32_16x16x32_bf16 v[232:235], v[64:67], a[64:67], v[232:235]
    ds_read_b128 v[96:99], v10 offset:8192
    ds_read_b128 v[100:103], v10 offset:17408
    v_mfma_f32_16x16x32_bf16 v[232:235], v[68:71], a[68:71], v[232:235]
    v_mfma_f32_16x16x32_bf16 v[232:235], v[72:75], a[72:75], v[232:235]
    s_add_u32 s79, s84, 2064384
    ds_read_b128 v[104:107], v10 offset:26624
    ds_read_b128 v[108:111], v10 offset:35840
    v_mfma_f32_16x16x32_bf16 v[232:235], v[76:79], a[76:79], v[232:235]
    s_add_u32 m0, s88, 8192
    v_mfma_f32_16x16x32_bf16 v[236:239], v[76:79], a[92:95], v[236:239]
    buffer_load_dwordx4 v2, s[28:31], s79 offen offset:0 sc1 lds
    v_mfma_f32_16x16x32_bf16 v[236:239], v[72:75], a[88:91], v[236:239]
    v_mfma_f32_16x16x32_bf16 v[236:239], v[68:71], a[84:87], v[236:239]
    v_mfma_f32_16x16x32_bf16 v[236:239], v[64:67], a[80:83], v[236:239]
    s_waitcnt lgkmcnt(4)
    v_mfma_f32_16x16x32_bf16 v[240:243], v[80:83], a[64:67], v[240:243]
    s_waitcnt vmcnt(17)
    v_add_u32 v10, 36864, v10
    v_mfma_f32_16x16x32_bf16 v[240:243], v[84:87], a[68:71], v[240:243]
    s_barrier
    v_mfma_f32_16x16x32_bf16 v[240:243], v[88:91], a[72:75], v[240:243]
    s_add_u32 s79, s80, 2211840
    ds_read_b128 v[64:67], v10 offset:2048
    ds_read_b128 v[68:71], v10 offset:11264
    v_mfma_f32_16x16x32_bf16 v[240:243], v[92:95], a[76:79], v[240:243]
    s_add_u32 m0, s88, 36864
    v_mfma_f32_16x16x32_bf16 v[244:247], v[92:95], a[92:95], v[244:247]
    ds_read_b128 v[72:75], v10 offset:20480
    ds_read_b128 v[76:79], v10 offset:29696
    v_mfma_f32_16x16x32_bf16 v[244:247], v[88:91], a[88:91], v[244:247]
    buffer_load_dwordx4 v2, s[28:31], s79 offen offset:0 sc1 lds
    v_mfma_f32_16x16x32_bf16 v[244:247], v[84:87], a[84:87], v[244:247]
    s_add_u32 s87, s86, 3145728
    v_mfma_f32_16x16x32_bf16 v[244:247], v[80:83], a[80:83], v[244:247]
    s_waitcnt lgkmcnt(4)
    buffer_load_dwordx4 a[0:3], v2, s[28:31], s87 offen offset:0 sc1
    v_mfma_f32_16x16x32_bf16 v[248:251], v[96:99], a[64:67], v[248:251]
    ds_read_b128 v[80:83], v10 offset:3072
    ds_read_b128 v[84:87], v10 offset:12288
    v_mfma_f32_16x16x32_bf16 v[248:251], v[100:103], a[68:71], v[248:251]
    buffer_load_dwordx4 v2, s[28:31], s79 offen offset:1024 sc1 lds
    v_mfma_f32_16x16x32_bf16 v[248:251], v[104:107], a[72:75], v[248:251]
    ds_read_b128 v[88:91], v10 offset:21504
    ds_read_b128 v[92:95], v10 offset:30720
    v_mfma_f32_16x16x32_bf16 v[248:251], v[108:111], a[76:79], v[248:251]
    buffer_load_dwordx4 a[4:7], v2, s[28:31], s87 offen offset:1024 sc1
    v_mfma_f32_16x16x32_bf16 v[252:255], v[108:111], a[92:95], v[252:255]
    v_mfma_f32_16x16x32_bf16 v[252:255], v[104:107], a[88:91], v[252:255]
    v_mfma_f32_16x16x32_bf16 v[252:255], v[100:103], a[84:87], v[252:255]
    s_add_u32 s79, s81, 2211840
    s_add_u32 m0, s88, 38912
    v_mfma_f32_16x16x32_bf16 v[252:255], v[96:99], a[80:83], v[252:255]
    s_waitcnt lgkmcnt(4)
    buffer_load_dwordx4 v2, s[28:31], s79 offen offset:0 sc1 lds
    v_mfma_f32_16x16x32_bf16 v[200:203], v[64:67], a[32:35], v[200:203]
    ds_read_b128 v[96:99], v10 offset:4096
    ds_read_b128 v[100:103], v10 offset:13312
    v_mfma_f32_16x16x32_bf16 v[200:203], v[68:71], a[36:39], v[200:203]
    buffer_load_dwordx4 a[8:11], v2, s[28:31], s87 offen offset:2048 sc1
    v_mfma_f32_16x16x32_bf16 v[200:203], v[72:75], a[40:43], v[200:203]
    ds_read_b128 v[104:107], v10 offset:22528
    ds_read_b128 v[108:111], v10 offset:31744
    v_mfma_f32_16x16x32_bf16 v[200:203], v[76:79], a[44:47], v[200:203]
    v_mfma_f32_16x16x32_bf16 v[204:207], v[76:79], a[60:63], v[204:207]
    buffer_load_dwordx4 v2, s[28:31], s79 offen offset:1024 sc1 lds
    v_mfma_f32_16x16x32_bf16 v[204:207], v[72:75], a[56:59], v[204:207]
    v_mfma_f32_16x16x32_bf16 v[204:207], v[68:71], a[52:55], v[204:207]
    v_mfma_f32_16x16x32_bf16 v[204:207], v[64:67], a[48:51], v[204:207]
    s_waitcnt lgkmcnt(4)
    buffer_load_dwordx4 a[12:15], v2, s[28:31], s87 offen offset:3072 sc1
    v_mfma_f32_16x16x32_bf16 v[208:211], v[80:83], a[32:35], v[208:211]
    ds_read_b128 v[64:67], v10 offset:5120
    ds_read_b128 v[68:71], v10 offset:14336
    v_mfma_f32_16x16x32_bf16 v[208:211], v[84:87], a[36:39], v[208:211]
    v_mfma_f32_16x16x32_bf16 v[208:211], v[88:91], a[40:43], v[208:211]
    s_add_u32 s79, s82, 2211840
    ds_read_b128 v[72:75], v10 offset:23552
    ds_read_b128 v[76:79], v10 offset:32768
    v_mfma_f32_16x16x32_bf16 v[208:211], v[92:95], a[44:47], v[208:211]
    s_add_u32 m0, s88, 40960
    v_mfma_f32_16x16x32_bf16 v[212:215], v[92:95], a[60:63], v[212:215]
    buffer_load_dwordx4 v2, s[28:31], s79 offen offset:0 sc1 lds
    v_mfma_f32_16x16x32_bf16 v[212:215], v[88:91], a[56:59], v[212:215]
    v_mfma_f32_16x16x32_bf16 v[212:215], v[84:87], a[52:55], v[212:215]
    s_add_u32 s87, s86, 3149824
    v_mfma_f32_16x16x32_bf16 v[212:215], v[80:83], a[48:51], v[212:215]
    s_waitcnt lgkmcnt(4)
    buffer_load_dwordx4 a[16:19], v2, s[28:31], s87 offen offset:0 sc1
    v_mfma_f32_16x16x32_bf16 v[216:219], v[96:99], a[32:35], v[216:219]
    ds_read_b128 v[80:83], v10 offset:6144
    ds_read_b128 v[84:87], v10 offset:15360
    v_mfma_f32_16x16x32_bf16 v[216:219], v[100:103], a[36:39], v[216:219]
    buffer_load_dwordx4 v2, s[28:31], s79 offen offset:1024 sc1 lds
    v_mfma_f32_16x16x32_bf16 v[216:219], v[104:107], a[40:43], v[216:219]
    ds_read_b128 v[88:91], v10 offset:24576
    ds_read_b128 v[92:95], v10 offset:33792
    v_mfma_f32_16x16x32_bf16 v[216:219], v[108:111], a[44:47], v[216:219]
    v_mfma_f32_16x16x32_bf16 v[220:223], v[108:111], a[60:63], v[220:223]
    buffer_load_dwordx4 a[20:23], v2, s[28:31], s87 offen offset:1024 sc1
    v_mfma_f32_16x16x32_bf16 v[220:223], v[104:107], a[56:59], v[220:223]
    v_mfma_f32_16x16x32_bf16 v[220:223], v[100:103], a[52:55], v[220:223]
    v_mfma_f32_16x16x32_bf16 v[220:223], v[96:99], a[48:51], v[220:223]
    s_waitcnt lgkmcnt(4)
    s_add_u32 s79, s83, 2211840
    s_add_u32 m0, s88, 43008
    v_mfma_f32_16x16x32_bf16 v[224:227], v[64:67], a[32:35], v[224:227]
    ds_read_b128 v[96:99], v10 offset:7168
    ds_read_b128 v[100:103], v10 offset:16384
    v_mfma_f32_16x16x32_bf16 v[224:227], v[68:71], a[36:39], v[224:227]
    buffer_load_dwordx4 v2, s[28:31], s79 offen offset:0 sc1 lds
    v_mfma_f32_16x16x32_bf16 v[224:227], v[72:75], a[40:43], v[224:227]
    ds_read_b128 v[104:107], v10 offset:25600
    ds_read_b128 v[108:111], v10 offset:34816
    v_mfma_f32_16x16x32_bf16 v[224:227], v[76:79], a[44:47], v[224:227]
    buffer_load_dwordx4 a[24:27], v2, s[28:31], s87 offen offset:2048 sc1
    v_mfma_f32_16x16x32_bf16 v[228:231], v[76:79], a[60:63], v[228:231]
    v_mfma_f32_16x16x32_bf16 v[228:231], v[72:75], a[56:59], v[228:231]
    buffer_load_dwordx4 v2, s[28:31], s79 offen offset:1024 sc1 lds
    v_mfma_f32_16x16x32_bf16 v[228:231], v[68:71], a[52:55], v[228:231]
    v_mfma_f32_16x16x32_bf16 v[228:231], v[64:67], a[48:51], v[228:231]
    s_waitcnt lgkmcnt(4)
    v_mfma_f32_16x16x32_bf16 v[232:235], v[80:83], a[32:35], v[232:235]
    ds_read_b128 v[64:67], v10 offset:8192
    ds_read_b128 v[68:71], v10 offset:17408
    v_mfma_f32_16x16x32_bf16 v[232:235], v[84:87], a[36:39], v[232:235]
    buffer_load_dwordx4 a[28:31], v2, s[28:31], s87 offen offset:3072 sc1
    v_mfma_f32_16x16x32_bf16 v[232:235], v[88:91], a[40:43], v[232:235]
    ds_read_b128 v[72:75], v10 offset:26624
    ds_read_b128 v[76:79], v10 offset:35840
    v_mfma_f32_16x16x32_bf16 v[232:235], v[92:95], a[44:47], v[232:235]
    s_add_u32 s79, s84, 2211840
    s_add_u32 m0, s88, 45056
    v_mfma_f32_16x16x32_bf16 v[236:239], v[92:95], a[60:63], v[236:239]
    buffer_load_dwordx4 v2, s[28:31], s79 offen offset:0 sc1 lds
    v_mfma_f32_16x16x32_bf16 v[236:239], v[88:91], a[56:59], v[236:239]
    v_mfma_f32_16x16x32_bf16 v[236:239], v[84:87], a[52:55], v[236:239]
    v_mfma_f32_16x16x32_bf16 v[236:239], v[80:83], a[48:51], v[236:239]
    s_waitcnt lgkmcnt(4)
    v_mfma_f32_16x16x32_bf16 v[240:243], v[96:99], a[32:35], v[240:243]
    s_waitcnt vmcnt(17)
    v_subrev_u32 v10, 110592, v10
    v_mfma_f32_16x16x32_bf16 v[240:243], v[100:103], a[36:39], v[240:243]
    s_barrier
    v_mfma_f32_16x16x32_bf16 v[240:243], v[104:107], a[40:43], v[240:243]
    s_add_u32 s79, s80, 2359296
    ds_read_b128 v[80:83], v10 offset:2048
    ds_read_b128 v[84:87], v10 offset:11264
    v_mfma_f32_16x16x32_bf16 v[240:243], v[108:111], a[44:47], v[240:243]
    s_add_u32 m0, s88, 73728
    v_mfma_f32_16x16x32_bf16 v[244:247], v[108:111], a[60:63], v[244:247]
    ds_read_b128 v[88:91], v10 offset:20480
    ds_read_b128 v[92:95], v10 offset:29696
    v_mfma_f32_16x16x32_bf16 v[244:247], v[104:107], a[56:59], v[244:247]
    buffer_load_dwordx4 v2, s[28:31], s79 offen offset:0 sc1 lds
    v_mfma_f32_16x16x32_bf16 v[244:247], v[100:103], a[52:55], v[244:247]
    s_add_u32 s87, s86, 3670016
    v_mfma_f32_16x16x32_bf16 v[244:247], v[96:99], a[48:51], v[244:247]
    s_waitcnt lgkmcnt(4)
    buffer_load_dwordx4 a[64:67], v2, s[28:31], s87 offen offset:0 sc1
    v_mfma_f32_16x16x32_bf16 v[248:251], v[64:67], a[32:35], v[248:251]
    ds_read_b128 v[96:99], v10 offset:3072
    ds_read_b128 v[100:103], v10 offset:12288
    v_mfma_f32_16x16x32_bf16 v[248:251], v[68:71], a[36:39], v[248:251]
    buffer_load_dwordx4 v2, s[28:31], s79 offen offset:1024 sc1 lds
    v_mfma_f32_16x16x32_bf16 v[248:251], v[72:75], a[40:43], v[248:251]
    ds_read_b128 v[104:107], v10 offset:21504
    ds_read_b128 v[108:111], v10 offset:30720
    v_mfma_f32_16x16x32_bf16 v[248:251], v[76:79], a[44:47], v[248:251]
    buffer_load_dwordx4 a[68:71], v2, s[28:31], s87 offen offset:1024 sc1
    v_mfma_f32_16x16x32_bf16 v[252:255], v[76:79], a[60:63], v[252:255]
    v_mfma_f32_16x16x32_bf16 v[252:255], v[72:75], a[56:59], v[252:255]
    v_mfma_f32_16x16x32_bf16 v[252:255], v[68:71], a[52:55], v[252:255]
    s_add_u32 s79, s81, 2359296
    s_add_u32 m0, s88, 75776
    v_mfma_f32_16x16x32_bf16 v[252:255], v[64:67], a[48:51], v[252:255]
    s_waitcnt lgkmcnt(4)
    buffer_load_dwordx4 v2, s[28:31], s79 offen offset:0 sc1 lds
    v_mfma_f32_16x16x32_bf16 v[200:203], v[80:83], a[96:99], v[200:203]
    ds_read_b128 v[64:67], v10 offset:4096
    ds_read_b128 v[68:71], v10 offset:13312
    v_mfma_f32_16x16x32_bf16 v[200:203], v[84:87], a[100:103], v[200:203]
    buffer_load_dwordx4 a[72:75], v2, s[28:31], s87 offen offset:2048 sc1
    v_mfma_f32_16x16x32_bf16 v[200:203], v[88:91], a[104:107], v[200:203]
    ds_read_b128 v[72:75], v10 offset:22528
    ds_read_b128 v[76:79], v10 offset:31744
    v_mfma_f32_16x16x32_bf16 v[200:203], v[92:95], a[108:111], v[200:203]
    v_mfma_f32_16x16x32_bf16 v[204:207], v[92:95], a[124:127], v[204:207]
    buffer_load_dwordx4 v2, s[28:31], s79 offen offset:1024 sc1 lds
    v_mfma_f32_16x16x32_bf16 v[204:207], v[88:91], a[120:123], v[204:207]
    v_mfma_f32_16x16x32_bf16 v[204:207], v[84:87], a[116:119], v[204:207]
    v_mfma_f32_16x16x32_bf16 v[204:207], v[80:83], a[112:115], v[204:207]
    s_waitcnt lgkmcnt(4)
    buffer_load_dwordx4 a[76:79], v2, s[28:31], s87 offen offset:3072 sc1
    v_mfma_f32_16x16x32_bf16 v[208:211], v[96:99], a[96:99], v[208:211]
    ds_read_b128 v[80:83], v10 offset:5120
    ds_read_b128 v[84:87], v10 offset:14336
    v_mfma_f32_16x16x32_bf16 v[208:211], v[100:103], a[100:103], v[208:211]
    v_mfma_f32_16x16x32_bf16 v[208:211], v[104:107], a[104:107], v[208:211]
    s_add_u32 s79, s82, 2359296
    ds_read_b128 v[88:91], v10 offset:23552
    ds_read_b128 v[92:95], v10 offset:32768
    v_mfma_f32_16x16x32_bf16 v[208:211], v[108:111], a[108:111], v[208:211]
    s_add_u32 m0, s88, 77824
    v_mfma_f32_16x16x32_bf16 v[212:215], v[108:111], a[124:127], v[212:215]
    buffer_load_dwordx4 v2, s[28:31], s79 offen offset:0 sc1 lds
    v_mfma_f32_16x16x32_bf16 v[212:215], v[104:107], a[120:123], v[212:215]
    v_mfma_f32_16x16x32_bf16 v[212:215], v[100:103], a[116:119], v[212:215]
    s_add_u32 s87, s86, 3674112
    v_mfma_f32_16x16x32_bf16 v[212:215], v[96:99], a[112:115], v[212:215]
    s_waitcnt lgkmcnt(4)
    buffer_load_dwordx4 a[80:83], v2, s[28:31], s87 offen offset:0 sc1
    v_mfma_f32_16x16x32_bf16 v[216:219], v[64:67], a[96:99], v[216:219]
    ds_read_b128 v[96:99], v10 offset:6144
    ds_read_b128 v[100:103], v10 offset:15360
    v_mfma_f32_16x16x32_bf16 v[216:219], v[68:71], a[100:103], v[216:219]
    buffer_load_dwordx4 v2, s[28:31], s79 offen offset:1024 sc1 lds
    v_mfma_f32_16x16x32_bf16 v[216:219], v[72:75], a[104:107], v[216:219]
    ds_read_b128 v[104:107], v10 offset:24576
    ds_read_b128 v[108:111], v10 offset:33792
    v_mfma_f32_16x16x32_bf16 v[216:219], v[76:79], a[108:111], v[216:219]
    v_mfma_f32_16x16x32_bf16 v[220:223], v[76:79], a[124:127], v[220:223]
    buffer_load_dwordx4 a[84:87], v2, s[28:31], s87 offen offset:1024 sc1
    v_mfma_f32_16x16x32_bf16 v[220:223], v[72:75], a[120:123], v[220:223]
    v_mfma_f32_16x16x32_bf16 v[220:223], v[68:71], a[116:119], v[220:223]
    v_mfma_f32_16x16x32_bf16 v[220:223], v[64:67], a[112:115], v[220:223]
    s_waitcnt lgkmcnt(4)
    s_add_u32 s79, s83, 2359296
    s_add_u32 m0, s88, 79872
    v_mfma_f32_16x16x32_bf16 v[224:227], v[80:83], a[96:99], v[224:227]
    ds_read_b128 v[64:67], v10 offset:7168
    ds_read_b128 v[68:71], v10 offset:16384
    v_mfma_f32_16x16x32_bf16 v[224:227], v[84:87], a[100:103], v[224:227]
    buffer_load_dwordx4 v2, s[28:31], s79 offen offset:0 sc1 lds
    v_mfma_f32_16x16x32_bf16 v[224:227], v[88:91], a[104:107], v[224:227]
    ds_read_b128 v[72:75], v10 offset:25600
    ds_read_b128 v[76:79], v10 offset:34816
    v_mfma_f32_16x16x32_bf16 v[224:227], v[92:95], a[108:111], v[224:227]
    buffer_load_dwordx4 a[88:91], v2, s[28:31], s87 offen offset:2048 sc1
    v_mfma_f32_16x16x32_bf16 v[228:231], v[92:95], a[124:127], v[228:231]
    v_mfma_f32_16x16x32_bf16 v[228:231], v[88:91], a[120:123], v[228:231]
    buffer_load_dwordx4 v2, s[28:31], s79 offen offset:1024 sc1 lds
    v_mfma_f32_16x16x32_bf16 v[228:231], v[84:87], a[116:119], v[228:231]
    v_mfma_f32_16x16x32_bf16 v[228:231], v[80:83], a[112:115], v[228:231]
    s_waitcnt lgkmcnt(4)
    v_mfma_f32_16x16x32_bf16 v[232:235], v[96:99], a[96:99], v[232:235]
    ds_read_b128 v[80:83], v10 offset:8192
    ds_read_b128 v[84:87], v10 offset:17408
    v_mfma_f32_16x16x32_bf16 v[232:235], v[100:103], a[100:103], v[232:235]
    buffer_load_dwordx4 a[92:95], v2, s[28:31], s87 offen offset:3072 sc1
    v_mfma_f32_16x16x32_bf16 v[232:235], v[104:107], a[104:107], v[232:235]
    ds_read_b128 v[88:91], v10 offset:26624
    ds_read_b128 v[92:95], v10 offset:35840
    v_mfma_f32_16x16x32_bf16 v[232:235], v[108:111], a[108:111], v[232:235]
    s_add_u32 s79, s84, 2359296
    s_add_u32 m0, s88, 81920
    v_mfma_f32_16x16x32_bf16 v[236:239], v[108:111], a[124:127], v[236:239]
    buffer_load_dwordx4 v2, s[28:31], s79 offen offset:0 sc1 lds
    v_mfma_f32_16x16x32_bf16 v[236:239], v[104:107], a[120:123], v[236:239]
    v_mfma_f32_16x16x32_bf16 v[236:239], v[100:103], a[116:119], v[236:239]
    v_mfma_f32_16x16x32_bf16 v[236:239], v[96:99], a[112:115], v[236:239]
    s_waitcnt lgkmcnt(4)
    v_mfma_f32_16x16x32_bf16 v[240:243], v[64:67], a[96:99], v[240:243]
    s_waitcnt vmcnt(17)
    v_add_u32 v10, 36864, v10
    v_cvt_pk_bf16_f32 v36, v128, v129
    v_mfma_f32_16x16x32_bf16 v[240:243], v[68:71], a[100:103], v[240:243]
    s_barrier
    v_cvt_pk_bf16_f32 v37, v130, v131
    v_cvt_pk_bf16_f32 v38, v132, v133
    v_mfma_f32_16x16x32_bf16 v[240:243], v[72:75], a[104:107], v[240:243]
    ds_read_b128 v[96:99], v10 offset:2048
    ds_read_b128 v[100:103], v10 offset:11264
    v_mfma_f32_16x16x32_bf16 v[240:243], v[76:79], a[108:111], v[240:243]
    v_cvt_pk_bf16_f32 v39, v134, v135
    v_mfma_f32_16x16x32_bf16 v[244:247], v[76:79], a[124:127], v[244:247]
    ds_read_b128 v[104:107], v10 offset:20480
    ds_read_b128 v[108:111], v10 offset:29696
    v_mfma_f32_16x16x32_bf16 v[244:247], v[72:75], a[120:123], v[244:247]
    buffer_store_dwordx4 v[36:39], v2, s[28:31], s92 offen offset:0 sc1
    v_cvt_pk_bf16_f32 v40, v136, v137
    v_mfma_f32_16x16x32_bf16 v[244:247], v[68:71], a[116:119], v[244:247]
    v_cvt_pk_bf16_f32 v41, v138, v139
    v_cvt_pk_bf16_f32 v42, v140, v141
    v_mfma_f32_16x16x32_bf16 v[244:247], v[64:67], a[112:115], v[244:247]
    s_waitcnt lgkmcnt(4)
    v_cvt_pk_bf16_f32 v43, v142, v143
    v_mfma_f32_16x16x32_bf16 v[248:251], v[80:83], a[96:99], v[248:251]
    ds_read_b128 v[64:67], v10 offset:3072
    ds_read_b128 v[68:71], v10 offset:12288
    v_mfma_f32_16x16x32_bf16 v[248:251], v[84:87], a[100:103], v[248:251]
    buffer_store_dwordx4 v[40:43], v2, s[28:31], s92 offen offset:1024 sc1
    v_cvt_pk_bf16_f32 v44, v144, v145
    v_mfma_f32_16x16x32_bf16 v[248:251], v[88:91], a[104:107], v[248:251]
    ds_read_b128 v[72:75], v10 offset:21504
    ds_read_b128 v[76:79], v10 offset:30720
    v_mfma_f32_16x16x32_bf16 v[248:251], v[92:95], a[108:111], v[248:251]
    v_cvt_pk_bf16_f32 v45, v146, v147
    v_cvt_pk_bf16_f32 v46, v148, v149
    v_mfma_f32_16x16x32_bf16 v[252:255], v[92:95], a[124:127], v[252:255]
    v_cvt_pk_bf16_f32 v47, v150, v151
    v_mfma_f32_16x16x32_bf16 v[252:255], v[88:91], a[120:123], v[252:255]
    buffer_store_dwordx4 v[44:47], v2, s[28:31], s93 offen offset:0 sc1
    v_cvt_pk_bf16_f32 v36, v152, v153
    v_mfma_f32_16x16x32_bf16 v[252:255], v[84:87], a[116:119], v[252:255]
    v_cvt_pk_bf16_f32 v37, v154, v155
    v_cvt_pk_bf16_f32 v38, v156, v157
    v_mfma_f32_16x16x32_bf16 v[252:255], v[80:83], a[112:115], v[252:255]
    s_waitcnt lgkmcnt(4)
    v_cvt_pk_bf16_f32 v39, v158, v159
    v_mfma_f32_16x16x32_bf16 v[200:203], v[96:99], a[0:3], v[200:203]
    ds_read_b128 v[80:83], v10 offset:4096
    ds_read_b128 v[84:87], v10 offset:13312
    v_mfma_f32_16x16x32_bf16 v[200:203], v[100:103], a[4:7], v[200:203]
    buffer_store_dwordx4 v[36:39], v2, s[28:31], s93 offen offset:1024 sc1
    v_cvt_pk_bf16_f32 v40, v160, v161
    v_mfma_f32_16x16x32_bf16 v[200:203], v[104:107], a[8:11], v[200:203]
    ds_read_b128 v[88:91], v10 offset:22528
    ds_read_b128 v[92:95], v10 offset:31744
    v_mfma_f32_16x16x32_bf16 v[200:203], v[108:111], a[12:15], v[200:203]
    v_cvt_pk_bf16_f32 v41, v162, v163
    v_cvt_pk_bf16_f32 v42, v164, v165
    v_mfma_f32_16x16x32_bf16 v[204:207], v[108:111], a[28:31], v[204:207]
    v_cvt_pk_bf16_f32 v43, v166, v167
    v_mfma_f32_16x16x32_bf16 v[204:207], v[104:107], a[24:27], v[204:207]
    buffer_store_dwordx4 v[40:43], v2, s[28:31], s94 offen offset:0 sc1
    v_cvt_pk_bf16_f32 v44, v168, v169
    v_mfma_f32_16x16x32_bf16 v[204:207], v[100:103], a[20:23], v[204:207]
    v_cvt_pk_bf16_f32 v45, v170, v171
    v_cvt_pk_bf16_f32 v46, v172, v173
    v_mfma_f32_16x16x32_bf16 v[204:207], v[96:99], a[16:19], v[204:207]
    s_waitcnt lgkmcnt(4)
    v_cvt_pk_bf16_f32 v47, v174, v175
    v_mfma_f32_16x16x32_bf16 v[208:211], v[64:67], a[0:3], v[208:211]
    ds_read_b128 v[96:99], v10 offset:5120
    ds_read_b128 v[100:103], v10 offset:14336
    v_mfma_f32_16x16x32_bf16 v[208:211], v[68:71], a[4:7], v[208:211]
    buffer_store_dwordx4 v[44:47], v2, s[28:31], s94 offen offset:1024 sc1
    v_cvt_pk_bf16_f32 v36, v176, v177
    v_mfma_f32_16x16x32_bf16 v[208:211], v[72:75], a[8:11], v[208:211]
    ds_read_b128 v[104:107], v10 offset:23552
    ds_read_b128 v[108:111], v10 offset:32768
    v_mfma_f32_16x16x32_bf16 v[208:211], v[76:79], a[12:15], v[208:211]
    v_cvt_pk_bf16_f32 v37, v178, v179
    v_cvt_pk_bf16_f32 v38, v180, v181
    v_mfma_f32_16x16x32_bf16 v[212:215], v[76:79], a[28:31], v[212:215]
    v_cvt_pk_bf16_f32 v39, v182, v183
    v_mfma_f32_16x16x32_bf16 v[212:215], v[72:75], a[24:27], v[212:215]
    buffer_store_dwordx4 v[36:39], v2, s[28:31], s95 offen offset:0 sc1
    v_mfma_f32_16x16x32_bf16 v[212:215], v[68:71], a[20:23], v[212:215]
    v_mfma_f32_16x16x32_bf16 v[212:215], v[64:67], a[16:19], v[212:215]
    s_waitcnt lgkmcnt(4)
    v_mfma_f32_16x16x32_bf16 v[216:219], v[80:83], a[0:3], v[216:219]
    ds_read_b128 v[64:67], v10 offset:6144
    ds_read_b128 v[68:71], v10 offset:15360
    v_mfma_f32_16x16x32_bf16 v[216:219], v[84:87], a[4:7], v[216:219]
    v_mfma_f32_16x16x32_bf16 v[216:219], v[88:91], a[8:11], v[216:219]
    ds_read_b128 v[72:75], v10 offset:24576
    ds_read_b128 v[76:79], v10 offset:33792
    v_mfma_f32_16x16x32_bf16 v[216:219], v[92:95], a[12:15], v[216:219]
    v_mfma_f32_16x16x32_bf16 v[220:223], v[92:95], a[28:31], v[220:223]
    v_mfma_f32_16x16x32_bf16 v[220:223], v[88:91], a[24:27], v[220:223]
    v_mfma_f32_16x16x32_bf16 v[220:223], v[84:87], a[20:23], v[220:223]
    v_mfma_f32_16x16x32_bf16 v[220:223], v[80:83], a[16:19], v[220:223]
    s_waitcnt lgkmcnt(4)
    v_mfma_f32_16x16x32_bf16 v[224:227], v[96:99], a[0:3], v[224:227]
    ds_read_b128 v[80:83], v10 offset:7168
    ds_read_b128 v[84:87], v10 offset:16384
    v_mfma_f32_16x16x32_bf16 v[224:227], v[100:103], a[4:7], v[224:227]
    v_mfma_f32_16x16x32_bf16 v[224:227], v[104:107], a[8:11], v[224:227]
    ds_read_b128 v[88:91], v10 offset:25600
    ds_read_b128 v[92:95], v10 offset:34816
    v_mfma_f32_16x16x32_bf16 v[224:227], v[108:111], a[12:15], v[224:227]
    v_mfma_f32_16x16x32_bf16 v[228:231], v[108:111], a[28:31], v[228:231]
    v_mfma_f32_16x16x32_bf16 v[228:231], v[104:107], a[24:27], v[228:231]
    v_mfma_f32_16x16x32_bf16 v[228:231], v[100:103], a[20:23], v[228:231]
    v_mfma_f32_16x16x32_bf16 v[228:231], v[96:99], a[16:19], v[228:231]
    s_waitcnt lgkmcnt(4)
    v_mfma_f32_16x16x32_bf16 v[232:235], v[64:67], a[0:3], v[232:235]
    ds_read_b128 v[96:99], v10 offset:8192
    ds_read_b128 v[100:103], v10 offset:17408
    v_mfma_f32_16x16x32_bf16 v[232:235], v[68:71], a[4:7], v[232:235]
    v_mfma_f32_16x16x32_bf16 v[232:235], v[72:75], a[8:11], v[232:235]
    ds_read_b128 v[104:107], v10 offset:26624
    ds_read_b128 v[108:111], v10 offset:35840
    v_mfma_f32_16x16x32_bf16 v[232:235], v[76:79], a[12:15], v[232:235]
    v_mfma_f32_16x16x32_bf16 v[236:239], v[76:79], a[28:31], v[236:239]
    v_mfma_f32_16x16x32_bf16 v[236:239], v[72:75], a[24:27], v[236:239]
    v_mfma_f32_16x16x32_bf16 v[236:239], v[68:71], a[20:23], v[236:239]
    v_mfma_f32_16x16x32_bf16 v[236:239], v[64:67], a[16:19], v[236:239]
    s_waitcnt lgkmcnt(4)
    v_mfma_f32_16x16x32_bf16 v[240:243], v[80:83], a[0:3], v[240:243]
    s_waitcnt vmcnt(7)
    v_add_u32 v10, 36864, v10
    v_mfma_f32_16x16x32_bf16 v[240:243], v[84:87], a[4:7], v[240:243]
    s_barrier
    v_mfma_f32_16x16x32_bf16 v[240:243], v[88:91], a[8:11], v[240:243]
    ds_read_b128 v[64:67], v10 offset:2048
    ds_read_b128 v[68:71], v10 offset:11264
    v_mfma_f32_16x16x32_bf16 v[240:243], v[92:95], a[12:15], v[240:243]
    v_mfma_f32_16x16x32_bf16 v[244:247], v[92:95], a[28:31], v[244:247]
    ds_read_b128 v[72:75], v10 offset:20480
    ds_read_b128 v[76:79], v10 offset:29696
    v_mfma_f32_16x16x32_bf16 v[244:247], v[88:91], a[24:27], v[244:247]
    v_mfma_f32_16x16x32_bf16 v[244:247], v[84:87], a[20:23], v[244:247]
    buffer_load_dword v60, v19, s[28:31], s73 offen sc1
    v_mfma_f32_16x16x32_bf16 v[244:247], v[80:83], a[16:19], v[244:247]
    s_waitcnt lgkmcnt(4)
    v_mfma_f32_16x16x32_bf16 v[248:251], v[96:99], a[0:3], v[248:251]
    ds_read_b128 v[80:83], v10 offset:3072
    ds_read_b128 v[84:87], v10 offset:12288
    v_mfma_f32_16x16x32_bf16 v[248:251], v[100:103], a[4:7], v[248:251]
    v_mfma_f32_16x16x32_bf16 v[248:251], v[104:107], a[8:11], v[248:251]
    ds_read_b128 v[88:91], v10 offset:21504
    ds_read_b128 v[92:95], v10 offset:30720
    v_mfma_f32_16x16x32_bf16 v[248:251], v[108:111], a[12:15], v[248:251]
    v_mfma_f32_16x16x32_bf16 v[252:255], v[108:111], a[28:31], v[252:255]
    v_mfma_f32_16x16x32_bf16 v[252:255], v[104:107], a[24:27], v[252:255]
    v_mfma_f32_16x16x32_bf16 v[252:255], v[100:103], a[20:23], v[252:255]
    v_mfma_f32_16x16x32_bf16 v[252:255], v[96:99], a[16:19], v[252:255]
    s_waitcnt lgkmcnt(4)
    v_mfma_f32_16x16x32_bf16 v[200:203], v[64:67], a[64:67], v[200:203]
    ds_read_b128 v[96:99], v10 offset:4096
    ds_read_b128 v[100:103], v10 offset:13312
    v_mfma_f32_16x16x32_bf16 v[200:203], v[68:71], a[68:71], v[200:203]
    v_mfma_f32_16x16x32_bf16 v[200:203], v[72:75], a[72:75], v[200:203]
    ds_read_b128 v[104:107], v10 offset:22528
    ds_read_b128 v[108:111], v10 offset:31744
    v_mfma_f32_16x16x32_bf16 v[200:203], v[76:79], a[76:79], v[200:203]
    v_mfma_f32_16x16x32_bf16 v[204:207], v[76:79], a[92:95], v[204:207]
    v_mfma_f32_16x16x32_bf16 v[204:207], v[72:75], a[88:91], v[204:207]
    v_mfma_f32_16x16x32_bf16 v[204:207], v[68:71], a[84:87], v[204:207]
    v_mfma_f32_16x16x32_bf16 v[204:207], v[64:67], a[80:83], v[204:207]
    s_waitcnt lgkmcnt(4)
    s_waitcnt vmcnt(1)
    v_mfma_f32_16x16x32_bf16 v[208:211], v[80:83], a[64:67], v[208:211]
    ds_read_b128 v[64:67], v10 offset:5120
    ds_read_b128 v[68:71], v10 offset:14336
    v_mfma_f32_16x16x32_bf16 v[208:211], v[84:87], a[68:71], v[208:211]
    s_mov_b64 exec, 7
    buffer_store_dword v12, v11, s[28:31], s74 offen sc1
    s_mov_b64 exec, -1
    v_mfma_f32_16x16x32_bf16 v[208:211], v[88:91], a[72:75], v[208:211]
    s_add_u32 s92, s92, 3072
    ds_read_b128 v[72:75], v10 offset:23552
    ds_read_b128 v[76:79], v10 offset:32768
    v_mfma_f32_16x16x32_bf16 v[208:211], v[92:95], a[76:79], v[208:211]
    v_cvt_pk_bf16_f32 v36, v200, v201
    v_cvt_pk_bf16_f32 v37, v202, v203
    v_mfma_f32_16x16x32_bf16 v[212:215], v[92:95], a[92:95], v[212:215]
    v_cvt_pk_bf16_f32 v38, v204, v205
    v_cvt_pk_bf16_f32 v39, v206, v207
    v_mfma_f32_16x16x32_bf16 v[212:215], v[88:91], a[88:91], v[212:215]
    buffer_store_dwordx4 v[36:39], v2, s[28:31], s92 offen offset:0 sc1
    v_mfma_f32_16x16x32_bf16 v[212:215], v[84:87], a[84:87], v[212:215]
    v_mfma_f32_16x16x32_bf16 v[212:215], v[80:83], a[80:83], v[212:215]
    s_waitcnt lgkmcnt(4)
    v_mfma_f32_16x16x32_bf16 v[216:219], v[96:99], a[64:67], v[216:219]
    ds_read_b128 v[80:83], v10 offset:6144
    ds_read_b128 v[84:87], v10 offset:15360
    v_mfma_f32_16x16x32_bf16 v[216:219], v[100:103], a[68:71], v[216:219]
    v_mfma_f32_16x16x32_bf16 v[216:219], v[104:107], a[72:75], v[216:219]
    ds_read_b128 v[88:91], v10 offset:24576
    ds_read_b128 v[92:95], v10 offset:33792
    v_mfma_f32_16x16x32_bf16 v[216:219], v[108:111], a[76:79], v[216:219]
    v_cvt_pk_bf16_f32 v40, v208, v209
    v_cvt_pk_bf16_f32 v41, v210, v211
    v_mfma_f32_16x16x32_bf16 v[220:223], v[108:111], a[92:95], v[220:223]
    v_cvt_pk_bf16_f32 v42, v212, v213
    v_cvt_pk_bf16_f32 v43, v214, v215
    v_mfma_f32_16x16x32_bf16 v[220:223], v[104:107], a[88:91], v[220:223]
    buffer_store_dwordx4 v[40:43], v2, s[28:31], s92 offen offset:1024 sc1
    v_mfma_f32_16x16x32_bf16 v[220:223], v[100:103], a[84:87], v[220:223]
    v_mfma_f32_16x16x32_bf16 v[220:223], v[96:99], a[80:83], v[220:223]
    s_waitcnt lgkmcnt(4)
    v_mfma_f32_16x16x32_bf16 v[224:227], v[64:67], a[64:67], v[224:227]
    ds_read_b128 v[96:99], v10 offset:7168
    ds_read_b128 v[100:103], v10 offset:16384
    v_mfma_f32_16x16x32_bf16 v[224:227], v[68:71], a[68:71], v[224:227]
    v_mfma_f32_16x16x32_bf16 v[224:227], v[72:75], a[72:75], v[224:227]
    s_add_u32 s93, s93, 3072
    ds_read_b128 v[104:107], v10 offset:25600
    ds_read_b128 v[108:111], v10 offset:34816
    v_mfma_f32_16x16x32_bf16 v[224:227], v[76:79], a[76:79], v[224:227]
    v_cvt_pk_bf16_f32 v44, v216, v217
    v_cvt_pk_bf16_f32 v45, v218, v219
    v_mfma_f32_16x16x32_bf16 v[228:231], v[76:79], a[92:95], v[228:231]
    v_cvt_pk_bf16_f32 v46, v220, v221
    v_cvt_pk_bf16_f32 v47, v222, v223
    v_mfma_f32_16x16x32_bf16 v[228:231], v[72:75], a[88:91], v[228:231]
    buffer_store_dwordx4 v[44:47], v2, s[28:31], s93 offen offset:0 sc1
    v_mfma_f32_16x16x32_bf16 v[228:231], v[68:71], a[84:87], v[228:231]
    s_waitcnt vmcnt(3)
    v_cmp_eq_u32 vcc, 0, v60
    v_mfma_f32_16x16x32_bf16 v[228:231], v[64:67], a[80:83], v[228:231]
    s_waitcnt lgkmcnt(4)
    v_mfma_f32_16x16x32_bf16 v[232:235], v[80:83], a[64:67], v[232:235]
    s_mov_b32 s70, 0
    s_cmp_eq_u64 vcc, 0
    s_cbranch_scc0 L_probe_no1
    s_mov_b32 s70, 1
    s_add_u32 s64, s90, 0
    buffer_load_dwordx4 a[136:139], v2, s[28:31], s64 offen offset:0 sc1
    buffer_load_dwordx4 a[140:143], v2, s[28:31], s64 offen offset:1024 sc1
    s_add_u32 s64, s91, 0
    buffer_load_dwordx4 a[144:147], v2, s[28:31], s64 offen offset:0 sc1
    s_add_u32 s64, s90, 6144
    buffer_load_dwordx4 a[148:151], v2, s[28:31], s64 offen offset:0 sc1
    buffer_load_dwordx4 a[152:155], v2, s[28:31], s64 offen offset:1024 sc1
    s_add_u32 s64, s91, 6144
    buffer_load_dwordx4 a[156:159], v2, s[28:31], s64 offen offset:0 sc1
    s_add_u32 s64, s90, 12288
    buffer_load_dwordx4 a[160:163], v2, s[28:31], s64 offen offset:0 sc1
    buffer_load_dwordx4 a[164:167], v2, s[28:31], s64 offen offset:1024 sc1
    s_add_u32 s64, s91, 12288
    buffer_load_dwordx4 a[168:171], v2, s[28:31], s64 offen offset:0 sc1
L_probe_no1:
    ds_read_b128 v[64:67], v10 offset:8192
    ds_read_b128 v[68:71], v10 offset:17408
    v_mfma_f32_16x16x32_bf16 v[232:235], v[84:87], a[68:71], v[232:235]
    s_add_u32 s68, s90, 5116
    buffer_load_dword v61, v62, s[28:31], s68 offen sc1
    v_mfma_f32_16x16x32_bf16 v[232:235], v[88:91], a[72:75], v[232:235]
    ds_read_b128 v[72:75], v10 offset:26624
    ds_read_b128 v[76:79], v10 offset:35840
    v_mfma_f32_16x16x32_bf16 v[232:235], v[92:95], a[76:79], v[232:235]
    v_cvt_pk_bf16_f32 v36, v224, v225
    v_cvt_pk_bf16_f32 v37, v226, v227
    v_mfma_f32_16x16x32_bf16 v[236:239], v[92:95], a[92:95], v[236:239]
    v_cvt_pk_bf16_f32 v38, v228, v229
    v_cvt_pk_bf16_f32 v39, v230, v231
    v_mfma_f32_16x16x32_bf16 v[236:239], v[88:91], a[88:91], v[236:239]
    buffer_store_dwordx4 v[36:39], v2, s[28:31], s93 offen offset:1024 sc1
    v_mfma_f32_16x16x32_bf16 v[236:239], v[84:87], a[84:87], v[236:239]
    v_mfma_f32_16x16x32_bf16 v[236:239], v[80:83], a[80:83], v[236:239]
    s_waitcnt lgkmcnt(4)
    v_add_u32 v10, 36864, v10
    v_mfma_f32_16x16x32_bf16 v[240:243], v[96:99], a[64:67], v[240:243]
    ds_read_b128 v[80:83], v10 offset:0
    ds_read_b128 v[84:87], v10 offset:9216
    v_mfma_f32_16x16x32_bf16 v[240:243], v[100:103], a[68:71], v[240:243]
    v_mfma_f32_16x16x32_bf16 v[240:243], v[104:107], a[72:75], v[240:243]
    s_add_u32 s94, s94, 3072
    ds_read_b128 v[88:91], v10 offset:18432
    ds_read_b128 v[92:95], v10 offset:27648
    v_mfma_f32_16x16x32_bf16 v[240:243], v[108:111], a[76:79], v[240:243]
    v_cvt_pk_bf16_f32 v40, v232, v233
    v_cvt_pk_bf16_f32 v41, v234, v235
    v_mfma_f32_16x16x32_bf16 v[244:247], v[108:111], a[92:95], v[244:247]
    v_cvt_pk_bf16_f32 v42, v236, v237
    v_cvt_pk_bf16_f32 v43, v238, v239
    v_mfma_f32_16x16x32_bf16 v[244:247], v[104:107], a[88:91], v[244:247]
    buffer_store_dwordx4 v[40:43], v2, s[28:31], s94 offen offset:0 sc1
    v_mfma_f32_16x16x32_bf16 v[244:247], v[100:103], a[84:87], v[244:247]
    v_mfma_f32_16x16x32_bf16 v[244:247], v[96:99], a[80:83], v[244:247]
    s_waitcnt lgkmcnt(4)
    v_subrev_u32 v10, 110592, v10
    v_mfma_f32_16x16x32_bf16 v[248:251], v[64:67], a[64:67], v[248:251]
    ds_read_b128 v[96:99], v10 offset:0
    ds_read_b128 v[100:103], v10 offset:9216
    v_mfma_f32_16x16x32_bf16 v[248:251], v[68:71], a[68:71], v[248:251]
    v_mfma_f32_16x16x32_bf16 v[248:251], v[72:75], a[72:75], v[248:251]
    ds_read_b128 v[104:107], v10 offset:18432
    ds_read_b128 v[108:111], v10 offset:27648
    v_mfma_f32_16x16x32_bf16 v[248:251], v[76:79], a[76:79], v[248:251]
    v_cvt_pk_bf16_f32 v44, v240, v241
    v_cvt_pk_bf16_f32 v45, v242, v243
    v_mfma_f32_16x16x32_bf16 v[252:255], v[76:79], a[92:95], v[252:255]
    v_cvt_pk_bf16_f32 v46, v244, v245
    v_cvt_pk_bf16_f32 v47, v246, v247
    v_mfma_f32_16x16x32_bf16 v[252:255], v[72:75], a[88:91], v[252:255]
    buffer_store_dwordx4 v[44:47], v2, s[28:31], s94 offen offset:1024 sc1
    v_mfma_f32_16x16x32_bf16 v[252:255], v[68:71], a[84:87], v[252:255]
    v_mfma_f32_16x16x32_bf16 v[252:255], v[64:67], a[80:83], v[252:255]
    s_waitcnt lgkmcnt(4)
    v_add_u32 v10, 36864, v10
    v_mfma_f32_16x16x32_bf16 v[184:187], v[80:83], a[32:35], v[184:187]
    ds_read_b128 v[64:67], v10 offset:0
    ds_read_b128 v[68:71], v10 offset:9216
    v_mfma_f32_16x16x32_bf16 v[184:187], v[84:87], a[36:39], v[184:187]
    v_mfma_f32_16x16x32_bf16 v[184:187], v[88:91], a[40:43], v[184:187]
    s_add_u32 s95, s95, 3072
    ds_read_b128 v[72:75], v10 offset:18432
    ds_read_b128 v[76:79], v10 offset:27648
    v_mfma_f32_16x16x32_bf16 v[184:187], v[92:95], a[44:47], v[184:187]
    v_cvt_pk_bf16_f32 v36, v248, v249
    v_cvt_pk_bf16_f32 v37, v250, v251
    v_mfma_f32_16x16x32_bf16 v[188:191], v[92:95], a[60:63], v[188:191]
    v_cvt_pk_bf16_f32 v38, v252, v253
    v_cvt_pk_bf16_f32 v39, v254, v255
    v_mfma_f32_16x16x32_bf16 v[188:191], v[88:91], a[56:59], v[188:191]
    buffer_store_dwordx4 v[36:39], v2, s[28:31], s95 offen offset:0 sc1
    v_mfma_f32_16x16x32_bf16 v[188:191], v[84:87], a[52:55], v[188:191]
    v_mfma_f32_16x16x32_bf16 v[188:191], v[80:83], a[48:51], v[188:191]
    s_waitcnt lgkmcnt(4)
    v_add_u32 v10, 36864, v10
    v_mfma_f32_16x16x32_bf16 v[184:187], v[96:99], a[96:99], v[184:187]
    ds_read_b128 v[80:83], v10 offset:0
    ds_read_b128 v[84:87], v10 offset:9216
    v_mfma_f32_16x16x32_bf16 v[184:187], v[100:103], a[100:103], v[184:187]
    v_mfma_f32_16x16x32_bf16 v[184:187], v[104:107], a[104:107], v[184:187]
    ds_read_b128 v[88:91], v10 offset:18432
    ds_read_b128 v[92:95], v10 offset:27648
    v_mfma_f32_16x16x32_bf16 v[184:187], v[108:111], a[108:111], v[184:187]
    v_mfma_f32_16x16x32_bf16 v[188:191], v[108:111], a[124:127], v[188:191]
    v_mfma_f32_16x16x32_bf16 v[188:191], v[104:107], a[120:123], v[188:191]
    v_mfma_f32_16x16x32_bf16 v[188:191], v[100:103], a[116:119], v[188:191]
    v_mfma_f32_16x16x32_bf16 v[188:191], v[96:99], a[112:115], v[188:191]
    s_waitcnt lgkmcnt(4)
    v_add_u32 v10, 36864, v10
    v_mfma_f32_16x16x32_bf16 v[184:187], v[64:67], a[0:3], v[184:187]
    ds_read_b128 v[96:99], v10 offset:1024
    ds_read_b128 v[100:103], v10 offset:10240
    v_mfma_f32_16x16x32_bf16 v[184:187], v[68:71], a[4:7], v[184:187]
    s_waitcnt vmcnt(4)
    v_cmp_eq_u32 vcc, -1, v61
    v_mfma_f32_16x16x32_bf16 v[184:187], v[72:75], a[8:11], v[184:187]
    ds_read_b128 v[104:107], v10 offset:19456
    ds_read_b128 v[108:111], v10 offset:28672
    v_mfma_f32_16x16x32_bf16 v[184:187], v[76:79], a[12:15], v[184:187]
    s_mov_b32 s71, 0
    s_cmp_eq_u64 vcc, 0
    s_cbranch_scc0 L_probe_no2
    s_mov_b32 s71, 1
    s_add_u32 s64, s90, 3072
    buffer_load_dwordx4 a[172:175], v2, s[28:31], s64 offen offset:0 sc1
    buffer_load_dwordx4 a[176:179], v2, s[28:31], s64 offen offset:1024 sc1
    s_add_u32 s64, s91, 3072
    buffer_load_dwordx4 a[180:183], v2, s[28:31], s64 offen offset:0 sc1
    s_add_u32 s64, s90, 9216
    buffer_load_dwordx4 a[184:187], v2, s[28:31], s64 offen offset:0 sc1
    buffer_load_dwordx4 a[188:191], v2, s[28:31], s64 offen offset:1024 sc1
    s_add_u32 s64, s91, 9216
    buffer_load_dwordx4 a[192:195], v2, s[28:31], s64 offen offset:0 sc1
    s_add_u32 s64, s90, 15360
    buffer_load_dwordx4 a[196:199], v2, s[28:31], s64 offen offset:0 sc1
    buffer_load_dwordx4 a[200:203], v2, s[28:31], s64 offen offset:1024 sc1
    s_add_u32 s64, s91, 15360
    buffer_load_dwordx4 a[204:207], v2, s[28:31], s64 offen offset:0 sc1
L_probe_no2:
    v_mfma_f32_16x16x32_bf16 v[188:191], v[76:79], a[28:31], v[188:191]
    v_mfma_f32_16x16x32_bf16 v[188:191], v[72:75], a[24:27], v[188:191]
    v_mfma_f32_16x16x32_bf16 v[188:191], v[68:71], a[20:23], v[188:191]
    v_mfma_f32_16x16x32_bf16 v[188:191], v[64:67], a[16:19], v[188:191]
    s_waitcnt lgkmcnt(4)
    v_subrev_u32 v10, 110592, v10
    v_mfma_f32_16x16x32_bf16 v[184:187], v[80:83], a[64:67], v[184:187]
    ds_read_b128 v[64:67], v10 offset:1024
    ds_read_b128 v[68:71], v10 offset:10240
    v_mfma_f32_16x16x32_bf16 v[184:187], v[84:87], a[68:71], v[184:187]
    v_mfma_f32_16x16x32_bf16 v[184:187], v[88:91], a[72:75], v[184:187]
    ds_read_b128 v[72:75], v10 offset:19456
    ds_read_b128 v[76:79], v10 offset:28672
    v_mfma_f32_16x16x32_bf16 v[184:187], v[92:95], a[76:79], v[184:187]
    v_mfma_f32_16x16x32_bf16 v[188:191], v[92:95], a[92:95], v[188:191]
    v_mfma_f32_16x16x32_bf16 v[188:191], v[88:91], a[88:91], v[188:191]
    v_mfma_f32_16x16x32_bf16 v[188:191], v[84:87], a[84:87], v[188:191]
    v_mfma_f32_16x16x32_bf16 v[188:191], v[80:83], a[80:83], v[188:191]
    s_waitcnt lgkmcnt(4)
    v_add_u32 v10, 36864, v10
    v_mfma_f32_16x16x32_bf16 v[192:195], v[96:99], a[32:35], v[192:195]
    ds_read_b128 v[80:83], v10 offset:1024
    ds_read_b128 v[84:87], v10 offset:10240
    v_mfma_f32_16x16x32_bf16 v[192:195], v[100:103], a[36:39], v[192:195]
    v_mfma_f32_16x16x32_bf16 v[192:195], v[104:107], a[40:43], v[192:195]
    ds_read_b128 v[88:91], v10 offset:19456
    ds_read_b128 v[92:95], v10 offset:28672
    v_mfma_f32_16x16x32_bf16 v[192:195], v[108:111], a[44:47], v[192:195]
    v_mfma_f32_16x16x32_bf16 v[196:199], v[108:111], a[60:63], v[196:199]
    v_mfma_f32_16x16x32_bf16 v[196:199], v[104:107], a[56:59], v[196:199]
    v_mfma_f32_16x16x32_bf16 v[196:199], v[100:103], a[52:55], v[196:199]
    v_mfma_f32_16x16x32_bf16 v[196:199], v[96:99], a[48:51], v[196:199]
    s_waitcnt lgkmcnt(4)
    s_add_u32 s68, s90, 5116
    v_add_u32 v10, 36864, v10
    v_mfma_f32_16x16x32_bf16 v[192:195], v[64:67], a[96:99], v[192:195]
    ds_read_b128 v[96:99], v10 offset:1024
    ds_read_b128 v[100:103], v10 offset:10240
    v_mfma_f32_16x16x32_bf16 v[192:195], v[68:71], a[100:103], v[192:195]
    buffer_load_dword v63, v62, s[28:31], s68 offen sc1
    v_mfma_f32_16x16x32_bf16 v[192:195], v[72:75], a[104:107], v[192:195]
    ds_read_b128 v[104:107], v10 offset:19456
    ds_read_b128 v[108:111], v10 offset:28672
    v_mfma_f32_16x16x32_bf16 v[192:195], v[76:79], a[108:111], v[192:195]
    v_mfma_f32_16x16x32_bf16 v[196:199], v[76:79], a[124:127], v[196:199]
    v_mfma_f32_16x16x32_bf16 v[196:199], v[72:75], a[120:123], v[196:199]
    v_mfma_f32_16x16x32_bf16 v[196:199], v[68:71], a[116:119], v[196:199]
    v_mfma_f32_16x16x32_bf16 v[196:199], v[64:67], a[112:115], v[196:199]
    s_waitcnt lgkmcnt(4)
    v_mfma_f32_16x16x32_bf16 v[192:195], v[80:83], a[0:3], v[192:195]
    v_mfma_f32_16x16x32_bf16 v[192:195], v[84:87], a[4:7], v[192:195]
    v_mfma_f32_16x16x32_bf16 v[192:195], v[88:91], a[8:11], v[192:195]
    v_mfma_f32_16x16x32_bf16 v[192:195], v[92:95], a[12:15], v[192:195]
    v_mfma_f32_16x16x32_bf16 v[196:199], v[92:95], a[28:31], v[196:199]
    v_mfma_f32_16x16x32_bf16 v[196:199], v[88:91], a[24:27], v[196:199]
    v_mfma_f32_16x16x32_bf16 v[196:199], v[84:87], a[20:23], v[196:199]
    v_mfma_f32_16x16x32_bf16 v[196:199], v[80:83], a[16:19], v[196:199]
    s_waitcnt lgkmcnt(0)
    v_mfma_f32_16x16x32_bf16 v[192:195], v[96:99], a[64:67], v[192:195]
    v_mfma_f32_16x16x32_bf16 v[192:195], v[100:103], a[68:71], v[192:195]
    v_mfma_f32_16x16x32_bf16 v[192:195], v[104:107], a[72:75], v[192:195]
    v_mfma_f32_16x16x32_bf16 v[192:195], v[108:111], a[76:79], v[192:195]
    v_mfma_f32_16x16x32_bf16 v[196:199], v[108:111], a[92:95], v[196:199]
    v_mfma_f32_16x16x32_bf16 v[196:199], v[104:107], a[88:91], v[196:199]
    v_mfma_f32_16x16x32_bf16 v[196:199], v[100:103], a[84:87], v[196:199]
    v_mfma_f32_16x16x32_bf16 v[196:199], v[96:99], a[80:83], v[196:199]
    s_cmp_lg_u32 s71, 0
    s_cbranch_scc1 L_dn_w10
    s_waitcnt vmcnt(6)
L_dn_w10:
    s_waitcnt vmcnt(15)
    s_cmp_eq_u32 s70, 0
    s_cbranch_scc1 L_inbox_slow0
L_inbox_sum0:
    v_mfma_f32_16x16x32_bf16 v[64:67], a[128:131], a[136:139], v[112:115]
    v_mfma_f32_16x16x32_bf16 v[64:67], a[128:131], a[148:151], v[64:67]
    v_mfma_f32_16x16x32_bf16 v[64:67], a[128:131], a[160:163], v[64:67]
    v_mfma_f32_16x16x32_bf16 v[68:71], a[132:135], a[136:139], v[116:119]
    v_mfma_f32_16x16x32_bf16 v[68:71], a[132:135], a[148:151], v[68:71]
    v_mfma_f32_16x16x32_bf16 v[68:71], a[132:135], a[160:163], v[68:71]
    v_mfma_f32_16x16x32_bf16 v[72:75], a[128:131], a[140:143], v[120:123]
    v_mfma_f32_16x16x32_bf16 v[72:75], a[128:131], a[152:155], v[72:75]
    v_mfma_f32_16x16x32_bf16 v[72:75], a[128:131], a[164:167], v[72:75]
    v_mfma_f32_16x16x32_bf16 v[76:79], a[132:135], a[140:143], v[124:127]
    v_mfma_f32_16x16x32_bf16 v[76:79], a[132:135], a[152:155], v[76:79]
    v_mfma_f32_16x16x32_bf16 v[76:79], a[132:135], a[164:167], v[76:79]
    v_mfma_f32_16x16x32_bf16 v[80:83], a[128:131], a[144:147], v[176:179]
    v_mfma_f32_16x16x32_bf16 v[80:83], a[128:131], a[156:159], v[80:83]
    v_mfma_f32_16x16x32_bf16 v[80:83], a[128:131], a[168:171], v[80:83]
    v_mfma_f32_16x16x32_bf16 v[84:87], a[132:135], a[144:147], v[180:183]
    v_mfma_f32_16x16x32_bf16 v[84:87], a[132:135], a[156:159], v[84:87]
    v_mfma_f32_16x16x32_bf16 v[84:87], a[132:135], a[168:171], v[84:87]
    s_cmp_lg_u32 s71, 0
    s_cbranch_scc1 L_s_here
    s_waitcnt vmcnt(0)
    v_cmp_eq_u32 vcc, -1, v63
    s_nop 1
    s_cmp_eq_u64 vcc, 0
    s_cbranch_scc0 L_s_here
    s_mov_b32 s71, 3
    s_add_u32 s64, s90, 3072
    buffer_load_dwordx4 a[172:175], v2, s[28:31], s64 offen offset:0 sc1
    buffer_load_dwordx4 a[176:179], v2, s[28:31], s64 offen offset:1024 sc1
    s_add_u32 s64, s91, 3072
    buffer_load_dwordx4 a[180:183], v2, s[28:31], s64 offen offset:0 sc1
    s_add_u32 s64, s90, 9216
    buffer_load_dwordx4 a[184:187], v2, s[28:31], s64 offen offset:0 sc1
    buffer_load_dwordx4 a[188:191], v2, s[28:31], s64 offen offset:1024 sc1
    s_add_u32 s64, s91, 9216
    buffer_load_dwordx4 a[192:195], v2, s[28:31], s64 offen offset:0 sc1
    s_add_u32 s64, s90, 15360
    buffer_load_dwordx4 a[196:199], v2, s[28:31], s64 offen offset:0 sc1
    buffer_load_dwordx4 a[200:203], v2, s[28:31], s64 offen offset:1024 sc1
    s_add_u32 s64, s91, 15360
    buffer_load_dwordx4 a[204:207], v2, s[28:31], s64 offen offset:0 sc1
L_s_here:
    v_mul_f32 v48, 0xbfb8aa3b, v64
    v_mul_f32 v49, 0xbfb8aa3b, v65
    v_mul_f32 v50, 0xbfb8aa3b, v66
    v_mul_f32 v51, 0xbfb8aa3b, v67
    v_mul_f32 v52, 0xbfb8aa3b, v68
    v_mul_f32 v53, 0xbfb8aa3b, v69
    v_mul_f32 v54, 0xbfb8aa3b, v70
    v_mul_f32 v55, 0xbfb8aa3b, v71
    v_exp_f32 v48, v48
    v_exp_f32 v49, v49
    v_exp_f32 v50, v50
    v_exp_f32 v51, v51
    v_exp_f32 v52, v52
    v_exp_f32 v53, v53
    v_exp_f32 v54, v54
    v_exp_f32 v55, v55
    v_add_f32 v48, 1.0, v48
    v_add_f32 v49, 1.0, v49
    v_add_f32 v50, 1.0, v50
    v_add_f32 v51, 1.0, v51
    v_add_f32 v52, 1.0, v52
    v_add_f32 v53, 1.0, v53
    v_add_f32 v54, 1.0, v54
    v_add_f32 v55, 1.0, v55
    v_rcp_f32 v48, v48
    v_rcp_f32 v49, v49
    v_rcp_f32 v50, v50
    v_rcp_f32 v51, v51
    v_rcp_f32 v52, v52
    v_rcp_f32 v53, v53
    v_rcp_f32 v54, v54
    v_rcp_f32 v55, v55
    v_mul_f32 v64, v64, v48
    v_mul_f32 v65, v65, v49
    v_mul_f32 v66, v66, v50
    v_mul_f32 v67, v67, v51
    v_mul_f32 v68, v68, v52
    v_mul_f32 v69, v69, v53
    v_mul_f32 v70, v70, v54
    v_mul_f32 v71, v71, v55
    v_mul_f32 v48, 0xbfb8aa3b, v72
    v_mul_f32 v49, 0xbfb8aa3b, v73
    v_mul_f32 v50, 0xbfb8aa3b, v74
    v_mul_f32 v51, 0xbfb8aa3b, v75
    v_mul_f32 v52, 0xbfb8aa3b, v76
    v_mul_f32 v53, 0xbfb8aa3b, v77
    v_mul_f32 v54, 0xbfb8aa3b, v78
    v_mul_f32 v55, 0xbfb8aa3b, v79
    v_exp_f32 v48, v48
    v_exp_f32 v49, v49
    v_exp_f32 v50, v50
    v_exp_f32 v51, v51
    v_exp_f32 v52, v52
    v_exp_f32 v53, v53
    v_exp_f32 v54, v54
    v_exp_f32 v55, v55
    v_add_f32 v48, 1.0, v48
    v_add_f32 v49, 1.0, v49
    v_add_f32 v50, 1.0, v50
    v_add_f32 v51, 1.0, v51
    v_add_f32 v52, 1.0, v52
    v_add_f32 v53, 1.0, v53
    v_add_f32 v54, 1.0, v54
    v_add_f32 v55, 1.0, v55
    v_rcp_f32 v48, v48
    v_rcp_f32 v49, v49
    v_rcp_f32 v50, v50
    v_rcp_f32 v51, v51
    v_rcp_f32 v52, v52
    v_rcp_f32 v53, v53
    v_rcp_f32 v54, v54
    v_rcp_f32 v55, v55
    v_mul_f32 v72, v72, v48
    v_mul_f32 v73, v73, v49
    v_mul_f32 v74, v74, v50
    v_mul_f32 v75, v75, v51
    v_mul_f32 v76, v76, v52
    v_mul_f32 v77, v77, v53
    v_mul_f32 v78, v78, v54
    v_mul_f32 v79, v79, v55
    v_mul_f32 v48, 0xbfb8aa3b, v80
    v_mul_f32 v49, 0xbfb8aa3b, v81
    v_mul_f32 v50, 0xbfb8aa3b, v82
    v_mul_f32 v51, 0xbfb8aa3b, v83
    v_mul_f32 v52, 0xbfb8aa3b, v84
    v_mul_f32 v53, 0xbfb8aa3b, v85
    v_mul_f32 v54, 0xbfb8aa3b, v86
    v_mul_f32 v55, 0xbfb8aa3b, v87
    v_exp_f32 v48, v48
    v_exp_f32 v49, v49
    v_exp_f32 v50, v50
    v_exp_f32 v51, v51
    v_exp_f32 v52, v52
    v_exp_f32 v53, v53
    v_exp_f32 v54, v54
    v_exp_f32 v55, v55
    v_add_f32 v48, 1.0, v48
    v_add_f32 v49, 1.0, v49
    v_add_f32 v50, 1.0, v50
    v_add_f32 v51, 1.0, v51
    v_add_f32 v52, 1.0, v52
    v_add_f32 v53, 1.0, v53
    v_add_f32 v54, 1.0, v54
    v_add_f32 v55, 1.0, v55
    v_rcp_f32 v48, v48
    v_rcp_f32 v49, v49
    v_rcp_f32 v50, v50
    v_rcp_f32 v51, v51
    v_rcp_f32 v52, v52
    v_rcp_f32 v53, v53
    v_rcp_f32 v54, v54
    v_rcp_f32 v55, v55
    v_mul_f32 v80, v80, v48
    v_mul_f32 v81, v81, v49
    v_mul_f32 v82, v82, v50
    v_mul_f32 v83, v83, v51
    v_mul_f32 v84, v84, v52
    v_mul_f32 v85, v85, v53
    v_mul_f32 v86, v86, v54
    v_mul_f32 v87, v87, v55
    s_waitcnt vmcnt(1)
    s_cmp_lg_u32 s71, 3
    s_cbranch_scc1 L_s_landed
    s_waitcnt vmcnt(0)
L_s_landed:
    s_cmp_eq_u32 s71, 0
    s_cbranch_scc1 L_inbox_slow1
L_inbox_sum1:
    v_mfma_f32_16x16x32_bf16 v[88:91], a[128:131], a[172:175], v[184:187]
    v_mfma_f32_16x16x32_bf16 v[88:91], a[128:131], a[184:187], v[88:91]
    v_mfma_f32_16x16x32_bf16 v[88:91], a[128:131], a[196:199], v[88:91]
    v_mfma_f32_16x16x32_bf16 v[92:95], a[132:135], a[172:175], v[188:191]
    v_mfma_f32_16x16x32_bf16 v[92:95], a[132:135], a[184:187], v[92:95]
    v_mfma_f32_16x16x32_bf16 v[92:95], a[132:135], a[196:199], v[92:95]
    v_mfma_f32_16x16x32_bf16 v[96:99], a[128:131], a[176:179], v[192:195]
    v_mfma_f32_16x16x32_bf16 v[96:99], a[128:131], a[188:191], v[96:99]
    v_mfma_f32_16x16x32_bf16 v[96:99], a[128:131], a[200:203], v[96:99]
    v_mfma_f32_16x16x32_bf16 v[100:103], a[132:135], a[176:179], v[196:199]
    v_mfma_f32_16x16x32_bf16 v[100:103], a[132:135], a[188:191], v[100:103]
    v_mfma_f32_16x16x32_bf16 v[100:103], a[132:135], a[200:203], v[100:103]
    v_mfma_f32_16x16x32_bf16 v[104:107], a[128:131], a[180:183], v[248:251]
    v_mfma_f32_16x16x32_bf16 v[104:107], a[128:131], a[192:195], v[104:107]
    v_mfma_f32_16x16x32_bf16 v[104:107], a[128:131], a[204:207], v[104:107]
    v_mfma_f32_16x16x32_bf16 v[108:111], a[132:135], a[180:183], v[252:255]
    v_mfma_f32_16x16x32_bf16 v[108:111], a[132:135], a[192:195], v[108:111]
    v_mfma_f32_16x16x32_bf16 v[108:111], a[132:135], a[204:207], v[108:111]
    v_add_f32 v60, v88, v96
    s_nop 3
    v_add_f32 v60, v60, v104
    v_cmp_u_f32 vcc, v60, v60
    s_nop 0
    s_cmp_eq_u64 vcc, 0
    s_cbranch_scc1 L_inbox_ok1
    s_cmp_lg_u32 s71, 2
    s_cbranch_scc1 L_inbox_slow1
L_inbox_ok1:
    s_mov_b32 s67, 0xffff0000
    v_lshlrev_b32 v36, 16, v24
    v_and_b32 v37, s67, v24
    v_lshlrev_b32 v38, 16, v25
    v_and_b32 v39, s67, v25
    v_lshlrev_b32 v40, 16, v26
    v_and_b32 v41, s67, v26
    v_lshlrev_b32 v42, 16, v27
    v_and_b32 v43, s67, v27
    v_fma_f32 v36, v88, v64, v36
    v_fma_f32 v37, v89, v65, v37
    v_fma_f32 v38, v90, v66, v38
    v_fma_f32 v39, v91, v67, v39
    v_fma_f32 v40, v92, v68, v40
    v_fma_f32 v41, v93, v69, v41
    v_fma_f32 v42, v94, v70, v42
    v_fma_f32 v43, v95, v71, v43
    v_cvt_pk_bf16_f32 v24, v36, v37
    v_cvt_pk_bf16_f32 v25, v38, v39
    v_cvt_pk_bf16_f32 v26, v40, v41
    v_cvt_pk_bf16_f32 v27, v42, v43
    ds_write_b64 v15, v[24:25] offset:0
    ds_write_b64 v15, v[26:27] offset:1024
    v_lshlrev_b32 v44, 16, v28
    v_and_b32 v45, s67, v28
    v_lshlrev_b32 v46, 16, v29
    v_and_b32 v47, s67, v29
    v_lshlrev_b32 v48, 16, v30
    v_and_b32 v49, s67, v30
    v_lshlrev_b32 v50, 16, v31
    v_and_b32 v51, s67, v31
    v_fma_f32 v44, v96, v72, v44
    v_fma_f32 v45, v97, v73, v45
    v_fma_f32 v46, v98, v74, v46
    v_fma_f32 v47, v99, v75, v47
    v_fma_f32 v48, v100, v76, v48
    v_fma_f32 v49, v101, v77, v49
    v_fma_f32 v50, v102, v78, v50
    v_fma_f32 v51, v103, v79, v51
    v_cvt_pk_bf16_f32 v28, v44, v45
    v_cvt_pk_bf16_f32 v29, v46, v47
    v_cvt_pk_bf16_f32 v30, v48, v49
    v_cvt_pk_bf16_f32 v31, v50, v51
    ds_write_b64 v15, v[28:29] offset:32
    ds_write_b64 v15, v[30:31] offset:1056
    v_lshlrev_b32 v36, 16, v32
    v_and_b32 v37, s67, v32
    v_lshlrev_b32 v38, 16, v33
    v_and_b32 v39, s67, v33
    v_lshlrev_b32 v40, 16, v34
    v_and_b32 v41, s67, v34
    v_lshlrev_b32 v42, 16, v35
    v_and_b32 v43, s67, v35
    v_fma_f32 v36, v104, v80, v36
    v_fma_f32 v37, v105, v81, v37
    v_fma_f32 v38, v106, v82, v38
    v_fma_f32 v39, v107, v83, v39
    v_fma_f32 v40, v108, v84, v40
    v_fma_f32 v41, v109, v85, v41
    v_fma_f32 v42, v110, v86, v42
    v_fma_f32 v43, v111, v87, v43
    v_cvt_pk_bf16_f32 v32, v36, v37
    v_cvt_pk_bf16_f32 v33, v38, v39
    v_cvt_pk_bf16_f32 v34, v40, v41
    v_cvt_pk_bf16_f32 v35, v42, v43
    ds_write_b64 v16, v[32:33] offset:2048
    ds_write_b64 v16, v[34:35] offset:2560
    v_add_u32 v52, s58, v2
    s_waitcnt lgkmcnt(0)
    ds_read_b128 v[36:39], v52 offset:0
    ds_read_b128 v[40:43], v52 offset:1024
    ds_read_b128 v[44:47], v52 offset:2048
    s_add_u32 s65, s53, 0
    s_waitcnt lgkmcnt(2)
    buffer_store_dwordx4 v[36:39], v13, s[40:43], s65 offen sc1
    s_add_u32 s65, s53, 18432
    s_waitcnt lgkmcnt(1)
    buffer_store_dwordx4 v[40:43], v13, s[40:43], s65 offen sc1
    s_add_u32 s65, s54, 0
    s_waitcnt lgkmcnt(0)
    buffer_store_dwordx4 v[44:47], v14, s[40:43], s65 offen sc1
    s_endpgm
L_inbox_slow0:
    s_nop 7
    s_mov_b32 s69, 65536
L_inbox_slow0_spin:
    buffer_load_dword v60, v19, s[28:31], s73 offen sc1
    s_waitcnt vmcnt(0)
    v_cmp_eq_u32 vcc, 0, v60
    s_nop 1
    s_cmp_eq_u64 vcc, 0
    s_cbranch_scc0 L_inbox_slow0_again
    s_add_u32 s64, s90, 0
    buffer_load_dwordx4 a[136:139], v2, s[28:31], s64 offen offset:0 sc1
    buffer_load_dwordx4 a[140:143], v2, s[28:31], s64 offen offset:1024 sc1
    s_add_u32 s64, s91, 0
    buffer_load_dwordx4 a[144:147], v2, s[28:31], s64 offen offset:0 sc1
    s_add_u32 s64, s90, 6144
    buffer_load_dwordx4 a[148:151], v2, s[28:31], s64 offen offset:0 sc1
    buffer_load_dwordx4 a[152:155], v2, s[28:31], s64 offen offset:1024 sc1
    s_add_u32 s64, s91, 6144
    buffer_load_dwordx4 a[156:159], v2, s[28:31], s64 offen offset:0 sc1
    s_add_u32 s64, s90, 12288
    buffer_load_dwordx4 a[160:163], v2, s[28:31], s64 offen offset:0 sc1
    buffer_load_dwordx4 a[164:167], v2, s[28:31], s64 offen offset:1024 sc1
    s_add_u32 s64, s91, 12288
    buffer_load_dwordx4 a[168:171], v2, s[28:31], s64 offen offset:0 sc1
    s_add_u32 s68, s90, 5116
    buffer_load_dword v63, v62, s[28:31], s68 offen sc1
    s_waitcnt vmcnt(1)
    s_branch L_inbox_slow0_ok
L_inbox_slow0_again:
    s_sleep 3
    s_sub_u32 s69, s69, 1
    s_cmp_lg_u32 s69, 0
    s_cbranch_scc1 L_inbox_slow0_spin
L_inbox_slow0_ok:
    s_mov_b32 s70, 2
    s_branch L_inbox_sum0
L_inbox_slow1:
    s_nop 7
    s_mov_b32 s69, 65536
L_inbox_slow1_spin:
    s_add_u32 s68, s90, 5116
    buffer_load_dword v60, v62, s[28:31], s68 offen sc1
    s_waitcnt vmcnt(0)
    v_cmp_eq_u32 vcc, -1, v60
    s_nop 1
    s_cmp_eq_u64 vcc, 0
    s_cbranch_scc0 L_inbox_slow1_again
    s_add_u32 s64, s90, 3072
    buffer_load_dwordx4 a[172:175], v2, s[28:31], s64 offen offset:0 sc1
    buffer_load_dwordx4 a[176:179], v2, s[28:31], s64 offen offset:1024 sc1
    s_add_u32 s64, s91, 3072
    buffer_load_dwordx4 a[180:183], v2, s[28:31], s64 offen offset:0 sc1
    s_add_u32 s64, s90, 9216
    buffer_load_dwordx4 a[184:187], v2, s[28:31], s64 offen offset:0 sc1
    buffer_load_dwordx4 a[188:191], v2, s[28:31], s64 offen offset:1024 sc1
    s_add_u32 s64, s91, 9216
    buffer_load_dwordx4 a[192:195], v2, s[28:31], s64 offen offset:0 sc1
    s_add_u32 s64, s90, 15360
    buffer_load_dwordx4 a[196:199], v2, s[28:31], s64 offen offset:0 sc1
    buffer_load_dwordx4 a[200:203], v2, s[28:31], s64 offen offset:1024 sc1
    s_add_u32 s64, s91, 15360
    buffer_load_dwordx4 a[204:207], v2, s[28:31], s64 offen offset:0 sc1
    s_waitcnt vmcnt(0)
    v_mov_b32 v60, 0
    v_accvgpr_read_b32 v36, a172
    v_accvgpr_read_b32 v37, a173
    v_accvgpr_read_b32 v38, a174
    v_accvgpr_read_b32 v39, a175
    v_max3_u32 v60, v60, v36, v37
    v_max3_u32 v60, v60, v38, v39
    v_accvgpr_read_b32 v36, a176
    v_accvgpr_read_b32 v37, a177
    v_accvgpr_read_b32 v38, a178
    v_accvgpr_read_b32 v39, a179
    v_max3_u32 v60, v60, v36, v37
    v_max3_u32 v60, v60, v38, v39
    v_accvgpr_read_b32 v36, a180
    v_accvgpr_read_b32 v37, a181
    v_accvgpr_read_b32 v38, a182
    v_accvgpr_read_b32 v39, a183
    v_max3_u32 v60, v60, v36, v37
    v_max3_u32 v60, v60, v38, v39
    v_accvgpr_read_b32 v36, a184
    v_accvgpr_read_b32 v37, a185
    v_accvgpr_read_b32 v38, a186
    v_accvgpr_read_b32 v39, a187
    v_max3_u32 v60, v60, v36, v37
    v_max3_u32 v60, v60, v38, v39
    v_accvgpr_read_b32 v36, a188
    v_accvgpr_read_b32 v37, a189
    v_accvgpr_read_b32 v38, a190
    v_accvgpr_read_b32 v39, a191
    v_max3_u32 v60, v60, v36, v37
    v_max3_u32 v60, v60, v38, v39
    v_accvgpr_read_b32 v36, a192
    v_accvgpr_read_b32 v37, a193
    v_accvgpr_read_b32 v38, a194
    v_accvgpr_read_b32 v39, a195
    v_max3_u32 v60, v60, v36, v37
    v_max3_u32 v60, v60, v38, v39
    v_accvgpr_read_b32 v36, a196
    v_accvgpr_read_b32 v37, a197
    v_accvgpr_read_b32 v38, a198
    v_accvgpr_read_b32 v39, a199
    v_max3_u32 v60, v60, v36, v37
    v_max3_u32 v60, v60, v38, v39
    v_accvgpr_read_b32 v36, a200
    v_accvgpr_read_b32 v37, a201
    v_accvgpr_read_b32 v38, a202
    v_accvgpr_read_b32 v39, a203
    v_max3_u32 v60, v60, v36, v37
    v_max3_u32 v60, v60, v38, v39
    v_accvgpr_read_b32 v36, a204
    v_accvgpr_read_b32 v37, a205
    v_accvgpr_read_b32 v38, a206
    v_accvgpr_read_b32 v39, a207
    v_max3_u32 v60, v60, v36, v37
    v_max3_u32 v60, v60, v38, v39
    v_cmp_eq_u32 vcc, -1, v60
    s_nop 1
    s_cmp_eq_u64 vcc, 0
    s_cbranch_scc1 L_inbox_slow1_ok
L_inbox_slow1_again:
    s_sleep 3
    s_sub_u32 s69, s69, 1
    s_cmp_lg_u32 s69, 0
    s_cbranch_scc1 L_inbox_slow1_spin
L_inbox_slow1_ok:
    s_mov_b32 s71, 2
    s_branch L_inbox_sum1
L_slow:
    s_waitcnt vmcnt(0) lgkmcnt(0)
    s_barrier
    s_nop 7
    v_and_b32 v128, 15, v1
    v_lshrrev_b32 v129, 4, v1
    v_xor_b32 v130, v129, v128
    v_lshlrev_b32 v130, 4, v130
    v_lshl_add_u32 v130, v128, 8, v130
    v_xor_b32 v131, 0, v130
    v_add_u32 v228, 98304, v131
    v_xor_b32 v131, 64, v130
    v_add_u32 v229, 98304, v131
    v_xor_b32 v131, 128, v130
    v_add_u32 v230, 98304, v131
    v_xor_b32 v131, 192, v130
    v_add_u32 v231, 98304, v131
    v_mov_b32 v128, 0xff800000
    v_mov_b32 v129, 0xff800000
    v_mov_b32 v130, 0xff800000
    v_mov_b32 v131, 0xff800000
    s_mov_b32 s16, s18
    s_mov_b32 s62, 32
L_maxpass:
    s_add_u32 m0, s52, 98304
    s_nop 0
    buffer_load_dwordx4 v4, s[20:23], s16 offen offset:0 nt lds
    buffer_load_dwordx4 v5, s[20:23], s16 offen offset:1024 nt lds
    buffer_load_dwordx4 v6, s[20:23], s16 offen offset:2048 nt lds
    buffer_load_dwordx4 v7, s[20:23], s16 offen offset:3072 nt lds
    s_add_u32 s16, s16, 16384
    s_and_b32 s16, s16, 0x7ffff
    s_waitcnt vmcnt(0)
    s_barrier
    ds_read_b128 a[32:35], v228 offset:0
    ds_read_b128 a[36:39], v229 offset:0
    ds_read_b128 a[40:43], v230 offset:0
    ds_read_b128 a[44:47], v231 offset:0
    ds_read_b128 a[48:51], v228 offset:4096
    ds_read_b128 a[52:55], v229 offset:4096
    ds_read_b128 a[56:59], v230 offset:4096
    ds_read_b128 a[60:63], v231 offset:4096
    s_waitcnt lgkmcnt(7)
    v_mfma_f32_16x16x32_bf16 v[64:67], a[32:35], a[0:3], 0
    s_waitcnt lgkmcnt(6)
    v_mfma_f32_16x16x32_bf16 v[64:67], a[36:39], a[4:7], v[64:67]
    s_waitcnt lgkmcnt(5)
    v_mfma_f32_16x16x32_bf16 v[64:67], a[40:43], a[64:67], v[64:67]
    s_waitcnt lgkmcnt(4)
    v_mfma_f32_16x16x32_bf16 v[64:67], a[44:47], a[68:71], v[64:67]
    v_mfma_f32_16x16x32_bf16 v[72:75], a[44:47], a[76:79], 0
    v_mfma_f32_16x16x32_bf16 v[72:75], a[40:43], a[72:75], v[72:75]
    v_mfma_f32_16x16x32_bf16 v[72:75], a[36:39], a[12:15], v[72:75]
    v_mfma_f32_16x16x32_bf16 v[72:75], a[32:35], a[8:11], v[72:75]
    v_mfma_f32_16x16x32_bf16 v[80:83], a[32:35], a[16:19], 0
    v_mfma_f32_16x16x32_bf16 v[80:83], a[36:39], a[20:23], v[80:83]
    v_mfma_f32_16x16x32_bf16 v[80:83], a[40:43], a[80:83], v[80:83]
    v_mfma_f32_16x16x32_bf16 v[80:83], a[44:47], a[84:87], v[80:83]
    v_mfma_f32_16x16x32_bf16 v[88:91], a[44:47], a[92:95], 0
    v_mfma_f32_16x16x32_bf16 v[88:91], a[40:43], a[88:91], v[88:91]
    v_mfma_f32_16x16x32_bf16 v[88:91], a[36:39], a[28:31], v[88:91]
    v_mfma_f32_16x16x32_bf16 v[88:91], a[32:35], a[24:27], v[88:91]
    s_waitcnt lgkmcnt(3)
    v_mfma_f32_16x16x32_bf16 v[68:71], a[48:51], a[0:3], 0
    s_waitcnt lgkmcnt(2)
    v_mfma_f32_16x16x32_bf16 v[68:71], a[52:55], a[4:7], v[68:71]
    s_waitcnt lgkmcnt(1)
    v_mfma_f32_16x16x32_bf16 v[68:71], a[56:59], a[64:67], v[68:71]
    s_waitcnt lgkmcnt(0)
    v_mfma_f32_16x16x32_bf16 v[68:71], a[60:63], a[68:71], v[68:71]
    v_mfma_f32_16x16x32_bf16 v[76:79], a[60:63], a[76:79], 0
    v_mfma_f32_16x16x32_bf16 v[76:79], a[56:59], a[72:75], v[76:79]
    v_mfma_f32_16x16x32_bf16 v[76:79], a[52:55], a[12:15], v[76:79]
    v_mfma_f32_16x16x32_bf16 v[76:79], a[48:51], a[8:11], v[76:79]
    v_mfma_f32_16x16x32_bf16 v[84:87], a[48:51], a[16:19], 0
    v_mfma_f32_16x16x32_bf16 v[84:87], a[52:55], a[20:23], v[84:87]
    v_mfma_f32_16x16x32_bf16 v[84:87], a[56:59], a[80:83], v[84:87]
    v_mfma_f32_16x16x32_bf16 v[84:87], a[60:63], a[84:87], v[84:87]
    v_mfma_f32_16x16x32_bf16 v[92:95], a[60:63], a[92:95], 0
    v_mfma_f32_16x16x32_bf16 v[92:95], a[56:59], a[88:91], v[92:95]
    v_mfma_f32_16x16x32_bf16 v[92:95], a[52:55], a[28:31], v[92:95]
    v_mfma_f32_16x16x32_bf16 v[92:95], a[48:51], a[24:27], v[92:95]
    ds_read_b128 a[32:35], v228 offset:8192
    ds_read_b128 a[36:39], v229 offset:8192
    ds_read_b128 a[40:43], v230 offset:8192
    ds_read_b128 a[44:47], v231 offset:8192
    ds_read_b128 a[48:51], v228 offset:12288
    ds_read_b128 a[52:55], v229 offset:12288
    ds_read_b128 a[56:59], v230 offset:12288
    ds_read_b128 a[60:63], v231 offset:12288
    s_waitcnt lgkmcnt(7)
    v_mfma_f32_16x16x32_bf16 v[96:99], a[32:35], a[0:3], 0
    s_waitcnt lgkmcnt(6)
    v_mfma_f32_16x16x32_bf16 v[96:99], a[36:39], a[4:7], v[96:99]
    s_waitcnt lgkmcnt(5)
    v_mfma_f32_16x16x32_bf16 v[96:99], a[40:43], a[64:67], v[96:99]
    s_waitcnt lgkmcnt(4)
    v_mfma_f32_16x16x32_bf16 v[96:99], a[44:47], a[68:71], v[96:99]
    v_mfma_f32_16x16x32_bf16 v[104:107], a[44:47], a[76:79], 0
    v_mfma_f32_16x16x32_bf16 v[104:107], a[40:43], a[72:75], v[104:107]
    v_mfma_f32_16x16x32_bf16 v[104:107], a[36:39], a[12:15], v[104:107]
    v_mfma_f32_16x16x32_bf16 v[104:107], a[32:35], a[8:11], v[104:107]
    v_mfma_f32_16x16x32_bf16 v[112:115], a[32:35], a[16:19], 0
    v_mfma_f32_16x16x32_bf16 v[112:115], a[36:39], a[20:23], v[112:115]
    v_mfma_f32_16x16x32_bf16 v[112:115], a[40:43], a[80:83], v[112:115]
    v_mfma_f32_16x16x32_bf16 v[112:115], a[44:47], a[84:87], v[112:115]
    v_mfma_f32_16x16x32_bf16 v[120:123], a[44:47], a[92:95], 0
    v_mfma_f32_16x16x32_bf16 v[120:123], a[40:43], a[88:91], v[120:123]
    v_mfma_f32_16x16x32_bf16 v[120:123], a[36:39], a[28:31], v[120:123]
    v_mfma_f32_16x16x32_bf16 v[120:123], a[32:35], a[24:27], v[120:123]
    s_waitcnt lgkmcnt(3)
    v_mfma_f32_16x16x32_bf16 v[100:103], a[48:51], a[0:3], 0
    s_waitcnt lgkmcnt(2)
    v_mfma_f32_16x16x32_bf16 v[100:103], a[52:55], a[4:7], v[100:103]
    s_waitcnt lgkmcnt(1)
    v_mfma_f32_16x16x32_bf16 v[100:103], a[56:59], a[64:67], v[100:103]
    s_waitcnt lgkmcnt(0)
    v_mfma_f32_16x16x32_bf16 v[100:103], a[60:63], a[68:71], v[100:103]
    v_mfma_f32_16x16x32_bf16 v[108:111], a[60:63], a[76:79], 0
    v_mfma_f32_16x16x32_bf16 v[108:111], a[56:59], a[72:75], v[108:111]
    v_mfma_f32_16x16x32_bf16 v[108:111], a[52:55], a[12:15], v[108:111]
    v_mfma_f32_16x16x32_bf16 v[108:111], a[48:51], a[8:11], v[108:111]
    v_mfma_f32_16x16x32_bf16 v[116:119], a[48:51], a[16:19], 0
    v_mfma_f32_16x16x32_bf16 v[116:119], a[52:55], a[20:23], v[116:119]
    v_mfma_f32_16x16x32_bf16 v[116:119], a[56:59], a[80:83], v[116:119]
    v_mfma_f32_16x16x32_bf16 v[116:119], a[60:63], a[84:87], v[116:119]
    v_mfma_f32_16x16x32_bf16 v[124:127], a[60:63], a[92:95], 0
    v_mfma_f32_16x16x32_bf16 v[124:127], a[56:59], a[88:91], v[124:127]
    v_mfma_f32_16x16x32_bf16 v[124:127], a[52:55], a[28:31], v[124:127]
    v_mfma_f32_16x16x32_bf16 v[124:127], a[48:51], a[24:27], v[124:127]
    s_barrier
    v_max3_f32 v128, v128, v64, v65
    v_max3_f32 v128, v128, v66, v67
    v_max3_f32 v128, v128, v68, v69
    v_max3_f32 v128, v128, v70, v71
    v_max3_f32 v129, v129, v72, v73
    v_max3_f32 v129, v129, v74, v75
    v_max3_f32 v129, v129, v76, v77
    v_max3_f32 v129, v129, v78, v79
    v_max3_f32 v130, v130, v80, v81
    v_max3_f32 v130, v130, v82, v83
    v_max3_f32 v130, v130, v84, v85
    v_max3_f32 v130, v130, v86, v87
    v_max3_f32 v131, v131, v88, v89
    v_max3_f32 v131, v131, v90, v91
    v_max3_f32 v131, v131, v92, v93
    v_max3_f32 v131, v131, v94, v95
    v_max3_f32 v128, v128, v96, v97
    v_max3_f32 v128, v128, v98, v99
    v_max3_f32 v128, v128, v100, v101
    v_max3_f32 v128, v128, v102, v103
    v_max3_f32 v129, v129, v104, v105
    v_max3_f32 v129, v129, v106, v107
    v_max3_f32 v129, v129, v108, v109
    v_max3_f32 v129, v129, v110, v111
    v_max3_f32 v130, v130, v112, v113
    v_max3_f32 v130, v130, v114, v115
    v_max3_f32 v130, v130, v116, v117
    v_max3_f32 v130, v130, v118, v119
    v_max3_f32 v131, v131, v120, v121
    v_max3_f32 v131, v131, v122, v123
    v_max3_f32 v131, v131, v124, v125
    v_max3_f32 v131, v131, v126, v127
    s_sub_u32 s62, s62, 1
    s_cmp_lg_u32 s62, 0
    s_cbranch_scc1 L_maxpass
    v_mov_b32 v132, v128
    v_mov_b32 v133, v129
    v_mov_b32 v134, v130
    v_mov_b32 v135, v131
    v_permlane32_swap_b32 v128, v132
    v_permlane32_swap_b32 v129, v133
    v_permlane32_swap_b32 v130, v134
    v_permlane32_swap_b32 v131, v135
    v_max_f32 v128, v128, v132
    v_max_f32 v129, v129, v133
    v_max_f32 v130, v130, v134
    v_max_f32 v131, v131, v135
    v_mov_b32 v132, v128
    v_mov_b32 v133, v129
    v_mov_b32 v134, v130
    v_mov_b32 v135, v131
    v_permlane16_swap_b32 v128, v132
    v_permlane16_swap_b32 v129, v133
    v_permlane16_swap_b32 v130, v134
    v_permlane16_swap_b32 v131, v135
    v_max_f32 v128, v128, v132
    v_max_f32 v129, v129, v133
    v_max_f32 v130, v130, v134
    v_max_f32 v131, v131, v135
    v_mov_b32 v56, v128
    v_mov_b32 v57, v129
    v_mov_b32 v58, v130
    v_mov_b32 v59, v131
    s_mov_b32 s0, 0x10000
    s_mov_b32 s101, 99
    s_mov_b32 s60, 2146435072
    s_mov_b32 s16, s18
    s_add_u32 m0, s52, 98304
    s_nop 0
    buffer_load_dwordx4 v4, s[20:23], s16 offen offset:0 nt lds
    buffer_load_dwordx4 v5, s[20:23], s16 offen offset:1024 nt lds
    buffer_load_dwordx4 v6, s[20:23], s16 offen offset:2048 nt lds
    buffer_load_dwordx4 v7, s[20:23], s16 offen offset:3072 nt lds
    s_add_u32 s16, s16, 16384
    s_and_b32 s16, s16, 0x7ffff
    s_add_u32 m0, s52, 114688
    s_nop 0
    buffer_load_dwordx4 v4, s[20:23], s16 offen offset:0 nt lds
    buffer_load_dwordx4 v5, s[20:23], s16 offen offset:1024 nt lds
    buffer_load_dwordx4 v6, s[20:23], s16 offen offset:2048 nt lds
    buffer_load_dwordx4 v7, s[20:23], s16 offen offset:3072 nt lds
    s_add_u32 s16, s16, 16384
    s_and_b32 s16, s16, 0x7ffff
    s_add_u32 m0, s52, 131072
    s_nop 0
    buffer_load_dwordx4 v4, s[20:23], s16 offen offset:0 nt lds
    buffer_load_dwordx4 v5, s[20:23], s16 offen offset:1024 nt lds
    buffer_load_dwordx4 v6, s[20:23], s16 offen offset:2048 nt lds
    buffer_load_dwordx4 v7, s[20:23], s16 offen offset:3072 nt lds
    s_add_u32 s16, s16, 16384
    s_and_b32 s16, s16, 0x7ffff
    s_add_u32 m0, s52, 147456
    s_nop 0
    buffer_load_dwordx4 v4, s[20:23], s16 offen offset:0 nt lds
    buffer_load_dwordx4 v5, s[20:23], s16 offen offset:1024 nt lds
    buffer_load_dwordx4 v6, s[20:23], s16 offen offset:2048 nt lds
    buffer_load_dwordx4 v7, s[20:23], s16 offen offset:3072 nt lds
    s_sub_u32 s17, s18, 8192
    s_and_b32 s17, s17, 0x7ffff
    s_add_u32 m0, s52, 32768
    s_nop 0
    buffer_load_dwordx4 v8, s[24:27], s17 offen offset:0 nt lds
    buffer_load_dwordx4 v9, s[24:27], s17 offen offset:1024 nt lds
    buffer_load_dwordx4 v8, s[24:27], s17 offen offset:2048 nt lds
    buffer_load_dwordx4 v9, s[24:27], s17 offen offset:3072 nt lds
    s_add_u32 s17, s17, 16384
    s_and_b32 s17, s17, 0x7ffff
    s_add_u32 m0, s52, 49152
    s_nop 0
    buffer_load_dwordx4 v8, s[24:27], s17 offen offset:0 nt lds
    buffer_load_dwordx4 v9, s[24:27], s17 offen offset:1024 nt lds
    buffer_load_dwordx4 v8, s[24:27], s17 offen offset:2048 nt lds
    buffer_load_dwordx4 v9, s[24:27], s17 offen offset:3072 nt lds
    s_waitcnt vmcnt(0)
    s_barrier
    s_branch L_attn_start
    s_endpgm
.section .rodata,"a"
.p2align 6
.amdhsa_kernel recurrent_scan__mha_block_cached__swiglu_ffn__prompt_kernel
  .amdhsa_next_free_vgpr 512
  .amdhsa_next_free_sgpr 102
  .amdhsa_accum_offset 256
  .amdhsa_group_segment_fixed_size 0
  .amdhsa_kernarg_size 96
  .amdhsa_user_sgpr_count 2
  .amdhsa_user_sgpr_kernarg_segment_ptr 1
  .amdhsa_system_sgpr_workgroup_id_x 1
  .amdhsa_float_denorm_mode_32 3
.end_amdhsa_kernel
```
